```python
import torch

def _softmax(x, axis=-1):
    return torch.softmax(x, dim=axis)

def _gelu(x):
    return torch.nn.functional.gelu(x, approximate='tanh')

def _silu(x):
    return torch.nn.functional.silu(x)

def _sigmoid(x):
    return torch.sigmoid(x)

def _layernorm(x, axis=-1, eps=1e-05):
    m = x.mean(dim=axis, keepdim=True)
    v = x.var(dim=axis, keepdim=True, unbiased=False)
    return (x - m) / torch.sqrt(v + eps)

def _scatter_add(tgt, idx, src, axis=0):
    return tgt.clone().index_add_(axis, idx, src)

def _segment_sum(src, seg, n):
    out = torch.zeros((n,) + src.shape[1:], dtype=src.dtype)
    return out.index_add_(0, seg, src)

def _pad(x, pw):
    flat = tuple((v for pair in reversed(pw) for v in pair))
    return torch.nn.functional.pad(x, flat)
kernel_name = 'adaLN_cond__grouped_kv_mqa__dense_activation_silu__prompt'

def setup_inputs():

    _w = lambda a: (lambda t: t.to(torch.bfloat16) if t.is_floating_point() else t)(torch.as_tensor(a))

    def _A_setup():
        B, S, D, H = (1, 2048, 640, 32)
        Dh = D // H
        return {'x': _w((lambda *s: torch.randn(*s, dtype=torch.bfloat16) * 0.05)(B, S, D)), 'wq': _w((lambda *s: torch.randn(*s, dtype=torch.bfloat16) * 0.05)(D, H * Dh)), 'wk': _w((lambda *s: torch.randn(*s, dtype=torch.bfloat16) * 0.05)(D, Dh)), 'wv': _w((lambda *s: torch.randn(*s, dtype=torch.bfloat16) * 0.05)(D, Dh)), 'wo': _w((lambda *s: torch.randn(*s, dtype=torch.bfloat16) * 0.05)(H * Dh, D))}
    _A_in = _A_setup()

    def _B_setup():
        B, S, D, F = (1, 2048, 640, 1536)
        return {'x': _w((lambda *s: torch.randn(*s, dtype=torch.bfloat16) * 0.05)(B, S, D)), 'w1': _w((lambda *s: torch.randn(*s, dtype=torch.bfloat16) * 3.2)(D, F) * D ** (-0.5)), 'w2': _w((lambda *s: torch.randn(*s, dtype=torch.bfloat16) * 0.4)(F, D) * F ** (-0.5))}
    _B_in = _B_setup()
    return {'A_x': _A_in['x'], 'A_wq': _A_in['wq'], 'A_wk': _A_in['wk'], 'A_wv': _A_in['wv'], 'A_wo': _A_in['wo'], 'B_x': _B_in['x'], 'B_w1': _B_in['w1'], 'B_w2': _B_in['w2'], 'c': _w((lambda *s: torch.randn(*s, dtype=torch.bfloat16) * 0.1)(1, 640) * 8.0), 'w_mod': _w((lambda *s: torch.randn(*s, dtype=torch.bfloat16) * 0.1)(640, 6 * 640) * 640 ** (-0.5) * 8.0)}

def reference(A_x, A_wq, A_wk, A_wv, A_wo, B_x, B_w1, B_w2, c, w_mod):

    def _A_ref(x, wq, wk, wv, wo):
        B, S, D = x.shape
        H = 32
        Dh = D // H
        q = (lambda x, *d: x.permute(*d))((x @ wq).reshape(B, S, H, Dh), 0, 2, 1, 3)
        k = x @ wk
        v = x @ wv
        scores = torch.einsum('bhqd,bkd->bhqk', q, k) * Dh ** (-0.5)
        p = _softmax(scores, axis=-1)
        o = torch.einsum('bhqk,bkd->bhqd', p, v)
        return (lambda x, *d: x.permute(*d))(o, 0, 2, 1, 3).reshape(B, S, H * Dh) @ wo

    def _B_ref(x, w1, w2):
        h = torch.einsum('bsd,df->bsf', x, w1)
        h = _silu(h)
        out = torch.einsum('bsf,fd->bsd', h, w2)
        return out
    x = A_x
    mod = (_silu(c) @ w_mod).reshape(c.shape[0], 6, 1, -1)
    sa, ca, ga, sb, cb, gb = (mod[:, 0].clone(), mod[:, 1].clone(), mod[:, 2].clone(), mod[:, 3].clone(), mod[:, 4].clone(), mod[:, 5].clone())
    h = _layernorm(x, axis=-1) * (1 + ca) + sa
    x = x + ga * _A_ref(h, A_wq, A_wk, A_wv, A_wo)
    h = _layernorm(x, axis=-1) * (1 + cb) + sb
    x = x + gb * _B_ref(h, B_w1, B_w2)
    return x
```

```asm
; @launch grid=(256,1,1) block=(512,1,1) lds=163840
.amdgcn_target "amdgcn-amd-amdhsa--gfx950"
.text
.globl adaLN_cond__grouped_kv_mqa__dense_activation_silu__prompt_kernel
.p2align 8
.type adaLN_cond__grouped_kv_mqa__dense_activation_silu__prompt_kernel,@function
adaLN_cond__grouped_kv_mqa__dense_activation_silu__prompt_kernel:
    s_cmp_ge_u32 s2, 256
    s_cbranch_scc1 L_end
    s_load_dwordx8 s[20:27], s[0:1], 64
    s_getpc_b64 s[88:89]
    s_lshr_b32 s3, s2, 3
    v_and_b32 v1, 31, v0
    s_mul_i32 s80, s3, 19
    v_add_u32 v1, s80, v1
    v_min_u32 v1, 580, v1
    v_lshlrev_b32 v1, 7, v1
    global_load_dword v251, v1, s[88:89]
    s_load_dwordx2 s[28:29], s[0:1], 96
    s_load_dwordx16 s[4:19], s[0:1], 0
    v_lshrrev_b32 v8, 6, v0
    v_and_b32 v0, 63, v0
    s_and_b32 s73, s3, 7
    v_readfirstlane_b32 s74, v8
    s_and_b32 s81, s73, 3
    s_and_b32 s80, s2, 7
    s_lshl_b32 s83, s80, 2
    s_lshr_b32 s82, s3, 3
    s_add_u32 s72, s83, s82
    s_lshr_b32 s82, s74, 1
    s_sub_u32 s80, s74, 2
    s_cmp_gt_u32 s82, s81
    s_cselect_b32 s93, s80, s74
    s_and_b32 s86, s74, 1
    s_add_u32 s80, s86, 6
    s_cmp_eq_u32 s82, s81
    s_cselect_b32 s93, s80, s93
    s_sub_u32 s84, s93, 5
    s_cbranch_scc1 L_modpath
    s_add_u32 s88, s84, s73
    s_and_b32 s88, s88, 7
    s_lshr_b32 s87, s88, 1
    s_lshl_b32 s85, s72, 2
    s_add_u32 s85, s85, s87
    s_mul_i32 s85, s85, 20480
    s_and_b32 s87, s88, 1
    s_mul_i32 s87, s87, 640
    s_add_u32 s85, s85, s87
    s_mul_i32 s87, s88, 10240
    s_mov_b32 s38, 2621440
    s_mov_b32 s39, 0x20000
    v_add_u32 v12, 0, v0
    v_mul_u32_u24 v13, 1639, v12
    v_lshrrev_b32 v13, 16, v13
    v_mul_u32_u24 v10, 40, v13
    v_sub_u32 v12, v12, v10
    v_lshrrev_b32 v10, 1, v13
    v_xor_b32 v12, v12, v10
    v_mul_u32_u24 v13, 1280, v13
    v_lshl_add_u32 v112, v12, 4, v13
    s_waitcnt lgkmcnt(0)
    s_mov_b32 s36, s4
    s_mov_b32 s37, s5
    s_add_u32 m0, s87, 0
    s_nop 0
    buffer_load_dwordx4 v112, s[36:39], s85 offen lds
    v_add_u32 v12, 64, v0
    v_mul_u32_u24 v13, 1639, v12
    v_lshrrev_b32 v13, 16, v13
    v_mul_u32_u24 v10, 40, v13
    v_sub_u32 v12, v12, v10
    v_lshrrev_b32 v10, 1, v13
    v_xor_b32 v12, v12, v10
    v_mul_u32_u24 v13, 1280, v13
    v_lshl_add_u32 v113, v12, 4, v13
    s_add_u32 m0, s87, 1024
    s_nop 0
    buffer_load_dwordx4 v113, s[36:39], s85 offen lds
    v_add_u32 v12, 128, v0
    v_mul_u32_u24 v13, 1639, v12
    v_lshrrev_b32 v13, 16, v13
    v_mul_u32_u24 v10, 40, v13
    v_sub_u32 v12, v12, v10
    v_lshrrev_b32 v10, 1, v13
    v_xor_b32 v12, v12, v10
    v_mul_u32_u24 v13, 1280, v13
    v_lshl_add_u32 v114, v12, 4, v13
    s_add_u32 m0, s87, 2048
    s_nop 0
    buffer_load_dwordx4 v114, s[36:39], s85 offen lds
    v_add_u32 v12, 192, v0
    v_mul_u32_u24 v13, 1639, v12
    v_lshrrev_b32 v13, 16, v13
    v_mul_u32_u24 v10, 40, v13
    v_sub_u32 v12, v12, v10
    v_lshrrev_b32 v10, 1, v13
    v_xor_b32 v12, v12, v10
    v_mul_u32_u24 v13, 1280, v13
    v_lshl_add_u32 v115, v12, 4, v13
    s_add_u32 m0, s87, 3072
    s_nop 0
    buffer_load_dwordx4 v115, s[36:39], s85 offen lds
    v_add_u32 v12, 256, v0
    v_mul_u32_u24 v13, 1639, v12
    v_lshrrev_b32 v13, 16, v13
    v_mul_u32_u24 v10, 40, v13
    v_sub_u32 v12, v12, v10
    v_lshrrev_b32 v10, 1, v13
    v_xor_b32 v12, v12, v10
    v_mul_u32_u24 v13, 1280, v13
    v_lshl_add_u32 v116, v12, 4, v13
    s_add_u32 m0, s87, 4096
    s_nop 0
    buffer_load_dwordx4 v116, s[36:39], s85 offen lds
    v_xor_b32 v117, 64, v112
    s_add_u32 m0, s87, 5120
    s_add_u32 s85, s85, 10240
    buffer_load_dwordx4 v117, s[36:39], s85 offen lds
    v_xor_b32 v118, 64, v113
    s_add_u32 m0, s87, 6144
    s_nop 0
    buffer_load_dwordx4 v118, s[36:39], s85 offen lds
    v_xor_b32 v119, 64, v114
    s_add_u32 m0, s87, 7168
    s_nop 0
    buffer_load_dwordx4 v119, s[36:39], s85 offen lds
    v_xor_b32 v120, 64, v115
    s_add_u32 m0, s87, 8192
    s_nop 0
    buffer_load_dwordx4 v120, s[36:39], s85 offen lds
    v_xor_b32 v121, 64, v116
    s_add_u32 m0, s87, 9216
    s_nop 0
    buffer_load_dwordx4 v121, s[36:39], s85 offen lds
    s_lshl_b32 s81, s73, 5
    s_add_u32 s79, s81, s72
    s_mov_b32 s34, 16875520
    s_mov_b32 s35, 0x20000
    s_mov_b32 s66, 4915200
    s_mov_b32 s67, 0x20000
    s_mov_b32 s70, 1280
    s_mov_b32 s71, 0x20000
    v_mov_b32 v11, 0
    v_lshlrev_b32 v1, 4, v0
    s_mov_b32 s64, s22
    s_mov_b32 s65, s23
    s_mov_b32 s68, s20
    s_mov_b32 s69, s21
    s_mov_b32 s32, s28
    s_mov_b32 s33, s29
    s_mov_b32 s83, 255
    s_barrier
    buffer_load_dword v13, v11, s[32:35], 0 offen sc1
    s_add_u32 s84, s84, 3
L_xdma:
    s_add_u32 s88, s84, s73
    s_and_b32 s88, s88, 7
    s_lshr_b32 s87, s88, 1
    s_lshl_b32 s85, s72, 2
    s_add_u32 s85, s85, s87
    s_mul_i32 s85, s85, 20480
    s_and_b32 s87, s88, 1
    s_mul_i32 s87, s87, 640
    s_add_u32 s85, s85, s87
    s_mul_i32 s87, s88, 10240
    s_add_u32 m0, s87, 0
    s_nop 0
    buffer_load_dwordx4 v112, s[36:39], s85 offen lds
    s_add_u32 m0, s87, 1024
    s_nop 0
    buffer_load_dwordx4 v113, s[36:39], s85 offen lds
    s_add_u32 m0, s87, 2048
    s_nop 0
    buffer_load_dwordx4 v114, s[36:39], s85 offen lds
    s_add_u32 m0, s87, 3072
    s_nop 0
    buffer_load_dwordx4 v115, s[36:39], s85 offen lds
    s_add_u32 m0, s87, 4096
    s_nop 0
    buffer_load_dwordx4 v116, s[36:39], s85 offen lds
    s_add_u32 m0, s87, 5120
    s_add_u32 s85, s85, 10240
    buffer_load_dwordx4 v117, s[36:39], s85 offen lds
    s_add_u32 m0, s87, 6144
    s_nop 0
    buffer_load_dwordx4 v118, s[36:39], s85 offen lds
    s_add_u32 m0, s87, 7168
    s_nop 0
    buffer_load_dwordx4 v119, s[36:39], s85 offen lds
    s_add_u32 m0, s87, 8192
    s_nop 0
    buffer_load_dwordx4 v120, s[36:39], s85 offen lds
    s_add_u32 m0, s87, 9216
    s_nop 0
    buffer_load_dwordx4 v121, s[36:39], s85 offen lds
    s_add_u32 s84, s84, 3
    s_cmp_lt_u32 s84, 8
    s_cbranch_scc1 L_xdma
    s_cmp_lt_u32 s73, 4
    s_cselect_b32 s60, s8, s10
    s_cselect_b32 s61, s9, s11
    s_mov_b32 s62, 25600
    s_mov_b32 s63, 0x20000
    s_sub_u32 s88, s93, 5
    s_lshl_b32 s88, s88, 13
    s_add_u32 m0, s88, 136192
    s_add_u32 s89, s88, 0
    buffer_load_dwordx4 v1, s[60:63], s89 offen offset:0 lds
    buffer_load_dwordx4 v1, s[60:63], s89 offen offset:1024 lds
    buffer_load_dwordx4 v1, s[60:63], s89 offen offset:2048 lds
    buffer_load_dwordx4 v1, s[60:63], s89 offen offset:3072 lds
    s_add_u32 m0, s88, 140288
    s_add_u32 s89, s88, 4096
    buffer_load_dwordx4 v1, s[60:63], s89 offen offset:0 lds
    buffer_load_dwordx4 v1, s[60:63], s89 offen offset:1024 lds
    buffer_load_dwordx4 v1, s[60:63], s89 offen offset:2048 lds
    buffer_load_dwordx4 v1, s[60:63], s89 offen offset:3072 lds
    s_add_u32 m0, s88, 144384
    s_add_u32 s89, s88, 8192
    buffer_load_dwordx4 v1, s[60:63], s89 offen offset:0 lds
    s_mov_b32 s40, s6
    s_mov_b32 s41, s7
    s_mov_b32 s42, 819200
    s_mov_b32 s43, 0x20000
    s_mul_i32 s84, s3, 3
    s_add_u32 s84, s84, s93
    s_sub_u32 s84, s84, 5
    s_mul_i32 s84, s84, 8576
    v_lshlrev_b32 v14, 7, v0
    s_mov_b32 m0, 163328
    s_nop 0
    buffer_load_dword v14, s[40:43], s84 offen lds
    s_add_u32 s84, s84, 8192
    s_mov_b64 exec, 7
    buffer_load_dword v14, s[40:43], s84 offen lds
    s_mov_b64 exec, -1
    s_branch L_common
L_modpath:
    s_lshl_b32 s81, s73, 5
    s_add_u32 s79, s81, s72
    s_mov_b32 s34, 16875520
    s_mov_b32 s35, 0x20000
    s_mov_b32 s66, 4915200
    s_mov_b32 s67, 0x20000
    s_mov_b32 s70, 1280
    s_mov_b32 s71, 0x20000
    v_mov_b32 v11, 0
    v_lshlrev_b32 v1, 4, v0
    s_mov_b32 s83, s79
    v_bfe_u32 v8, v0, 3, 2
    v_lshlrev_b32 v8, 3, v8
    v_lshrrev_b32 v9, 5, v0
    v_lshl_add_u32 v8, v9, 2, v8
    v_bfe_u32 v9, v0, 1, 2
    v_add_u32 v8, v8, v9
    v_mul_u32_u24 v8, 7680, v8
    v_and_b32 v9, 1, v0
    v_lshl_add_u32 v8, v9, 4, v8
    s_lshl_b32 s81, s93, 8
    v_lshl_add_u32 v9, v0, 2, s81
    s_mul_i32 s80, s93, 983040
    s_lshl_b32 s81, s79, 5
    s_add_u32 s80, s80, s81
    s_lshl_b32 s81, s93, 12
    s_waitcnt lgkmcnt(0)
    s_mov_b32 s64, s22
    s_mov_b32 s65, s23
    s_mov_b32 s68, s20
    s_mov_b32 s69, s21
    s_mov_b32 s32, s28
    s_mov_b32 s33, s29
    s_cmp_lt_u32 s83, 80
    s_cbranch_scc0 L_nomodld
    s_setprio 1
    buffer_load_dword v20, v9, s[68:71], 0 offen
    s_add_u32 m0, s81, 83968
    s_nop 0
    buffer_load_dwordx4 v8, s[64:67], s80 offen lds
    s_add_u32 m0, s81, 84992
    s_add_u32 s80, s80, 245760
    buffer_load_dwordx4 v8, s[64:67], s80 offen lds
    s_add_u32 m0, s81, 86016
    s_add_u32 s80, s80, 245760
    buffer_load_dwordx4 v8, s[64:67], s80 offen lds
    s_add_u32 m0, s81, 87040
    s_add_u32 s80, s80, 245760
    buffer_load_dwordx4 v8, s[64:67], s80 offen lds
    buffer_load_dword v13, v11, s[32:35], 0 offen sc1
    v_mov_b32 v12, 162176
    ds_write2_b32 v12, v11, v11 offset0:0 offset1:1
    ds_write2_b32 v12, v11, v11 offset0:3 offset1:4
    v_mov_b32 v10, -1
    v_lshlrev_b32 v12, 2, v0
    v_add_u32 v12, 161792, v12
    ds_write2_b32 v12, v10, v10 offset0:0 offset1:16
    s_waitcnt lgkmcnt(0)
    s_barrier
    s_waitcnt vmcnt(5)
    v_lshlrev_b32 v24, 16, v20
    v_and_b32 v25, 0xffff0000, v20
    v_mul_f32 v26, 0xbfb8aa3b, v24
    v_mul_f32 v27, 0xbfb8aa3b, v25
    v_exp_f32 v26, v26
    v_exp_f32 v27, v27
    s_lshl_b32 s80, s93, 8
    v_add_f32 v26, 1.0, v26
    v_add_f32 v27, 1.0, v27
    v_rcp_f32 v26, v26
    v_rcp_f32 v27, v27
    s_add_u32 s80, s80, 124928
    v_mul_f32 v24, v24, v26
    v_mul_f32 v25, v25, v27
    v_lshl_add_u32 v26, v0, 2, s80
    v_cvt_pk_bf16_f32 v24, v24, v25
    v_lshrrev_b32 v27, 4, v0
    v_lshl_add_u32 v27, v27, 4, s80
    ds_write_b32 v26, v24
    ds_read_b128 v[28:31], v27 offset:0
    ds_read_b128 v[32:35], v27 offset:64
    ds_read_b128 v[36:39], v27 offset:128
    ds_read_b128 v[40:43], v27 offset:192
    s_branch L_skip_modld
L_nomodld:
    s_cmp_lt_u32 s73, 3
    s_cbranch_scc1 L_skip_t0
    s_lshr_b32 s89, s3, 3
    s_mul_i32 s89, s89, 5
    s_add_u32 s89, s89, s73
    s_sub_u32 s89, s89, 3
    s_mul_i32 s90, s89, 5
    s_add_u32 s90, s90, s93
    s_and_b32 s89, s2, 7
    s_mul_i32 s89, s89, 100
    s_add_u32 s89, s89, s90
    s_mul_i32 s89, s89, 7680
    v_lshlrev_b32 v14, 7, v0
    s_mov_b64 exec, 0xfffff
    buffer_load_dword v250, v14, s[64:67], s89 offen
    s_mov_b64 exec, -1
L_skip_t0:
    buffer_load_dword v13, v11, s[32:35], 0 offen sc1
    v_mov_b32 v12, 162176
    ds_write2_b32 v12, v11, v11 offset0:0 offset1:1
    ds_write2_b32 v12, v11, v11 offset0:3 offset1:4
    v_mov_b32 v10, -1
    v_lshlrev_b32 v12, 2, v0
    v_add_u32 v12, 161792, v12
    ds_write2_b32 v12, v10, v10 offset0:0 offset1:16
    s_waitcnt lgkmcnt(0)
    s_barrier
L_skip_modld:
    s_cmp_lg_u32 s93, 4
    s_cbranch_scc1 L_common
    s_lshl_b32 s87, s72, 3
    s_add_u32 s87, s87, s73
    s_mul_i32 s88, s87, 688
    s_add_u32 s88, s88, 65536
    v_mov_b32 v16, -1
    v_mov_b32 v17, -1
    v_mov_b32 v18, -1
    v_mov_b32 v19, -1
    s_mov_b32 exec_hi, 0x7ff
    buffer_store_dwordx4 v[16:19], v1, s[32:35], s88 offen sc1
    s_mov_b64 exec, -1
L_common:
    v_mov_b32 v236, 0
    v_mov_b32 v237, 0
    v_mov_b32 v235, 0
    s_mov_b32 s36, s4
    s_mov_b32 s37, s5
    s_mov_b32 s38, 2621440
    s_mov_b32 s39, 0x20000
    s_mov_b32 s40, s6
    s_mov_b32 s41, s7
    s_mov_b32 s42, 819200
    s_mov_b32 s43, 0x20000
    s_mul_i32 s30, s73, 160
    v_add_u32 v12, 0, v0
    v_mul_u32_u24 v9, 6554, v12
    v_lshrrev_b32 v9, 16, v9
    v_mul_u32_u24 v8, 10, v9
    v_sub_u32 v12, v12, v8
    v_bfe_u32 v8, v9, 2, 2
    v_lshlrev_b32 v8, 3, v8
    v_and_b32 v2, 3, v9
    v_add_u32 v8, v8, v2
    v_lshrrev_b32 v9, 4, v9
    v_lshl_add_u32 v8, v9, 2, v8
    v_mul_u32_u24 v8, 1280, v8
    v_lshl_add_u32 v2, v12, 4, v8
    v_add_u32 v12, 64, v0
    v_mul_u32_u24 v9, 6554, v12
    v_lshrrev_b32 v9, 16, v9
    v_mul_u32_u24 v8, 10, v9
    v_sub_u32 v12, v12, v8
    v_bfe_u32 v8, v9, 2, 2
    v_lshlrev_b32 v8, 3, v8
    v_and_b32 v3, 3, v9
    v_add_u32 v8, v8, v3
    v_lshrrev_b32 v9, 4, v9
    v_lshl_add_u32 v8, v9, 2, v8
    v_mul_u32_u24 v8, 1280, v8
    v_lshl_add_u32 v3, v12, 4, v8
    v_add_u32 v12, 128, v0
    v_mul_u32_u24 v9, 6554, v12
    v_lshrrev_b32 v9, 16, v9
    v_mul_u32_u24 v8, 10, v9
    v_sub_u32 v12, v12, v8
    v_bfe_u32 v8, v9, 2, 2
    v_lshlrev_b32 v8, 3, v8
    v_and_b32 v4, 3, v9
    v_add_u32 v8, v8, v4
    v_lshrrev_b32 v9, 4, v9
    v_lshl_add_u32 v8, v9, 2, v8
    v_mul_u32_u24 v8, 1280, v8
    v_lshl_add_u32 v4, v12, 4, v8
    v_add_u32 v12, 192, v0
    v_mul_u32_u24 v9, 6554, v12
    v_lshrrev_b32 v9, 16, v9
    v_mul_u32_u24 v8, 10, v9
    v_sub_u32 v12, v12, v8
    v_bfe_u32 v8, v9, 2, 2
    v_lshlrev_b32 v8, 3, v8
    v_and_b32 v5, 3, v9
    v_add_u32 v8, v8, v5
    v_lshrrev_b32 v9, 4, v9
    v_lshl_add_u32 v8, v9, 2, v8
    v_mul_u32_u24 v8, 1280, v8
    v_lshl_add_u32 v5, v12, 4, v8
    v_add_u32 v12, 256, v0
    v_mul_u32_u24 v9, 6554, v12
    v_lshrrev_b32 v9, 16, v9
    v_mul_u32_u24 v8, 10, v9
    v_sub_u32 v12, v12, v8
    v_bfe_u32 v8, v9, 2, 2
    v_lshlrev_b32 v8, 3, v8
    v_and_b32 v6, 3, v9
    v_add_u32 v8, v8, v6
    v_lshrrev_b32 v9, 4, v9
    v_lshl_add_u32 v8, v9, 2, v8
    v_mul_u32_u24 v8, 1280, v8
    v_lshl_add_u32 v6, v12, 4, v8
    v_lshrrev_b32 v12, 2, v0
    v_mul_u32_u24 v12, 160, v12
    v_and_b32 v9, 3, v0
    v_lshl_add_u32 v7, v9, 3, v12
    s_mov_b32 s44, s12
    s_mov_b32 s45, s13
    s_mov_b32 s46, 819200
    s_mov_b32 s47, 0x20000
    s_mov_b32 s48, s16
    s_mov_b32 s49, s17
    s_mov_b32 s50, 1966080
    s_mov_b32 s51, 0x20000
    s_mov_b32 s52, s18
    s_mov_b32 s53, s19
    s_mov_b32 s54, 1966080
    s_mov_b32 s55, 0x20000
    s_mov_b32 s56, s24
    s_mov_b32 s57, s25
    s_mov_b32 s58, 2621440
    s_mov_b32 s59, 0x20000
    s_mul_i32 s78, s72, 368640
    s_add_u32 s78, s78, 327680
    s_mov_b32 s77, 262144
    s_getreg_b32 s31, hwreg(HW_REG_XCC_ID)
    s_and_b32 s31, s31, 15
    s_cmp_lt_u32 s93, 5
    s_cbranch_scc1 L_tag0
    s_waitcnt vmcnt(11)
    s_branch L_tag
L_tag0:
    s_cmp_eq_u32 s93, 4
    s_cbranch_scc1 L_tag4
    s_waitcnt vmcnt(0)
L_tag4:
    s_waitcnt vmcnt(1)
L_tag:
    v_readfirstlane_b32 s75, v13
    s_mul_i32 s75, s75, 1664525
    s_add_u32 s75, s75, 1013904223
    s_cmp_lt_u32 s83, 80
    s_cbranch_scc0 L_mod_skip
    s_lshl_b32 s80, s93, 12
    s_add_u32 s80, s80, 83968
    v_lshl_add_u32 v24, v0, 3, s80
    ds_read_b64_tr_b16 v[48:49], v24 offset:0
    ds_read_b64_tr_b16 v[50:51], v24 offset:512
    ds_read_b64_tr_b16 v[52:53], v24 offset:1024
    ds_read_b64_tr_b16 v[54:55], v24 offset:1536
    ds_read_b64_tr_b16 v[56:57], v24 offset:2048
    ds_read_b64_tr_b16 v[58:59], v24 offset:2560
    ds_read_b64_tr_b16 v[60:61], v24 offset:3072
    ds_read_b64_tr_b16 v[62:63], v24 offset:3584
    s_lshl_b32 s80, s93, 6
    s_add_u32 s80, s80, 161792
    v_add_u32 v25, s80, v0
    s_waitcnt lgkmcnt(6)
    v_mfma_f32_16x16x32_bf16 v[64:67], v[48:51], v[28:31], 0
    s_waitcnt lgkmcnt(4)
    v_mfma_f32_16x16x32_bf16 v[64:67], v[52:55], v[32:35], v[64:67]
    s_waitcnt lgkmcnt(2)
    v_mfma_f32_16x16x32_bf16 v[64:67], v[56:59], v[36:39], v[64:67]
    s_waitcnt lgkmcnt(0)
    v_mfma_f32_16x16x32_bf16 v[64:67], v[60:63], v[40:43], v[64:67]
    s_mov_b32 exec_lo, 0x00010001
    s_mov_b32 exec_hi, 0x00010001
    s_nop 5
    ds_write_b128 v25, v[64:67]
    s_mov_b64 exec, -1
    s_cmp_lg_u32 s93, 0
    s_cbranch_scc1 L_mod_skip
    s_mov_b64 exec, 0xffff
    v_lshlrev_b32 v8, 2, v0
    v_add_u32 v8, 161792, v8
    v_lshlrev_b32 v9, 3, v0
    s_lshl_b32 s80, s79, 7
    s_add_u32 s80, s80, 4096
L_mod_spin:
    ds_read_b32 v10, v8 offset:0
    ds_read_b32 v11, v8 offset:64
    ds_read_b32 v12, v8 offset:128
    ds_read_b32 v13, v8 offset:192
    ds_read_b32 v14, v8 offset:256
    s_waitcnt lgkmcnt(0)
    v_max3_u32 v15, v10, v11, v12
    v_max3_u32 v15, v15, v13, v14
    v_cmp_eq_u32 vcc, -1, v15
    s_cbranch_vccz L_spinout_1
    s_sub_u32 s77, s77, 1
    s_cbranch_scc1 L_spinout_1_x
    s_branch L_mod_spin
L_spinout_1_x:
    s_mov_b32 s77, 0
L_spinout_1:
    v_add_f32 v10, v10, v11
    v_add_f32 v12, v12, v13
    v_add_f32 v10, v10, v14
    v_mov_b32 v11, s75
    v_add_f32 v10, v10, v12
    buffer_store_dwordx2 v[10:11], v9, s[32:35], s80 offen sc1
    s_mov_b64 exec, -1
L_mod_skip:
    s_setprio 0
    s_cmp_lg_u32 s93, 4
    s_cbranch_scc1 L_skip_ef
    s_lshl_b32 s87, s72, 3
    s_add_u32 s87, s87, s73
    s_lshl_b32 s87, s87, 7
    s_add_u32 s87, s87, 278528
    v_mov_b32 v14, s75
    v_mov_b32 v15, s31
    s_waitcnt vmcnt(0)
    s_mov_b64 exec, 1
    buffer_store_dwordx2 v[14:15], v11, s[32:35], s87 offen sc1
    s_mov_b64 exec, -1
L_skip_ef:
    v_and_b32 v12, 15, v0
    v_lshrrev_b32 v13, 4, v0
    v_lshrrev_b32 v10, 1, v12
    v_xor_b32 v13, v13, v10
    v_mul_u32_u24 v12, 640, v12
    v_lshl_add_u32 v12, v13, 4, v12
    s_mul_i32 s90, s74, 10240
    v_add_u32 v12, s90, v12
    v_xor_b32 v13, 64, v12
    s_waitcnt lgkmcnt(0)
    s_barrier
    ds_read_b128 v[16:19], v12 offset:0
    ds_read_b128 v[20:23], v13 offset:0
    ds_read_b128 v[24:27], v12 offset:128
    ds_read_b128 v[28:31], v13 offset:128
    ds_read_b128 v[32:35], v12 offset:256
    ds_read_b128 v[36:39], v13 offset:256
    ds_read_b128 v[40:43], v12 offset:384
    ds_read_b128 v[44:47], v13 offset:384
    ds_read_b128 v[48:51], v12 offset:512
    ds_read_b128 v[52:55], v13 offset:512
    s_cmp_lt_u32 s93, 5
    s_cbranch_scc1 L_b2
    s_waitcnt vmcnt(2)
L_b2:
    s_waitcnt lgkmcnt(0)
    s_barrier
    s_cmp_lt_u32 s93, 6
    s_cbranch_scc1 L_nokvw
    v_lshrrev_b32 v11, 4, v0
    v_bfe_u32 v12, v0, 2, 2
    v_lshl_add_u32 v11, v11, 3, v12
    v_mul_u32_u24 v11, 40, v11
    v_and_b32 v12, 3, v0
    v_lshl_add_u32 v11, v12, 3, v11
    s_mul_i32 s84, s86, 12800
    s_add_u32 s84, s84, 136192
    v_add_u32 v11, s84, v11
    ds_read_b64_tr_b16 v[160:161], v11 offset:0
    ds_read_b64_tr_b16 v[162:163], v11 offset:160
    ds_read_b64_tr_b16 v[164:165], v11 offset:32
    ds_read_b64_tr_b16 v[166:167], v11 offset:192
    ds_read_b64_tr_b16 v[168:169], v11 offset:1280
    ds_read_b64_tr_b16 v[170:171], v11 offset:1440
    ds_read_b64_tr_b16 v[172:173], v11 offset:1312
    ds_read_b64_tr_b16 v[174:175], v11 offset:1472
    ds_read_b64_tr_b16 v[176:177], v11 offset:2560
    ds_read_b64_tr_b16 v[178:179], v11 offset:2720
    ds_read_b64_tr_b16 v[180:181], v11 offset:2592
    ds_read_b64_tr_b16 v[182:183], v11 offset:2752
    s_waitcnt lgkmcnt(3)
    ds_read_b64_tr_b16 v[184:185], v11 offset:3840
    ds_read_b64_tr_b16 v[186:187], v11 offset:4000
    ds_read_b64_tr_b16 v[188:189], v11 offset:3872
    ds_read_b64_tr_b16 v[190:191], v11 offset:4032
    ds_read_b64_tr_b16 v[192:193], v11 offset:5120
    ds_read_b64_tr_b16 v[194:195], v11 offset:5280
    ds_read_b64_tr_b16 v[196:197], v11 offset:5152
    ds_read_b64_tr_b16 v[198:199], v11 offset:5312
    ds_read_b64_tr_b16 v[200:201], v11 offset:6400
    ds_read_b64_tr_b16 v[202:203], v11 offset:6560
    ds_read_b64_tr_b16 v[204:205], v11 offset:6432
    ds_read_b64_tr_b16 v[206:207], v11 offset:6592
    s_waitcnt lgkmcnt(3)
    ds_read_b64_tr_b16 v[208:209], v11 offset:7680
    ds_read_b64_tr_b16 v[210:211], v11 offset:7840
    ds_read_b64_tr_b16 v[212:213], v11 offset:7712
    ds_read_b64_tr_b16 v[214:215], v11 offset:7872
    ds_read_b64_tr_b16 v[216:217], v11 offset:8960
    ds_read_b64_tr_b16 v[218:219], v11 offset:9120
    ds_read_b64_tr_b16 v[220:221], v11 offset:8992
    ds_read_b64_tr_b16 v[222:223], v11 offset:9152
    ds_read_b64_tr_b16 v[224:225], v11 offset:10240
    ds_read_b64_tr_b16 v[226:227], v11 offset:10400
    ds_read_b64_tr_b16 v[228:229], v11 offset:10272
    ds_read_b64_tr_b16 v[230:231], v11 offset:10432
    s_waitcnt lgkmcnt(3)
    v_mov_b32 v235, v11
    s_and_b32 s85, s73, 3
    s_lshr_b32 s92, s85, 1
    s_lshl_b32 s88, s72, 1
    s_add_u32 s92, s92, s88
    s_mul_i32 s92, s92, 2752
    s_add_u32 s92, s92, 65536
    s_and_b32 s88, s85, 1
    v_and_b32 v14, 15, v0
    v_lshrrev_b32 v15, 4, v0
    v_mov_b32 v12, 0x7fffffff
    s_cmp_ge_u32 s73, 4
    s_cbranch_scc1 L_kv_voff
    s_lshl_b32 s89, s88, 4
    v_add_u32 v14, s89, v14
    v_lshrrev_b32 v236, 1, v15
    v_lshl_add_u32 v236, v236, 5, v14
    v_lshlrev_b32 v236, 4, v236
    v_and_b32 v237, 1, v15
    v_lshl_add_u32 v236, v237, 3, v236
    v_lshlrev_b32 v237, 3, v14
    v_add_u32 v237, 1024, v237
    v_cmp_eq_u32 vcc, 0, v15
    v_mov_b32 v239, 0
    s_nop 0
    v_cndmask_b32 v237, v12, v237, vcc
    s_branch L_nokvw
L_kv_voff:
    s_mul_i32 s89, s88, 736
    s_add_u32 s89, s89, 1280
    v_and_b32 v236, 1, v15
    v_mul_u32_u24 v236, 368, v236
    v_lshl_add_u32 v236, v14, 4, v236
    v_lshrrev_b32 v237, 1, v15
    v_lshl_add_u32 v236, v237, 3, v236
    v_add_u32 v236, s89, v236
    v_add_u32 v237, 256, v236
    v_cmp_ge_u32 vcc, 6, v14
    v_mov_b32 v239, v14
    s_nop 0
    v_cndmask_b32 v237, v12, v237, vcc
    v_mov_b32 v238, 0x3f803f80
    v_cmp_eq_u32 vcc, 4, v14
    s_nop 1
    v_cndmask_b32 v238, 0, v238, vcc
L_nokvw:
    s_mov_b32 s85, 0x3f803f80
    s_lshr_b32 s82, s3, 3
    s_lshl_b32 s82, s82, 1
    s_and_b32 s84, s73, 1
    s_add_u32 s82, s82, s84
    s_add_u32 s84, s82, s93
    s_and_b32 s84, s84, 7
    s_xor_b32 s87, s84, 4
    s_add_u32 s82, s93, 4
    s_add_u32 s81, s93, 8
    s_cmp_ge_u32 s93, 4
    s_cselect_b32 s84, s82, s84
    s_cselect_b32 s87, s81, s87
    s_and_b32 s88, s84, 1
    s_mul_i32 s88, s88, 10
    s_lshr_b32 s89, s84, 1
    s_add_u32 s89, s89, s88
    s_mul_i32 s89, s89, 40960
    s_add_u32 s89, s89, s30
    s_mul_i32 s88, s84, 5120
    s_add_u32 s91, s88, 83968
    s_sub_u32 s88, s88, 40960
    s_cselect_b32 s88, s91, s88
    s_mov_b32 s84, s87
    s_add_u32 m0, s88, 0
    s_nop 0
    buffer_load_dwordx4 v2, s[40:43], s89 offen lds
    v_dot2_f32_bf16 v8, v16, s85, 0
    v_dot2_f32_bf16 v9, v16, v16, 0
    v_dot2_f32_bf16 v10, v17, s85, 0
    v_dot2_f32_bf16 v11, v17, v17, 0
    v_dot2_f32_bf16 v8, v18, s85, v8
    v_dot2_f32_bf16 v9, v18, v18, v9
    v_dot2_f32_bf16 v10, v19, s85, v10
    v_dot2_f32_bf16 v11, v19, v19, v11
    s_add_u32 m0, s88, 1024
    s_nop 0
    buffer_load_dwordx4 v3, s[40:43], s89 offen lds
    v_dot2_f32_bf16 v8, v20, s85, v8
    v_dot2_f32_bf16 v9, v20, v20, v9
    v_dot2_f32_bf16 v10, v21, s85, v10
    v_dot2_f32_bf16 v11, v21, v21, v11
    v_dot2_f32_bf16 v8, v22, s85, v8
    v_dot2_f32_bf16 v9, v22, v22, v9
    v_dot2_f32_bf16 v10, v23, s85, v10
    v_dot2_f32_bf16 v11, v23, v23, v11
    s_add_u32 m0, s88, 2048
    s_nop 0
    buffer_load_dwordx4 v4, s[40:43], s89 offen lds
    v_dot2_f32_bf16 v8, v24, s85, v8
    v_dot2_f32_bf16 v9, v24, v24, v9
    v_dot2_f32_bf16 v10, v25, s85, v10
    v_dot2_f32_bf16 v11, v25, v25, v11
    v_dot2_f32_bf16 v8, v26, s85, v8
    v_dot2_f32_bf16 v9, v26, v26, v9
    v_dot2_f32_bf16 v10, v27, s85, v10
    v_dot2_f32_bf16 v11, v27, v27, v11
    s_add_u32 m0, s88, 3072
    s_nop 0
    buffer_load_dwordx4 v5, s[40:43], s89 offen lds
    v_dot2_f32_bf16 v8, v28, s85, v8
    v_dot2_f32_bf16 v9, v28, v28, v9
    v_dot2_f32_bf16 v10, v29, s85, v10
    v_dot2_f32_bf16 v11, v29, v29, v11
    v_dot2_f32_bf16 v8, v30, s85, v8
    v_dot2_f32_bf16 v9, v30, v30, v9
    v_dot2_f32_bf16 v10, v31, s85, v10
    v_dot2_f32_bf16 v11, v31, v31, v11
    s_add_u32 m0, s88, 4096
    s_nop 0
    buffer_load_dwordx4 v6, s[40:43], s89 offen lds
    v_dot2_f32_bf16 v8, v32, s85, v8
    v_dot2_f32_bf16 v9, v32, v32, v9
    v_dot2_f32_bf16 v10, v33, s85, v10
    v_dot2_f32_bf16 v11, v33, v33, v11
    v_dot2_f32_bf16 v8, v34, s85, v8
    v_dot2_f32_bf16 v9, v34, v34, v9
    v_dot2_f32_bf16 v10, v35, s85, v10
    v_dot2_f32_bf16 v11, v35, v35, v11
    s_and_b32 s88, s84, 1
    s_mul_i32 s88, s88, 10
    s_lshr_b32 s89, s84, 1
    s_add_u32 s89, s89, s88
    s_mul_i32 s89, s89, 40960
    s_add_u32 s89, s89, s30
    s_mul_i32 s88, s84, 5120
    s_add_u32 s91, s88, 83968
    s_sub_u32 s88, s88, 40960
    s_cselect_b32 s88, s91, s88
    s_add_u32 m0, s88, 0
    s_nop 0
    buffer_load_dwordx4 v2, s[40:43], s89 offen lds
    v_dot2_f32_bf16 v8, v36, s85, v8
    v_dot2_f32_bf16 v9, v36, v36, v9
    v_dot2_f32_bf16 v10, v37, s85, v10
    v_dot2_f32_bf16 v11, v37, v37, v11
    v_dot2_f32_bf16 v8, v38, s85, v8
    v_dot2_f32_bf16 v9, v38, v38, v9
    v_dot2_f32_bf16 v10, v39, s85, v10
    v_dot2_f32_bf16 v11, v39, v39, v11
    s_add_u32 m0, s88, 1024
    s_nop 0
    buffer_load_dwordx4 v3, s[40:43], s89 offen lds
    v_dot2_f32_bf16 v8, v40, s85, v8
    v_dot2_f32_bf16 v9, v40, v40, v9
    v_dot2_f32_bf16 v10, v41, s85, v10
    v_dot2_f32_bf16 v11, v41, v41, v11
    v_dot2_f32_bf16 v8, v42, s85, v8
    v_dot2_f32_bf16 v9, v42, v42, v9
    v_dot2_f32_bf16 v10, v43, s85, v10
    v_dot2_f32_bf16 v11, v43, v43, v11
    s_add_u32 m0, s88, 2048
    s_nop 0
    buffer_load_dwordx4 v4, s[40:43], s89 offen lds
    v_dot2_f32_bf16 v8, v44, s85, v8
    v_dot2_f32_bf16 v9, v44, v44, v9
    v_dot2_f32_bf16 v10, v45, s85, v10
    v_dot2_f32_bf16 v11, v45, v45, v11
    v_dot2_f32_bf16 v8, v46, s85, v8
    v_dot2_f32_bf16 v9, v46, v46, v9
    v_dot2_f32_bf16 v10, v47, s85, v10
    v_dot2_f32_bf16 v11, v47, v47, v11
    s_add_u32 m0, s88, 3072
    s_nop 0
    buffer_load_dwordx4 v5, s[40:43], s89 offen lds
    v_dot2_f32_bf16 v8, v48, s85, v8
    v_dot2_f32_bf16 v9, v48, v48, v9
    v_dot2_f32_bf16 v10, v49, s85, v10
    v_dot2_f32_bf16 v11, v49, v49, v11
    v_dot2_f32_bf16 v8, v50, s85, v8
    v_dot2_f32_bf16 v9, v50, v50, v9
    v_dot2_f32_bf16 v10, v51, s85, v10
    v_dot2_f32_bf16 v11, v51, v51, v11
    s_add_u32 m0, s88, 4096
    s_nop 0
    buffer_load_dwordx4 v6, s[40:43], s89 offen lds
    v_dot2_f32_bf16 v8, v52, s85, v8
    v_dot2_f32_bf16 v9, v52, v52, v9
    v_dot2_f32_bf16 v10, v53, s85, v10
    v_dot2_f32_bf16 v11, v53, v53, v11
    v_dot2_f32_bf16 v8, v54, s85, v8
    v_dot2_f32_bf16 v9, v54, v54, v9
    v_dot2_f32_bf16 v10, v55, s85, v10
    v_dot2_f32_bf16 v11, v55, v55, v11
    v_and_b32 v12, 15, v0
    v_lshlrev_b32 v12, 3, v12
    s_lshl_b32 s84, s74, 7
    s_add_u32 s84, s84, 162304
    v_add_f32 v232, v8, v10
    v_add_f32 v233, v9, v11
    s_nop 1
    v_permlane16_swap_b32 v232, v233
    v_add_f32 v232, v232, v233
    v_mov_b32 v10, v232
    s_nop 1
    v_permlane32_swap_b32 v232, v10
    v_add_f32 v232, v232, v10
    v_mov_b32 v233, v232
    s_nop 1
    v_permlane16_swap_b32 v232, v233
    v_add_u32 v11, s84, v12
    s_xor_b32 s84, s84, 128
    v_add_u32 v234, s84, v12
    ds_write_b64 v11, v[232:233]
    s_lshl_b32 s84, s93, 10
    s_add_u32 s90, s84, 4096
    s_add_u32 s91, s84, 9216
    s_lshr_b32 s82, s72, 2
    s_lshl_b32 s82, s82, 12
    s_add_u32 s82, s82, 278528
    v_and_b32 v138, 31, v0
    v_lshlrev_b32 v138, 7, v138
    v_mov_b32 v136, s75
    s_cmp_ge_u32 s93, 5
    s_cbranch_scc1 L_unp
    s_cmp_lg_u32 s93, 4
    s_cbranch_scc1 L_gat0
    buffer_load_dwordx2 v[136:137], v138, s[32:35], s82 offen sc1
L_gat0:
    buffer_load_dwordx4 v[140:143], v1, s[32:35], s90 offen sc1
    buffer_load_dwordx4 v[144:147], v1, s[32:35], s91 offen sc1
L_unp:
    v_lshlrev_b32 v56, 16, v16
    v_and_b32 v57, 0xffff0000, v16
    v_lshlrev_b32 v58, 16, v17
    v_and_b32 v59, 0xffff0000, v17
    v_lshlrev_b32 v60, 16, v18
    v_and_b32 v61, 0xffff0000, v18
    v_lshlrev_b32 v62, 16, v19
    v_and_b32 v63, 0xffff0000, v19
    v_lshlrev_b32 v64, 16, v20
    v_and_b32 v65, 0xffff0000, v20
    v_lshlrev_b32 v66, 16, v21
    v_and_b32 v67, 0xffff0000, v21
    v_lshlrev_b32 v68, 16, v22
    v_and_b32 v69, 0xffff0000, v22
    v_lshlrev_b32 v70, 16, v23
    v_and_b32 v71, 0xffff0000, v23
    v_lshlrev_b32 v72, 16, v24
    v_and_b32 v73, 0xffff0000, v24
    v_lshlrev_b32 v74, 16, v25
    v_and_b32 v75, 0xffff0000, v25
    v_lshlrev_b32 v76, 16, v26
    v_and_b32 v77, 0xffff0000, v26
    v_lshlrev_b32 v78, 16, v27
    v_and_b32 v79, 0xffff0000, v27
    v_lshlrev_b32 v80, 16, v28
    v_and_b32 v81, 0xffff0000, v28
    v_lshlrev_b32 v82, 16, v29
    v_and_b32 v83, 0xffff0000, v29
    v_lshlrev_b32 v84, 16, v30
    v_and_b32 v85, 0xffff0000, v30
    v_lshlrev_b32 v86, 16, v31
    v_and_b32 v87, 0xffff0000, v31
    v_lshlrev_b32 v88, 16, v32
    v_and_b32 v89, 0xffff0000, v32
    v_lshlrev_b32 v90, 16, v33
    v_and_b32 v91, 0xffff0000, v33
    v_lshlrev_b32 v92, 16, v34
    v_and_b32 v93, 0xffff0000, v34
    v_lshlrev_b32 v94, 16, v35
    v_and_b32 v95, 0xffff0000, v35
    v_lshlrev_b32 v96, 16, v36
    v_and_b32 v97, 0xffff0000, v36
    v_lshlrev_b32 v98, 16, v37
    v_and_b32 v99, 0xffff0000, v37
    v_lshlrev_b32 v100, 16, v38
    v_and_b32 v101, 0xffff0000, v38
    v_lshlrev_b32 v102, 16, v39
    v_and_b32 v103, 0xffff0000, v39
    v_lshlrev_b32 v104, 16, v40
    v_and_b32 v105, 0xffff0000, v40
    v_lshlrev_b32 v106, 16, v41
    v_and_b32 v107, 0xffff0000, v41
    v_lshlrev_b32 v108, 16, v42
    v_and_b32 v109, 0xffff0000, v42
    v_lshlrev_b32 v110, 16, v43
    v_and_b32 v111, 0xffff0000, v43
    v_lshlrev_b32 v112, 16, v44
    v_and_b32 v113, 0xffff0000, v44
    v_lshlrev_b32 v114, 16, v45
    v_and_b32 v115, 0xffff0000, v45
    v_lshlrev_b32 v116, 16, v46
    v_and_b32 v117, 0xffff0000, v46
    v_lshlrev_b32 v118, 16, v47
    v_and_b32 v119, 0xffff0000, v47
    v_lshlrev_b32 v120, 16, v48
    v_and_b32 v121, 0xffff0000, v48
    v_lshlrev_b32 v122, 16, v49
    v_and_b32 v123, 0xffff0000, v49
    v_lshlrev_b32 v124, 16, v50
    v_and_b32 v125, 0xffff0000, v50
    v_lshlrev_b32 v126, 16, v51
    v_and_b32 v127, 0xffff0000, v51
    v_lshlrev_b32 v128, 16, v52
    v_and_b32 v129, 0xffff0000, v52
    v_lshlrev_b32 v130, 16, v53
    v_and_b32 v131, 0xffff0000, v53
    v_lshlrev_b32 v132, 16, v54
    v_and_b32 v133, 0xffff0000, v54
    v_lshlrev_b32 v134, 16, v55
    v_and_b32 v135, 0xffff0000, v55
    s_cmp_ge_u32 s93, 5
    s_cbranch_scc1 L_b3w
    s_branch L_gather1
L_gather:
    s_cmp_lg_u32 s93, 4
    s_cbranch_scc1 L_gather3
    buffer_load_dwordx2 v[136:137], v138, s[32:35], s82 offen sc1
L_gather3:
    buffer_load_dwordx4 v[140:143], v1, s[32:35], s90 offen sc1
    buffer_load_dwordx4 v[144:147], v1, s[32:35], s91 offen sc1
L_gather1:
    s_waitcnt vmcnt(0)
    v_cmp_ne_u32 vcc, s75, v141
    v_cmp_ne_u32 s[88:89], s75, v143
    v_cmp_ne_u32 s[84:85], s75, v145
    v_cmp_ne_u32 s[94:95], s75, v147
    s_or_b64 vcc, vcc, s[88:89]
    v_cmp_ne_u32 s[88:89], s75, v136
    s_or_b64 s[84:85], s[84:85], s[94:95]
    s_or_b64 vcc, vcc, s[84:85]
    s_or_b64 vcc, vcc, s[88:89]
    s_cbranch_vccz L_spinout_2
    s_sub_u32 s77, s77, 1
    s_cbranch_scc1 L_spinout_2_x
    s_branch L_gather
L_spinout_2_x:
    s_mov_b32 s77, 0
L_spinout_2:
    s_cmp_lg_u32 s93, 4
    s_cbranch_scc1 L_gather2
    v_cmp_ne_u32 vcc, s31, v137
    s_and_b32 s94, s72, 3
    s_lshl_b32 s94, s94, 3
    s_lshr_b32 s94, vcc_lo, s94
    s_and_b32 s94, s94, 0xff
    v_mov_b32 v136, 162184
    v_mov_b32 v137, s94
    ds_write_b32 v136, v137
L_gather2:
    v_add_f32 v12, 1.0, v144
    v_add_f32 v14, 1.0, v146
    s_lshl_b32 s84, s93, 8
    s_add_u32 s84, s84, 127488
    v_cvt_pk_bf16_f32 v12, v12, v14
    v_cvt_pk_bf16_f32 v13, v140, v142
    v_lshl_add_u32 v10, v0, 2, s84
    s_lshl_b32 s84, s93, 9
    s_add_u32 s84, s84, 124928
    v_lshlrev_b32 v8, 16, v12
    v_and_b32 v9, 0xffff0000, v12
    v_lshl_add_u32 v11, v0, 3, s84
    ds_write_b64 v11, v[8:9]
    ds_write_b32 v10, v12
    ds_write_b32 v10, v13 offset:1280
    s_waitcnt lgkmcnt(0)
    s_barrier
    s_cmp_eq_u32 s93, 4
    s_cbranch_scc1 L_b3
    s_add_u32 s84, s93, 16
    s_and_b32 s88, s84, 1
    s_mul_i32 s88, s88, 10
    s_lshr_b32 s89, s84, 1
    s_add_u32 s89, s89, s88
    s_mul_i32 s89, s89, 40960
    s_add_u32 s89, s89, s30
    s_mul_i32 s88, s84, 5120
    s_add_u32 s91, s88, 83968
    s_sub_u32 s88, s88, 40960
    s_cselect_b32 s88, s91, s88
    s_add_u32 m0, s88, 0
    s_nop 0
    buffer_load_dwordx4 v2, s[40:43], s89 offen lds
    s_add_u32 m0, s88, 1024
    s_nop 0
    buffer_load_dwordx4 v3, s[40:43], s89 offen lds
    s_add_u32 m0, s88, 2048
    s_nop 0
    buffer_load_dwordx4 v4, s[40:43], s89 offen lds
    s_add_u32 m0, s88, 3072
    s_nop 0
    buffer_load_dwordx4 v5, s[40:43], s89 offen lds
    s_add_u32 m0, s88, 4096
    s_nop 0
    buffer_load_dwordx4 v6, s[40:43], s89 offen lds
    s_branch L_b3
L_b3w:
    s_cmp_lt_u32 s93, 6
    s_cbranch_scc1 L_b3y
    ds_read_b64_tr_b16 v[128:129], v235 offset:11520
    ds_read_b64_tr_b16 v[130:131], v235 offset:11680
    ds_read_b64_tr_b16 v[132:133], v235 offset:11552
    ds_read_b64_tr_b16 v[134:135], v235 offset:11712
L_b3y:
    s_waitcnt lgkmcnt(0)
    s_barrier
L_b3:
    s_mul_i32 s84, s86, 1280
    s_add_u32 s84, s84, 124928
    v_lshrrev_b32 v9, 4, v0
    v_lshl_add_u32 v8, v9, 5, s84
    ds_read_b128 v[136:139], v8 offset:0
    ds_read_b128 v[140:143], v8 offset:16
    ds_read_b128 v[144:147], v8 offset:128
    ds_read_b128 v[148:151], v8 offset:144
    v_bfe_u32 v11, v0, 3, 1
    v_mul_u32_u24 v11, 1280, v11
    v_lshl_add_u32 v11, v9, 4, v11
    s_mul_i32 s84, s86, 640
    s_add_u32 s84, s84, 127488
    v_add_u32 v11, s84, v11
    s_mul_i32 s84, s86, 5120
    v_add_u32 v10, s84, v7
    v_add_u32 v9, 83968, v10
    v_mov_b32 v15, 162188
    ds_read_b128 v[152:155], v11 offset:0
    ds_read_b128 v[156:159], v11 offset:64
    s_cmp_ge_u32 s93, 6
    s_cbranch_scc1 L_kvwave
    s_lshr_b32 s84, s93, 1
    s_cmp_lg_u32 s84, 0
    s_cbranch_scc1 L_q1
    ds_read_b64_tr_b16 v[188:189], v9 offset:0
    ds_read_b64_tr_b16 v[190:191], v9 offset:2560
    ds_read_b64_tr_b16 v[192:193], v9 offset:32
    ds_read_b64_tr_b16 v[194:195], v9 offset:2592
    ds_read_b64_tr_b16 v[196:197], v9 offset:64
    ds_read_b64_tr_b16 v[198:199], v9 offset:2624
    ds_read_b64_tr_b16 v[200:201], v9 offset:96
    ds_read_b64_tr_b16 v[202:203], v9 offset:2656
    ds_read_b64_tr_b16 v[204:205], v9 offset:128
    ds_read_b64_tr_b16 v[206:207], v9 offset:2688
    s_waitcnt lgkmcnt(14)
    v_mul_f32 v56, v136, v56
    v_mul_f32 v57, v137, v57
    v_mul_f32 v58, v138, v58
    v_mul_f32 v59, v139, v59
    v_mul_f32 v60, v140, v60
    v_mul_f32 v61, v141, v61
    v_mul_f32 v62, v142, v62
    v_mul_f32 v63, v143, v63
    ds_read_b128 v[136:139], v8 offset:256
    ds_read_b128 v[140:143], v8 offset:272
    v_cvt_pk_bf16_f32 v16, v56, v57
    v_cvt_pk_bf16_f32 v17, v58, v59
    v_cvt_pk_bf16_f32 v18, v60, v61
    v_cvt_pk_bf16_f32 v19, v62, v63
    s_waitcnt lgkmcnt(10)
    s_nop 0
    v_mfma_f32_16x16x32_bf16 v[160:163], v[188:191], v[16:19], 0
    v_mfma_f32_16x16x32_bf16 v[180:183], v[188:191], v[152:155], 0
    ds_read_b64_tr_b16 v[188:189], v9 offset:10240
    ds_read_b64_tr_b16 v[190:191], v9 offset:12800
    v_mul_f32 v64, v144, v64
    v_mul_f32 v65, v145, v65
    v_mul_f32 v66, v146, v66
    s_waitcnt lgkmcnt(10)
    v_mfma_f32_16x16x32_bf16 v[164:167], v[192:195], v[16:19], 0
    v_mfma_f32_16x16x32_bf16 v[184:187], v[192:195], v[152:155], 0
    ds_read_b128 v[152:155], v11 offset:128
    ds_read_b64_tr_b16 v[192:193], v9 offset:10272
    ds_read_b64_tr_b16 v[194:195], v9 offset:12832
    v_mul_f32 v67, v147, v67
    v_mul_f32 v68, v148, v68
    v_mul_f32 v69, v149, v69
    s_waitcnt lgkmcnt(11)
    v_mfma_f32_16x16x32_bf16 v[168:171], v[196:199], v[16:19], 0
    ds_read_b64_tr_b16 v[196:197], v9 offset:10304
    ds_read_b64_tr_b16 v[198:199], v9 offset:12864
    v_mul_f32 v70, v150, v70
    v_mul_f32 v71, v151, v71
    ds_read_b128 v[144:147], v8 offset:384
    ds_read_b128 v[148:151], v8 offset:400
    s_waitcnt lgkmcnt(13)
    v_mfma_f32_16x16x32_bf16 v[172:175], v[200:203], v[16:19], 0
    ds_read_b64_tr_b16 v[200:201], v9 offset:10336
    ds_read_b64_tr_b16 v[202:203], v9 offset:12896
    v_cvt_pk_bf16_f32 v20, v64, v65
    v_cvt_pk_bf16_f32 v21, v66, v67
    s_waitcnt lgkmcnt(13)
    v_mfma_f32_16x16x32_bf16 v[176:179], v[204:207], v[16:19], 0
    ds_read_b64_tr_b16 v[204:205], v9 offset:10368
    ds_read_b64_tr_b16 v[206:207], v9 offset:12928
    v_cvt_pk_bf16_f32 v22, v68, v69
    v_cvt_pk_bf16_f32 v23, v70, v71
    s_waitcnt lgkmcnt(11)
    s_nop 0
    v_mfma_f32_16x16x32_bf16 v[160:163], v[188:191], v[20:23], v[160:163]
    v_mfma_f32_16x16x32_bf16 v[180:183], v[188:191], v[156:159], v[180:183]
    ds_read_b64_tr_b16 v[188:189], v9 offset:20480
    ds_read_b64_tr_b16 v[190:191], v9 offset:23040
    v_mul_f32 v72, v136, v72
    v_mul_f32 v73, v137, v73
    v_mul_f32 v74, v138, v74
    s_waitcnt lgkmcnt(10)
    v_mfma_f32_16x16x32_bf16 v[164:167], v[192:195], v[20:23], v[164:167]
    v_mfma_f32_16x16x32_bf16 v[184:187], v[192:195], v[156:159], v[184:187]
    ds_read_b128 v[156:159], v11 offset:192
    ds_read_b64_tr_b16 v[192:193], v9 offset:20512
    ds_read_b64_tr_b16 v[194:195], v9 offset:23072
    v_mul_f32 v75, v139, v75
    v_mul_f32 v76, v140, v76
    v_mul_f32 v77, v141, v77
    s_waitcnt lgkmcnt(11)
    v_mfma_f32_16x16x32_bf16 v[168:171], v[196:199], v[20:23], v[168:171]
    ds_read_b64_tr_b16 v[196:197], v9 offset:20544
    ds_read_b64_tr_b16 v[198:199], v9 offset:23104
    v_mul_f32 v78, v142, v78
    v_mul_f32 v79, v143, v79
    ds_read_b128 v[136:139], v8 offset:512
    ds_read_b128 v[140:143], v8 offset:528
    s_waitcnt lgkmcnt(11)
    v_mfma_f32_16x16x32_bf16 v[172:175], v[200:203], v[20:23], v[172:175]
    ds_read_b64_tr_b16 v[200:201], v9 offset:20576
    ds_read_b64_tr_b16 v[202:203], v9 offset:23136
    v_cvt_pk_bf16_f32 v24, v72, v73
    v_cvt_pk_bf16_f32 v25, v74, v75
    s_waitcnt lgkmcnt(11)
    v_mfma_f32_16x16x32_bf16 v[176:179], v[204:207], v[20:23], v[176:179]
    ds_read_b64_tr_b16 v[204:205], v9 offset:20608
    ds_read_b64_tr_b16 v[206:207], v9 offset:23168
    v_cvt_pk_bf16_f32 v26, v76, v77
    v_cvt_pk_bf16_f32 v27, v78, v79
    v_mov_b32 v14, 1
    s_waitcnt vmcnt(0)
    s_mov_b64 exec, 1
    ds_add_u32 v15, v14 offset:4
    s_mov_b64 exec, -1
L_lwa_3:
    ds_read_b32 v14, v15 offset:0
    s_waitcnt lgkmcnt(12)
    v_mfma_f32_16x16x32_bf16 v[160:163], v[188:191], v[24:27], v[160:163]
    v_mfma_f32_16x16x32_bf16 v[180:183], v[188:191], v[152:155], v[180:183]
    ds_read_b64_tr_b16 v[188:189], v9 offset:30720
    ds_read_b64_tr_b16 v[190:191], v9 offset:33280
    v_mul_f32 v80, v144, v80
    v_mul_f32 v81, v145, v81
    v_mul_f32 v82, v146, v82
    s_waitcnt lgkmcnt(11)
    v_mfma_f32_16x16x32_bf16 v[164:167], v[192:195], v[24:27], v[164:167]
    v_mfma_f32_16x16x32_bf16 v[184:187], v[192:195], v[152:155], v[184:187]
    ds_read_b128 v[152:155], v11 offset:256
    ds_read_b64_tr_b16 v[192:193], v9 offset:30752
    ds_read_b64_tr_b16 v[194:195], v9 offset:33312
    v_mul_f32 v83, v147, v83
    v_mul_f32 v84, v148, v84
    v_mul_f32 v85, v149, v85
    s_waitcnt lgkmcnt(12)
    v_mfma_f32_16x16x32_bf16 v[168:171], v[196:199], v[24:27], v[168:171]
    ds_read_b64_tr_b16 v[196:197], v9 offset:30784
    ds_read_b64_tr_b16 v[198:199], v9 offset:33344
    v_mul_f32 v86, v150, v86
    v_mul_f32 v87, v151, v87
    ds_read_b128 v[144:147], v8 offset:640
    ds_read_b128 v[148:151], v8 offset:656
    s_waitcnt lgkmcnt(12)
    v_mfma_f32_16x16x32_bf16 v[172:175], v[200:203], v[24:27], v[172:175]
    ds_read_b64_tr_b16 v[200:201], v9 offset:30816
    ds_read_b64_tr_b16 v[202:203], v9 offset:33376
    v_cvt_pk_bf16_f32 v28, v80, v81
    v_cvt_pk_bf16_f32 v29, v82, v83
    s_waitcnt lgkmcnt(12)
    v_mfma_f32_16x16x32_bf16 v[176:179], v[204:207], v[24:27], v[176:179]
    ds_read_b64_tr_b16 v[204:205], v9 offset:30848
    ds_read_b64_tr_b16 v[206:207], v9 offset:33408
    v_cvt_pk_bf16_f32 v30, v84, v85
    v_cvt_pk_bf16_f32 v31, v86, v87
    s_waitcnt lgkmcnt(13)
    v_cmp_gt_u32 vcc, 3, v14
    s_cbranch_vccz L_lwok_4
L_lwspin_5:
    ds_read_b32 v14, v15 offset:0
    s_waitcnt lgkmcnt(0)
    v_cmp_gt_u32 vcc, 3, v14
    s_cbranch_vccz L_spinout_6
    s_sub_u32 s77, s77, 1
    s_cbranch_scc1 L_spinout_6_x
    s_branch L_lwspin_5
L_spinout_6_x:
    s_mov_b32 s77, 0
L_spinout_6:
L_lwok_4:
    s_mul_i32 s84, s2, 6
    s_add_u32 s84, s84, s93
    s_mov_b32 s88, s48
    s_mov_b32 s89, s49
    s_mov_b32 s90, s50
    s_mov_b32 s91, 0x20000
    s_mov_b32 s85, 871
    s_cmp_lt_u32 s84, 871
    s_cselect_b32 s88, s52, s88
    s_cselect_b32 s89, s53, s89
    s_cselect_b32 s90, s54, s90
    s_cselect_b32 s85, 256, s85
    s_cmp_lt_u32 s84, 256
    s_cselect_b32 s88, s44, s88
    s_cselect_b32 s89, s45, s89
    s_cselect_b32 s90, s46, s90
    s_cselect_b32 s85, 0, s85
    s_sub_u32 s84, s84, s85
    s_mul_i32 s84, s84, 3200
    v_lshlrev_b32 v12, 7, v0
    s_mov_b64 exec, 0x1ffffff
    buffer_load_dword v238, v12, s[88:91], s84 offen
    s_mov_b64 exec, -1
    s_waitcnt lgkmcnt(11)
    v_mfma_f32_16x16x32_bf16 v[160:163], v[188:191], v[28:31], v[160:163]
    v_mfma_f32_16x16x32_bf16 v[180:183], v[188:191], v[156:159], v[180:183]
    ds_read_b64_tr_b16 v[188:189], v10 offset:0
    ds_read_b64_tr_b16 v[190:191], v10 offset:2560
    v_mul_f32 v88, v136, v88
    v_mul_f32 v89, v137, v89
    v_mul_f32 v90, v138, v90
    s_waitcnt lgkmcnt(10)
    v_mfma_f32_16x16x32_bf16 v[164:167], v[192:195], v[28:31], v[164:167]
    v_mfma_f32_16x16x32_bf16 v[184:187], v[192:195], v[156:159], v[184:187]
    ds_read_b128 v[156:159], v11 offset:320
    ds_read_b64_tr_b16 v[192:193], v10 offset:32
    ds_read_b64_tr_b16 v[194:195], v10 offset:2592
    v_mul_f32 v91, v139, v91
    v_mul_f32 v92, v140, v92
    v_mul_f32 v93, v141, v93
    s_waitcnt lgkmcnt(11)
    v_mfma_f32_16x16x32_bf16 v[168:171], v[196:199], v[28:31], v[168:171]
    ds_read_b64_tr_b16 v[196:197], v10 offset:64
    ds_read_b64_tr_b16 v[198:199], v10 offset:2624
    v_mul_f32 v94, v142, v94
    v_mul_f32 v95, v143, v95
    ds_read_b128 v[136:139], v8 offset:768
    ds_read_b128 v[140:143], v8 offset:784
    s_waitcnt lgkmcnt(11)
    v_mfma_f32_16x16x32_bf16 v[172:175], v[200:203], v[28:31], v[172:175]
    ds_read_b64_tr_b16 v[200:201], v10 offset:96
    ds_read_b64_tr_b16 v[202:203], v10 offset:2656
    v_cvt_pk_bf16_f32 v32, v88, v89
    v_cvt_pk_bf16_f32 v33, v90, v91
    s_waitcnt lgkmcnt(11)
    v_mfma_f32_16x16x32_bf16 v[176:179], v[204:207], v[28:31], v[176:179]
    ds_read_b64_tr_b16 v[204:205], v10 offset:128
    ds_read_b64_tr_b16 v[206:207], v10 offset:2688
    v_cvt_pk_bf16_f32 v34, v92, v93
    v_cvt_pk_bf16_f32 v35, v94, v95
    s_waitcnt lgkmcnt(11)
    s_nop 0
    v_mfma_f32_16x16x32_bf16 v[160:163], v[188:191], v[32:35], v[160:163]
    v_mfma_f32_16x16x32_bf16 v[180:183], v[188:191], v[152:155], v[180:183]
    ds_read_b64_tr_b16 v[188:189], v10 offset:10240
    ds_read_b64_tr_b16 v[190:191], v10 offset:12800
    v_mul_f32 v96, v144, v96
    v_mul_f32 v97, v145, v97
    v_mul_f32 v98, v146, v98
    s_waitcnt lgkmcnt(10)
    v_mfma_f32_16x16x32_bf16 v[164:167], v[192:195], v[32:35], v[164:167]
    v_mfma_f32_16x16x32_bf16 v[184:187], v[192:195], v[152:155], v[184:187]
    ds_read_b128 v[152:155], v11 offset:384
    ds_read_b64_tr_b16 v[192:193], v10 offset:10272
    ds_read_b64_tr_b16 v[194:195], v10 offset:12832
    v_mul_f32 v99, v147, v99
    v_mul_f32 v100, v148, v100
    v_mul_f32 v101, v149, v101
    s_waitcnt lgkmcnt(11)
    v_mfma_f32_16x16x32_bf16 v[168:171], v[196:199], v[32:35], v[168:171]
    ds_read_b64_tr_b16 v[196:197], v10 offset:10304
    ds_read_b64_tr_b16 v[198:199], v10 offset:12864
    v_mul_f32 v102, v150, v102
    v_mul_f32 v103, v151, v103
    ds_read_b128 v[144:147], v8 offset:896
    ds_read_b128 v[148:151], v8 offset:912
    s_waitcnt lgkmcnt(11)
    v_mfma_f32_16x16x32_bf16 v[172:175], v[200:203], v[32:35], v[172:175]
    ds_read_b64_tr_b16 v[200:201], v10 offset:10336
    ds_read_b64_tr_b16 v[202:203], v10 offset:12896
    v_cvt_pk_bf16_f32 v36, v96, v97
    v_cvt_pk_bf16_f32 v37, v98, v99
    s_waitcnt lgkmcnt(11)
    v_mfma_f32_16x16x32_bf16 v[176:179], v[204:207], v[32:35], v[176:179]
    ds_read_b64_tr_b16 v[204:205], v10 offset:10368
    ds_read_b64_tr_b16 v[206:207], v10 offset:12928
    v_cvt_pk_bf16_f32 v38, v100, v101
    v_cvt_pk_bf16_f32 v39, v102, v103
    s_waitcnt lgkmcnt(11)
    s_nop 0
    v_mfma_f32_16x16x32_bf16 v[160:163], v[188:191], v[36:39], v[160:163]
    v_mfma_f32_16x16x32_bf16 v[180:183], v[188:191], v[156:159], v[180:183]
    ds_read_b64_tr_b16 v[188:189], v10 offset:20480
    ds_read_b64_tr_b16 v[190:191], v10 offset:23040
    v_mul_f32 v104, v136, v104
    v_mul_f32 v105, v137, v105
    v_mul_f32 v106, v138, v106
    s_waitcnt lgkmcnt(10)
    v_mfma_f32_16x16x32_bf16 v[164:167], v[192:195], v[36:39], v[164:167]
    v_mfma_f32_16x16x32_bf16 v[184:187], v[192:195], v[156:159], v[184:187]
    ds_read_b128 v[156:159], v11 offset:448
    ds_read_b64_tr_b16 v[192:193], v10 offset:20512
    ds_read_b64_tr_b16 v[194:195], v10 offset:23072
    v_mul_f32 v107, v139, v107
    v_mul_f32 v108, v140, v108
    v_mul_f32 v109, v141, v109
    s_waitcnt lgkmcnt(11)
    v_mfma_f32_16x16x32_bf16 v[168:171], v[196:199], v[36:39], v[168:171]
    ds_read_b64_tr_b16 v[196:197], v10 offset:20544
    ds_read_b64_tr_b16 v[198:199], v10 offset:23104
    v_mul_f32 v110, v142, v110
    v_mul_f32 v111, v143, v111
    ds_read_b128 v[136:139], v8 offset:1024
    ds_read_b128 v[140:143], v8 offset:1040
    s_waitcnt lgkmcnt(11)
    v_mfma_f32_16x16x32_bf16 v[172:175], v[200:203], v[36:39], v[172:175]
    ds_read_b64_tr_b16 v[200:201], v10 offset:20576
    ds_read_b64_tr_b16 v[202:203], v10 offset:23136
    v_cvt_pk_bf16_f32 v40, v104, v105
    v_cvt_pk_bf16_f32 v41, v106, v107
    s_waitcnt lgkmcnt(11)
    v_mfma_f32_16x16x32_bf16 v[176:179], v[204:207], v[36:39], v[176:179]
    ds_read_b64_tr_b16 v[204:205], v10 offset:20608
    ds_read_b64_tr_b16 v[206:207], v10 offset:23168
    v_cvt_pk_bf16_f32 v42, v108, v109
    v_cvt_pk_bf16_f32 v43, v110, v111
    ds_read_b32 v14, v15 offset:4
    s_waitcnt lgkmcnt(12)
    v_mfma_f32_16x16x32_bf16 v[160:163], v[188:191], v[40:43], v[160:163]
    v_mfma_f32_16x16x32_bf16 v[180:183], v[188:191], v[152:155], v[180:183]
    ds_read_b64_tr_b16 v[188:189], v10 offset:30720
    ds_read_b64_tr_b16 v[190:191], v10 offset:33280
    v_mul_f32 v112, v144, v112
    v_mul_f32 v113, v145, v113
    v_mul_f32 v114, v146, v114
    s_waitcnt lgkmcnt(11)
    v_mfma_f32_16x16x32_bf16 v[164:167], v[192:195], v[40:43], v[164:167]
    v_mfma_f32_16x16x32_bf16 v[184:187], v[192:195], v[152:155], v[184:187]
    ds_read_b128 v[152:155], v11 offset:512
    ds_read_b64_tr_b16 v[192:193], v10 offset:30752
    ds_read_b64_tr_b16 v[194:195], v10 offset:33312
    v_mul_f32 v115, v147, v115
    v_mul_f32 v116, v148, v116
    v_mul_f32 v117, v149, v117
    s_waitcnt lgkmcnt(12)
    v_mfma_f32_16x16x32_bf16 v[168:171], v[196:199], v[40:43], v[168:171]
    ds_read_b64_tr_b16 v[196:197], v10 offset:30784
    ds_read_b64_tr_b16 v[198:199], v10 offset:33344
    v_mul_f32 v118, v150, v118
    v_mul_f32 v119, v151, v119
    ds_read_b128 v[144:147], v8 offset:1152
    ds_read_b128 v[148:151], v8 offset:1168
    s_waitcnt lgkmcnt(12)
    v_mfma_f32_16x16x32_bf16 v[172:175], v[200:203], v[40:43], v[172:175]
    ds_read_b64_tr_b16 v[200:201], v10 offset:30816
    ds_read_b64_tr_b16 v[202:203], v10 offset:33376
    v_cvt_pk_bf16_f32 v44, v112, v113
    v_cvt_pk_bf16_f32 v45, v114, v115
    s_waitcnt lgkmcnt(12)
    v_mfma_f32_16x16x32_bf16 v[176:179], v[204:207], v[40:43], v[176:179]
    ds_read_b64_tr_b16 v[204:205], v10 offset:30848
    ds_read_b64_tr_b16 v[206:207], v10 offset:33408
    v_cvt_pk_bf16_f32 v46, v116, v117
    v_cvt_pk_bf16_f32 v47, v118, v119
    s_waitcnt lgkmcnt(13)
    v_cmp_gt_u32 vcc, 4, v14
    s_cbranch_vccz L_lwok_7
L_lwspin_8:
    ds_read_b32 v14, v15 offset:4
    s_waitcnt lgkmcnt(0)
    v_cmp_gt_u32 vcc, 4, v14
    s_cbranch_vccz L_spinout_9
    s_sub_u32 s77, s77, 1
    s_cbranch_scc1 L_spinout_9_x
    s_branch L_lwspin_8
L_spinout_9_x:
    s_mov_b32 s77, 0
L_spinout_9:
L_lwok_7:
    s_waitcnt lgkmcnt(11)
    v_mfma_f32_16x16x32_bf16 v[160:163], v[188:191], v[44:47], v[160:163]
    v_mfma_f32_16x16x32_bf16 v[180:183], v[188:191], v[156:159], v[180:183]
    ds_read_b64_tr_b16 v[188:189], v10 offset:40960
    ds_read_b64_tr_b16 v[190:191], v10 offset:43520
    v_mul_f32 v120, v136, v120
    v_mul_f32 v121, v137, v121
    v_mul_f32 v122, v138, v122
    s_waitcnt lgkmcnt(10)
    v_mfma_f32_16x16x32_bf16 v[164:167], v[192:195], v[44:47], v[164:167]
    v_mfma_f32_16x16x32_bf16 v[184:187], v[192:195], v[156:159], v[184:187]
    ds_read_b128 v[156:159], v11 offset:576
    ds_read_b64_tr_b16 v[192:193], v10 offset:40992
    ds_read_b64_tr_b16 v[194:195], v10 offset:43552
    v_mul_f32 v123, v139, v123
    v_mul_f32 v124, v140, v124
    v_mul_f32 v125, v141, v125
    s_waitcnt lgkmcnt(11)
    v_mfma_f32_16x16x32_bf16 v[168:171], v[196:199], v[44:47], v[168:171]
    ds_read_b64_tr_b16 v[196:197], v10 offset:41024
    ds_read_b64_tr_b16 v[198:199], v10 offset:43584
    v_mul_f32 v126, v142, v126
    v_mul_f32 v127, v143, v127
    s_waitcnt lgkmcnt(9)
    v_mfma_f32_16x16x32_bf16 v[172:175], v[200:203], v[44:47], v[172:175]
    ds_read_b64_tr_b16 v[200:201], v10 offset:41056
    ds_read_b64_tr_b16 v[202:203], v10 offset:43616
    v_cvt_pk_bf16_f32 v48, v120, v121
    v_cvt_pk_bf16_f32 v49, v122, v123
    s_waitcnt lgkmcnt(9)
    v_mfma_f32_16x16x32_bf16 v[176:179], v[204:207], v[44:47], v[176:179]
    ds_read_b64_tr_b16 v[204:205], v10 offset:41088
    ds_read_b64_tr_b16 v[206:207], v10 offset:43648
    v_cvt_pk_bf16_f32 v50, v124, v125
    v_cvt_pk_bf16_f32 v51, v126, v127
    s_waitcnt lgkmcnt(9)
    s_nop 0
    v_mfma_f32_16x16x32_bf16 v[160:163], v[188:191], v[48:51], v[160:163]
    v_mfma_f32_16x16x32_bf16 v[180:183], v[188:191], v[152:155], v[180:183]
    ds_read_b64_tr_b16 v[188:189], v10 offset:51200
    ds_read_b64_tr_b16 v[190:191], v10 offset:53760
    v_mul_f32 v128, v144, v128
    v_mul_f32 v129, v145, v129
    v_mul_f32 v130, v146, v130
    s_waitcnt lgkmcnt(8)
    v_mfma_f32_16x16x32_bf16 v[164:167], v[192:195], v[48:51], v[164:167]
    v_mfma_f32_16x16x32_bf16 v[184:187], v[192:195], v[152:155], v[184:187]
    ds_read_b64_tr_b16 v[192:193], v10 offset:51232
    ds_read_b64_tr_b16 v[194:195], v10 offset:53792
    v_mul_f32 v131, v147, v131
    v_mul_f32 v132, v148, v132
    v_mul_f32 v133, v149, v133
    s_waitcnt lgkmcnt(8)
    v_mfma_f32_16x16x32_bf16 v[168:171], v[196:199], v[48:51], v[168:171]
    ds_read_b64_tr_b16 v[196:197], v10 offset:51264
    ds_read_b64_tr_b16 v[198:199], v10 offset:53824
    v_mul_f32 v134, v150, v134
    v_mul_f32 v135, v151, v135
    s_waitcnt lgkmcnt(8)
    v_mfma_f32_16x16x32_bf16 v[172:175], v[200:203], v[48:51], v[172:175]
    ds_read_b64_tr_b16 v[200:201], v10 offset:51296
    ds_read_b64_tr_b16 v[202:203], v10 offset:53856
    v_cvt_pk_bf16_f32 v52, v128, v129
    v_cvt_pk_bf16_f32 v53, v130, v131
    s_waitcnt lgkmcnt(8)
    v_mfma_f32_16x16x32_bf16 v[176:179], v[204:207], v[48:51], v[176:179]
    ds_read_b64_tr_b16 v[204:205], v10 offset:51328
    ds_read_b64_tr_b16 v[206:207], v10 offset:53888
    v_cvt_pk_bf16_f32 v54, v132, v133
    v_cvt_pk_bf16_f32 v55, v134, v135
    s_waitcnt lgkmcnt(8)
    s_nop 0
    v_mfma_f32_16x16x32_bf16 v[160:163], v[188:191], v[52:55], v[160:163]
    v_mfma_f32_16x16x32_bf16 v[180:183], v[188:191], v[156:159], v[180:183]
    s_waitcnt lgkmcnt(6)
    v_mfma_f32_16x16x32_bf16 v[164:167], v[192:195], v[52:55], v[164:167]
    v_mfma_f32_16x16x32_bf16 v[184:187], v[192:195], v[156:159], v[184:187]
    s_waitcnt lgkmcnt(4)
    v_mfma_f32_16x16x32_bf16 v[168:171], v[196:199], v[52:55], v[168:171]
    s_waitcnt lgkmcnt(2)
    v_mfma_f32_16x16x32_bf16 v[172:175], v[200:203], v[52:55], v[172:175]
    s_waitcnt lgkmcnt(0)
    v_mfma_f32_16x16x32_bf16 v[176:179], v[204:207], v[52:55], v[176:179]
    ds_read_b64 v[12:13], v234
    v_bfe_u32 v15, v0, 3, 1
    v_mul_u32_u24 v15, 320, v15
    v_lshrrev_b32 v14, 4, v0
    v_lshl_add_u32 v15, v14, 4, v15
    s_mul_i32 s84, s86, 640
    s_add_u32 s84, s84, 132096
    v_add_u32 v15, s84, v15
    s_waitcnt lgkmcnt(0)
    v_add_f32 v12, v12, v232
    v_add_f32 v13, v13, v233
    v_mul_f32 v12, 0x3acccccd, v12
    v_mul_f32 v13, 0x3acccccd, v13
    v_fma_f32 v13, -v12, v12, v13
    v_max_f32 v13, 0, v13
    v_add_f32 v13, 0x3727c5ac, v13
    v_rsq_f32 v232, v13
    v_and_b32 v14, 15, v0
    s_lshr_b32 s84, s74, 1
    s_lshl_b32 s84, s84, 7
    s_add_u32 s84, s84, 133376
    v_mul_f32_e64 v233, -v12, v232
    v_lshl_add_u32 v14, v14, 3, s84
    ds_write_b64 v14, v[232:233]
    s_mov_b32 exec_lo, 0x01010101
    s_mov_b32 exec_hi, 0x01010101
    ds_write_b128 v15, v[180:183] offset:0
    ds_write_b128 v15, v[184:187] offset:64
    s_mov_b64 exec, -1
    s_branch L_qdone
L_q1:
    s_lshr_b32 s84, s93, 1
    s_cmp_lg_u32 s84, 1
    s_cbranch_scc1 L_q2
    ds_read_b64_tr_b16 v[188:189], v9 offset:0
    ds_read_b64_tr_b16 v[190:191], v9 offset:2560
    ds_read_b64_tr_b16 v[192:193], v9 offset:32
    ds_read_b64_tr_b16 v[194:195], v9 offset:2592
    ds_read_b64_tr_b16 v[196:197], v9 offset:64
    ds_read_b64_tr_b16 v[198:199], v9 offset:2624
    ds_read_b64_tr_b16 v[200:201], v9 offset:96
    ds_read_b64_tr_b16 v[202:203], v9 offset:2656
    ds_read_b64_tr_b16 v[204:205], v9 offset:128
    ds_read_b64_tr_b16 v[206:207], v9 offset:2688
    s_waitcnt lgkmcnt(14)
    v_mul_f32 v56, v136, v56
    v_mul_f32 v57, v137, v57
    v_mul_f32 v58, v138, v58
    v_mul_f32 v59, v139, v59
    v_mul_f32 v60, v140, v60
    v_mul_f32 v61, v141, v61
    v_mul_f32 v62, v142, v62
    v_mul_f32 v63, v143, v63
    ds_read_b128 v[136:139], v8 offset:256
    ds_read_b128 v[140:143], v8 offset:272
    v_cvt_pk_bf16_f32 v16, v56, v57
    v_cvt_pk_bf16_f32 v17, v58, v59
    v_cvt_pk_bf16_f32 v18, v60, v61
    v_cvt_pk_bf16_f32 v19, v62, v63
    s_waitcnt lgkmcnt(10)
    s_nop 0
    v_mfma_f32_16x16x32_bf16 v[160:163], v[188:191], v[16:19], 0
    ds_read_b64_tr_b16 v[188:189], v9 offset:10240
    ds_read_b64_tr_b16 v[190:191], v9 offset:12800
    v_mul_f32 v64, v144, v64
    v_mul_f32 v65, v145, v65
    v_mul_f32 v66, v146, v66
    s_waitcnt lgkmcnt(10)
    v_mfma_f32_16x16x32_bf16 v[164:167], v[192:195], v[16:19], 0
    ds_read_b64_tr_b16 v[192:193], v9 offset:10272
    ds_read_b64_tr_b16 v[194:195], v9 offset:12832
    v_mul_f32 v67, v147, v67
    v_mul_f32 v68, v148, v68
    v_mul_f32 v69, v149, v69
    s_waitcnt lgkmcnt(10)
    v_mfma_f32_16x16x32_bf16 v[168:171], v[196:199], v[16:19], 0
    v_mfma_f32_16x16x32_bf16 v[180:183], v[196:199], v[152:155], 0
    ds_read_b64_tr_b16 v[196:197], v9 offset:10304
    ds_read_b64_tr_b16 v[198:199], v9 offset:12864
    v_mul_f32 v70, v150, v70
    v_mul_f32 v71, v151, v71
    ds_read_b128 v[144:147], v8 offset:384
    ds_read_b128 v[148:151], v8 offset:400
    s_waitcnt lgkmcnt(12)
    v_mfma_f32_16x16x32_bf16 v[172:175], v[200:203], v[16:19], 0
    v_mfma_f32_16x16x32_bf16 v[184:187], v[200:203], v[152:155], 0
    ds_read_b128 v[152:155], v11 offset:128
    ds_read_b64_tr_b16 v[200:201], v9 offset:10336
    ds_read_b64_tr_b16 v[202:203], v9 offset:12896
    v_cvt_pk_bf16_f32 v20, v64, v65
    v_cvt_pk_bf16_f32 v21, v66, v67
    s_waitcnt lgkmcnt(13)
    v_mfma_f32_16x16x32_bf16 v[176:179], v[204:207], v[16:19], 0
    ds_read_b64_tr_b16 v[204:205], v9 offset:10368
    ds_read_b64_tr_b16 v[206:207], v9 offset:12928
    v_cvt_pk_bf16_f32 v22, v68, v69
    v_cvt_pk_bf16_f32 v23, v70, v71
    s_waitcnt lgkmcnt(11)
    s_nop 0
    v_mfma_f32_16x16x32_bf16 v[160:163], v[188:191], v[20:23], v[160:163]
    ds_read_b64_tr_b16 v[188:189], v9 offset:20480
    ds_read_b64_tr_b16 v[190:191], v9 offset:23040
    v_mul_f32 v72, v136, v72
    v_mul_f32 v73, v137, v73
    v_mul_f32 v74, v138, v74
    s_waitcnt lgkmcnt(11)
    v_mfma_f32_16x16x32_bf16 v[164:167], v[192:195], v[20:23], v[164:167]
    ds_read_b64_tr_b16 v[192:193], v9 offset:20512
    ds_read_b64_tr_b16 v[194:195], v9 offset:23072
    v_mul_f32 v75, v139, v75
    v_mul_f32 v76, v140, v76
    v_mul_f32 v77, v141, v77
    s_waitcnt lgkmcnt(11)
    v_mfma_f32_16x16x32_bf16 v[168:171], v[196:199], v[20:23], v[168:171]
    v_mfma_f32_16x16x32_bf16 v[180:183], v[196:199], v[156:159], v[180:183]
    ds_read_b64_tr_b16 v[196:197], v9 offset:20544
    ds_read_b64_tr_b16 v[198:199], v9 offset:23104
    v_mul_f32 v78, v142, v78
    v_mul_f32 v79, v143, v79
    ds_read_b128 v[136:139], v8 offset:512
    ds_read_b128 v[140:143], v8 offset:528
    s_waitcnt lgkmcnt(10)
    v_mfma_f32_16x16x32_bf16 v[172:175], v[200:203], v[20:23], v[172:175]
    v_mfma_f32_16x16x32_bf16 v[184:187], v[200:203], v[156:159], v[184:187]
    ds_read_b128 v[156:159], v11 offset:192
    ds_read_b64_tr_b16 v[200:201], v9 offset:20576
    ds_read_b64_tr_b16 v[202:203], v9 offset:23136
    v_cvt_pk_bf16_f32 v24, v72, v73
    v_cvt_pk_bf16_f32 v25, v74, v75
    s_waitcnt lgkmcnt(11)
    v_mfma_f32_16x16x32_bf16 v[176:179], v[204:207], v[20:23], v[176:179]
    ds_read_b64_tr_b16 v[204:205], v9 offset:20608
    ds_read_b64_tr_b16 v[206:207], v9 offset:23168
    v_cvt_pk_bf16_f32 v26, v76, v77
    v_cvt_pk_bf16_f32 v27, v78, v79
    v_mov_b32 v14, 1
    s_waitcnt vmcnt(0)
    s_mov_b64 exec, 1
    ds_add_u32 v15, v14 offset:4
    s_mov_b64 exec, -1
L_lwa_10:
    ds_read_b32 v14, v15 offset:0
    s_waitcnt lgkmcnt(12)
    v_mfma_f32_16x16x32_bf16 v[160:163], v[188:191], v[24:27], v[160:163]
    ds_read_b64_tr_b16 v[188:189], v9 offset:30720
    ds_read_b64_tr_b16 v[190:191], v9 offset:33280
    v_mul_f32 v80, v144, v80
    v_mul_f32 v81, v145, v81
    v_mul_f32 v82, v146, v82
    s_waitcnt lgkmcnt(12)
    v_mfma_f32_16x16x32_bf16 v[164:167], v[192:195], v[24:27], v[164:167]
    ds_read_b64_tr_b16 v[192:193], v9 offset:30752
    ds_read_b64_tr_b16 v[194:195], v9 offset:33312
    v_mul_f32 v83, v147, v83
    v_mul_f32 v84, v148, v84
    v_mul_f32 v85, v149, v85
    s_waitcnt lgkmcnt(12)
    v_mfma_f32_16x16x32_bf16 v[168:171], v[196:199], v[24:27], v[168:171]
    v_mfma_f32_16x16x32_bf16 v[180:183], v[196:199], v[152:155], v[180:183]
    ds_read_b64_tr_b16 v[196:197], v9 offset:30784
    ds_read_b64_tr_b16 v[198:199], v9 offset:33344
    v_mul_f32 v86, v150, v86
    v_mul_f32 v87, v151, v87
    ds_read_b128 v[144:147], v8 offset:640
    ds_read_b128 v[148:151], v8 offset:656
    s_waitcnt lgkmcnt(11)
    v_mfma_f32_16x16x32_bf16 v[172:175], v[200:203], v[24:27], v[172:175]
    v_mfma_f32_16x16x32_bf16 v[184:187], v[200:203], v[152:155], v[184:187]
    ds_read_b128 v[152:155], v11 offset:256
    ds_read_b64_tr_b16 v[200:201], v9 offset:30816
    ds_read_b64_tr_b16 v[202:203], v9 offset:33376
    v_cvt_pk_bf16_f32 v28, v80, v81
    v_cvt_pk_bf16_f32 v29, v82, v83
    s_waitcnt lgkmcnt(12)
    v_mfma_f32_16x16x32_bf16 v[176:179], v[204:207], v[24:27], v[176:179]
    ds_read_b64_tr_b16 v[204:205], v9 offset:30848
    ds_read_b64_tr_b16 v[206:207], v9 offset:33408
    v_cvt_pk_bf16_f32 v30, v84, v85
    v_cvt_pk_bf16_f32 v31, v86, v87
    s_waitcnt lgkmcnt(13)
    v_cmp_gt_u32 vcc, 3, v14
    s_cbranch_vccz L_lwok_11
L_lwspin_12:
    ds_read_b32 v14, v15 offset:0
    s_waitcnt lgkmcnt(0)
    v_cmp_gt_u32 vcc, 3, v14
    s_cbranch_vccz L_spinout_13
    s_sub_u32 s77, s77, 1
    s_cbranch_scc1 L_spinout_13_x
    s_branch L_lwspin_12
L_spinout_13_x:
    s_mov_b32 s77, 0
L_spinout_13:
L_lwok_11:
    s_mul_i32 s84, s2, 6
    s_add_u32 s84, s84, s93
    s_mov_b32 s88, s48
    s_mov_b32 s89, s49
    s_mov_b32 s90, s50
    s_mov_b32 s91, 0x20000
    s_mov_b32 s85, 871
    s_cmp_lt_u32 s84, 871
    s_cselect_b32 s88, s52, s88
    s_cselect_b32 s89, s53, s89
    s_cselect_b32 s90, s54, s90
    s_cselect_b32 s85, 256, s85
    s_cmp_lt_u32 s84, 256
    s_cselect_b32 s88, s44, s88
    s_cselect_b32 s89, s45, s89
    s_cselect_b32 s90, s46, s90
    s_cselect_b32 s85, 0, s85
    s_sub_u32 s84, s84, s85
    s_mul_i32 s84, s84, 3200
    v_lshlrev_b32 v12, 7, v0
    s_mov_b64 exec, 0x1ffffff
    buffer_load_dword v238, v12, s[88:91], s84 offen
    s_mov_b64 exec, -1
    s_waitcnt lgkmcnt(11)
    v_mfma_f32_16x16x32_bf16 v[160:163], v[188:191], v[28:31], v[160:163]
    ds_read_b64_tr_b16 v[188:189], v10 offset:0
    ds_read_b64_tr_b16 v[190:191], v10 offset:2560
    v_mul_f32 v88, v136, v88
    v_mul_f32 v89, v137, v89
    v_mul_f32 v90, v138, v90
    s_waitcnt lgkmcnt(11)
    v_mfma_f32_16x16x32_bf16 v[164:167], v[192:195], v[28:31], v[164:167]
    ds_read_b64_tr_b16 v[192:193], v10 offset:32
    ds_read_b64_tr_b16 v[194:195], v10 offset:2592
    v_mul_f32 v91, v139, v91
    v_mul_f32 v92, v140, v92
    v_mul_f32 v93, v141, v93
    s_waitcnt lgkmcnt(11)
    v_mfma_f32_16x16x32_bf16 v[168:171], v[196:199], v[28:31], v[168:171]
    v_mfma_f32_16x16x32_bf16 v[180:183], v[196:199], v[156:159], v[180:183]
    ds_read_b64_tr_b16 v[196:197], v10 offset:64
    ds_read_b64_tr_b16 v[198:199], v10 offset:2624
    v_mul_f32 v94, v142, v94
    v_mul_f32 v95, v143, v95
    ds_read_b128 v[136:139], v8 offset:768
    ds_read_b128 v[140:143], v8 offset:784
    s_waitcnt lgkmcnt(10)
    v_mfma_f32_16x16x32_bf16 v[172:175], v[200:203], v[28:31], v[172:175]
    v_mfma_f32_16x16x32_bf16 v[184:187], v[200:203], v[156:159], v[184:187]
    ds_read_b128 v[156:159], v11 offset:320
    ds_read_b64_tr_b16 v[200:201], v10 offset:96
    ds_read_b64_tr_b16 v[202:203], v10 offset:2656
    v_cvt_pk_bf16_f32 v32, v88, v89
    v_cvt_pk_bf16_f32 v33, v90, v91
    s_waitcnt lgkmcnt(11)
    v_mfma_f32_16x16x32_bf16 v[176:179], v[204:207], v[28:31], v[176:179]
    ds_read_b64_tr_b16 v[204:205], v10 offset:128
    ds_read_b64_tr_b16 v[206:207], v10 offset:2688
    v_cvt_pk_bf16_f32 v34, v92, v93
    v_cvt_pk_bf16_f32 v35, v94, v95
    s_waitcnt lgkmcnt(11)
    s_nop 0
    v_mfma_f32_16x16x32_bf16 v[160:163], v[188:191], v[32:35], v[160:163]
    ds_read_b64_tr_b16 v[188:189], v10 offset:10240
    ds_read_b64_tr_b16 v[190:191], v10 offset:12800
    v_mul_f32 v96, v144, v96
    v_mul_f32 v97, v145, v97
    v_mul_f32 v98, v146, v98
    s_waitcnt lgkmcnt(11)
    v_mfma_f32_16x16x32_bf16 v[164:167], v[192:195], v[32:35], v[164:167]
    ds_read_b64_tr_b16 v[192:193], v10 offset:10272
    ds_read_b64_tr_b16 v[194:195], v10 offset:12832
    v_mul_f32 v99, v147, v99
    v_mul_f32 v100, v148, v100
    v_mul_f32 v101, v149, v101
    s_waitcnt lgkmcnt(11)
    v_mfma_f32_16x16x32_bf16 v[168:171], v[196:199], v[32:35], v[168:171]
    v_mfma_f32_16x16x32_bf16 v[180:183], v[196:199], v[152:155], v[180:183]
    ds_read_b64_tr_b16 v[196:197], v10 offset:10304
    ds_read_b64_tr_b16 v[198:199], v10 offset:12864
    v_mul_f32 v102, v150, v102
    v_mul_f32 v103, v151, v103
    ds_read_b128 v[144:147], v8 offset:896
    ds_read_b128 v[148:151], v8 offset:912
    s_waitcnt lgkmcnt(10)
    v_mfma_f32_16x16x32_bf16 v[172:175], v[200:203], v[32:35], v[172:175]
    v_mfma_f32_16x16x32_bf16 v[184:187], v[200:203], v[152:155], v[184:187]
    ds_read_b128 v[152:155], v11 offset:384
    ds_read_b64_tr_b16 v[200:201], v10 offset:10336
    ds_read_b64_tr_b16 v[202:203], v10 offset:12896
    v_cvt_pk_bf16_f32 v36, v96, v97
    v_cvt_pk_bf16_f32 v37, v98, v99
    s_waitcnt lgkmcnt(11)
    v_mfma_f32_16x16x32_bf16 v[176:179], v[204:207], v[32:35], v[176:179]
    ds_read_b64_tr_b16 v[204:205], v10 offset:10368
    ds_read_b64_tr_b16 v[206:207], v10 offset:12928
    v_cvt_pk_bf16_f32 v38, v100, v101
    v_cvt_pk_bf16_f32 v39, v102, v103
    s_waitcnt lgkmcnt(11)
    s_nop 0
    v_mfma_f32_16x16x32_bf16 v[160:163], v[188:191], v[36:39], v[160:163]
    ds_read_b64_tr_b16 v[188:189], v10 offset:20480
    ds_read_b64_tr_b16 v[190:191], v10 offset:23040
    v_mul_f32 v104, v136, v104
    v_mul_f32 v105, v137, v105
    v_mul_f32 v106, v138, v106
    s_waitcnt lgkmcnt(11)
    v_mfma_f32_16x16x32_bf16 v[164:167], v[192:195], v[36:39], v[164:167]
    ds_read_b64_tr_b16 v[192:193], v10 offset:20512
    ds_read_b64_tr_b16 v[194:195], v10 offset:23072
    v_mul_f32 v107, v139, v107
    v_mul_f32 v108, v140, v108
    v_mul_f32 v109, v141, v109
    s_waitcnt lgkmcnt(11)
    v_mfma_f32_16x16x32_bf16 v[168:171], v[196:199], v[36:39], v[168:171]
    v_mfma_f32_16x16x32_bf16 v[180:183], v[196:199], v[156:159], v[180:183]
    ds_read_b64_tr_b16 v[196:197], v10 offset:20544
    ds_read_b64_tr_b16 v[198:199], v10 offset:23104
    v_mul_f32 v110, v142, v110
    v_mul_f32 v111, v143, v111
    ds_read_b128 v[136:139], v8 offset:1024
    ds_read_b128 v[140:143], v8 offset:1040
    s_waitcnt lgkmcnt(10)
    v_mfma_f32_16x16x32_bf16 v[172:175], v[200:203], v[36:39], v[172:175]
    v_mfma_f32_16x16x32_bf16 v[184:187], v[200:203], v[156:159], v[184:187]
    ds_read_b128 v[156:159], v11 offset:448
    ds_read_b64_tr_b16 v[200:201], v10 offset:20576
    ds_read_b64_tr_b16 v[202:203], v10 offset:23136
    v_cvt_pk_bf16_f32 v40, v104, v105
    v_cvt_pk_bf16_f32 v41, v106, v107
    s_waitcnt lgkmcnt(11)
    v_mfma_f32_16x16x32_bf16 v[176:179], v[204:207], v[36:39], v[176:179]
    ds_read_b64_tr_b16 v[204:205], v10 offset:20608
    ds_read_b64_tr_b16 v[206:207], v10 offset:23168
    v_cvt_pk_bf16_f32 v42, v108, v109
    v_cvt_pk_bf16_f32 v43, v110, v111
    ds_read_b32 v14, v15 offset:4
    s_waitcnt lgkmcnt(12)
    v_mfma_f32_16x16x32_bf16 v[160:163], v[188:191], v[40:43], v[160:163]
    ds_read_b64_tr_b16 v[188:189], v10 offset:30720
    ds_read_b64_tr_b16 v[190:191], v10 offset:33280
    v_mul_f32 v112, v144, v112
    v_mul_f32 v113, v145, v113
    v_mul_f32 v114, v146, v114
    s_waitcnt lgkmcnt(12)
    v_mfma_f32_16x16x32_bf16 v[164:167], v[192:195], v[40:43], v[164:167]
    ds_read_b64_tr_b16 v[192:193], v10 offset:30752
    ds_read_b64_tr_b16 v[194:195], v10 offset:33312
    v_mul_f32 v115, v147, v115
    v_mul_f32 v116, v148, v116
    v_mul_f32 v117, v149, v117
    s_waitcnt lgkmcnt(12)
    v_mfma_f32_16x16x32_bf16 v[168:171], v[196:199], v[40:43], v[168:171]
    v_mfma_f32_16x16x32_bf16 v[180:183], v[196:199], v[152:155], v[180:183]
    ds_read_b64_tr_b16 v[196:197], v10 offset:30784
    ds_read_b64_tr_b16 v[198:199], v10 offset:33344
    v_mul_f32 v118, v150, v118
    v_mul_f32 v119, v151, v119
    ds_read_b128 v[144:147], v8 offset:1152
    ds_read_b128 v[148:151], v8 offset:1168
    s_waitcnt lgkmcnt(11)
    v_mfma_f32_16x16x32_bf16 v[172:175], v[200:203], v[40:43], v[172:175]
    v_mfma_f32_16x16x32_bf16 v[184:187], v[200:203], v[152:155], v[184:187]
    ds_read_b128 v[152:155], v11 offset:512
    ds_read_b64_tr_b16 v[200:201], v10 offset:30816
    ds_read_b64_tr_b16 v[202:203], v10 offset:33376
    v_cvt_pk_bf16_f32 v44, v112, v113
    v_cvt_pk_bf16_f32 v45, v114, v115
    s_waitcnt lgkmcnt(12)
    v_mfma_f32_16x16x32_bf16 v[176:179], v[204:207], v[40:43], v[176:179]
    ds_read_b64_tr_b16 v[204:205], v10 offset:30848
    ds_read_b64_tr_b16 v[206:207], v10 offset:33408
    v_cvt_pk_bf16_f32 v46, v116, v117
    v_cvt_pk_bf16_f32 v47, v118, v119
    s_waitcnt lgkmcnt(13)
    v_cmp_gt_u32 vcc, 4, v14
    s_cbranch_vccz L_lwok_14
L_lwspin_15:
    ds_read_b32 v14, v15 offset:4
    s_waitcnt lgkmcnt(0)
    v_cmp_gt_u32 vcc, 4, v14
    s_cbranch_vccz L_spinout_16
    s_sub_u32 s77, s77, 1
    s_cbranch_scc1 L_spinout_16_x
    s_branch L_lwspin_15
L_spinout_16_x:
    s_mov_b32 s77, 0
L_spinout_16:
L_lwok_14:
    s_waitcnt lgkmcnt(11)
    v_mfma_f32_16x16x32_bf16 v[160:163], v[188:191], v[44:47], v[160:163]
    ds_read_b64_tr_b16 v[188:189], v10 offset:40960
    ds_read_b64_tr_b16 v[190:191], v10 offset:43520
    v_mul_f32 v120, v136, v120
    v_mul_f32 v121, v137, v121
    v_mul_f32 v122, v138, v122
    s_waitcnt lgkmcnt(11)
    v_mfma_f32_16x16x32_bf16 v[164:167], v[192:195], v[44:47], v[164:167]
    ds_read_b64_tr_b16 v[192:193], v10 offset:40992
    ds_read_b64_tr_b16 v[194:195], v10 offset:43552
    v_mul_f32 v123, v139, v123
    v_mul_f32 v124, v140, v124
    v_mul_f32 v125, v141, v125
    s_waitcnt lgkmcnt(11)
    v_mfma_f32_16x16x32_bf16 v[168:171], v[196:199], v[44:47], v[168:171]
    v_mfma_f32_16x16x32_bf16 v[180:183], v[196:199], v[156:159], v[180:183]
    ds_read_b64_tr_b16 v[196:197], v10 offset:41024
    ds_read_b64_tr_b16 v[198:199], v10 offset:43584
    v_mul_f32 v126, v142, v126
    v_mul_f32 v127, v143, v127
    s_waitcnt lgkmcnt(8)
    v_mfma_f32_16x16x32_bf16 v[172:175], v[200:203], v[44:47], v[172:175]
    v_mfma_f32_16x16x32_bf16 v[184:187], v[200:203], v[156:159], v[184:187]
    ds_read_b128 v[156:159], v11 offset:576
    ds_read_b64_tr_b16 v[200:201], v10 offset:41056
    ds_read_b64_tr_b16 v[202:203], v10 offset:43616
    v_cvt_pk_bf16_f32 v48, v120, v121
    v_cvt_pk_bf16_f32 v49, v122, v123
    s_waitcnt lgkmcnt(9)
    v_mfma_f32_16x16x32_bf16 v[176:179], v[204:207], v[44:47], v[176:179]
    ds_read_b64_tr_b16 v[204:205], v10 offset:41088
    ds_read_b64_tr_b16 v[206:207], v10 offset:43648
    v_cvt_pk_bf16_f32 v50, v124, v125
    v_cvt_pk_bf16_f32 v51, v126, v127
    s_waitcnt lgkmcnt(9)
    s_nop 0
    v_mfma_f32_16x16x32_bf16 v[160:163], v[188:191], v[48:51], v[160:163]
    ds_read_b64_tr_b16 v[188:189], v10 offset:51200
    ds_read_b64_tr_b16 v[190:191], v10 offset:53760
    v_mul_f32 v128, v144, v128
    v_mul_f32 v129, v145, v129
    v_mul_f32 v130, v146, v130
    s_waitcnt lgkmcnt(9)
    v_mfma_f32_16x16x32_bf16 v[164:167], v[192:195], v[48:51], v[164:167]
    ds_read_b64_tr_b16 v[192:193], v10 offset:51232
    ds_read_b64_tr_b16 v[194:195], v10 offset:53792
    v_mul_f32 v131, v147, v131
    v_mul_f32 v132, v148, v132
    v_mul_f32 v133, v149, v133
    s_waitcnt lgkmcnt(9)
    v_mfma_f32_16x16x32_bf16 v[168:171], v[196:199], v[48:51], v[168:171]
    v_mfma_f32_16x16x32_bf16 v[180:183], v[196:199], v[152:155], v[180:183]
    ds_read_b64_tr_b16 v[196:197], v10 offset:51264
    ds_read_b64_tr_b16 v[198:199], v10 offset:53824
    v_mul_f32 v134, v150, v134
    v_mul_f32 v135, v151, v135
    s_waitcnt lgkmcnt(8)
    v_mfma_f32_16x16x32_bf16 v[172:175], v[200:203], v[48:51], v[172:175]
    v_mfma_f32_16x16x32_bf16 v[184:187], v[200:203], v[152:155], v[184:187]
    ds_read_b64_tr_b16 v[200:201], v10 offset:51296
    ds_read_b64_tr_b16 v[202:203], v10 offset:53856
    v_cvt_pk_bf16_f32 v52, v128, v129
    v_cvt_pk_bf16_f32 v53, v130, v131
    s_waitcnt lgkmcnt(8)
    v_mfma_f32_16x16x32_bf16 v[176:179], v[204:207], v[48:51], v[176:179]
    ds_read_b64_tr_b16 v[204:205], v10 offset:51328
    ds_read_b64_tr_b16 v[206:207], v10 offset:53888
    v_cvt_pk_bf16_f32 v54, v132, v133
    v_cvt_pk_bf16_f32 v55, v134, v135
    s_waitcnt lgkmcnt(8)
    s_nop 0
    v_mfma_f32_16x16x32_bf16 v[160:163], v[188:191], v[52:55], v[160:163]
    s_waitcnt lgkmcnt(6)
    v_mfma_f32_16x16x32_bf16 v[164:167], v[192:195], v[52:55], v[164:167]
    s_waitcnt lgkmcnt(4)
    v_mfma_f32_16x16x32_bf16 v[168:171], v[196:199], v[52:55], v[168:171]
    v_mfma_f32_16x16x32_bf16 v[180:183], v[196:199], v[156:159], v[180:183]
    s_waitcnt lgkmcnt(2)
    v_mfma_f32_16x16x32_bf16 v[172:175], v[200:203], v[52:55], v[172:175]
    v_mfma_f32_16x16x32_bf16 v[184:187], v[200:203], v[156:159], v[184:187]
    s_waitcnt lgkmcnt(0)
    v_mfma_f32_16x16x32_bf16 v[176:179], v[204:207], v[52:55], v[176:179]
    ds_read_b64 v[12:13], v234
    v_bfe_u32 v15, v0, 3, 1
    v_mul_u32_u24 v15, 320, v15
    v_lshrrev_b32 v14, 4, v0
    v_lshl_add_u32 v15, v14, 4, v15
    s_mul_i32 s84, s86, 640
    s_add_u32 s84, s84, 132096
    v_add_u32 v15, s84, v15
    s_waitcnt lgkmcnt(0)
    v_add_f32 v12, v12, v232
    v_add_f32 v13, v13, v233
    v_mul_f32 v12, 0x3acccccd, v12
    v_mul_f32 v13, 0x3acccccd, v13
    v_fma_f32 v13, -v12, v12, v13
    v_max_f32 v13, 0, v13
    v_add_f32 v13, 0x3727c5ac, v13
    v_rsq_f32 v232, v13
    v_and_b32 v14, 15, v0
    s_lshr_b32 s84, s74, 1
    s_lshl_b32 s84, s84, 7
    s_add_u32 s84, s84, 133376
    v_mul_f32_e64 v233, -v12, v232
    v_lshl_add_u32 v14, v14, 3, s84
    ds_write_b64 v14, v[232:233]
    s_mov_b32 exec_lo, 0x01010101
    s_mov_b32 exec_hi, 0x01010101
    ds_write_b128 v15, v[180:183] offset:128
    ds_write_b128 v15, v[184:187] offset:192
    s_mov_b64 exec, -1
    s_branch L_qdone
L_q2:
    ds_read_b64_tr_b16 v[188:189], v9 offset:0
    ds_read_b64_tr_b16 v[190:191], v9 offset:2560
    ds_read_b64_tr_b16 v[192:193], v9 offset:32
    ds_read_b64_tr_b16 v[194:195], v9 offset:2592
    ds_read_b64_tr_b16 v[196:197], v9 offset:64
    ds_read_b64_tr_b16 v[198:199], v9 offset:2624
    ds_read_b64_tr_b16 v[200:201], v9 offset:96
    ds_read_b64_tr_b16 v[202:203], v9 offset:2656
    ds_read_b64_tr_b16 v[204:205], v9 offset:128
    ds_read_b64_tr_b16 v[206:207], v9 offset:2688
    s_waitcnt lgkmcnt(14)
    v_mul_f32 v56, v136, v56
    v_mul_f32 v57, v137, v57
    v_mul_f32 v58, v138, v58
    v_mul_f32 v59, v139, v59
    v_mul_f32 v60, v140, v60
    v_mul_f32 v61, v141, v61
    v_mul_f32 v62, v142, v62
    v_mul_f32 v63, v143, v63
    ds_read_b128 v[136:139], v8 offset:256
    ds_read_b128 v[140:143], v8 offset:272
    v_cvt_pk_bf16_f32 v16, v56, v57
    v_cvt_pk_bf16_f32 v17, v58, v59
    v_cvt_pk_bf16_f32 v18, v60, v61
    v_cvt_pk_bf16_f32 v19, v62, v63
    s_cmp_lg_u32 s93, 5
    s_cbranch_scc1 L_lwa_17
    v_mov_b32 v14, 1
    s_waitcnt vmcnt(0)
    s_mov_b64 exec, 1
    ds_add_u32 v15, v14 offset:0
    s_mov_b64 exec, -1
L_lwa_17:
    s_waitcnt lgkmcnt(10)
    v_mfma_f32_16x16x32_bf16 v[160:163], v[188:191], v[16:19], 0
    ds_read_b64_tr_b16 v[188:189], v9 offset:10240
    ds_read_b64_tr_b16 v[190:191], v9 offset:12800
    v_mul_f32 v64, v144, v64
    v_mul_f32 v65, v145, v65
    v_mul_f32 v66, v146, v66
    s_waitcnt lgkmcnt(10)
    v_mfma_f32_16x16x32_bf16 v[164:167], v[192:195], v[16:19], 0
    ds_read_b64_tr_b16 v[192:193], v9 offset:10272
    ds_read_b64_tr_b16 v[194:195], v9 offset:12832
    v_mul_f32 v67, v147, v67
    v_mul_f32 v68, v148, v68
    v_mul_f32 v69, v149, v69
    s_waitcnt lgkmcnt(10)
    v_mfma_f32_16x16x32_bf16 v[168:171], v[196:199], v[16:19], 0
    ds_read_b64_tr_b16 v[196:197], v9 offset:10304
    ds_read_b64_tr_b16 v[198:199], v9 offset:12864
    v_mul_f32 v70, v150, v70
    v_mul_f32 v71, v151, v71
    ds_read_b128 v[144:147], v8 offset:384
    ds_read_b128 v[148:151], v8 offset:400
    s_waitcnt lgkmcnt(12)
    v_mfma_f32_16x16x32_bf16 v[172:175], v[200:203], v[16:19], 0
    ds_read_b64_tr_b16 v[200:201], v9 offset:10336
    ds_read_b64_tr_b16 v[202:203], v9 offset:12896
    v_cvt_pk_bf16_f32 v20, v64, v65
    v_cvt_pk_bf16_f32 v21, v66, v67
    s_waitcnt lgkmcnt(12)
    v_mfma_f32_16x16x32_bf16 v[176:179], v[204:207], v[16:19], 0
    v_mfma_f32_16x16x32_bf16 v[180:183], v[204:207], v[152:155], 0
    ds_read_b128 v[152:155], v11 offset:128
    ds_read_b64_tr_b16 v[204:205], v9 offset:10368
    ds_read_b64_tr_b16 v[206:207], v9 offset:12928
    v_cvt_pk_bf16_f32 v22, v68, v69
    v_cvt_pk_bf16_f32 v23, v70, v71
    s_waitcnt lgkmcnt(11)
    s_nop 0
    v_mfma_f32_16x16x32_bf16 v[160:163], v[188:191], v[20:23], v[160:163]
    ds_read_b64_tr_b16 v[188:189], v9 offset:20480
    ds_read_b64_tr_b16 v[190:191], v9 offset:23040
    v_mul_f32 v72, v136, v72
    v_mul_f32 v73, v137, v73
    v_mul_f32 v74, v138, v74
    s_waitcnt lgkmcnt(11)
    v_mfma_f32_16x16x32_bf16 v[164:167], v[192:195], v[20:23], v[164:167]
    ds_read_b64_tr_b16 v[192:193], v9 offset:20512
    ds_read_b64_tr_b16 v[194:195], v9 offset:23072
    v_mul_f32 v75, v139, v75
    v_mul_f32 v76, v140, v76
    v_mul_f32 v77, v141, v77
    s_waitcnt lgkmcnt(11)
    v_mfma_f32_16x16x32_bf16 v[168:171], v[196:199], v[20:23], v[168:171]
    ds_read_b64_tr_b16 v[196:197], v9 offset:20544
    ds_read_b64_tr_b16 v[198:199], v9 offset:23104
    v_mul_f32 v78, v142, v78
    v_mul_f32 v79, v143, v79
    ds_read_b128 v[136:139], v8 offset:512
    ds_read_b128 v[140:143], v8 offset:528
    s_waitcnt lgkmcnt(11)
    v_mfma_f32_16x16x32_bf16 v[172:175], v[200:203], v[20:23], v[172:175]
    ds_read_b64_tr_b16 v[200:201], v9 offset:20576
    ds_read_b64_tr_b16 v[202:203], v9 offset:23136
    v_cvt_pk_bf16_f32 v24, v72, v73
    v_cvt_pk_bf16_f32 v25, v74, v75
    s_waitcnt lgkmcnt(10)
    v_mfma_f32_16x16x32_bf16 v[176:179], v[204:207], v[20:23], v[176:179]
    v_mfma_f32_16x16x32_bf16 v[180:183], v[204:207], v[156:159], v[180:183]
    ds_read_b128 v[156:159], v11 offset:192
    ds_read_b64_tr_b16 v[204:205], v9 offset:20608
    ds_read_b64_tr_b16 v[206:207], v9 offset:23168
    v_cvt_pk_bf16_f32 v26, v76, v77
    v_cvt_pk_bf16_f32 v27, v78, v79
    ds_read_b32 v14, v15 offset:0
    s_waitcnt lgkmcnt(12)
    v_mfma_f32_16x16x32_bf16 v[160:163], v[188:191], v[24:27], v[160:163]
    ds_read_b64_tr_b16 v[188:189], v9 offset:30720
    ds_read_b64_tr_b16 v[190:191], v9 offset:33280
    v_mul_f32 v80, v144, v80
    v_mul_f32 v81, v145, v81
    v_mul_f32 v82, v146, v82
    s_waitcnt lgkmcnt(12)
    v_mfma_f32_16x16x32_bf16 v[164:167], v[192:195], v[24:27], v[164:167]
    ds_read_b64_tr_b16 v[192:193], v9 offset:30752
    ds_read_b64_tr_b16 v[194:195], v9 offset:33312
    v_mul_f32 v83, v147, v83
    v_mul_f32 v84, v148, v84
    v_mul_f32 v85, v149, v85
    s_waitcnt lgkmcnt(12)
    v_mfma_f32_16x16x32_bf16 v[168:171], v[196:199], v[24:27], v[168:171]
    ds_read_b64_tr_b16 v[196:197], v9 offset:30784
    ds_read_b64_tr_b16 v[198:199], v9 offset:33344
    v_mul_f32 v86, v150, v86
    v_mul_f32 v87, v151, v87
    ds_read_b128 v[144:147], v8 offset:640
    ds_read_b128 v[148:151], v8 offset:656
    s_waitcnt lgkmcnt(12)
    v_mfma_f32_16x16x32_bf16 v[172:175], v[200:203], v[24:27], v[172:175]
    ds_read_b64_tr_b16 v[200:201], v9 offset:30816
    ds_read_b64_tr_b16 v[202:203], v9 offset:33376
    v_cvt_pk_bf16_f32 v28, v80, v81
    v_cvt_pk_bf16_f32 v29, v82, v83
    s_waitcnt lgkmcnt(11)
    v_mfma_f32_16x16x32_bf16 v[176:179], v[204:207], v[24:27], v[176:179]
    v_mfma_f32_16x16x32_bf16 v[180:183], v[204:207], v[152:155], v[180:183]
    ds_read_b128 v[152:155], v11 offset:256
    ds_read_b64_tr_b16 v[204:205], v9 offset:30848
    ds_read_b64_tr_b16 v[206:207], v9 offset:33408
    v_cvt_pk_bf16_f32 v30, v84, v85
    v_cvt_pk_bf16_f32 v31, v86, v87
    s_waitcnt lgkmcnt(13)
    v_cmp_gt_u32 vcc, 3, v14
    s_cbranch_vccz L_lwok_18
L_lwspin_19:
    ds_read_b32 v14, v15 offset:0
    s_waitcnt lgkmcnt(0)
    v_cmp_gt_u32 vcc, 3, v14
    s_cbranch_vccz L_spinout_20
    s_sub_u32 s77, s77, 1
    s_cbranch_scc1 L_spinout_20_x
    s_branch L_lwspin_19
L_spinout_20_x:
    s_mov_b32 s77, 0
L_spinout_20:
L_lwok_18:
    s_mul_i32 s84, s2, 6
    s_add_u32 s84, s84, s93
    s_mov_b32 s88, s48
    s_mov_b32 s89, s49
    s_mov_b32 s90, s50
    s_mov_b32 s91, 0x20000
    s_mov_b32 s85, 871
    s_cmp_lt_u32 s84, 871
    s_cselect_b32 s88, s52, s88
    s_cselect_b32 s89, s53, s89
    s_cselect_b32 s90, s54, s90
    s_cselect_b32 s85, 256, s85
    s_cmp_lt_u32 s84, 256
    s_cselect_b32 s88, s44, s88
    s_cselect_b32 s89, s45, s89
    s_cselect_b32 s90, s46, s90
    s_cselect_b32 s85, 0, s85
    s_sub_u32 s84, s84, s85
    s_mul_i32 s84, s84, 3200
    v_lshlrev_b32 v12, 7, v0
    s_mov_b64 exec, 0x1ffffff
    buffer_load_dword v238, v12, s[88:91], s84 offen
    s_mov_b64 exec, -1
    s_waitcnt lgkmcnt(11)
    v_mfma_f32_16x16x32_bf16 v[160:163], v[188:191], v[28:31], v[160:163]
    ds_read_b64_tr_b16 v[188:189], v10 offset:0
    ds_read_b64_tr_b16 v[190:191], v10 offset:2560
    v_mul_f32 v88, v136, v88
    v_mul_f32 v89, v137, v89
    v_mul_f32 v90, v138, v90
    s_waitcnt lgkmcnt(11)
    v_mfma_f32_16x16x32_bf16 v[164:167], v[192:195], v[28:31], v[164:167]
    ds_read_b64_tr_b16 v[192:193], v10 offset:32
    ds_read_b64_tr_b16 v[194:195], v10 offset:2592
    v_mul_f32 v91, v139, v91
    v_mul_f32 v92, v140, v92
    v_mul_f32 v93, v141, v93
    s_waitcnt lgkmcnt(11)
    v_mfma_f32_16x16x32_bf16 v[168:171], v[196:199], v[28:31], v[168:171]
    ds_read_b64_tr_b16 v[196:197], v10 offset:64
    ds_read_b64_tr_b16 v[198:199], v10 offset:2624
    v_mul_f32 v94, v142, v94
    v_mul_f32 v95, v143, v95
    ds_read_b128 v[136:139], v8 offset:768
    ds_read_b128 v[140:143], v8 offset:784
    s_waitcnt lgkmcnt(11)
    v_mfma_f32_16x16x32_bf16 v[172:175], v[200:203], v[28:31], v[172:175]
    ds_read_b64_tr_b16 v[200:201], v10 offset:96
    ds_read_b64_tr_b16 v[202:203], v10 offset:2656
    v_cvt_pk_bf16_f32 v32, v88, v89
    v_cvt_pk_bf16_f32 v33, v90, v91
    s_waitcnt lgkmcnt(10)
    v_mfma_f32_16x16x32_bf16 v[176:179], v[204:207], v[28:31], v[176:179]
    v_mfma_f32_16x16x32_bf16 v[180:183], v[204:207], v[156:159], v[180:183]
    ds_read_b128 v[156:159], v11 offset:320
    ds_read_b64_tr_b16 v[204:205], v10 offset:128
    ds_read_b64_tr_b16 v[206:207], v10 offset:2688
    v_cvt_pk_bf16_f32 v34, v92, v93
    v_cvt_pk_bf16_f32 v35, v94, v95
    s_waitcnt lgkmcnt(11)
    s_nop 0
    v_mfma_f32_16x16x32_bf16 v[160:163], v[188:191], v[32:35], v[160:163]
    ds_read_b64_tr_b16 v[188:189], v10 offset:10240
    ds_read_b64_tr_b16 v[190:191], v10 offset:12800
    v_mul_f32 v96, v144, v96
    v_mul_f32 v97, v145, v97
    v_mul_f32 v98, v146, v98
    s_waitcnt lgkmcnt(11)
    v_mfma_f32_16x16x32_bf16 v[164:167], v[192:195], v[32:35], v[164:167]
    ds_read_b64_tr_b16 v[192:193], v10 offset:10272
    ds_read_b64_tr_b16 v[194:195], v10 offset:12832
    v_mul_f32 v99, v147, v99
    v_mul_f32 v100, v148, v100
    v_mul_f32 v101, v149, v101
    s_waitcnt lgkmcnt(11)
    v_mfma_f32_16x16x32_bf16 v[168:171], v[196:199], v[32:35], v[168:171]
    ds_read_b64_tr_b16 v[196:197], v10 offset:10304
    ds_read_b64_tr_b16 v[198:199], v10 offset:12864
    v_mul_f32 v102, v150, v102
    v_mul_f32 v103, v151, v103
    ds_read_b128 v[144:147], v8 offset:896
    ds_read_b128 v[148:151], v8 offset:912
    s_waitcnt lgkmcnt(11)
    v_mfma_f32_16x16x32_bf16 v[172:175], v[200:203], v[32:35], v[172:175]
    ds_read_b64_tr_b16 v[200:201], v10 offset:10336
    ds_read_b64_tr_b16 v[202:203], v10 offset:12896
    v_cvt_pk_bf16_f32 v36, v96, v97
    v_cvt_pk_bf16_f32 v37, v98, v99
    s_waitcnt lgkmcnt(10)
    v_mfma_f32_16x16x32_bf16 v[176:179], v[204:207], v[32:35], v[176:179]
    v_mfma_f32_16x16x32_bf16 v[180:183], v[204:207], v[152:155], v[180:183]
    ds_read_b128 v[152:155], v11 offset:384
    ds_read_b64_tr_b16 v[204:205], v10 offset:10368
    ds_read_b64_tr_b16 v[206:207], v10 offset:12928
    v_cvt_pk_bf16_f32 v38, v100, v101
    v_cvt_pk_bf16_f32 v39, v102, v103
    s_waitcnt lgkmcnt(11)
    s_nop 0
    v_mfma_f32_16x16x32_bf16 v[160:163], v[188:191], v[36:39], v[160:163]
    ds_read_b64_tr_b16 v[188:189], v10 offset:20480
    ds_read_b64_tr_b16 v[190:191], v10 offset:23040
    v_mul_f32 v104, v136, v104
    v_mul_f32 v105, v137, v105
    v_mul_f32 v106, v138, v106
    s_waitcnt lgkmcnt(11)
    v_mfma_f32_16x16x32_bf16 v[164:167], v[192:195], v[36:39], v[164:167]
    ds_read_b64_tr_b16 v[192:193], v10 offset:20512
    ds_read_b64_tr_b16 v[194:195], v10 offset:23072
    v_mul_f32 v107, v139, v107
    v_mul_f32 v108, v140, v108
    v_mul_f32 v109, v141, v109
    s_waitcnt lgkmcnt(11)
    v_mfma_f32_16x16x32_bf16 v[168:171], v[196:199], v[36:39], v[168:171]
    ds_read_b64_tr_b16 v[196:197], v10 offset:20544
    ds_read_b64_tr_b16 v[198:199], v10 offset:23104
    v_mul_f32 v110, v142, v110
    v_mul_f32 v111, v143, v111
    ds_read_b128 v[136:139], v8 offset:1024
    ds_read_b128 v[140:143], v8 offset:1040
    s_waitcnt lgkmcnt(11)
    v_mfma_f32_16x16x32_bf16 v[172:175], v[200:203], v[36:39], v[172:175]
    ds_read_b64_tr_b16 v[200:201], v10 offset:20576
    ds_read_b64_tr_b16 v[202:203], v10 offset:23136
    v_cvt_pk_bf16_f32 v40, v104, v105
    v_cvt_pk_bf16_f32 v41, v106, v107
    s_waitcnt lgkmcnt(10)
    v_mfma_f32_16x16x32_bf16 v[176:179], v[204:207], v[36:39], v[176:179]
    v_mfma_f32_16x16x32_bf16 v[180:183], v[204:207], v[156:159], v[180:183]
    ds_read_b128 v[156:159], v11 offset:448
    ds_read_b64_tr_b16 v[204:205], v10 offset:20608
    ds_read_b64_tr_b16 v[206:207], v10 offset:23168
    v_cvt_pk_bf16_f32 v42, v108, v109
    v_cvt_pk_bf16_f32 v43, v110, v111
    ds_read_b32 v14, v15 offset:4
    s_waitcnt lgkmcnt(12)
    v_mfma_f32_16x16x32_bf16 v[160:163], v[188:191], v[40:43], v[160:163]
    ds_read_b64_tr_b16 v[188:189], v10 offset:30720
    ds_read_b64_tr_b16 v[190:191], v10 offset:33280
    v_mul_f32 v112, v144, v112
    v_mul_f32 v113, v145, v113
    v_mul_f32 v114, v146, v114
    s_waitcnt lgkmcnt(12)
    v_mfma_f32_16x16x32_bf16 v[164:167], v[192:195], v[40:43], v[164:167]
    ds_read_b64_tr_b16 v[192:193], v10 offset:30752
    ds_read_b64_tr_b16 v[194:195], v10 offset:33312
    v_mul_f32 v115, v147, v115
    v_mul_f32 v116, v148, v116
    v_mul_f32 v117, v149, v117
    s_waitcnt lgkmcnt(12)
    v_mfma_f32_16x16x32_bf16 v[168:171], v[196:199], v[40:43], v[168:171]
    ds_read_b64_tr_b16 v[196:197], v10 offset:30784
    ds_read_b64_tr_b16 v[198:199], v10 offset:33344
    v_mul_f32 v118, v150, v118
    v_mul_f32 v119, v151, v119
    ds_read_b128 v[144:147], v8 offset:1152
    ds_read_b128 v[148:151], v8 offset:1168
    s_waitcnt lgkmcnt(12)
    v_mfma_f32_16x16x32_bf16 v[172:175], v[200:203], v[40:43], v[172:175]
    ds_read_b64_tr_b16 v[200:201], v10 offset:30816
    ds_read_b64_tr_b16 v[202:203], v10 offset:33376
    v_cvt_pk_bf16_f32 v44, v112, v113
    v_cvt_pk_bf16_f32 v45, v114, v115
    s_waitcnt lgkmcnt(11)
    v_mfma_f32_16x16x32_bf16 v[176:179], v[204:207], v[40:43], v[176:179]
    v_mfma_f32_16x16x32_bf16 v[180:183], v[204:207], v[152:155], v[180:183]
    ds_read_b128 v[152:155], v11 offset:512
    ds_read_b64_tr_b16 v[204:205], v10 offset:30848
    ds_read_b64_tr_b16 v[206:207], v10 offset:33408
    v_cvt_pk_bf16_f32 v46, v116, v117
    v_cvt_pk_bf16_f32 v47, v118, v119
    s_waitcnt lgkmcnt(13)
    v_cmp_gt_u32 vcc, 4, v14
    s_cbranch_vccz L_lwok_21
L_lwspin_22:
    ds_read_b32 v14, v15 offset:4
    s_waitcnt lgkmcnt(0)
    v_cmp_gt_u32 vcc, 4, v14
    s_cbranch_vccz L_spinout_23
    s_sub_u32 s77, s77, 1
    s_cbranch_scc1 L_spinout_23_x
    s_branch L_lwspin_22
L_spinout_23_x:
    s_mov_b32 s77, 0
L_spinout_23:
L_lwok_21:
    s_waitcnt lgkmcnt(11)
    v_mfma_f32_16x16x32_bf16 v[160:163], v[188:191], v[44:47], v[160:163]
    ds_read_b64_tr_b16 v[188:189], v10 offset:40960
    ds_read_b64_tr_b16 v[190:191], v10 offset:43520
    v_mul_f32 v120, v136, v120
    v_mul_f32 v121, v137, v121
    v_mul_f32 v122, v138, v122
    s_waitcnt lgkmcnt(11)
    v_mfma_f32_16x16x32_bf16 v[164:167], v[192:195], v[44:47], v[164:167]
    ds_read_b64_tr_b16 v[192:193], v10 offset:40992
    ds_read_b64_tr_b16 v[194:195], v10 offset:43552
    v_mul_f32 v123, v139, v123
    v_mul_f32 v124, v140, v124
    v_mul_f32 v125, v141, v125
    s_waitcnt lgkmcnt(11)
    v_mfma_f32_16x16x32_bf16 v[168:171], v[196:199], v[44:47], v[168:171]
    ds_read_b64_tr_b16 v[196:197], v10 offset:41024
    ds_read_b64_tr_b16 v[198:199], v10 offset:43584
    v_mul_f32 v126, v142, v126
    v_mul_f32 v127, v143, v127
    s_waitcnt lgkmcnt(9)
    v_mfma_f32_16x16x32_bf16 v[172:175], v[200:203], v[44:47], v[172:175]
    ds_read_b64_tr_b16 v[200:201], v10 offset:41056
    ds_read_b64_tr_b16 v[202:203], v10 offset:43616
    v_cvt_pk_bf16_f32 v48, v120, v121
    v_cvt_pk_bf16_f32 v49, v122, v123
    s_waitcnt lgkmcnt(8)
    v_mfma_f32_16x16x32_bf16 v[176:179], v[204:207], v[44:47], v[176:179]
    v_mfma_f32_16x16x32_bf16 v[180:183], v[204:207], v[156:159], v[180:183]
    ds_read_b128 v[156:159], v11 offset:576
    ds_read_b64_tr_b16 v[204:205], v10 offset:41088
    ds_read_b64_tr_b16 v[206:207], v10 offset:43648
    v_cvt_pk_bf16_f32 v50, v124, v125
    v_cvt_pk_bf16_f32 v51, v126, v127
    s_waitcnt lgkmcnt(9)
    s_nop 0
    v_mfma_f32_16x16x32_bf16 v[160:163], v[188:191], v[48:51], v[160:163]
    ds_read_b64_tr_b16 v[188:189], v10 offset:51200
    ds_read_b64_tr_b16 v[190:191], v10 offset:53760
    v_mul_f32 v128, v144, v128
    v_mul_f32 v129, v145, v129
    v_mul_f32 v130, v146, v130
    s_waitcnt lgkmcnt(9)
    v_mfma_f32_16x16x32_bf16 v[164:167], v[192:195], v[48:51], v[164:167]
    ds_read_b64_tr_b16 v[192:193], v10 offset:51232
    ds_read_b64_tr_b16 v[194:195], v10 offset:53792
    v_mul_f32 v131, v147, v131
    v_mul_f32 v132, v148, v132
    v_mul_f32 v133, v149, v133
    s_waitcnt lgkmcnt(9)
    v_mfma_f32_16x16x32_bf16 v[168:171], v[196:199], v[48:51], v[168:171]
    ds_read_b64_tr_b16 v[196:197], v10 offset:51264
    ds_read_b64_tr_b16 v[198:199], v10 offset:53824
    v_mul_f32 v134, v150, v134
    v_mul_f32 v135, v151, v135
    s_waitcnt lgkmcnt(9)
    v_mfma_f32_16x16x32_bf16 v[172:175], v[200:203], v[48:51], v[172:175]
    ds_read_b64_tr_b16 v[200:201], v10 offset:51296
    ds_read_b64_tr_b16 v[202:203], v10 offset:53856
    v_cvt_pk_bf16_f32 v52, v128, v129
    v_cvt_pk_bf16_f32 v53, v130, v131
    s_waitcnt lgkmcnt(8)
    v_mfma_f32_16x16x32_bf16 v[176:179], v[204:207], v[48:51], v[176:179]
    v_mfma_f32_16x16x32_bf16 v[180:183], v[204:207], v[152:155], v[180:183]
    ds_read_b64_tr_b16 v[204:205], v10 offset:51328
    ds_read_b64_tr_b16 v[206:207], v10 offset:53888
    v_cvt_pk_bf16_f32 v54, v132, v133
    v_cvt_pk_bf16_f32 v55, v134, v135
    s_waitcnt lgkmcnt(8)
    s_nop 0
    v_mfma_f32_16x16x32_bf16 v[160:163], v[188:191], v[52:55], v[160:163]
    s_waitcnt lgkmcnt(6)
    v_mfma_f32_16x16x32_bf16 v[164:167], v[192:195], v[52:55], v[164:167]
    s_waitcnt lgkmcnt(4)
    v_mfma_f32_16x16x32_bf16 v[168:171], v[196:199], v[52:55], v[168:171]
    s_waitcnt lgkmcnt(2)
    v_mfma_f32_16x16x32_bf16 v[172:175], v[200:203], v[52:55], v[172:175]
    s_waitcnt lgkmcnt(0)
    v_mfma_f32_16x16x32_bf16 v[176:179], v[204:207], v[52:55], v[176:179]
    v_mfma_f32_16x16x32_bf16 v[180:183], v[204:207], v[156:159], v[180:183]
    ds_read_b64 v[12:13], v234
    v_bfe_u32 v15, v0, 3, 1
    v_mul_u32_u24 v15, 320, v15
    v_lshrrev_b32 v14, 4, v0
    v_lshl_add_u32 v15, v14, 4, v15
    s_mul_i32 s84, s86, 640
    s_add_u32 s84, s84, 132096
    v_add_u32 v15, s84, v15
    s_waitcnt lgkmcnt(0)
    v_add_f32 v12, v12, v232
    v_add_f32 v13, v13, v233
    v_mul_f32 v12, 0x3acccccd, v12
    v_mul_f32 v13, 0x3acccccd, v13
    v_fma_f32 v13, -v12, v12, v13
    v_max_f32 v13, 0, v13
    v_add_f32 v13, 0x3727c5ac, v13
    v_rsq_f32 v232, v13
    v_and_b32 v14, 15, v0
    s_lshr_b32 s84, s74, 1
    s_lshl_b32 s84, s84, 7
    s_add_u32 s84, s84, 133376
    v_mul_f32_e64 v233, -v12, v232
    v_lshl_add_u32 v14, v14, 3, s84
    ds_write_b64 v14, v[232:233]
    s_mov_b32 exec_lo, 0x01010101
    s_mov_b32 exec_hi, 0x01010101
    ds_write_b128 v15, v[180:183] offset:256
    s_mov_b64 exec, -1
    s_branch L_qdone
L_kvwave:
    s_setprio 2
    v_mov_b32 v14, 1
    s_waitcnt vmcnt(0)
    s_mov_b64 exec, 1
    ds_add_u32 v15, v14
    s_mov_b64 exec, -1
    s_cmp_lg_u32 s93, 7
    s_cbranch_scc1 L_skip_mt
    s_mul_i32 s84, s2, 100
    s_add_u32 s84, s84, 0
    v_add_u32 v12, s84, v0
    v_mul_u32_u24 v13, 52429, v12
    v_lshrrev_b32 v13, 21, v13
    v_mul_u32_u24 v13, 20, v13
    v_add3_u32 v12, v12, v13, 20
    v_lshlrev_b32 v12, 7, v12
    s_mov_b32 m0, 163328
    s_mov_b32 exec_hi, 0x3ffff
    buffer_load_dword v12, s[64:67], 0 offen lds
    s_mov_b64 exec, -1
    s_mul_i32 s84, s2, 100
    s_add_u32 s84, s84, 50
    v_add_u32 v12, s84, v0
    v_mul_u32_u24 v13, 52429, v12
    v_lshrrev_b32 v13, 21, v13
    v_mul_u32_u24 v13, 20, v13
    v_add3_u32 v12, v12, v13, 20
    v_lshlrev_b32 v12, 7, v12
    s_mov_b32 m0, 163328
    s_mov_b32 exec_hi, 0x3ffff
    buffer_load_dword v12, s[64:67], 0 offen lds
    s_mov_b64 exec, -1
L_skip_mt:
    ds_read_b64 v[12:13], v234
    s_cmp_ge_u32 s73, 4
    s_cbranch_scc1 L_vwave
    s_waitcnt lgkmcnt(6)
    v_mul_f32 v56, v136, v56
    v_mul_f32 v57, v137, v57
    v_mul_f32 v58, v138, v58
    v_mul_f32 v59, v139, v59
    v_mul_f32 v60, v140, v60
    v_mul_f32 v61, v141, v61
    v_mul_f32 v62, v142, v62
    v_mul_f32 v63, v143, v63
    ds_read_b128 v[136:139], v8 offset:256
    ds_read_b128 v[140:143], v8 offset:272
    s_waitcnt lgkmcnt(5)
    v_mfma_f32_16x16x32_bf16 v[248:251], v[160:163], v[152:155], 0
    v_mfma_f32_16x16x32_bf16 v[252:255], v[164:167], v[152:155], 0
    ds_read_b128 v[152:155], v11 offset:128
    v_mul_f32 v64, v144, v64
    v_mul_f32 v65, v145, v65
    v_mul_f32 v66, v146, v66
    v_mul_f32 v67, v147, v67
    v_mul_f32 v68, v148, v68
    v_mul_f32 v69, v149, v69
    v_mul_f32 v70, v150, v70
    v_mul_f32 v71, v151, v71
    ds_read_b128 v[144:147], v8 offset:384
    ds_read_b128 v[148:151], v8 offset:400
    s_waitcnt lgkmcnt(7)
    v_mfma_f32_16x16x32_bf16 v[248:251], v[168:171], v[156:159], v[248:251]
    v_mfma_f32_16x16x32_bf16 v[252:255], v[172:175], v[156:159], v[252:255]
    ds_read_b128 v[156:159], v11 offset:192
    v_cvt_pk_bf16_f32 v16, v56, v57
    v_cvt_pk_bf16_f32 v17, v58, v59
    v_cvt_pk_bf16_f32 v18, v60, v61
    v_cvt_pk_bf16_f32 v19, v62, v63
    s_waitcnt lgkmcnt(4)
    v_mul_f32 v72, v136, v72
    v_mul_f32 v73, v137, v73
    v_mul_f32 v74, v138, v74
    v_mul_f32 v75, v139, v75
    v_mul_f32 v76, v140, v76
    v_mul_f32 v77, v141, v77
    v_mul_f32 v78, v142, v78
    v_mul_f32 v79, v143, v79
    ds_read_b128 v[136:139], v8 offset:512
    ds_read_b128 v[140:143], v8 offset:528
    s_waitcnt lgkmcnt(5)
    v_mfma_f32_16x16x32_bf16 v[248:251], v[176:179], v[152:155], v[248:251]
    v_mfma_f32_16x16x32_bf16 v[252:255], v[180:183], v[152:155], v[252:255]
    ds_read_b128 v[152:155], v11 offset:256
    v_cvt_pk_bf16_f32 v20, v64, v65
    v_cvt_pk_bf16_f32 v21, v66, v67
    v_cvt_pk_bf16_f32 v22, v68, v69
    v_cvt_pk_bf16_f32 v23, v70, v71
    v_mfma_f32_16x16x32_bf16 v[240:243], v[160:163], v[16:19], 0
    v_mfma_f32_16x16x32_bf16 v[244:247], v[164:167], v[16:19], 0
    v_lshlrev_b32 v56, 16, v52
    v_and_b32 v57, 0xffff0000, v52
    v_lshlrev_b32 v58, 16, v53
    v_and_b32 v59, 0xffff0000, v53
    v_lshlrev_b32 v60, 16, v54
    v_and_b32 v61, 0xffff0000, v54
    v_lshlrev_b32 v62, 16, v55
    v_and_b32 v63, 0xffff0000, v55
    s_waitcnt lgkmcnt(4)
    v_mul_f32 v80, v144, v80
    v_mul_f32 v81, v145, v81
    v_mul_f32 v82, v146, v82
    v_mul_f32 v83, v147, v83
    v_mul_f32 v84, v148, v84
    v_mul_f32 v85, v149, v85
    v_mul_f32 v86, v150, v86
    v_mul_f32 v87, v151, v87
    ds_read_b128 v[144:147], v8 offset:640
    ds_read_b128 v[148:151], v8 offset:656
    s_waitcnt lgkmcnt(5)
    v_mfma_f32_16x16x32_bf16 v[248:251], v[184:187], v[156:159], v[248:251]
    v_mfma_f32_16x16x32_bf16 v[252:255], v[188:191], v[156:159], v[252:255]
    ds_read_b128 v[156:159], v11 offset:320
    v_cvt_pk_bf16_f32 v24, v72, v73
    v_cvt_pk_bf16_f32 v25, v74, v75
    v_cvt_pk_bf16_f32 v26, v76, v77
    v_cvt_pk_bf16_f32 v27, v78, v79
    v_mfma_f32_16x16x32_bf16 v[240:243], v[168:171], v[20:23], v[240:243]
    v_mfma_f32_16x16x32_bf16 v[244:247], v[172:175], v[20:23], v[244:247]
    v_add_f32 v12, v12, v232
    v_add_f32 v13, v13, v233
    v_mul_f32 v12, 0x3acccccd, v12
    v_mul_f32 v13, 0x3acccccd, v13
    v_fma_f32 v13, -v12, v12, v13
    v_max_f32 v13, 0, v13
    v_add_f32 v13, 0x3727c5ac, v13
    v_rsq_f32 v232, v13
    v_and_b32 v14, 15, v0
    s_lshr_b32 s84, s74, 1
    s_lshl_b32 s84, s84, 7
    s_add_u32 s84, s84, 133376
    v_mul_f32_e64 v233, -v12, v232
    v_lshl_add_u32 v14, v14, 3, s84
    ds_write_b64 v14, v[232:233]
    s_waitcnt lgkmcnt(5)
    v_mul_f32 v88, v136, v88
    v_mul_f32 v89, v137, v89
    v_mul_f32 v90, v138, v90
    v_mul_f32 v91, v139, v91
    v_mul_f32 v92, v140, v92
    v_mul_f32 v93, v141, v93
    v_mul_f32 v94, v142, v94
    v_mul_f32 v95, v143, v95
    ds_read_b128 v[136:139], v8 offset:768
    ds_read_b128 v[140:143], v8 offset:784
    s_waitcnt lgkmcnt(6)
    v_mfma_f32_16x16x32_bf16 v[248:251], v[192:195], v[152:155], v[248:251]
    v_mfma_f32_16x16x32_bf16 v[252:255], v[196:199], v[152:155], v[252:255]
    ds_read_b128 v[152:155], v11 offset:384
    v_cvt_pk_bf16_f32 v28, v80, v81
    v_cvt_pk_bf16_f32 v29, v82, v83
    v_cvt_pk_bf16_f32 v30, v84, v85
    v_cvt_pk_bf16_f32 v31, v86, v87
    v_mfma_f32_16x16x32_bf16 v[240:243], v[176:179], v[24:27], v[240:243]
    v_mfma_f32_16x16x32_bf16 v[244:247], v[180:183], v[24:27], v[244:247]
    s_waitcnt lgkmcnt(5)
    v_mul_f32 v96, v144, v96
    v_mul_f32 v97, v145, v97
    v_mul_f32 v98, v146, v98
    v_mul_f32 v99, v147, v99
    v_mul_f32 v100, v148, v100
    v_mul_f32 v101, v149, v101
    v_mul_f32 v102, v150, v102
    v_mul_f32 v103, v151, v103
    ds_read_b128 v[144:147], v8 offset:896
    ds_read_b128 v[148:151], v8 offset:912
    s_waitcnt lgkmcnt(6)
    v_mfma_f32_16x16x32_bf16 v[248:251], v[200:203], v[156:159], v[248:251]
    v_mfma_f32_16x16x32_bf16 v[252:255], v[204:207], v[156:159], v[252:255]
    ds_read_b128 v[156:159], v11 offset:448
    v_cvt_pk_bf16_f32 v32, v88, v89
    v_cvt_pk_bf16_f32 v33, v90, v91
    v_cvt_pk_bf16_f32 v34, v92, v93
    v_cvt_pk_bf16_f32 v35, v94, v95
    v_mfma_f32_16x16x32_bf16 v[240:243], v[184:187], v[28:31], v[240:243]
    v_mfma_f32_16x16x32_bf16 v[244:247], v[188:191], v[28:31], v[244:247]
    s_waitcnt lgkmcnt(4)
    v_mul_f32 v104, v136, v104
    v_mul_f32 v105, v137, v105
    v_mul_f32 v106, v138, v106
    v_mul_f32 v107, v139, v107
    v_mul_f32 v108, v140, v108
    v_mul_f32 v109, v141, v109
    v_mul_f32 v110, v142, v110
    v_mul_f32 v111, v143, v111
    ds_read_b128 v[136:139], v8 offset:1024
    ds_read_b128 v[140:143], v8 offset:1040
    s_waitcnt lgkmcnt(5)
    v_mfma_f32_16x16x32_bf16 v[248:251], v[208:211], v[152:155], v[248:251]
    v_mfma_f32_16x16x32_bf16 v[252:255], v[212:215], v[152:155], v[252:255]
    ds_read_b128 v[152:155], v11 offset:512
    v_cvt_pk_bf16_f32 v36, v96, v97
    v_cvt_pk_bf16_f32 v37, v98, v99
    v_cvt_pk_bf16_f32 v38, v100, v101
    v_cvt_pk_bf16_f32 v39, v102, v103
    v_mfma_f32_16x16x32_bf16 v[240:243], v[192:195], v[32:35], v[240:243]
    v_mfma_f32_16x16x32_bf16 v[244:247], v[196:199], v[32:35], v[244:247]
    s_waitcnt lgkmcnt(4)
    v_mul_f32 v112, v144, v112
    v_mul_f32 v113, v145, v113
    v_mul_f32 v114, v146, v114
    v_mul_f32 v115, v147, v115
    v_mul_f32 v116, v148, v116
    v_mul_f32 v117, v149, v117
    v_mul_f32 v118, v150, v118
    v_mul_f32 v119, v151, v119
    ds_read_b128 v[144:147], v8 offset:1152
    ds_read_b128 v[148:151], v8 offset:1168
    s_waitcnt lgkmcnt(5)
    v_mfma_f32_16x16x32_bf16 v[248:251], v[216:219], v[156:159], v[248:251]
    v_mfma_f32_16x16x32_bf16 v[252:255], v[220:223], v[156:159], v[252:255]
    ds_read_b128 v[156:159], v11 offset:576
    v_cvt_pk_bf16_f32 v40, v104, v105
    v_cvt_pk_bf16_f32 v41, v106, v107
    v_cvt_pk_bf16_f32 v42, v108, v109
    v_cvt_pk_bf16_f32 v43, v110, v111
    v_mfma_f32_16x16x32_bf16 v[240:243], v[200:203], v[36:39], v[240:243]
    v_mfma_f32_16x16x32_bf16 v[244:247], v[204:207], v[36:39], v[244:247]
    s_waitcnt lgkmcnt(4)
    v_mul_f32 v120, v136, v120
    v_mul_f32 v121, v137, v121
    v_mul_f32 v122, v138, v122
    v_mul_f32 v123, v139, v123
    v_mul_f32 v124, v140, v124
    v_mul_f32 v125, v141, v125
    v_mul_f32 v126, v142, v126
    v_mul_f32 v127, v143, v127
    s_waitcnt lgkmcnt(3)
    v_mfma_f32_16x16x32_bf16 v[248:251], v[224:227], v[152:155], v[248:251]
    v_mfma_f32_16x16x32_bf16 v[252:255], v[228:231], v[152:155], v[252:255]
    v_cvt_pk_bf16_f32 v44, v112, v113
    v_cvt_pk_bf16_f32 v45, v114, v115
    v_cvt_pk_bf16_f32 v46, v116, v117
    v_cvt_pk_bf16_f32 v47, v118, v119
    v_mfma_f32_16x16x32_bf16 v[240:243], v[208:211], v[40:43], v[240:243]
    v_mfma_f32_16x16x32_bf16 v[244:247], v[212:215], v[40:43], v[244:247]
    s_waitcnt lgkmcnt(1)
    v_mul_f32 v56, v144, v56
    v_mul_f32 v57, v145, v57
    v_mul_f32 v58, v146, v58
    v_mul_f32 v59, v147, v59
    v_mul_f32 v60, v148, v60
    v_mul_f32 v61, v149, v61
    v_mul_f32 v62, v150, v62
    v_mul_f32 v63, v151, v63
    s_waitcnt lgkmcnt(0)
    v_mfma_f32_16x16x32_bf16 v[248:251], v[128:131], v[156:159], v[248:251]
    v_mfma_f32_16x16x32_bf16 v[252:255], v[132:135], v[156:159], v[252:255]
    v_cvt_pk_bf16_f32 v48, v120, v121
    v_cvt_pk_bf16_f32 v49, v122, v123
    v_cvt_pk_bf16_f32 v50, v124, v125
    v_cvt_pk_bf16_f32 v51, v126, v127
    v_mfma_f32_16x16x32_bf16 v[240:243], v[216:219], v[44:47], v[240:243]
    v_mfma_f32_16x16x32_bf16 v[244:247], v[220:223], v[44:47], v[244:247]
    v_mfma_f32_16x16x32_bf16 v[240:243], v[224:227], v[48:51], v[240:243]
    v_mfma_f32_16x16x32_bf16 v[244:247], v[228:231], v[48:51], v[244:247]
    v_cvt_pk_bf16_f32 v52, v56, v57
    v_cvt_pk_bf16_f32 v53, v58, v59
    v_cvt_pk_bf16_f32 v54, v60, v61
    v_cvt_pk_bf16_f32 v55, v62, v63
    s_nop 1
    v_mfma_f32_16x16x32_bf16 v[240:243], v[128:131], v[52:55], v[240:243]
    v_mfma_f32_16x16x32_bf16 v[244:247], v[132:135], v[52:55], v[244:247]
    v_mov_b32 v72, v248
    v_mov_b32 v73, v249
    v_mov_b32 v74, v250
    v_mov_b32 v75, v251
    v_mov_b32 v76, v252
    v_mov_b32 v77, v253
    v_mov_b32 v78, v254
    v_mov_b32 v79, v255
    v_mov_b32_dpp v72, v248 row_ror:8 row_mask:0xf bank_mask:0x3
    v_mov_b32_dpp v73, v249 row_ror:8 row_mask:0xf bank_mask:0x3
    v_mov_b32_dpp v74, v250 row_ror:8 row_mask:0xf bank_mask:0x3
    v_mov_b32_dpp v75, v251 row_ror:8 row_mask:0xf bank_mask:0x3
    v_mov_b32_dpp v76, v252 row_ror:8 row_mask:0xf bank_mask:0x3
    v_mov_b32_dpp v77, v253 row_ror:8 row_mask:0xf bank_mask:0x3
    v_mov_b32_dpp v78, v254 row_ror:8 row_mask:0xf bank_mask:0x3
    v_mov_b32_dpp v79, v255 row_ror:8 row_mask:0xf bank_mask:0x3
    v_mov_b32_dpp v248, v248 row_ror:8 row_mask:0xf bank_mask:0xc
    v_mov_b32_dpp v249, v249 row_ror:8 row_mask:0xf bank_mask:0xc
    v_mov_b32_dpp v250, v250 row_ror:8 row_mask:0xf bank_mask:0xc
    v_mov_b32_dpp v251, v251 row_ror:8 row_mask:0xf bank_mask:0xc
    v_mov_b32_dpp v252, v252 row_ror:8 row_mask:0xf bank_mask:0xc
    v_mov_b32_dpp v253, v253 row_ror:8 row_mask:0xf bank_mask:0xc
    v_mov_b32_dpp v254, v254 row_ror:8 row_mask:0xf bank_mask:0xc
    v_mov_b32_dpp v255, v255 row_ror:8 row_mask:0xf bank_mask:0xc
    v_fmac_f32 v72, v233, v248
    v_fmac_f32 v73, v233, v249
    v_fmac_f32 v74, v233, v250
    v_fmac_f32 v75, v233, v251
    v_fmac_f32 v76, v233, v252
    v_fmac_f32 v77, v233, v253
    v_fmac_f32 v78, v233, v254
    v_fmac_f32 v79, v233, v255
    v_fma_f32 v240, v232, v240, v72
    v_fma_f32 v241, v232, v241, v73
    v_fma_f32 v242, v232, v242, v74
    v_fma_f32 v243, v232, v243, v75
    v_fma_f32 v244, v232, v244, v76
    v_fma_f32 v245, v232, v245, v77
    v_fma_f32 v246, v232, v246, v78
    v_fma_f32 v247, v232, v247, v79
    s_branch L_kvred
L_vwave:
    s_waitcnt lgkmcnt(6)
    v_mul_f32 v56, v136, v56
    v_mul_f32 v57, v137, v57
    v_mul_f32 v58, v138, v58
    v_mul_f32 v59, v139, v59
    v_mul_f32 v60, v140, v60
    v_mul_f32 v61, v141, v61
    v_mul_f32 v62, v142, v62
    v_mul_f32 v63, v143, v63
    ds_read_b128 v[136:139], v8 offset:256
    ds_read_b128 v[140:143], v8 offset:272
    s_waitcnt lgkmcnt(5)
    v_mfma_f32_16x16x32_bf16 v[248:251], v[152:155], v[160:163], 0
    v_mfma_f32_16x16x32_bf16 v[252:255], v[152:155], v[164:167], 0
    ds_read_b128 v[152:155], v11 offset:128
    v_mul_f32 v64, v144, v64
    v_mul_f32 v65, v145, v65
    v_mul_f32 v66, v146, v66
    v_mul_f32 v67, v147, v67
    v_mul_f32 v68, v148, v68
    v_mul_f32 v69, v149, v69
    v_mul_f32 v70, v150, v70
    v_mul_f32 v71, v151, v71
    ds_read_b128 v[144:147], v8 offset:384
    ds_read_b128 v[148:151], v8 offset:400
    s_waitcnt lgkmcnt(7)
    v_mfma_f32_16x16x32_bf16 v[248:251], v[156:159], v[168:171], v[248:251]
    v_mfma_f32_16x16x32_bf16 v[252:255], v[156:159], v[172:175], v[252:255]
    ds_read_b128 v[156:159], v11 offset:192
    v_cvt_pk_bf16_f32 v16, v56, v57
    v_cvt_pk_bf16_f32 v17, v58, v59
    v_cvt_pk_bf16_f32 v18, v60, v61
    v_cvt_pk_bf16_f32 v19, v62, v63
    s_waitcnt lgkmcnt(4)
    v_mul_f32 v72, v136, v72
    v_mul_f32 v73, v137, v73
    v_mul_f32 v74, v138, v74
    v_mul_f32 v75, v139, v75
    v_mul_f32 v76, v140, v76
    v_mul_f32 v77, v141, v77
    v_mul_f32 v78, v142, v78
    v_mul_f32 v79, v143, v79
    ds_read_b128 v[136:139], v8 offset:512
    ds_read_b128 v[140:143], v8 offset:528
    s_waitcnt lgkmcnt(5)
    v_mfma_f32_16x16x32_bf16 v[248:251], v[152:155], v[176:179], v[248:251]
    v_mfma_f32_16x16x32_bf16 v[252:255], v[152:155], v[180:183], v[252:255]
    ds_read_b128 v[152:155], v11 offset:256
    v_cvt_pk_bf16_f32 v20, v64, v65
    v_cvt_pk_bf16_f32 v21, v66, v67
    v_cvt_pk_bf16_f32 v22, v68, v69
    v_cvt_pk_bf16_f32 v23, v70, v71
    v_mfma_f32_16x16x32_bf16 v[240:243], v[16:19], v[160:163], 0
    v_mfma_f32_16x16x32_bf16 v[244:247], v[16:19], v[164:167], 0
    v_lshlrev_b32 v56, 16, v52
    v_and_b32 v57, 0xffff0000, v52
    v_lshlrev_b32 v58, 16, v53
    v_and_b32 v59, 0xffff0000, v53
    v_lshlrev_b32 v60, 16, v54
    v_and_b32 v61, 0xffff0000, v54
    v_lshlrev_b32 v62, 16, v55
    v_and_b32 v63, 0xffff0000, v55
    s_waitcnt lgkmcnt(4)
    v_mul_f32 v80, v144, v80
    v_mul_f32 v81, v145, v81
    v_mul_f32 v82, v146, v82
    v_mul_f32 v83, v147, v83
    v_mul_f32 v84, v148, v84
    v_mul_f32 v85, v149, v85
    v_mul_f32 v86, v150, v86
    v_mul_f32 v87, v151, v87
    ds_read_b128 v[144:147], v8 offset:640
    ds_read_b128 v[148:151], v8 offset:656
    s_waitcnt lgkmcnt(5)
    v_mfma_f32_16x16x32_bf16 v[248:251], v[156:159], v[184:187], v[248:251]
    v_mfma_f32_16x16x32_bf16 v[252:255], v[156:159], v[188:191], v[252:255]
    ds_read_b128 v[156:159], v11 offset:320
    v_cvt_pk_bf16_f32 v24, v72, v73
    v_cvt_pk_bf16_f32 v25, v74, v75
    v_cvt_pk_bf16_f32 v26, v76, v77
    v_cvt_pk_bf16_f32 v27, v78, v79
    v_mfma_f32_16x16x32_bf16 v[240:243], v[20:23], v[168:171], v[240:243]
    v_mfma_f32_16x16x32_bf16 v[244:247], v[20:23], v[172:175], v[244:247]
    v_add_f32 v12, v12, v232
    v_add_f32 v13, v13, v233
    v_mul_f32 v12, 0x3acccccd, v12
    v_mul_f32 v13, 0x3acccccd, v13
    v_fma_f32 v13, -v12, v12, v13
    v_max_f32 v13, 0, v13
    v_add_f32 v13, 0x3727c5ac, v13
    v_rsq_f32 v232, v13
    v_and_b32 v14, 15, v0
    s_lshr_b32 s84, s74, 1
    s_lshl_b32 s84, s84, 7
    s_add_u32 s84, s84, 133376
    v_mul_f32_e64 v233, -v12, v232
    v_lshl_add_u32 v14, v14, 3, s84
    ds_write_b64 v14, v[232:233]
    s_waitcnt lgkmcnt(5)
    v_mul_f32 v88, v136, v88
    v_mul_f32 v89, v137, v89
    v_mul_f32 v90, v138, v90
    v_mul_f32 v91, v139, v91
    v_mul_f32 v92, v140, v92
    v_mul_f32 v93, v141, v93
    v_mul_f32 v94, v142, v94
    v_mul_f32 v95, v143, v95
    ds_read_b128 v[136:139], v8 offset:768
    ds_read_b128 v[140:143], v8 offset:784
    s_waitcnt lgkmcnt(6)
    v_mfma_f32_16x16x32_bf16 v[248:251], v[152:155], v[192:195], v[248:251]
    v_mfma_f32_16x16x32_bf16 v[252:255], v[152:155], v[196:199], v[252:255]
    ds_read_b128 v[152:155], v11 offset:384
    v_cvt_pk_bf16_f32 v28, v80, v81
    v_cvt_pk_bf16_f32 v29, v82, v83
    v_cvt_pk_bf16_f32 v30, v84, v85
    v_cvt_pk_bf16_f32 v31, v86, v87
    v_mfma_f32_16x16x32_bf16 v[240:243], v[24:27], v[176:179], v[240:243]
    v_mfma_f32_16x16x32_bf16 v[244:247], v[24:27], v[180:183], v[244:247]
    s_waitcnt lgkmcnt(5)
    v_mul_f32 v96, v144, v96
    v_mul_f32 v97, v145, v97
    v_mul_f32 v98, v146, v98
    v_mul_f32 v99, v147, v99
    v_mul_f32 v100, v148, v100
    v_mul_f32 v101, v149, v101
    v_mul_f32 v102, v150, v102
    v_mul_f32 v103, v151, v103
    ds_read_b128 v[144:147], v8 offset:896
    ds_read_b128 v[148:151], v8 offset:912
    s_waitcnt lgkmcnt(6)
    v_mfma_f32_16x16x32_bf16 v[248:251], v[156:159], v[200:203], v[248:251]
    v_mfma_f32_16x16x32_bf16 v[252:255], v[156:159], v[204:207], v[252:255]
    ds_read_b128 v[156:159], v11 offset:448
    v_cvt_pk_bf16_f32 v32, v88, v89
    v_cvt_pk_bf16_f32 v33, v90, v91
    v_cvt_pk_bf16_f32 v34, v92, v93
    v_cvt_pk_bf16_f32 v35, v94, v95
    v_mfma_f32_16x16x32_bf16 v[240:243], v[28:31], v[184:187], v[240:243]
    v_mfma_f32_16x16x32_bf16 v[244:247], v[28:31], v[188:191], v[244:247]
    s_waitcnt lgkmcnt(4)
    v_mul_f32 v104, v136, v104
    v_mul_f32 v105, v137, v105
    v_mul_f32 v106, v138, v106
    v_mul_f32 v107, v139, v107
    v_mul_f32 v108, v140, v108
    v_mul_f32 v109, v141, v109
    v_mul_f32 v110, v142, v110
    v_mul_f32 v111, v143, v111
    ds_read_b128 v[136:139], v8 offset:1024
    ds_read_b128 v[140:143], v8 offset:1040
    s_waitcnt lgkmcnt(5)
    v_mfma_f32_16x16x32_bf16 v[248:251], v[152:155], v[208:211], v[248:251]
    v_mfma_f32_16x16x32_bf16 v[252:255], v[152:155], v[212:215], v[252:255]
    ds_read_b128 v[152:155], v11 offset:512
    v_cvt_pk_bf16_f32 v36, v96, v97
    v_cvt_pk_bf16_f32 v37, v98, v99
    v_cvt_pk_bf16_f32 v38, v100, v101
    v_cvt_pk_bf16_f32 v39, v102, v103
    v_mfma_f32_16x16x32_bf16 v[240:243], v[32:35], v[192:195], v[240:243]
    v_mfma_f32_16x16x32_bf16 v[244:247], v[32:35], v[196:199], v[244:247]
    v_lshrrev_b32 v14, 4, v0
    v_lshl_add_u32 v14, v14, 5, s84
    ds_read_b128 v[64:67], v14
    ds_read_b128 v[68:71], v14 offset:16
    s_waitcnt lgkmcnt(6)
    v_mul_f32 v112, v144, v112
    v_mul_f32 v113, v145, v113
    v_mul_f32 v114, v146, v114
    v_mul_f32 v115, v147, v115
    v_mul_f32 v116, v148, v116
    v_mul_f32 v117, v149, v117
    v_mul_f32 v118, v150, v118
    v_mul_f32 v119, v151, v119
    ds_read_b128 v[144:147], v8 offset:1152
    ds_read_b128 v[148:151], v8 offset:1168
    s_waitcnt lgkmcnt(7)
    v_mfma_f32_16x16x32_bf16 v[248:251], v[156:159], v[216:219], v[248:251]
    v_mfma_f32_16x16x32_bf16 v[252:255], v[156:159], v[220:223], v[252:255]
    ds_read_b128 v[156:159], v11 offset:576
    v_cvt_pk_bf16_f32 v40, v104, v105
    v_cvt_pk_bf16_f32 v41, v106, v107
    v_cvt_pk_bf16_f32 v42, v108, v109
    v_cvt_pk_bf16_f32 v43, v110, v111
    v_mfma_f32_16x16x32_bf16 v[240:243], v[36:39], v[200:203], v[240:243]
    v_mfma_f32_16x16x32_bf16 v[244:247], v[36:39], v[204:207], v[244:247]
    s_waitcnt lgkmcnt(6)
    v_mul_f32 v120, v136, v120
    v_mul_f32 v121, v137, v121
    v_mul_f32 v122, v138, v122
    v_mul_f32 v123, v139, v123
    v_mul_f32 v124, v140, v124
    v_mul_f32 v125, v141, v125
    v_mul_f32 v126, v142, v126
    v_mul_f32 v127, v143, v127
    s_waitcnt lgkmcnt(5)
    v_mfma_f32_16x16x32_bf16 v[248:251], v[152:155], v[224:227], v[248:251]
    v_mfma_f32_16x16x32_bf16 v[252:255], v[152:155], v[228:231], v[252:255]
    v_cvt_pk_bf16_f32 v44, v112, v113
    v_cvt_pk_bf16_f32 v45, v114, v115
    v_cvt_pk_bf16_f32 v46, v116, v117
    v_cvt_pk_bf16_f32 v47, v118, v119
    v_mfma_f32_16x16x32_bf16 v[240:243], v[40:43], v[208:211], v[240:243]
    v_mfma_f32_16x16x32_bf16 v[244:247], v[40:43], v[212:215], v[244:247]
    s_waitcnt lgkmcnt(1)
    v_mul_f32 v56, v144, v56
    v_mul_f32 v57, v145, v57
    v_mul_f32 v58, v146, v58
    v_mul_f32 v59, v147, v59
    v_mul_f32 v60, v148, v60
    v_mul_f32 v61, v149, v61
    v_mul_f32 v62, v150, v62
    v_mul_f32 v63, v151, v63
    s_waitcnt lgkmcnt(0)
    v_mfma_f32_16x16x32_bf16 v[248:251], v[156:159], v[128:131], v[248:251]
    v_mfma_f32_16x16x32_bf16 v[252:255], v[156:159], v[132:135], v[252:255]
    v_cvt_pk_bf16_f32 v48, v120, v121
    v_cvt_pk_bf16_f32 v49, v122, v123
    v_cvt_pk_bf16_f32 v50, v124, v125
    v_cvt_pk_bf16_f32 v51, v126, v127
    v_mfma_f32_16x16x32_bf16 v[240:243], v[44:47], v[216:219], v[240:243]
    v_mfma_f32_16x16x32_bf16 v[244:247], v[44:47], v[220:223], v[244:247]
    v_mfma_f32_16x16x32_bf16 v[240:243], v[48:51], v[224:227], v[240:243]
    v_mfma_f32_16x16x32_bf16 v[244:247], v[48:51], v[228:231], v[244:247]
    v_cvt_pk_bf16_f32 v52, v56, v57
    v_cvt_pk_bf16_f32 v53, v58, v59
    v_cvt_pk_bf16_f32 v54, v60, v61
    v_cvt_pk_bf16_f32 v55, v62, v63
    s_nop 1
    v_mfma_f32_16x16x32_bf16 v[240:243], v[52:55], v[128:131], v[240:243]
    v_mfma_f32_16x16x32_bf16 v[244:247], v[52:55], v[132:135], v[244:247]
    v_mov_b32 v249, v248
    v_mov_b32 v253, v252
    s_nop 0
    v_permlane32_swap_b32 v248, v249
    v_permlane32_swap_b32 v252, v253
    v_fma_f32 v72, v65, v248, v249
    v_fma_f32 v73, v67, v248, v249
    v_fma_f32 v74, v69, v248, v249
    v_fma_f32 v75, v71, v248, v249
    v_fma_f32 v76, v65, v252, v253
    v_fma_f32 v77, v67, v252, v253
    v_fma_f32 v78, v69, v252, v253
    v_fma_f32 v79, v71, v252, v253
    v_fma_f32 v240, v64, v240, v72
    v_fma_f32 v241, v66, v241, v73
    v_fma_f32 v242, v68, v242, v74
    v_fma_f32 v243, v70, v243, v75
    v_fma_f32 v244, v64, v244, v76
    v_fma_f32 v245, v66, v245, v77
    v_fma_f32 v246, v68, v246, v78
    v_fma_f32 v247, v70, v247, v79
L_kvred:
    v_add_u32 v12, 130048, v1
    v_mov_b32 v13, 162180
    s_cmp_eq_u32 s86, 0
    s_cbranch_scc1 L_kv_done
    ds_write_b128 v12, v[240:243]
    ds_write_b128 v12, v[244:247] offset:1024
    v_mov_b32 v14, 1
    s_waitcnt lgkmcnt(0)
    ds_write_b32 v13, v14
L_kv_done:
    s_setprio 0
    ds_read_b64_tr_b16 v[188:189], v9 offset:0
    ds_read_b64_tr_b16 v[190:191], v9 offset:2560
    ds_read_b64_tr_b16 v[192:193], v9 offset:32
    ds_read_b64_tr_b16 v[194:195], v9 offset:2592
    ds_read_b64_tr_b16 v[196:197], v9 offset:64
    ds_read_b64_tr_b16 v[198:199], v9 offset:2624
    ds_read_b64_tr_b16 v[200:201], v9 offset:96
    ds_read_b64_tr_b16 v[202:203], v9 offset:2656
    ds_read_b64_tr_b16 v[204:205], v9 offset:128
    ds_read_b64_tr_b16 v[206:207], v9 offset:2688
    ds_read_b64_tr_b16 v[208:209], v9 offset:10240
    ds_read_b64_tr_b16 v[210:211], v9 offset:12800
    ds_read_b64_tr_b16 v[212:213], v9 offset:10272
    ds_read_b64_tr_b16 v[214:215], v9 offset:12832
    s_waitcnt lgkmcnt(10)
    v_mfma_f32_16x16x32_bf16 v[160:163], v[188:191], v[16:19], 0
    ds_read_b64_tr_b16 v[188:189], v9 offset:10304
    ds_read_b64_tr_b16 v[190:191], v9 offset:12864
    v_mfma_f32_16x16x32_bf16 v[164:167], v[192:195], v[16:19], 0
    ds_read_b64_tr_b16 v[192:193], v9 offset:10336
    ds_read_b64_tr_b16 v[194:195], v9 offset:12896
    s_waitcnt lgkmcnt(10)
    v_mfma_f32_16x16x32_bf16 v[168:171], v[196:199], v[16:19], 0
    ds_read_b64_tr_b16 v[196:197], v9 offset:10368
    ds_read_b64_tr_b16 v[198:199], v9 offset:12928
    v_mfma_f32_16x16x32_bf16 v[172:175], v[200:203], v[16:19], 0
    ds_read_b64_tr_b16 v[200:201], v9 offset:20480
    ds_read_b64_tr_b16 v[202:203], v9 offset:23040
    s_waitcnt lgkmcnt(10)
    v_mfma_f32_16x16x32_bf16 v[176:179], v[204:207], v[16:19], 0
    ds_read_b64_tr_b16 v[204:205], v9 offset:20512
    ds_read_b64_tr_b16 v[206:207], v9 offset:23072
    s_cmp_lg_u32 s93, 6
    s_cbranch_scc1 L_kvs_24
L_kv_spin:
    ds_read_b32 v14, v13
    ds_read_b128 v[64:67], v12
    ds_read_b128 v[68:71], v12 offset:1024
    s_waitcnt lgkmcnt(0)
    v_cmp_eq_u32 vcc, 0, v14
    s_cbranch_vccz L_spinout_25
    s_sub_u32 s77, s77, 1
    s_cbranch_scc1 L_spinout_25_x
    s_branch L_kv_spin
L_spinout_25_x:
    s_mov_b32 s77, 0
L_spinout_25:
    v_cmp_le_u32 vcc, 4, v239
    v_add_f32 v240, v240, v64
    v_add_f32 v241, v241, v65
    v_add_f32 v242, v242, v66
    v_add_f32 v243, v243, v67
    v_add_f32 v244, v244, v68
    v_add_f32 v245, v245, v69
    v_add_f32 v246, v246, v70
    v_add_f32 v247, v247, v71
    v_cvt_pk_bf16_f32 v64, v240, v241
    v_cvt_pk_bf16_f32 v65, v242, v243
    v_cvt_pk_bf16_f32 v66, v244, v245
    v_cvt_pk_bf16_f32 v67, v246, v247
    v_cndmask_b32 v66, v66, v238, vcc
    v_cndmask_b32 v67, v67, v238, vcc
    buffer_store_dwordx2 v[64:65], v236, s[32:35], s92 offen sc1
    buffer_store_dwordx2 v[66:67], v237, s[32:35], s92 offen sc1
L_kvs_24:
    ds_read_b32 v14, v15 offset:0
    v_mfma_f32_16x16x32_bf16 v[160:163], v[208:211], v[20:23], v[160:163]
    ds_read_b64_tr_b16 v[208:209], v9 offset:20544
    ds_read_b64_tr_b16 v[210:211], v9 offset:23104
    s_waitcnt lgkmcnt(11)
    v_mfma_f32_16x16x32_bf16 v[164:167], v[212:215], v[20:23], v[164:167]
    ds_read_b64_tr_b16 v[212:213], v9 offset:20576
    ds_read_b64_tr_b16 v[214:215], v9 offset:23136
    v_mfma_f32_16x16x32_bf16 v[168:171], v[188:191], v[20:23], v[168:171]
    ds_read_b64_tr_b16 v[188:189], v9 offset:20608
    ds_read_b64_tr_b16 v[190:191], v9 offset:23168
    s_waitcnt lgkmcnt(11)
    v_mfma_f32_16x16x32_bf16 v[172:175], v[192:195], v[20:23], v[172:175]
    ds_read_b64_tr_b16 v[192:193], v9 offset:30720
    ds_read_b64_tr_b16 v[194:195], v9 offset:33280
    v_mfma_f32_16x16x32_bf16 v[176:179], v[196:199], v[20:23], v[176:179]
    ds_read_b64_tr_b16 v[196:197], v9 offset:30752
    ds_read_b64_tr_b16 v[198:199], v9 offset:33312
    s_waitcnt lgkmcnt(10)
    v_cmp_gt_u32 vcc, 3, v14
    s_cbranch_vccz L_lwok_26
L_lwspin_27:
    ds_read_b32 v14, v15 offset:0
    s_waitcnt lgkmcnt(0)
    v_cmp_gt_u32 vcc, 3, v14
    s_cbranch_vccz L_spinout_28
    s_sub_u32 s77, s77, 1
    s_cbranch_scc1 L_spinout_28_x
    s_branch L_lwspin_27
L_spinout_28_x:
    s_mov_b32 s77, 0
L_spinout_28:
L_lwok_26:
    v_mfma_f32_16x16x32_bf16 v[160:163], v[200:203], v[24:27], v[160:163]
    ds_read_b64_tr_b16 v[200:201], v9 offset:30784
    ds_read_b64_tr_b16 v[202:203], v9 offset:33344
    v_mfma_f32_16x16x32_bf16 v[164:167], v[204:207], v[24:27], v[164:167]
    ds_read_b64_tr_b16 v[204:205], v9 offset:30816
    ds_read_b64_tr_b16 v[206:207], v9 offset:33376
    s_waitcnt lgkmcnt(10)
    v_mfma_f32_16x16x32_bf16 v[168:171], v[208:211], v[24:27], v[168:171]
    ds_read_b64_tr_b16 v[208:209], v9 offset:30848
    ds_read_b64_tr_b16 v[210:211], v9 offset:33408
    v_mfma_f32_16x16x32_bf16 v[172:175], v[212:215], v[24:27], v[172:175]
    ds_read_b64_tr_b16 v[212:213], v10 offset:0
    ds_read_b64_tr_b16 v[214:215], v10 offset:2560
    s_waitcnt lgkmcnt(10)
    v_mfma_f32_16x16x32_bf16 v[176:179], v[188:191], v[24:27], v[176:179]
    ds_read_b64_tr_b16 v[188:189], v10 offset:32
    ds_read_b64_tr_b16 v[190:191], v10 offset:2592
    v_mfma_f32_16x16x32_bf16 v[160:163], v[192:195], v[28:31], v[160:163]
    ds_read_b64_tr_b16 v[192:193], v10 offset:64
    ds_read_b64_tr_b16 v[194:195], v10 offset:2624
    s_waitcnt lgkmcnt(10)
    v_mfma_f32_16x16x32_bf16 v[164:167], v[196:199], v[28:31], v[164:167]
    ds_read_b64_tr_b16 v[196:197], v10 offset:96
    ds_read_b64_tr_b16 v[198:199], v10 offset:2656
    v_mfma_f32_16x16x32_bf16 v[168:171], v[200:203], v[28:31], v[168:171]
    ds_read_b64_tr_b16 v[200:201], v10 offset:128
    ds_read_b64_tr_b16 v[202:203], v10 offset:2688
    s_waitcnt lgkmcnt(10)
    v_mfma_f32_16x16x32_bf16 v[172:175], v[204:207], v[28:31], v[172:175]
    ds_read_b64_tr_b16 v[204:205], v10 offset:10240
    ds_read_b64_tr_b16 v[206:207], v10 offset:12800
    v_mfma_f32_16x16x32_bf16 v[176:179], v[208:211], v[28:31], v[176:179]
    ds_read_b64_tr_b16 v[208:209], v10 offset:10272
    ds_read_b64_tr_b16 v[210:211], v10 offset:12832
    s_waitcnt lgkmcnt(10)
    v_mfma_f32_16x16x32_bf16 v[160:163], v[212:215], v[32:35], v[160:163]
    ds_read_b64_tr_b16 v[212:213], v10 offset:10304
    ds_read_b64_tr_b16 v[214:215], v10 offset:12864
    v_mfma_f32_16x16x32_bf16 v[164:167], v[188:191], v[32:35], v[164:167]
    ds_read_b64_tr_b16 v[188:189], v10 offset:10336
    ds_read_b64_tr_b16 v[190:191], v10 offset:12896
    s_waitcnt lgkmcnt(10)
    v_mfma_f32_16x16x32_bf16 v[168:171], v[192:195], v[32:35], v[168:171]
    ds_read_b64_tr_b16 v[192:193], v10 offset:10368
    ds_read_b64_tr_b16 v[194:195], v10 offset:12928
    v_mfma_f32_16x16x32_bf16 v[172:175], v[196:199], v[32:35], v[172:175]
    ds_read_b64_tr_b16 v[196:197], v10 offset:20480
    ds_read_b64_tr_b16 v[198:199], v10 offset:23040
    s_waitcnt lgkmcnt(10)
    v_mfma_f32_16x16x32_bf16 v[176:179], v[200:203], v[32:35], v[176:179]
    ds_read_b64_tr_b16 v[200:201], v10 offset:20512
    ds_read_b64_tr_b16 v[202:203], v10 offset:23072
    ds_read_b32 v14, v15 offset:4
    v_mfma_f32_16x16x32_bf16 v[160:163], v[204:207], v[36:39], v[160:163]
    ds_read_b64_tr_b16 v[204:205], v10 offset:20544
    ds_read_b64_tr_b16 v[206:207], v10 offset:23104
    s_waitcnt lgkmcnt(11)
    v_mfma_f32_16x16x32_bf16 v[164:167], v[208:211], v[36:39], v[164:167]
    ds_read_b64_tr_b16 v[208:209], v10 offset:20576
    ds_read_b64_tr_b16 v[210:211], v10 offset:23136
    v_mfma_f32_16x16x32_bf16 v[168:171], v[212:215], v[36:39], v[168:171]
    ds_read_b64_tr_b16 v[212:213], v10 offset:20608
    ds_read_b64_tr_b16 v[214:215], v10 offset:23168
    s_waitcnt lgkmcnt(11)
    v_mfma_f32_16x16x32_bf16 v[172:175], v[188:191], v[36:39], v[172:175]
    ds_read_b64_tr_b16 v[188:189], v10 offset:30720
    ds_read_b64_tr_b16 v[190:191], v10 offset:33280
    v_mfma_f32_16x16x32_bf16 v[176:179], v[192:195], v[36:39], v[176:179]
    ds_read_b64_tr_b16 v[192:193], v10 offset:30752
    ds_read_b64_tr_b16 v[194:195], v10 offset:33312
    s_waitcnt lgkmcnt(10)
    v_cmp_gt_u32 vcc, 4, v14
    s_cbranch_vccz L_lwok_29
L_lwspin_30:
    ds_read_b32 v14, v15 offset:4
    s_waitcnt lgkmcnt(0)
    v_cmp_gt_u32 vcc, 4, v14
    s_cbranch_vccz L_spinout_31
    s_sub_u32 s77, s77, 1
    s_cbranch_scc1 L_spinout_31_x
    s_branch L_lwspin_30
L_spinout_31_x:
    s_mov_b32 s77, 0
L_spinout_31:
L_lwok_29:
    v_mfma_f32_16x16x32_bf16 v[160:163], v[196:199], v[40:43], v[160:163]
    ds_read_b64_tr_b16 v[196:197], v10 offset:30784
    ds_read_b64_tr_b16 v[198:199], v10 offset:33344
    v_mfma_f32_16x16x32_bf16 v[164:167], v[200:203], v[40:43], v[164:167]
    ds_read_b64_tr_b16 v[200:201], v10 offset:30816
    ds_read_b64_tr_b16 v[202:203], v10 offset:33376
    s_waitcnt lgkmcnt(10)
    v_mfma_f32_16x16x32_bf16 v[168:171], v[204:207], v[40:43], v[168:171]
    ds_read_b64_tr_b16 v[204:205], v10 offset:30848
    ds_read_b64_tr_b16 v[206:207], v10 offset:33408
    v_mfma_f32_16x16x32_bf16 v[172:175], v[208:211], v[40:43], v[172:175]
    ds_read_b64_tr_b16 v[208:209], v10 offset:40960
    ds_read_b64_tr_b16 v[210:211], v10 offset:43520
    s_waitcnt lgkmcnt(10)
    v_mfma_f32_16x16x32_bf16 v[176:179], v[212:215], v[40:43], v[176:179]
    ds_read_b64_tr_b16 v[212:213], v10 offset:40992
    ds_read_b64_tr_b16 v[214:215], v10 offset:43552
    v_mfma_f32_16x16x32_bf16 v[160:163], v[188:191], v[44:47], v[160:163]
    ds_read_b64_tr_b16 v[188:189], v10 offset:41024
    ds_read_b64_tr_b16 v[190:191], v10 offset:43584
    s_waitcnt lgkmcnt(10)
    v_mfma_f32_16x16x32_bf16 v[164:167], v[192:195], v[44:47], v[164:167]
    ds_read_b64_tr_b16 v[192:193], v10 offset:41056
    ds_read_b64_tr_b16 v[194:195], v10 offset:43616
    v_mfma_f32_16x16x32_bf16 v[168:171], v[196:199], v[44:47], v[168:171]
    ds_read_b64_tr_b16 v[196:197], v10 offset:41088
    ds_read_b64_tr_b16 v[198:199], v10 offset:43648
    s_waitcnt lgkmcnt(10)
    v_mfma_f32_16x16x32_bf16 v[172:175], v[200:203], v[44:47], v[172:175]
    ds_read_b64_tr_b16 v[200:201], v10 offset:51200
    ds_read_b64_tr_b16 v[202:203], v10 offset:53760
    v_mfma_f32_16x16x32_bf16 v[176:179], v[204:207], v[44:47], v[176:179]
    ds_read_b64_tr_b16 v[204:205], v10 offset:51232
    ds_read_b64_tr_b16 v[206:207], v10 offset:53792
    s_waitcnt lgkmcnt(10)
    v_mfma_f32_16x16x32_bf16 v[160:163], v[208:211], v[48:51], v[160:163]
    ds_read_b64_tr_b16 v[208:209], v10 offset:51264
    ds_read_b64_tr_b16 v[210:211], v10 offset:53824
    v_mfma_f32_16x16x32_bf16 v[164:167], v[212:215], v[48:51], v[164:167]
    ds_read_b64_tr_b16 v[212:213], v10 offset:51296
    ds_read_b64_tr_b16 v[214:215], v10 offset:53856
    s_waitcnt lgkmcnt(10)
    v_mfma_f32_16x16x32_bf16 v[168:171], v[188:191], v[48:51], v[168:171]
    ds_read_b64_tr_b16 v[188:189], v10 offset:51328
    ds_read_b64_tr_b16 v[190:191], v10 offset:53888
    v_mfma_f32_16x16x32_bf16 v[172:175], v[192:195], v[48:51], v[172:175]
    s_waitcnt lgkmcnt(8)
    v_mfma_f32_16x16x32_bf16 v[176:179], v[196:199], v[48:51], v[176:179]
    v_mfma_f32_16x16x32_bf16 v[160:163], v[200:203], v[52:55], v[160:163]
    s_waitcnt lgkmcnt(4)
    v_mfma_f32_16x16x32_bf16 v[164:167], v[204:207], v[52:55], v[164:167]
    v_mfma_f32_16x16x32_bf16 v[168:171], v[208:211], v[52:55], v[168:171]
    s_waitcnt lgkmcnt(0)
    v_mfma_f32_16x16x32_bf16 v[172:175], v[212:215], v[52:55], v[172:175]
    v_mfma_f32_16x16x32_bf16 v[176:179], v[188:191], v[52:55], v[176:179]
    s_setprio 0
L_qdone:
    s_lshr_b32 s84, s74, 1
    s_mul_i32 s84, s84, 5376
    s_mov_b32 s85, 61440
    s_cmp_eq_u32 s86, 0
    s_cselect_b32 s85, 136192, s85
    s_add_u32 s84, s84, s85
    v_and_b32 v12, 15, v0
    v_mul_u32_u24 v12, 336, v12
    v_lshrrev_b32 v13, 4, v0
    v_lshl_add_u32 v12, v13, 4, v12
    v_add_u32 v12, s84, v12
    s_lshr_b32 s60, s72, 2
    s_lshl_b32 s60, s60, 1
    s_mul_i32 s90, s60, 11008
    s_add_u32 s90, s90, 65536
    ds_write_b128 v12, v[160:163] offset:0
    ds_write_b128 v12, v[164:167] offset:64
    ds_write_b128 v12, v[168:171] offset:128
    ds_write_b128 v12, v[172:175] offset:192
    ds_write_b128 v12, v[176:179] offset:256
    s_lshr_b32 s84, s74, 2
    s_lshl_b32 s87, s84, 8
    s_add_u32 s87, s87, 133376
    s_mul_i32 s84, s84, 10752
    s_and_b32 s85, s74, 3
    s_mul_i32 s85, s85, 80
    s_add_u32 s84, s84, s85
    v_and_b32 v12, 31, v0
    v_lshl_add_u32 v11, v12, 3, s87
    v_mul_u32_u24 v12, 336, v12
    s_add_u32 s84, s84, 61440
    v_add_u32 v12, s84, v12
    v_lshrrev_b32 v13, 5, v0
    v_lshl_add_u32 v14, v13, 5, v12
    v_add_u32 v62, 74752, v12
    v_add_u32 v63, 74752, v14
    s_add_u32 s85, s85, 132096
    v_lshl_add_u32 v15, v13, 5, s85
    v_mov_b32 v10, s85
    v_mov_b32 v9, 162184
    v_cmp_eq_u32 vcc, 0, v13
    s_waitcnt lgkmcnt(0)
    s_cmp_lg_u32 s93, 6
    s_cbranch_scc1 L_skip_kvf
    s_lshl_b32 s94, s72, 3
    s_add_u32 s94, s94, s73
    s_lshl_b32 s94, s94, 7
    s_add_u32 s94, s94, 245760
    v_mov_b32 v60, s75
    v_mov_b32 v61, 0
    s_waitcnt vmcnt(0)
    s_mov_b64 exec, 1
    buffer_store_dword v60, v61, s[32:35], s94 offen sc1
    s_mov_b64 exec, -1
L_skip_kvf:
    s_barrier
    s_add_u32 s94, s74, 0
    s_lshl_b32 s95, s94, 10
    s_add_u32 m0, s95, 102400
    s_cmp_ge_u32 s94, 11
    s_cselect_b32 s94, 256, 0
    s_sub_u32 s95, s95, s94
    s_add_u32 s95, s95, s90
    buffer_load_dwordx4 v1, s[32:35], s95 offen sc1 lds
L_skip_kv0_32:
    s_add_u32 s94, s74, 8
    s_lshl_b32 s95, s94, 10
    s_add_u32 m0, s95, 102400
    s_cmp_ge_u32 s94, 11
    s_cselect_b32 s94, 256, 0
    s_sub_u32 s95, s95, s94
    s_add_u32 s95, s95, s90
    buffer_load_dwordx4 v1, s[32:35], s95 offen sc1 lds
L_skip_kv0_33:
    s_add_u32 s94, s74, 16
    s_cmp_ge_u32 s94, 22
    s_cbranch_scc1 L_skip_kv0_34
    s_lshl_b32 s95, s94, 10
    s_add_u32 m0, s95, 102400
    s_cmp_ge_u32 s94, 11
    s_cselect_b32 s94, 256, 0
    s_sub_u32 s95, s95, s94
    s_add_u32 s95, s95, s90
    buffer_load_dwordx4 v1, s[32:35], s95 offen sc1 lds
L_skip_kv0_34:
    ds_read_b64 v[64:65], v11
    ds_read_b32 v9, v9
    ds_read_b128 v[16:19], v14
    ds_read_b128 v[20:23], v14 offset:16
    ds_read_b128 v[24:27], v12 offset:64
    ds_read_b128 v[28:31], v63
    ds_read_b128 v[32:35], v63 offset:16
    ds_read_b128 v[36:39], v62 offset:64
    s_waitcnt lgkmcnt(6)
    ds_read_b128 v[100:103], v15 offset:0
    ds_read_b128 v[104:107], v15 offset:16
    ds_read_b128 v[108:111], v10 offset:64
    ds_read_b128 v[112:115], v15 offset:320
    ds_read_b128 v[116:119], v15 offset:336
    ds_read_b128 v[120:123], v10 offset:384
    ds_read_b128 v[124:127], v15 offset:640
    ds_read_b128 v[128:131], v15 offset:656
    ds_read_b128 v[132:135], v10 offset:704
    ds_read_b128 v[136:139], v15 offset:960
    ds_read_b128 v[140:143], v15 offset:976
    ds_read_b128 v[144:147], v10 offset:1024
    v_readfirstlane_b32 s94, v9
    v_mov_b32 v66, 0x3ea52b5c
    v_mul_f32 v64, v66, v64
    v_mul_f32 v65, v66, v65
    v_cndmask_b32 v67, 0, v64, vcc
    v_cndmask_b32 v68, 0, v65, vcc
    v_cndmask_b32 v69, 0, v66, vcc
    s_cmp_eq_u32 s94, 0
    s_cselect_b32 s76, 1, 0
    s_waitcnt lgkmcnt(12)
    v_add_f32 v16, v16, v28
    v_add_f32 v17, v17, v29
    v_add_f32 v18, v18, v30
    v_add_f32 v19, v19, v31
    v_add_f32 v20, v20, v32
    v_add_f32 v21, v21, v33
    v_add_f32 v22, v22, v34
    v_add_f32 v23, v23, v35
    v_add_f32 v24, v24, v36
    v_add_f32 v25, v25, v37
    v_add_f32 v26, v26, v38
    v_add_f32 v27, v27, v39
    s_waitcnt lgkmcnt(0)
    v_add_f32 v112, v112, v136
    v_add_f32 v113, v113, v137
    v_add_f32 v114, v114, v138
    v_add_f32 v115, v115, v139
    v_add_f32 v116, v116, v140
    v_add_f32 v117, v117, v141
    v_add_f32 v118, v118, v142
    v_add_f32 v119, v119, v143
    v_add_f32 v120, v120, v144
    v_add_f32 v121, v121, v145
    v_add_f32 v122, v122, v146
    v_add_f32 v123, v123, v147
    v_add_f32 v100, v100, v124
    v_add_f32 v101, v101, v125
    v_add_f32 v102, v102, v126
    v_add_f32 v103, v103, v127
    v_add_f32 v104, v104, v128
    v_add_f32 v105, v105, v129
    v_add_f32 v106, v106, v130
    v_add_f32 v107, v107, v131
    v_add_f32 v108, v108, v132
    v_add_f32 v109, v109, v133
    v_add_f32 v110, v110, v134
    v_add_f32 v111, v111, v135
    v_mul_f32 v112, v66, v112
    v_mul_f32 v113, v66, v113
    v_mul_f32 v114, v66, v114
    v_mul_f32 v115, v66, v115
    v_mul_f32 v116, v66, v116
    v_mul_f32 v117, v66, v117
    v_mul_f32 v118, v66, v118
    v_mul_f32 v119, v66, v119
    v_mul_f32 v120, v69, v120
    v_mul_f32 v121, v69, v121
    v_mul_f32 v122, v69, v122
    v_mul_f32 v123, v69, v123
    v_fmac_f32 v112, v65, v100
    v_fmac_f32 v113, v65, v101
    v_fmac_f32 v114, v65, v102
    v_fmac_f32 v115, v65, v103
    v_fmac_f32 v116, v65, v104
    v_fmac_f32 v117, v65, v105
    v_fmac_f32 v118, v65, v106
    v_fmac_f32 v119, v65, v107
    v_fmac_f32 v120, v68, v108
    v_fmac_f32 v121, v68, v109
    v_fmac_f32 v122, v68, v110
    v_fmac_f32 v123, v68, v111
    v_fmac_f32 v112, v64, v16
    v_fmac_f32 v113, v64, v17
    v_fmac_f32 v114, v64, v18
    v_fmac_f32 v115, v64, v19
    v_fmac_f32 v116, v64, v20
    v_fmac_f32 v117, v64, v21
    v_fmac_f32 v118, v64, v22
    v_fmac_f32 v119, v64, v23
    v_fmac_f32 v120, v67, v24
    v_fmac_f32 v121, v67, v25
    v_fmac_f32 v122, v67, v26
    v_fmac_f32 v123, v67, v27
    v_cvt_pk_bf16_f32 v80, v112, v113
    v_cvt_pk_bf16_f32 v81, v114, v115
    v_cvt_pk_bf16_f32 v82, v116, v117
    v_cvt_pk_bf16_f32 v83, v118, v119
    v_cvt_pk_bf16_f32 v70, v120, v121
    v_cvt_pk_bf16_f32 v71, v122, v123
    s_lshl_b32 s94, s74, 10
    s_add_u32 s94, s94, 102400
    v_add_u32 v12, s94, v1
    v_cmp_gt_u32 vcc, 48, v0
    s_cmp_eq_u32 s74, 2
    s_cselect_b64 s[88:89], vcc, -1
    s_cmp_eq_u32 s74, 5
    s_cselect_b64 s[86:87], vcc, -1
    s_cmp_ge_u32 s74, 6
    s_cselect_b64 s[86:87], 0, s[86:87]
    s_waitcnt vmcnt(0)
    ds_read_b128 v[32:35], v12 offset:0
    ds_read_b128 v[36:39], v12 offset:8192
    ds_read_b128 v[40:43], v12 offset:16384
    s_waitcnt lgkmcnt(0)
    v_max_u32 v32, v33, v35
    v_max_u32 v36, v37, v39
    v_max_u32 v40, v41, v43
    v_cmp_eq_u32 vcc, -1, v32
    v_cmp_eq_u32 s[94:95], -1, v36
    s_and_b64 s[94:95], s[94:95], s[88:89]
    s_or_b64 vcc, vcc, s[94:95]
    v_cmp_eq_u32 s[94:95], -1, v40
    s_and_b64 s[94:95], s[94:95], s[86:87]
    s_or_b64 vcc, vcc, s[94:95]
    s_cbranch_vccz L_kvok
L_kvretry:
    s_add_u32 s94, s74, 0
    s_lshl_b32 s95, s94, 10
    s_add_u32 m0, s95, 102400
    s_cmp_ge_u32 s94, 11
    s_cselect_b32 s94, 256, 0
    s_sub_u32 s95, s95, s94
    s_add_u32 s95, s95, s90
    buffer_load_dwordx4 v1, s[32:35], s95 offen sc1 lds
L_skip_kv0_35:
    s_add_u32 s94, s74, 8
    s_lshl_b32 s95, s94, 10
    s_add_u32 m0, s95, 102400
    s_cmp_ge_u32 s94, 11
    s_cselect_b32 s94, 256, 0
    s_sub_u32 s95, s95, s94
    s_add_u32 s95, s95, s90
    buffer_load_dwordx4 v1, s[32:35], s95 offen sc1 lds
L_skip_kv0_36:
    s_add_u32 s94, s74, 16
    s_cmp_ge_u32 s94, 22
    s_cbranch_scc1 L_skip_kv0_37
    s_lshl_b32 s95, s94, 10
    s_add_u32 m0, s95, 102400
    s_cmp_ge_u32 s94, 11
    s_cselect_b32 s94, 256, 0
    s_sub_u32 s95, s95, s94
    s_add_u32 s95, s95, s90
    buffer_load_dwordx4 v1, s[32:35], s95 offen sc1 lds
L_skip_kv0_37:
    s_waitcnt vmcnt(0)
    ds_read_b128 v[32:35], v12 offset:0
    ds_read_b128 v[36:39], v12 offset:8192
    ds_read_b128 v[40:43], v12 offset:16384
    s_waitcnt lgkmcnt(0)
    v_max_u32 v32, v33, v35
    v_max_u32 v36, v37, v39
    v_max_u32 v40, v41, v43
    v_cmp_eq_u32 vcc, -1, v32
    v_cmp_eq_u32 s[94:95], -1, v36
    s_and_b64 s[94:95], s[94:95], s[88:89]
    s_or_b64 vcc, vcc, s[94:95]
    v_cmp_eq_u32 s[94:95], -1, v40
    s_and_b64 s[94:95], s[94:95], s[86:87]
    s_or_b64 vcc, vcc, s[94:95]
    s_cbranch_vccz L_spinout_38
    s_sub_u32 s77, s77, 1
    s_cbranch_scc1 L_spinout_38_x
    s_branch L_kvretry
L_spinout_38_x:
    s_mov_b32 s77, 0
L_spinout_38:
L_kvok:
    v_add_u32 v8, 102400, v1
    v_and_b32 v9, 31, v0
    v_min_u32 v10, 21, v9
    v_cmp_eq_u32 vcc, 24, v9
    v_lshrrev_b32 v11, 5, v0
    s_nop 0
    v_cndmask_b32 v10, v10, 20, vcc
    v_xor_b32 v12, 1, v11
    v_cmp_le_u32 vcc, 28, v9
    v_lshlrev_b32 v10, 4, v10
    s_nop 0
    v_cndmask_b32 v12, v11, v12, vcc
    v_mul_u32_u24 v12, 368, v12
    v_add_u32 v10, v10, v12
    v_add_u32 v10, 103680, v10
    v_lshlrev_b32 v9, 3, v9
    v_add_u32 v9, 103424, v9
    v_mov_b32 v12, 104016
    v_cmp_eq_u32 vcc, 1, v11
    s_nop 1
    v_cndmask_b32 v9, v9, v12, vcc
    s_barrier
    s_and_b32 s61, s74, 3
    s_mul_i32 s84, s61, 3
    s_lshr_b32 s85, s74, 2
    s_lshl_b32 s86, s85, 1
    s_add_u32 s86, s86, s84
    s_sub_u32 s93, s84, s86
    s_add_u32 s93, s93, 1
    s_lshl_b32 s93, s93, 10
    s_lshl_b32 s86, s86, 10
    s_mul_i32 s84, s73, 245760
    s_add_u32 s86, s86, s84
    s_add_u32 s86, s86, 14909440
    s_add_u32 s84, s85, s60
    s_mul_i32 s29, s84, 11008
    s_mul_i32 s85, s61, 3072
    s_add_u32 s92, s85, 65536
    s_lshl_b32 s61, s61, 10
    s_mul_i32 s88, s73, 46080
    s_add_u32 s88, s88, s78
    s_mul_i32 s28, s73, 348160
    s_add_u32 s28, s28, 12124160
    v_mov_b32 v92, -1
    v_mov_b32 v93, -1
    v_mov_b32 v94, -1
    v_mov_b32 v95, -1
    s_cmp_ge_u32 s74, 4
    s_cbranch_scc1 L_att_b
    s_lshl_b32 s87, s61, 3
    s_add_u32 s87, s87, 245760
    v_lshlrev_b32 v90, 7, v0
    buffer_load_dword v91, v90, s[32:35], s87 offen sc1
    s_setprio 1
    ds_read_b128 v[64:67], v8 offset:0
    ds_read_b64 v[68:69], v9 offset:0
    ds_read_b128 v[72:75], v10 offset:0
    s_waitcnt lgkmcnt(1)
    v_mfma_f32_32x32x8bf16_1k v[32:47], v[68:69], v[70:71], 0
    v_mfma_f32_32x32x16_bf16 v[32:47], v[64:67], v[80:83], v[32:47]
    ds_read_b128 v[64:67], v8 offset:2752
    ds_read_b64 v[68:69], v9 offset:2752
    v_mov_b32 v16, 0
    v_mov_b32 v17, 0
    v_mov_b32 v18, 0
    v_mov_b32 v19, 0
    v_mov_b32 v20, 0
    v_mov_b32 v21, 0
    v_mov_b32 v22, 0
    v_mov_b32 v23, 0
    v_mov_b32 v24, 0
    v_mov_b32 v25, 0
    v_mov_b32 v26, 0
    v_mov_b32 v27, 0
    v_mov_b32 v28, 0
    v_mov_b32 v29, 0
    v_mov_b32 v30, 0
    v_mov_b32 v31, 0
    s_waitcnt lgkmcnt(0)
    v_mfma_f32_32x32x8bf16_1k v[48:63], v[68:69], v[70:71], 0
    v_exp_f32 v32, v32
    v_exp_f32 v33, v33
    v_exp_f32 v34, v34
    v_exp_f32 v35, v35
    v_exp_f32 v36, v36
    v_mfma_f32_32x32x16_bf16 v[48:63], v[64:67], v[80:83], v[48:63]
    ds_read_b128 v[64:67], v8 offset:5504
    ds_read_b64 v[68:69], v9 offset:5504
    v_exp_f32 v37, v37
    v_exp_f32 v38, v38
    v_exp_f32 v39, v39
    v_cvt_pk_bf16_f32 v32, v32, v33
    v_cvt_pk_bf16_f32 v33, v34, v35
    v_cvt_pk_bf16_f32 v34, v36, v37
    v_cvt_pk_bf16_f32 v35, v38, v39
    ds_read_b128 v[76:79], v10 offset:736
    v_exp_f32 v40, v40
    v_exp_f32 v41, v41
    v_exp_f32 v42, v42
    v_exp_f32 v43, v43
    v_exp_f32 v44, v44
    v_mfma_f32_32x32x16_bf16 v[16:31], v[72:75], v[32:35], v[16:31]
    s_waitcnt lgkmcnt(1)
    ds_read_b128 v[72:75], v10 offset:2752
    v_exp_f32 v45, v45
    v_exp_f32 v46, v46
    v_exp_f32 v47, v47
    v_cvt_pk_bf16_f32 v84, v40, v41
    v_cvt_pk_bf16_f32 v85, v42, v43
    v_cvt_pk_bf16_f32 v86, v44, v45
    v_cvt_pk_bf16_f32 v87, v46, v47
    v_mfma_f32_32x32x8bf16_1k v[32:47], v[68:69], v[70:71], 0
    v_exp_f32 v48, v48
    v_exp_f32 v49, v49
    v_exp_f32 v50, v50
    v_exp_f32 v51, v51
    v_exp_f32 v52, v52
    v_mfma_f32_32x32x16_bf16 v[32:47], v[64:67], v[80:83], v[32:47]
    s_waitcnt lgkmcnt(1)
    ds_read_b128 v[64:67], v8 offset:8256
    ds_read_b64 v[68:69], v9 offset:8256
    v_exp_f32 v53, v53
    v_exp_f32 v54, v54
    v_exp_f32 v55, v55
    v_cvt_pk_bf16_f32 v48, v48, v49
    v_cvt_pk_bf16_f32 v49, v50, v51
    v_cvt_pk_bf16_f32 v50, v52, v53
    v_cvt_pk_bf16_f32 v51, v54, v55
    v_mfma_f32_32x32x16_bf16 v[16:31], v[76:79], v[84:87], v[16:31]
    s_waitcnt lgkmcnt(2)
    ds_read_b128 v[76:79], v10 offset:3488
    v_exp_f32 v56, v56
    v_exp_f32 v57, v57
    v_exp_f32 v58, v58
    v_exp_f32 v59, v59
    v_exp_f32 v60, v60
    v_mfma_f32_32x32x16_bf16 v[16:31], v[72:75], v[48:51], v[16:31]
    s_waitcnt lgkmcnt(1)
    ds_read_b128 v[72:75], v10 offset:5504
    v_exp_f32 v61, v61
    v_exp_f32 v62, v62
    v_exp_f32 v63, v63
    v_cvt_pk_bf16_f32 v84, v56, v57
    v_cvt_pk_bf16_f32 v85, v58, v59
    v_cvt_pk_bf16_f32 v86, v60, v61
    v_cvt_pk_bf16_f32 v87, v62, v63
    s_waitcnt vmcnt(0)
    v_cmp_ne_u32 vcc, s75, v91
    s_cbranch_vccz L_kfok_40
L_kfspin_39:
    s_lshl_b32 s87, s61, 3
    s_add_u32 s87, s87, 245760
    v_lshlrev_b32 v90, 7, v0
    buffer_load_dword v91, v90, s[32:35], s87 offen sc1
    s_waitcnt vmcnt(0)
    v_cmp_ne_u32 vcc, s75, v91
    s_cbranch_vccz L_spinout_41
    s_sub_u32 s77, s77, 1
    s_cbranch_scc1 L_spinout_41_x
    s_branch L_kfspin_39
L_spinout_41_x:
    s_mov_b32 s77, 0
L_spinout_41:
L_kfok_40:
    s_barrier
    v_mfma_f32_32x32x8bf16_1k v[48:63], v[68:69], v[70:71], 0
    s_setprio 1
    s_add_u32 s29, s29, 22016
    s_cmp_ge_u32 s29, 176128
    s_cselect_b32 s95, 176128, 0
    s_sub_u32 s29, s29, s95
    s_add_u32 m0, s85, 124928
    s_add_u32 s95, s29, s92
    buffer_load_dwordx4 v1, s[32:35], s95 offen offset:0 sc1 lds
    v_exp_f32 v32, v32
    v_exp_f32 v33, v33
    v_exp_f32 v34, v34
    v_exp_f32 v35, v35
    v_exp_f32 v36, v36
    v_mfma_f32_32x32x16_bf16 v[48:63], v[64:67], v[80:83], v[48:63]
    s_waitcnt lgkmcnt(1)
    ds_read_b128 v[64:67], v8 offset:11264
    ds_read_b64 v[68:69], v9 offset:11264
    buffer_load_dwordx4 v1, s[32:35], s95 offen offset:1024 sc1 lds
    v_exp_f32 v37, v37
    v_exp_f32 v38, v38
    v_exp_f32 v39, v39
    v_cvt_pk_bf16_f32 v32, v32, v33
    v_cvt_pk_bf16_f32 v33, v34, v35
    v_cvt_pk_bf16_f32 v34, v36, v37
    v_cvt_pk_bf16_f32 v35, v38, v39
    v_mfma_f32_32x32x16_bf16 v[16:31], v[76:79], v[84:87], v[16:31]
    s_waitcnt lgkmcnt(2)
    ds_read_b128 v[76:79], v10 offset:6240
    s_cmp_eq_u32 s85, 9216
    s_cbranch_scc1 L_skip_kv_42
    buffer_load_dwordx4 v1, s[32:35], s95 offen offset:2048 sc1 lds
L_skip_kv_42:
    v_exp_f32 v40, v40
    v_exp_f32 v41, v41
    v_exp_f32 v42, v42
    v_exp_f32 v43, v43
    v_exp_f32 v44, v44
    v_mfma_f32_32x32x16_bf16 v[16:31], v[72:75], v[32:35], v[16:31]
    s_waitcnt lgkmcnt(1)
    ds_read_b128 v[72:75], v10 offset:8256
    s_cmp_ge_u32 s72, 20
    s_cbranch_scc1 L_skip_r1_43
    v_add_u32 v88, 0, v0
    v_mul_u32_u24 v89, 2731, v88
    v_lshrrev_b32 v89, 16, v89
    v_mul_u32_u24 v2, 24, v89
    v_sub_u32 v88, v88, v2
    v_and_b32 v2, 6, v89
    v_xor_b32 v88, v88, v2
    v_and_b32 v2, 4, v89
    v_add_u32 v89, v89, v2
    v_mul_u32_u24 v89, 3072, v89
    v_lshl_add_u32 v2, v88, 4, v89
    v_add_u32 v88, 64, v0
    v_mul_u32_u24 v89, 2731, v88
    v_lshrrev_b32 v89, 16, v89
    v_mul_u32_u24 v3, 24, v89
    v_sub_u32 v88, v88, v3
    v_and_b32 v3, 6, v89
    v_xor_b32 v88, v88, v3
    v_and_b32 v3, 4, v89
    v_add_u32 v89, v89, v3
    v_mul_u32_u24 v89, 3072, v89
    v_lshl_add_u32 v3, v88, 4, v89
    v_subrev_u32 v3, 1024, v3
    v_add_u32 v88, 128, v0
    v_mul_u32_u24 v89, 2731, v88
    v_lshrrev_b32 v89, 16, v89
    v_mul_u32_u24 v4, 24, v89
    v_sub_u32 v88, v88, v4
    v_and_b32 v4, 6, v89
    v_xor_b32 v88, v88, v4
    v_and_b32 v4, 4, v89
    v_add_u32 v89, v89, v4
    v_mul_u32_u24 v89, 3072, v89
    v_lshl_add_u32 v4, v88, 4, v89
    v_subrev_u32 v4, 2048, v4
    s_and_b32 s87, s74, 1
    s_lshl_b32 s87, s87, 4
    s_lshr_b32 s89, s74, 1
    s_lshl_b32 s89, s89, 2
    s_add_u32 s87, s87, s89
    s_lshl_b32 s89, s72, 5
    s_add_u32 s87, s87, s89
    s_mul_i32 s87, s87, 3072
    s_mul_i32 s89, s73, 384
    s_mov_b32 m0, s85
    s_add_u32 s87, s87, s89
    buffer_load_dwordx4 v2, s[48:51], s87 offen offset:0 lds
    buffer_load_dwordx4 v3, s[48:51], s87 offen offset:1024 lds
    buffer_load_dwordx4 v4, s[48:51], s87 offen offset:2048 lds
L_skip_r1_43:
    v_exp_f32 v45, v45
    v_exp_f32 v46, v46
    v_exp_f32 v47, v47
    v_cvt_pk_bf16_f32 v84, v40, v41
    v_cvt_pk_bf16_f32 v85, v42, v43
    v_cvt_pk_bf16_f32 v86, v44, v45
    v_cvt_pk_bf16_f32 v87, v46, v47
    v_mfma_f32_32x32x8bf16_1k v[32:47], v[68:69], v[70:71], 0
    s_mul_i32 s87, s74, 6144
    s_add_u32 s87, s87, s88
    s_cmp_eq_u32 s76, 1
    s_cbranch_scc0 L_far_44
    buffer_store_dwordx4 v[92:95], v1, s[32:35], s87 offen offset:0
    buffer_store_dwordx4 v[92:95], v1, s[32:35], s87 offen offset:1024
    buffer_store_dwordx4 v[92:95], v1, s[32:35], s87 offen offset:2048
L_pub_45:
    v_exp_f32 v48, v48
    v_exp_f32 v49, v49
    v_exp_f32 v50, v50
    v_exp_f32 v51, v51
    v_exp_f32 v52, v52
    v_mfma_f32_32x32x16_bf16 v[32:47], v[64:67], v[80:83], v[32:47]
    s_waitcnt lgkmcnt(1)
    ds_read_b128 v[64:67], v8 offset:14016
    ds_read_b64 v[68:69], v9 offset:14016
    s_cmp_eq_u32 s74, 7
    s_cbranch_scc1 L_skip_pf_46
    s_mul_i32 s87, s74, 6144
    s_add_u32 s87, s87, s88
    s_add_u32 s87, s87, 3072
    s_cmp_eq_u32 s76, 1
    s_cbranch_scc0 L_far_47
    buffer_store_dwordx4 v[92:95], v1, s[32:35], s87 offen offset:0
    buffer_store_dwordx4 v[92:95], v1, s[32:35], s87 offen offset:1024
    buffer_store_dwordx4 v[92:95], v1, s[32:35], s87 offen offset:2048
L_pub_48:
L_skip_pf_46:
    v_exp_f32 v53, v53
    v_exp_f32 v54, v54
    v_exp_f32 v55, v55
    v_cvt_pk_bf16_f32 v48, v48, v49
    v_cvt_pk_bf16_f32 v49, v50, v51
    v_cvt_pk_bf16_f32 v50, v52, v53
    v_cvt_pk_bf16_f32 v51, v54, v55
    v_mfma_f32_32x32x16_bf16 v[16:31], v[76:79], v[84:87], v[16:31]
    s_waitcnt lgkmcnt(2)
    ds_read_b128 v[76:79], v10 offset:8992
    s_or_b32 s87, s2, s74
    s_cmp_lg_u32 s87, 0
    s_cbranch_scc1 L_skip_epoch_49
    v_mov_b32 v91, s75
    v_mov_b32 v90, 0
    s_mov_b64 exec, 1
    buffer_store_dword v91, v90, s[32:35], 0 offen sc1
    s_mov_b64 exec, -1
L_skip_epoch_49:
    v_exp_f32 v56, v56
    v_exp_f32 v57, v57
    v_exp_f32 v58, v58
    v_exp_f32 v59, v59
    v_exp_f32 v60, v60
    v_mfma_f32_32x32x16_bf16 v[16:31], v[72:75], v[48:51], v[16:31]
    s_waitcnt lgkmcnt(1)
    ds_read_b128 v[72:75], v10 offset:11264
    s_sub_u32 s87, s79, 80
    s_cmp_ge_u32 s87, 160
    s_cbranch_scc1 L_skip_m2_50
    s_cmp_ge_u32 s74, 5
    s_cbranch_scc1 L_skip_m2_50
    v_bfe_u32 v152, v0, 3, 2
    v_lshlrev_b32 v152, 3, v152
    v_lshrrev_b32 v153, 5, v0
    v_lshl_add_u32 v152, v153, 2, v152
    v_bfe_u32 v153, v0, 1, 2
    v_add_u32 v152, v152, v153
    v_mul_u32_u24 v152, 7680, v152
    v_and_b32 v153, 1, v0
    v_lshl_add_u32 v152, v153, 4, v152
    s_lshl_b32 s81, s74, 8
    v_lshl_add_u32 v153, v0, 2, s81
    s_mul_i32 s80, s74, 983040
    s_lshl_b32 s81, s79, 5
    s_add_u32 s80, s80, s81
    s_lshl_b32 s81, s74, 12
    buffer_load_dword v154, v153, s[68:71], 0 offen
    s_add_u32 m0, s81, 136192
    s_nop 0
    buffer_load_dwordx4 v152, s[64:67], s80 offen lds
    s_add_u32 m0, s81, 137216
    s_add_u32 s80, s80, 245760
    buffer_load_dwordx4 v152, s[64:67], s80 offen lds
L_skip_m2_50:
    v_exp_f32 v61, v61
    v_exp_f32 v62, v62
    v_exp_f32 v63, v63
    v_cvt_pk_bf16_f32 v84, v56, v57
    v_cvt_pk_bf16_f32 v85, v58, v59
    v_cvt_pk_bf16_f32 v86, v60, v61
    v_cvt_pk_bf16_f32 v87, v62, v63
    v_mfma_f32_32x32x8bf16_1k v[48:63], v[68:69], v[70:71], 0
    v_exp_f32 v32, v32
    v_exp_f32 v33, v33
    v_exp_f32 v34, v34
    v_exp_f32 v35, v35
    v_exp_f32 v36, v36
    v_mfma_f32_32x32x16_bf16 v[48:63], v[64:67], v[80:83], v[48:63]
    s_waitcnt lgkmcnt(1)
    ds_read_b128 v[64:67], v8 offset:16768
    ds_read_b64 v[68:69], v9 offset:16768
    v_exp_f32 v37, v37
    v_exp_f32 v38, v38
    v_exp_f32 v39, v39
    v_cvt_pk_bf16_f32 v32, v32, v33
    v_cvt_pk_bf16_f32 v33, v34, v35
    v_cvt_pk_bf16_f32 v34, v36, v37
    v_cvt_pk_bf16_f32 v35, v38, v39
    v_mfma_f32_32x32x16_bf16 v[16:31], v[76:79], v[84:87], v[16:31]
    s_waitcnt lgkmcnt(2)
    ds_read_b128 v[76:79], v10 offset:12000
    v_exp_f32 v40, v40
    v_exp_f32 v41, v41
    v_exp_f32 v42, v42
    v_exp_f32 v43, v43
    v_exp_f32 v44, v44
    v_mfma_f32_32x32x16_bf16 v[16:31], v[72:75], v[32:35], v[16:31]
    s_waitcnt lgkmcnt(1)
    ds_read_b128 v[72:75], v10 offset:14016
    v_exp_f32 v45, v45
    v_exp_f32 v46, v46
    v_exp_f32 v47, v47
    v_cvt_pk_bf16_f32 v84, v40, v41
    v_cvt_pk_bf16_f32 v85, v42, v43
    v_cvt_pk_bf16_f32 v86, v44, v45
    v_cvt_pk_bf16_f32 v87, v46, v47
    v_mfma_f32_32x32x8bf16_1k v[32:47], v[68:69], v[70:71], 0
    v_exp_f32 v48, v48
    v_exp_f32 v49, v49
    v_exp_f32 v50, v50
    v_exp_f32 v51, v51
    v_exp_f32 v52, v52
    v_mfma_f32_32x32x16_bf16 v[32:47], v[64:67], v[80:83], v[32:47]
    s_waitcnt lgkmcnt(1)
    ds_read_b128 v[64:67], v8 offset:19520
    ds_read_b64 v[68:69], v9 offset:19520
    v_exp_f32 v53, v53
    v_exp_f32 v54, v54
    v_exp_f32 v55, v55
    v_cvt_pk_bf16_f32 v48, v48, v49
    v_cvt_pk_bf16_f32 v49, v50, v51
    v_cvt_pk_bf16_f32 v50, v52, v53
    v_cvt_pk_bf16_f32 v51, v54, v55
    v_mfma_f32_32x32x16_bf16 v[16:31], v[76:79], v[84:87], v[16:31]
    s_waitcnt lgkmcnt(2)
    ds_read_b128 v[76:79], v10 offset:14752
    v_exp_f32 v56, v56
    v_exp_f32 v57, v57
    v_exp_f32 v58, v58
    v_exp_f32 v59, v59
    v_exp_f32 v60, v60
    v_mfma_f32_32x32x16_bf16 v[16:31], v[72:75], v[48:51], v[16:31]
    s_waitcnt lgkmcnt(1)
    ds_read_b128 v[72:75], v10 offset:16768
    v_exp_f32 v61, v61
    v_exp_f32 v62, v62
    v_exp_f32 v63, v63
    v_cvt_pk_bf16_f32 v84, v56, v57
    v_cvt_pk_bf16_f32 v85, v58, v59
    v_cvt_pk_bf16_f32 v86, v60, v61
    v_cvt_pk_bf16_f32 v87, v62, v63
    s_waitcnt vmcnt(3)
    s_waitcnt vmcnt(3)
    s_barrier
    v_mfma_f32_32x32x8bf16_1k v[48:63], v[68:69], v[70:71], 0
    s_setprio 0
    v_exp_f32 v32, v32
    v_exp_f32 v33, v33
    v_exp_f32 v34, v34
    v_exp_f32 v35, v35
    v_exp_f32 v36, v36
    v_mfma_f32_32x32x16_bf16 v[48:63], v[64:67], v[80:83], v[48:63]
    s_waitcnt lgkmcnt(1)
    ds_read_b128 v[64:67], v8 offset:22528
    ds_read_b64 v[68:69], v9 offset:22528
    v_exp_f32 v37, v37
    v_exp_f32 v38, v38
    v_exp_f32 v39, v39
    v_cvt_pk_bf16_f32 v32, v32, v33
    v_cvt_pk_bf16_f32 v33, v34, v35
    v_cvt_pk_bf16_f32 v34, v36, v37
    v_cvt_pk_bf16_f32 v35, v38, v39
    v_mfma_f32_32x32x16_bf16 v[16:31], v[76:79], v[84:87], v[16:31]
    s_waitcnt lgkmcnt(2)
    ds_read_b128 v[76:79], v10 offset:17504
    v_exp_f32 v40, v40
    v_exp_f32 v41, v41
    v_exp_f32 v42, v42
    v_exp_f32 v43, v43
    v_exp_f32 v44, v44
    v_mfma_f32_32x32x16_bf16 v[16:31], v[72:75], v[32:35], v[16:31]
    s_waitcnt lgkmcnt(1)
    ds_read_b128 v[72:75], v10 offset:19520
    v_exp_f32 v45, v45
    v_exp_f32 v46, v46
    v_exp_f32 v47, v47
    v_cvt_pk_bf16_f32 v84, v40, v41
    v_cvt_pk_bf16_f32 v85, v42, v43
    v_cvt_pk_bf16_f32 v86, v44, v45
    v_cvt_pk_bf16_f32 v87, v46, v47
    v_mfma_f32_32x32x8bf16_1k v[32:47], v[68:69], v[70:71], 0
    v_exp_f32 v48, v48
    v_exp_f32 v49, v49
    v_exp_f32 v50, v50
    v_exp_f32 v51, v51
    v_exp_f32 v52, v52
    v_mfma_f32_32x32x16_bf16 v[32:47], v[64:67], v[80:83], v[32:47]
    s_waitcnt lgkmcnt(1)
    ds_read_b128 v[64:67], v8 offset:25280
    ds_read_b64 v[68:69], v9 offset:25280
    v_exp_f32 v53, v53
    v_exp_f32 v54, v54
    v_exp_f32 v55, v55
    v_cvt_pk_bf16_f32 v48, v48, v49
    v_cvt_pk_bf16_f32 v49, v50, v51
    v_cvt_pk_bf16_f32 v50, v52, v53
    v_cvt_pk_bf16_f32 v51, v54, v55
    v_mfma_f32_32x32x16_bf16 v[16:31], v[76:79], v[84:87], v[16:31]
    s_waitcnt lgkmcnt(2)
    ds_read_b128 v[76:79], v10 offset:20256
    v_exp_f32 v56, v56
    v_exp_f32 v57, v57
    v_exp_f32 v58, v58
    v_exp_f32 v59, v59
    v_exp_f32 v60, v60
    v_mfma_f32_32x32x16_bf16 v[16:31], v[72:75], v[48:51], v[16:31]
    s_waitcnt lgkmcnt(1)
    ds_read_b128 v[72:75], v10 offset:22528
    v_exp_f32 v61, v61
    v_exp_f32 v62, v62
    v_exp_f32 v63, v63
    v_cvt_pk_bf16_f32 v84, v56, v57
    v_cvt_pk_bf16_f32 v85, v58, v59
    v_cvt_pk_bf16_f32 v86, v60, v61
    v_cvt_pk_bf16_f32 v87, v62, v63
    v_mfma_f32_32x32x8bf16_1k v[48:63], v[68:69], v[70:71], 0
    v_exp_f32 v32, v32
    v_exp_f32 v33, v33
    v_exp_f32 v34, v34
    v_exp_f32 v35, v35
    v_exp_f32 v36, v36
    v_mfma_f32_32x32x16_bf16 v[48:63], v[64:67], v[80:83], v[48:63]
    s_waitcnt lgkmcnt(1)
    ds_read_b128 v[64:67], v8 offset:28032
    ds_read_b64 v[68:69], v9 offset:28032
    v_exp_f32 v37, v37
    v_exp_f32 v38, v38
    v_exp_f32 v39, v39
    v_cvt_pk_bf16_f32 v32, v32, v33
    v_cvt_pk_bf16_f32 v33, v34, v35
    v_cvt_pk_bf16_f32 v34, v36, v37
    v_cvt_pk_bf16_f32 v35, v38, v39
    v_mfma_f32_32x32x16_bf16 v[16:31], v[76:79], v[84:87], v[16:31]
    s_waitcnt lgkmcnt(2)
    ds_read_b128 v[76:79], v10 offset:23264
    v_exp_f32 v40, v40
    v_exp_f32 v41, v41
    v_exp_f32 v42, v42
    v_exp_f32 v43, v43
    v_exp_f32 v44, v44
    v_mfma_f32_32x32x16_bf16 v[16:31], v[72:75], v[32:35], v[16:31]
    s_waitcnt lgkmcnt(1)
    ds_read_b128 v[72:75], v10 offset:25280
    v_exp_f32 v45, v45
    v_exp_f32 v46, v46
    v_exp_f32 v47, v47
    v_cvt_pk_bf16_f32 v84, v40, v41
    v_cvt_pk_bf16_f32 v85, v42, v43
    v_cvt_pk_bf16_f32 v86, v44, v45
    v_cvt_pk_bf16_f32 v87, v46, v47
    v_mfma_f32_32x32x8bf16_1k v[32:47], v[68:69], v[70:71], 0
    v_exp_f32 v48, v48
    v_exp_f32 v49, v49
    v_exp_f32 v50, v50
    v_exp_f32 v51, v51
    v_exp_f32 v52, v52
    v_mfma_f32_32x32x16_bf16 v[32:47], v[64:67], v[80:83], v[32:47]
    s_waitcnt lgkmcnt(1)
    ds_read_b128 v[64:67], v8 offset:30784
    ds_read_b64 v[68:69], v9 offset:30784
    v_exp_f32 v53, v53
    v_exp_f32 v54, v54
    v_exp_f32 v55, v55
    v_cvt_pk_bf16_f32 v48, v48, v49
    v_cvt_pk_bf16_f32 v49, v50, v51
    v_cvt_pk_bf16_f32 v50, v52, v53
    v_cvt_pk_bf16_f32 v51, v54, v55
    v_mfma_f32_32x32x16_bf16 v[16:31], v[76:79], v[84:87], v[16:31]
    s_waitcnt lgkmcnt(2)
    ds_read_b128 v[76:79], v10 offset:26016
    v_exp_f32 v56, v56
    v_exp_f32 v57, v57
    v_exp_f32 v58, v58
    v_exp_f32 v59, v59
    v_exp_f32 v60, v60
    v_mfma_f32_32x32x16_bf16 v[16:31], v[72:75], v[48:51], v[16:31]
    s_waitcnt lgkmcnt(1)
    ds_read_b128 v[72:75], v10 offset:28032
    v_exp_f32 v61, v61
    v_exp_f32 v62, v62
    v_exp_f32 v63, v63
    v_cvt_pk_bf16_f32 v84, v56, v57
    v_cvt_pk_bf16_f32 v85, v58, v59
    v_cvt_pk_bf16_f32 v86, v60, v61
    v_cvt_pk_bf16_f32 v87, v62, v63
    s_barrier
    v_mfma_f32_32x32x8bf16_1k v[48:63], v[68:69], v[70:71], 0
    s_setprio 1
    s_add_u32 s29, s29, 22016
    s_cmp_ge_u32 s29, 176128
    s_cselect_b32 s95, 176128, 0
    s_sub_u32 s29, s29, s95
    s_add_u32 m0, s85, 113664
    s_add_u32 s95, s29, s92
    buffer_load_dwordx4 v1, s[32:35], s95 offen offset:0 sc1 lds
    v_exp_f32 v32, v32
    v_exp_f32 v33, v33
    v_exp_f32 v34, v34
    v_exp_f32 v35, v35
    v_exp_f32 v36, v36
    v_mfma_f32_32x32x16_bf16 v[48:63], v[64:67], v[80:83], v[48:63]
    s_waitcnt lgkmcnt(1)
    ds_read_b128 v[64:67], v8 offset:0
    ds_read_b64 v[68:69], v9 offset:0
    buffer_load_dwordx4 v1, s[32:35], s95 offen offset:1024 sc1 lds
    v_exp_f32 v37, v37
    v_exp_f32 v38, v38
    v_exp_f32 v39, v39
    v_cvt_pk_bf16_f32 v32, v32, v33
    v_cvt_pk_bf16_f32 v33, v34, v35
    v_cvt_pk_bf16_f32 v34, v36, v37
    v_cvt_pk_bf16_f32 v35, v38, v39
    v_mfma_f32_32x32x16_bf16 v[16:31], v[76:79], v[84:87], v[16:31]
    s_waitcnt lgkmcnt(2)
    ds_read_b128 v[76:79], v10 offset:28768
    s_cmp_eq_u32 s85, 9216
    s_cbranch_scc1 L_skip_kv_51
    buffer_load_dwordx4 v1, s[32:35], s95 offen offset:2048 sc1 lds
L_skip_kv_51:
    v_exp_f32 v40, v40
    v_exp_f32 v41, v41
    v_exp_f32 v42, v42
    v_exp_f32 v43, v43
    v_exp_f32 v44, v44
    v_mfma_f32_32x32x16_bf16 v[16:31], v[72:75], v[32:35], v[16:31]
    s_waitcnt lgkmcnt(1)
    ds_read_b128 v[72:75], v10 offset:30784
    s_cmp_ge_u32 s72, 20
    s_cbranch_scc1 L_skip_r1_52
    v_lshrrev_b32 v88, 2, v0
    v_mul_u32_u24 v89, 384, v88
    v_and_b32 v90, 3, v0
    v_lshl_add_u32 v89, v90, 3, v89
    v_bfe_u32 v88, v88, 1, 2
    s_mul_i32 s87, s74, 3
    v_xor_b32 v90, s87, v88
    v_lshl_add_u32 v90, v90, 5, v89
    s_add_u32 s87, s87, 1
    ds_read_b64_tr_b16 v[220:221], v90
    ds_read_b64_tr_b16 v[222:223], v90 offset:6144
    v_xor_b32 v90, s87, v88
    v_lshl_add_u32 v90, v90, 5, v89
    s_add_u32 s87, s87, 1
    ds_read_b64_tr_b16 v[224:225], v90
    ds_read_b64_tr_b16 v[226:227], v90 offset:6144
    v_xor_b32 v90, s87, v88
    v_lshl_add_u32 v90, v90, 5, v89
    s_add_u32 s87, s87, 1
    ds_read_b64_tr_b16 v[228:229], v90
    ds_read_b64_tr_b16 v[230:231], v90 offset:6144
    s_mul_i32 s87, s73, 20
    s_add_u32 s87, s87, s72
    s_mul_i32 s87, s87, 12288
    s_add_u32 s87, s87, s85
    s_add_u32 s87, s87, 14909440
    s_waitcnt lgkmcnt(0)
    buffer_store_dwordx4 v[220:223], v1, s[32:35], s87 offen offset:0 sc1
    buffer_store_dwordx4 v[224:227], v1, s[32:35], s87 offen offset:1024 sc1
    buffer_store_dwordx4 v[228:231], v1, s[32:35], s87 offen offset:2048 sc1
L_skip_r1_52:
    v_exp_f32 v45, v45
    v_exp_f32 v46, v46
    v_exp_f32 v47, v47
    v_cvt_pk_bf16_f32 v84, v40, v41
    v_cvt_pk_bf16_f32 v85, v42, v43
    v_cvt_pk_bf16_f32 v86, v44, v45
    v_cvt_pk_bf16_f32 v87, v46, v47
    v_mfma_f32_32x32x8bf16_1k v[32:47], v[68:69], v[70:71], 0
    s_sub_u32 s87, s79, 80
    s_cmp_ge_u32 s87, 160
    s_cbranch_scc1 L_skip_m2_53
    s_cmp_ge_u32 s74, 5
    s_cbranch_scc1 L_skip_m2_53
    s_add_u32 m0, s81, 138240
    s_add_u32 s80, s80, 245760
    buffer_load_dwordx4 v152, s[64:67], s80 offen lds
    s_add_u32 m0, s81, 139264
    s_add_u32 s80, s80, 245760
    buffer_load_dwordx4 v152, s[64:67], s80 offen lds
L_skip_m2_53:
    v_exp_f32 v48, v48
    v_exp_f32 v49, v49
    v_exp_f32 v50, v50
    v_exp_f32 v51, v51
    v_exp_f32 v52, v52
    v_mfma_f32_32x32x16_bf16 v[32:47], v[64:67], v[80:83], v[32:47]
    s_waitcnt lgkmcnt(1)
    ds_read_b128 v[64:67], v8 offset:2752
    ds_read_b64 v[68:69], v9 offset:2752
    v_exp_f32 v53, v53
    v_exp_f32 v54, v54
    v_exp_f32 v55, v55
    v_cvt_pk_bf16_f32 v48, v48, v49
    v_cvt_pk_bf16_f32 v49, v50, v51
    v_cvt_pk_bf16_f32 v50, v52, v53
    v_cvt_pk_bf16_f32 v51, v54, v55
    v_mfma_f32_32x32x16_bf16 v[16:31], v[76:79], v[84:87], v[16:31]
    s_waitcnt lgkmcnt(2)
    ds_read_b128 v[76:79], v10 offset:31520
    v_exp_f32 v56, v56
    v_exp_f32 v57, v57
    v_exp_f32 v58, v58
    v_exp_f32 v59, v59
    v_exp_f32 v60, v60
    v_mfma_f32_32x32x16_bf16 v[16:31], v[72:75], v[48:51], v[16:31]
    s_waitcnt lgkmcnt(1)
    ds_read_b128 v[72:75], v10 offset:0
    v_exp_f32 v61, v61
    v_exp_f32 v62, v62
    v_exp_f32 v63, v63
    v_cvt_pk_bf16_f32 v84, v56, v57
    v_cvt_pk_bf16_f32 v85, v58, v59
    v_cvt_pk_bf16_f32 v86, v60, v61
    v_cvt_pk_bf16_f32 v87, v62, v63
    v_mfma_f32_32x32x8bf16_1k v[48:63], v[68:69], v[70:71], 0
    v_exp_f32 v32, v32
    v_exp_f32 v33, v33
    v_exp_f32 v34, v34
    v_exp_f32 v35, v35
    v_exp_f32 v36, v36
    v_mfma_f32_32x32x16_bf16 v[48:63], v[64:67], v[80:83], v[48:63]
    s_waitcnt lgkmcnt(1)
    ds_read_b128 v[64:67], v8 offset:5504
    ds_read_b64 v[68:69], v9 offset:5504
    v_exp_f32 v37, v37
    v_exp_f32 v38, v38
    v_exp_f32 v39, v39
    v_cvt_pk_bf16_f32 v32, v32, v33
    v_cvt_pk_bf16_f32 v33, v34, v35
    v_cvt_pk_bf16_f32 v34, v36, v37
    v_cvt_pk_bf16_f32 v35, v38, v39
    v_mfma_f32_32x32x16_bf16 v[16:31], v[76:79], v[84:87], v[16:31]
    s_waitcnt lgkmcnt(2)
    ds_read_b128 v[76:79], v10 offset:736
    v_exp_f32 v40, v40
    v_exp_f32 v41, v41
    v_exp_f32 v42, v42
    v_exp_f32 v43, v43
    v_exp_f32 v44, v44
    v_mfma_f32_32x32x16_bf16 v[16:31], v[72:75], v[32:35], v[16:31]
    s_waitcnt lgkmcnt(1)
    ds_read_b128 v[72:75], v10 offset:2752
    v_exp_f32 v45, v45
    v_exp_f32 v46, v46
    v_exp_f32 v47, v47
    v_cvt_pk_bf16_f32 v84, v40, v41
    v_cvt_pk_bf16_f32 v85, v42, v43
    v_cvt_pk_bf16_f32 v86, v44, v45
    v_cvt_pk_bf16_f32 v87, v46, v47
    v_mfma_f32_32x32x8bf16_1k v[32:47], v[68:69], v[70:71], 0
    v_exp_f32 v48, v48
    v_exp_f32 v49, v49
    v_exp_f32 v50, v50
    v_exp_f32 v51, v51
    v_exp_f32 v52, v52
    v_mfma_f32_32x32x16_bf16 v[32:47], v[64:67], v[80:83], v[32:47]
    s_waitcnt lgkmcnt(1)
    ds_read_b128 v[64:67], v8 offset:8256
    ds_read_b64 v[68:69], v9 offset:8256
    v_exp_f32 v53, v53
    v_exp_f32 v54, v54
    v_exp_f32 v55, v55
    v_cvt_pk_bf16_f32 v48, v48, v49
    v_cvt_pk_bf16_f32 v49, v50, v51
    v_cvt_pk_bf16_f32 v50, v52, v53
    v_cvt_pk_bf16_f32 v51, v54, v55
    v_mfma_f32_32x32x16_bf16 v[16:31], v[76:79], v[84:87], v[16:31]
    s_waitcnt lgkmcnt(2)
    ds_read_b128 v[76:79], v10 offset:3488
    v_exp_f32 v56, v56
    v_exp_f32 v57, v57
    v_exp_f32 v58, v58
    v_exp_f32 v59, v59
    v_exp_f32 v60, v60
    v_mfma_f32_32x32x16_bf16 v[16:31], v[72:75], v[48:51], v[16:31]
    s_waitcnt lgkmcnt(1)
    ds_read_b128 v[72:75], v10 offset:5504
    v_exp_f32 v61, v61
    v_exp_f32 v62, v62
    v_exp_f32 v63, v63
    v_cvt_pk_bf16_f32 v84, v56, v57
    v_cvt_pk_bf16_f32 v85, v58, v59
    v_cvt_pk_bf16_f32 v86, v60, v61
    v_cvt_pk_bf16_f32 v87, v62, v63
    s_waitcnt vmcnt(0)
    s_barrier
    v_mfma_f32_32x32x8bf16_1k v[48:63], v[68:69], v[70:71], 0
    s_setprio 0
    v_exp_f32 v32, v32
    v_exp_f32 v33, v33
    v_exp_f32 v34, v34
    v_exp_f32 v35, v35
    v_exp_f32 v36, v36
    v_mfma_f32_32x32x16_bf16 v[48:63], v[64:67], v[80:83], v[48:63]
    s_waitcnt lgkmcnt(1)
    ds_read_b128 v[64:67], v8 offset:11264
    ds_read_b64 v[68:69], v9 offset:11264
    v_exp_f32 v37, v37
    v_exp_f32 v38, v38
    v_exp_f32 v39, v39
    v_cvt_pk_bf16_f32 v32, v32, v33
    v_cvt_pk_bf16_f32 v33, v34, v35
    v_cvt_pk_bf16_f32 v34, v36, v37
    v_cvt_pk_bf16_f32 v35, v38, v39
    v_mfma_f32_32x32x16_bf16 v[16:31], v[76:79], v[84:87], v[16:31]
    s_waitcnt lgkmcnt(2)
    ds_read_b128 v[76:79], v10 offset:6240
    v_exp_f32 v40, v40
    v_exp_f32 v41, v41
    v_exp_f32 v42, v42
    v_exp_f32 v43, v43
    v_exp_f32 v44, v44
    v_mfma_f32_32x32x16_bf16 v[16:31], v[72:75], v[32:35], v[16:31]
    s_waitcnt lgkmcnt(1)
    ds_read_b128 v[72:75], v10 offset:8256
    v_exp_f32 v45, v45
    v_exp_f32 v46, v46
    v_exp_f32 v47, v47
    v_cvt_pk_bf16_f32 v84, v40, v41
    v_cvt_pk_bf16_f32 v85, v42, v43
    v_cvt_pk_bf16_f32 v86, v44, v45
    v_cvt_pk_bf16_f32 v87, v46, v47
    v_mfma_f32_32x32x8bf16_1k v[32:47], v[68:69], v[70:71], 0
    v_exp_f32 v48, v48
    v_exp_f32 v49, v49
    v_exp_f32 v50, v50
    v_exp_f32 v51, v51
    v_exp_f32 v52, v52
    v_mfma_f32_32x32x16_bf16 v[32:47], v[64:67], v[80:83], v[32:47]
    s_waitcnt lgkmcnt(1)
    ds_read_b128 v[64:67], v8 offset:14016
    ds_read_b64 v[68:69], v9 offset:14016
    v_exp_f32 v53, v53
    v_exp_f32 v54, v54
    v_exp_f32 v55, v55
    v_cvt_pk_bf16_f32 v48, v48, v49
    v_cvt_pk_bf16_f32 v49, v50, v51
    v_cvt_pk_bf16_f32 v50, v52, v53
    v_cvt_pk_bf16_f32 v51, v54, v55
    v_mfma_f32_32x32x16_bf16 v[16:31], v[76:79], v[84:87], v[16:31]
    s_waitcnt lgkmcnt(2)
    ds_read_b128 v[76:79], v10 offset:8992
    v_exp_f32 v56, v56
    v_exp_f32 v57, v57
    v_exp_f32 v58, v58
    v_exp_f32 v59, v59
    v_exp_f32 v60, v60
    v_mfma_f32_32x32x16_bf16 v[16:31], v[72:75], v[48:51], v[16:31]
    s_waitcnt lgkmcnt(1)
    ds_read_b128 v[72:75], v10 offset:11264
    v_exp_f32 v61, v61
    v_exp_f32 v62, v62
    v_exp_f32 v63, v63
    v_cvt_pk_bf16_f32 v84, v56, v57
    v_cvt_pk_bf16_f32 v85, v58, v59
    v_cvt_pk_bf16_f32 v86, v60, v61
    v_cvt_pk_bf16_f32 v87, v62, v63
    v_mfma_f32_32x32x8bf16_1k v[48:63], v[68:69], v[70:71], 0
    v_exp_f32 v32, v32
    v_exp_f32 v33, v33
    v_exp_f32 v34, v34
    v_exp_f32 v35, v35
    v_exp_f32 v36, v36
    v_mfma_f32_32x32x16_bf16 v[48:63], v[64:67], v[80:83], v[48:63]
    s_waitcnt lgkmcnt(1)
    ds_read_b128 v[64:67], v8 offset:16768
    ds_read_b64 v[68:69], v9 offset:16768
    v_exp_f32 v37, v37
    v_exp_f32 v38, v38
    v_exp_f32 v39, v39
    v_cvt_pk_bf16_f32 v32, v32, v33
    v_cvt_pk_bf16_f32 v33, v34, v35
    v_cvt_pk_bf16_f32 v34, v36, v37
    v_cvt_pk_bf16_f32 v35, v38, v39
    v_mfma_f32_32x32x16_bf16 v[16:31], v[76:79], v[84:87], v[16:31]
    s_waitcnt lgkmcnt(2)
    ds_read_b128 v[76:79], v10 offset:12000
    v_exp_f32 v40, v40
    v_exp_f32 v41, v41
    v_exp_f32 v42, v42
    v_exp_f32 v43, v43
    v_exp_f32 v44, v44
    v_mfma_f32_32x32x16_bf16 v[16:31], v[72:75], v[32:35], v[16:31]
    s_waitcnt lgkmcnt(1)
    ds_read_b128 v[72:75], v10 offset:14016
    v_exp_f32 v45, v45
    v_exp_f32 v46, v46
    v_exp_f32 v47, v47
    v_cvt_pk_bf16_f32 v84, v40, v41
    v_cvt_pk_bf16_f32 v85, v42, v43
    v_cvt_pk_bf16_f32 v86, v44, v45
    v_cvt_pk_bf16_f32 v87, v46, v47
    v_mfma_f32_32x32x8bf16_1k v[32:47], v[68:69], v[70:71], 0
    v_exp_f32 v48, v48
    v_exp_f32 v49, v49
    v_exp_f32 v50, v50
    v_exp_f32 v51, v51
    v_exp_f32 v52, v52
    v_mfma_f32_32x32x16_bf16 v[32:47], v[64:67], v[80:83], v[32:47]
    s_waitcnt lgkmcnt(1)
    ds_read_b128 v[64:67], v8 offset:19520
    ds_read_b64 v[68:69], v9 offset:19520
    v_exp_f32 v53, v53
    v_exp_f32 v54, v54
    v_exp_f32 v55, v55
    v_cvt_pk_bf16_f32 v48, v48, v49
    v_cvt_pk_bf16_f32 v49, v50, v51
    v_cvt_pk_bf16_f32 v50, v52, v53
    v_cvt_pk_bf16_f32 v51, v54, v55
    v_mfma_f32_32x32x16_bf16 v[16:31], v[76:79], v[84:87], v[16:31]
    s_waitcnt lgkmcnt(2)
    ds_read_b128 v[76:79], v10 offset:14752
    v_exp_f32 v56, v56
    v_exp_f32 v57, v57
    v_exp_f32 v58, v58
    v_exp_f32 v59, v59
    v_exp_f32 v60, v60
    v_mfma_f32_32x32x16_bf16 v[16:31], v[72:75], v[48:51], v[16:31]
    s_waitcnt lgkmcnt(1)
    ds_read_b128 v[72:75], v10 offset:16768
    v_exp_f32 v61, v61
    v_exp_f32 v62, v62
    v_exp_f32 v63, v63
    v_cvt_pk_bf16_f32 v84, v56, v57
    v_cvt_pk_bf16_f32 v85, v58, v59
    v_cvt_pk_bf16_f32 v86, v60, v61
    v_cvt_pk_bf16_f32 v87, v62, v63
    s_waitcnt vmcnt(0)
    s_barrier
    v_mfma_f32_32x32x8bf16_1k v[48:63], v[68:69], v[70:71], 0
    s_setprio 1
    s_add_u32 s29, s29, 22016
    s_cmp_ge_u32 s29, 176128
    s_cselect_b32 s95, 176128, 0
    s_sub_u32 s29, s29, s95
    s_add_u32 m0, s85, 102400
    s_add_u32 s95, s29, s92
    buffer_load_dwordx4 v1, s[32:35], s95 offen offset:0 sc1 lds
    v_exp_f32 v32, v32
    v_exp_f32 v33, v33
    v_exp_f32 v34, v34
    v_exp_f32 v35, v35
    v_exp_f32 v36, v36
    v_mfma_f32_32x32x16_bf16 v[48:63], v[64:67], v[80:83], v[48:63]
    s_waitcnt lgkmcnt(1)
    ds_read_b128 v[64:67], v8 offset:22528
    ds_read_b64 v[68:69], v9 offset:22528
    buffer_load_dwordx4 v1, s[32:35], s95 offen offset:1024 sc1 lds
    v_exp_f32 v37, v37
    v_exp_f32 v38, v38
    v_exp_f32 v39, v39
    v_cvt_pk_bf16_f32 v32, v32, v33
    v_cvt_pk_bf16_f32 v33, v34, v35
    v_cvt_pk_bf16_f32 v34, v36, v37
    v_cvt_pk_bf16_f32 v35, v38, v39
    v_mfma_f32_32x32x16_bf16 v[16:31], v[76:79], v[84:87], v[16:31]
    s_waitcnt lgkmcnt(2)
    ds_read_b128 v[76:79], v10 offset:17504
    s_cmp_eq_u32 s85, 9216
    s_cbranch_scc1 L_skip_kv_54
    buffer_load_dwordx4 v1, s[32:35], s95 offen offset:2048 sc1 lds
L_skip_kv_54:
    v_exp_f32 v40, v40
    v_exp_f32 v41, v41
    v_exp_f32 v42, v42
    v_exp_f32 v43, v43
    v_exp_f32 v44, v44
    v_mfma_f32_32x32x16_bf16 v[16:31], v[72:75], v[32:35], v[16:31]
    s_waitcnt lgkmcnt(1)
    ds_read_b128 v[72:75], v10 offset:19520
    s_cmp_lg_u32 s74, 0
    s_cbranch_scc1 L_skip_pff_55
    s_lshl_b32 s87, s72, 7
    s_lshl_b32 s89, s73, 3
    s_add_u32 s87, s87, s89
    s_add_u32 s87, s87, 40960
    v_mov_b32 v88, s75
    v_mov_b32 v89, s31
    v_mov_b32 v90, 0
    s_mov_b64 exec, 1
    buffer_store_dwordx2 v[88:89], v90, s[32:35], s87 offen sc1
    s_mov_b64 exec, -1
L_skip_pff_55:
    v_exp_f32 v45, v45
    v_exp_f32 v46, v46
    v_exp_f32 v47, v47
    v_cvt_pk_bf16_f32 v84, v40, v41
    v_cvt_pk_bf16_f32 v85, v42, v43
    v_cvt_pk_bf16_f32 v86, v44, v45
    v_cvt_pk_bf16_f32 v87, v46, v47
    v_mfma_f32_32x32x8bf16_1k v[32:47], v[68:69], v[70:71], 0
    s_waitcnt vmcnt(2)
    v_exp_f32 v48, v48
    v_exp_f32 v49, v49
    v_exp_f32 v50, v50
    v_exp_f32 v51, v51
    v_exp_f32 v52, v52
    v_mfma_f32_32x32x16_bf16 v[32:47], v[64:67], v[80:83], v[32:47]
    s_waitcnt lgkmcnt(1)
    ds_read_b128 v[64:67], v8 offset:25280
    ds_read_b64 v[68:69], v9 offset:25280
    s_sub_u32 s87, s79, 80
    s_cmp_ge_u32 s87, 160
    s_cbranch_scc1 L_skip_m2_56
    s_cmp_ge_u32 s74, 5
    s_cbranch_scc1 L_skip_m2_56
    v_mov_b32 v188, v154
    v_lshlrev_b32 v152, 16, v188
    v_and_b32 v153, 0xffff0000, v188
    v_mul_f32 v154, 0xbfb8aa3b, v152
    v_mul_f32 v155, 0xbfb8aa3b, v153
    v_exp_f32 v154, v154
    v_exp_f32 v155, v155
    s_lshl_b32 s80, s74, 8
    v_add_f32 v154, 1.0, v154
    v_add_f32 v155, 1.0, v155
    v_rcp_f32 v154, v154
    v_rcp_f32 v155, v155
    s_add_u32 s80, s80, 156672
    v_mul_f32 v152, v152, v154
    v_mul_f32 v153, v153, v155
    v_lshl_add_u32 v154, v0, 2, s80
    v_cvt_pk_bf16_f32 v152, v152, v153
    v_lshrrev_b32 v155, 4, v0
    v_lshl_add_u32 v155, v155, 4, s80
    ds_write_b32 v154, v152
    ds_read_b128 v[156:159], v155 offset:0
    ds_read_b128 v[160:163], v155 offset:64
    ds_read_b128 v[164:167], v155 offset:128
    ds_read_b128 v[168:171], v155 offset:192
    s_lshl_b32 s80, s74, 12
    s_add_u32 s80, s80, 136192
    v_lshl_add_u32 v152, v0, 3, s80
    ds_read_b64_tr_b16 v[172:173], v152 offset:0
    ds_read_b64_tr_b16 v[174:175], v152 offset:512
    ds_read_b64_tr_b16 v[176:177], v152 offset:1024
    ds_read_b64_tr_b16 v[178:179], v152 offset:1536
    ds_read_b64_tr_b16 v[180:181], v152 offset:2048
    ds_read_b64_tr_b16 v[182:183], v152 offset:2560
    ds_read_b64_tr_b16 v[184:185], v152 offset:3072
    ds_read_b64_tr_b16 v[186:187], v152 offset:3584
    s_lshl_b32 s80, s74, 6
    s_add_u32 s80, s80, 161792
    v_add_u32 v153, s80, v0
    s_waitcnt lgkmcnt(6)
    v_mfma_f32_16x16x32_bf16 v[188:191], v[172:175], v[156:159], 0
    s_waitcnt lgkmcnt(4)
    v_mfma_f32_16x16x32_bf16 v[188:191], v[176:179], v[160:163], v[188:191]
    s_waitcnt lgkmcnt(2)
    v_mfma_f32_16x16x32_bf16 v[188:191], v[180:183], v[164:167], v[188:191]
    s_waitcnt lgkmcnt(0)
    v_mfma_f32_16x16x32_bf16 v[188:191], v[184:187], v[168:171], v[188:191]
    s_mov_b32 exec_lo, 0x00010001
    s_mov_b32 exec_hi, 0x00010001
    s_nop 5
    ds_write_b128 v153, v[188:191]
    s_mov_b64 exec, -1
    s_waitcnt lgkmcnt(0)
L_skip_m2_56:
    v_exp_f32 v53, v53
    v_exp_f32 v54, v54
    v_exp_f32 v55, v55
    v_cvt_pk_bf16_f32 v48, v48, v49
    v_cvt_pk_bf16_f32 v49, v50, v51
    v_cvt_pk_bf16_f32 v50, v52, v53
    v_cvt_pk_bf16_f32 v51, v54, v55
    v_mfma_f32_32x32x16_bf16 v[16:31], v[76:79], v[84:87], v[16:31]
    s_waitcnt lgkmcnt(2)
    ds_read_b128 v[76:79], v10 offset:20256
    v_exp_f32 v56, v56
    v_exp_f32 v57, v57
    v_exp_f32 v58, v58
    v_exp_f32 v59, v59
    v_exp_f32 v60, v60
    v_mfma_f32_32x32x16_bf16 v[16:31], v[72:75], v[48:51], v[16:31]
    s_waitcnt lgkmcnt(1)
    ds_read_b128 v[72:75], v10 offset:22528
    v_exp_f32 v61, v61
    v_exp_f32 v62, v62
    v_exp_f32 v63, v63
    v_cvt_pk_bf16_f32 v84, v56, v57
    v_cvt_pk_bf16_f32 v85, v58, v59
    v_cvt_pk_bf16_f32 v86, v60, v61
    v_cvt_pk_bf16_f32 v87, v62, v63
    v_mfma_f32_32x32x8bf16_1k v[48:63], v[68:69], v[70:71], 0
    v_exp_f32 v32, v32
    v_exp_f32 v33, v33
    v_exp_f32 v34, v34
    v_exp_f32 v35, v35
    v_exp_f32 v36, v36
    v_mfma_f32_32x32x16_bf16 v[48:63], v[64:67], v[80:83], v[48:63]
    s_waitcnt lgkmcnt(1)
    ds_read_b128 v[64:67], v8 offset:28032
    ds_read_b64 v[68:69], v9 offset:28032
    v_exp_f32 v37, v37
    v_exp_f32 v38, v38
    v_exp_f32 v39, v39
    v_cvt_pk_bf16_f32 v32, v32, v33
    v_cvt_pk_bf16_f32 v33, v34, v35
    v_cvt_pk_bf16_f32 v34, v36, v37
    v_cvt_pk_bf16_f32 v35, v38, v39
    v_mfma_f32_32x32x16_bf16 v[16:31], v[76:79], v[84:87], v[16:31]
    s_waitcnt lgkmcnt(2)
    ds_read_b128 v[76:79], v10 offset:23264
    v_exp_f32 v40, v40
    v_exp_f32 v41, v41
    v_exp_f32 v42, v42
    v_exp_f32 v43, v43
    v_exp_f32 v44, v44
    v_mfma_f32_32x32x16_bf16 v[16:31], v[72:75], v[32:35], v[16:31]
    s_waitcnt lgkmcnt(1)
    ds_read_b128 v[72:75], v10 offset:25280
    v_exp_f32 v45, v45
    v_exp_f32 v46, v46
    v_exp_f32 v47, v47
    v_cvt_pk_bf16_f32 v84, v40, v41
    v_cvt_pk_bf16_f32 v85, v42, v43
    v_cvt_pk_bf16_f32 v86, v44, v45
    v_cvt_pk_bf16_f32 v87, v46, v47
    v_mfma_f32_32x32x8bf16_1k v[32:47], v[68:69], v[70:71], 0
    v_exp_f32 v48, v48
    v_exp_f32 v49, v49
    v_exp_f32 v50, v50
    v_exp_f32 v51, v51
    v_exp_f32 v52, v52
    v_mfma_f32_32x32x16_bf16 v[32:47], v[64:67], v[80:83], v[32:47]
    s_waitcnt lgkmcnt(1)
    ds_read_b128 v[64:67], v8 offset:30784
    ds_read_b64 v[68:69], v9 offset:30784
    v_exp_f32 v53, v53
    v_exp_f32 v54, v54
    v_exp_f32 v55, v55
    v_cvt_pk_bf16_f32 v48, v48, v49
    v_cvt_pk_bf16_f32 v49, v50, v51
    v_cvt_pk_bf16_f32 v50, v52, v53
    v_cvt_pk_bf16_f32 v51, v54, v55
    v_mfma_f32_32x32x16_bf16 v[16:31], v[76:79], v[84:87], v[16:31]
    s_waitcnt lgkmcnt(2)
    ds_read_b128 v[76:79], v10 offset:26016
    v_exp_f32 v56, v56
    v_exp_f32 v57, v57
    v_exp_f32 v58, v58
    v_exp_f32 v59, v59
    v_exp_f32 v60, v60
    v_mfma_f32_32x32x16_bf16 v[16:31], v[72:75], v[48:51], v[16:31]
    s_waitcnt lgkmcnt(1)
    ds_read_b128 v[72:75], v10 offset:28032
    v_exp_f32 v61, v61
    v_exp_f32 v62, v62
    v_exp_f32 v63, v63
    v_cvt_pk_bf16_f32 v84, v56, v57
    v_cvt_pk_bf16_f32 v85, v58, v59
    v_cvt_pk_bf16_f32 v86, v60, v61
    v_cvt_pk_bf16_f32 v87, v62, v63
    s_waitcnt vmcnt(0)
    s_barrier
    v_mfma_f32_32x32x8bf16_1k v[48:63], v[68:69], v[70:71], 0
    s_setprio 0
    v_exp_f32 v32, v32
    v_exp_f32 v33, v33
    v_exp_f32 v34, v34
    v_exp_f32 v35, v35
    v_exp_f32 v36, v36
    v_mfma_f32_32x32x16_bf16 v[48:63], v[64:67], v[80:83], v[48:63]
    s_waitcnt lgkmcnt(1)
    ds_read_b128 v[64:67], v8 offset:0
    ds_read_b64 v[68:69], v9 offset:0
    v_exp_f32 v37, v37
    v_exp_f32 v38, v38
    v_exp_f32 v39, v39
    v_cvt_pk_bf16_f32 v32, v32, v33
    v_cvt_pk_bf16_f32 v33, v34, v35
    v_cvt_pk_bf16_f32 v34, v36, v37
    v_cvt_pk_bf16_f32 v35, v38, v39
    v_mfma_f32_32x32x16_bf16 v[16:31], v[76:79], v[84:87], v[16:31]
    s_waitcnt lgkmcnt(2)
    ds_read_b128 v[76:79], v10 offset:28768
    v_exp_f32 v40, v40
    v_exp_f32 v41, v41
    v_exp_f32 v42, v42
    v_exp_f32 v43, v43
    v_exp_f32 v44, v44
    v_mfma_f32_32x32x16_bf16 v[16:31], v[72:75], v[32:35], v[16:31]
    s_waitcnt lgkmcnt(1)
    ds_read_b128 v[72:75], v10 offset:30784
    v_exp_f32 v45, v45
    v_exp_f32 v46, v46
    v_exp_f32 v47, v47
    v_cvt_pk_bf16_f32 v84, v40, v41
    v_cvt_pk_bf16_f32 v85, v42, v43
    v_cvt_pk_bf16_f32 v86, v44, v45
    v_cvt_pk_bf16_f32 v87, v46, v47
    v_mfma_f32_32x32x8bf16_1k v[32:47], v[68:69], v[70:71], 0
    v_exp_f32 v48, v48
    v_exp_f32 v49, v49
    v_exp_f32 v50, v50
    v_exp_f32 v51, v51
    v_exp_f32 v52, v52
    v_mfma_f32_32x32x16_bf16 v[32:47], v[64:67], v[80:83], v[32:47]
    s_waitcnt lgkmcnt(1)
    ds_read_b128 v[64:67], v8 offset:2752
    ds_read_b64 v[68:69], v9 offset:2752
    v_exp_f32 v53, v53
    v_exp_f32 v54, v54
    v_exp_f32 v55, v55
    v_cvt_pk_bf16_f32 v48, v48, v49
    v_cvt_pk_bf16_f32 v49, v50, v51
    v_cvt_pk_bf16_f32 v50, v52, v53
    v_cvt_pk_bf16_f32 v51, v54, v55
    v_mfma_f32_32x32x16_bf16 v[16:31], v[76:79], v[84:87], v[16:31]
    s_waitcnt lgkmcnt(2)
    ds_read_b128 v[76:79], v10 offset:31520
    v_exp_f32 v56, v56
    v_exp_f32 v57, v57
    v_exp_f32 v58, v58
    v_exp_f32 v59, v59
    v_exp_f32 v60, v60
    v_mfma_f32_32x32x16_bf16 v[16:31], v[72:75], v[48:51], v[16:31]
    s_waitcnt lgkmcnt(1)
    ds_read_b128 v[72:75], v10 offset:0
    v_exp_f32 v61, v61
    v_exp_f32 v62, v62
    v_exp_f32 v63, v63
    v_cvt_pk_bf16_f32 v84, v56, v57
    v_cvt_pk_bf16_f32 v85, v58, v59
    v_cvt_pk_bf16_f32 v86, v60, v61
    v_cvt_pk_bf16_f32 v87, v62, v63
    v_mfma_f32_32x32x8bf16_1k v[48:63], v[68:69], v[70:71], 0
    v_exp_f32 v32, v32
    v_exp_f32 v33, v33
    v_exp_f32 v34, v34
    v_exp_f32 v35, v35
    v_exp_f32 v36, v36
    v_mfma_f32_32x32x16_bf16 v[48:63], v[64:67], v[80:83], v[48:63]
    s_waitcnt lgkmcnt(1)
    ds_read_b128 v[64:67], v8 offset:5504
    ds_read_b64 v[68:69], v9 offset:5504
    v_exp_f32 v37, v37
    v_exp_f32 v38, v38
    v_exp_f32 v39, v39
    v_cvt_pk_bf16_f32 v32, v32, v33
    v_cvt_pk_bf16_f32 v33, v34, v35
    v_cvt_pk_bf16_f32 v34, v36, v37
    v_cvt_pk_bf16_f32 v35, v38, v39
    v_mfma_f32_32x32x16_bf16 v[16:31], v[76:79], v[84:87], v[16:31]
    s_waitcnt lgkmcnt(2)
    ds_read_b128 v[76:79], v10 offset:736
    v_exp_f32 v40, v40
    v_exp_f32 v41, v41
    v_exp_f32 v42, v42
    v_exp_f32 v43, v43
    v_exp_f32 v44, v44
    v_mfma_f32_32x32x16_bf16 v[16:31], v[72:75], v[32:35], v[16:31]
    s_waitcnt lgkmcnt(1)
    ds_read_b128 v[72:75], v10 offset:2752
    v_exp_f32 v45, v45
    v_exp_f32 v46, v46
    v_exp_f32 v47, v47
    v_cvt_pk_bf16_f32 v84, v40, v41
    v_cvt_pk_bf16_f32 v85, v42, v43
    v_cvt_pk_bf16_f32 v86, v44, v45
    v_cvt_pk_bf16_f32 v87, v46, v47
    v_mfma_f32_32x32x8bf16_1k v[32:47], v[68:69], v[70:71], 0
    v_exp_f32 v48, v48
    v_exp_f32 v49, v49
    v_exp_f32 v50, v50
    v_exp_f32 v51, v51
    v_exp_f32 v52, v52
    v_mfma_f32_32x32x16_bf16 v[32:47], v[64:67], v[80:83], v[32:47]
    s_waitcnt lgkmcnt(1)
    ds_read_b128 v[64:67], v8 offset:8256
    ds_read_b64 v[68:69], v9 offset:8256
    v_exp_f32 v53, v53
    v_exp_f32 v54, v54
    v_exp_f32 v55, v55
    v_cvt_pk_bf16_f32 v48, v48, v49
    v_cvt_pk_bf16_f32 v49, v50, v51
    v_cvt_pk_bf16_f32 v50, v52, v53
    v_cvt_pk_bf16_f32 v51, v54, v55
    v_mfma_f32_32x32x16_bf16 v[16:31], v[76:79], v[84:87], v[16:31]
    s_waitcnt lgkmcnt(2)
    ds_read_b128 v[76:79], v10 offset:3488
    v_exp_f32 v56, v56
    v_exp_f32 v57, v57
    v_exp_f32 v58, v58
    v_exp_f32 v59, v59
    v_exp_f32 v60, v60
    v_mfma_f32_32x32x16_bf16 v[16:31], v[72:75], v[48:51], v[16:31]
    s_waitcnt lgkmcnt(1)
    ds_read_b128 v[72:75], v10 offset:5504
    v_exp_f32 v61, v61
    v_exp_f32 v62, v62
    v_exp_f32 v63, v63
    v_cvt_pk_bf16_f32 v84, v56, v57
    v_cvt_pk_bf16_f32 v85, v58, v59
    v_cvt_pk_bf16_f32 v86, v60, v61
    v_cvt_pk_bf16_f32 v87, v62, v63
    s_barrier
    v_mfma_f32_32x32x8bf16_1k v[48:63], v[68:69], v[70:71], 0
    s_setprio 1
    s_add_u32 s29, s29, 22016
    s_cmp_ge_u32 s29, 176128
    s_cselect_b32 s95, 176128, 0
    s_sub_u32 s29, s29, s95
    s_add_u32 m0, s85, 124928
    s_add_u32 s95, s29, s92
    buffer_load_dwordx4 v1, s[32:35], s95 offen offset:0 sc1 lds
    v_exp_f32 v32, v32
    v_exp_f32 v33, v33
    v_exp_f32 v34, v34
    v_exp_f32 v35, v35
    v_exp_f32 v36, v36
    v_mfma_f32_32x32x16_bf16 v[48:63], v[64:67], v[80:83], v[48:63]
    s_waitcnt lgkmcnt(1)
    ds_read_b128 v[64:67], v8 offset:11264
    ds_read_b64 v[68:69], v9 offset:11264
    buffer_load_dwordx4 v1, s[32:35], s95 offen offset:1024 sc1 lds
    v_exp_f32 v37, v37
    v_exp_f32 v38, v38
    v_exp_f32 v39, v39
    v_cvt_pk_bf16_f32 v32, v32, v33
    v_cvt_pk_bf16_f32 v33, v34, v35
    v_cvt_pk_bf16_f32 v34, v36, v37
    v_cvt_pk_bf16_f32 v35, v38, v39
    v_mfma_f32_32x32x16_bf16 v[16:31], v[76:79], v[84:87], v[16:31]
    s_waitcnt lgkmcnt(2)
    ds_read_b128 v[76:79], v10 offset:6240
    s_cmp_eq_u32 s85, 9216
    s_cbranch_scc1 L_skip_kv_57
    buffer_load_dwordx4 v1, s[32:35], s95 offen offset:2048 sc1 lds
L_skip_kv_57:
    v_exp_f32 v40, v40
    v_exp_f32 v41, v41
    v_exp_f32 v42, v42
    v_exp_f32 v43, v43
    v_exp_f32 v44, v44
    v_mfma_f32_32x32x16_bf16 v[16:31], v[72:75], v[32:35], v[16:31]
    s_waitcnt lgkmcnt(1)
    ds_read_b128 v[72:75], v10 offset:8256
    s_sub_u32 s87, s79, 80
    s_cmp_ge_u32 s87, 160
    s_cbranch_scc1 L_skip_m2_58
    s_cmp_ge_u32 s74, 1
    s_cbranch_scc1 L_skip_m2_58
    s_mov_b64 exec, 0xffff
    v_lshlrev_b32 v152, 2, v0
    v_add_u32 v152, 161792, v152
    v_lshlrev_b32 v153, 3, v0
    s_lshl_b32 s80, s79, 7
    s_add_u32 s80, s80, 4096
    ds_read_b32 v154, v152 offset:0
    ds_read_b32 v155, v152 offset:64
    ds_read_b32 v156, v152 offset:128
    ds_read_b32 v157, v152 offset:192
    ds_read_b32 v158, v152 offset:256
    s_waitcnt lgkmcnt(0)
    v_add_f32 v154, v154, v155
    v_add_f32 v156, v156, v157
    v_add_f32 v154, v154, v158
    v_mov_b32 v155, s75
    v_add_f32 v154, v154, v156
    buffer_store_dwordx2 v[154:155], v153, s[32:35], s80 offen sc1
    s_mov_b64 exec, -1
L_skip_m2_58:
    v_exp_f32 v45, v45
    v_exp_f32 v46, v46
    v_exp_f32 v47, v47
    v_cvt_pk_bf16_f32 v84, v40, v41
    v_cvt_pk_bf16_f32 v85, v42, v43
    v_cvt_pk_bf16_f32 v86, v44, v45
    v_cvt_pk_bf16_f32 v87, v46, v47
    v_mfma_f32_32x32x8bf16_1k v[32:47], v[68:69], v[70:71], 0
    s_lshl_b32 s87, s72, 7
    s_lshl_b32 s89, s73, 3
    v_and_b32 v90, 7, v0
    v_lshl_add_u32 v90, v90, 3, s87
    v_and_b32 v91, 31, v0
    v_lshl_add_u32 v91, v91, 7, s89
    v_cmp_gt_u32 vcc, 32, v0
    s_mov_b32 s87, 40960
    s_nop 0
    v_cndmask_b32 v90, v91, v90, vcc
    buffer_load_dwordx2 v[88:89], v90, s[32:35], s87 offen sc1
    v_exp_f32 v48, v48
    v_exp_f32 v49, v49
    v_exp_f32 v50, v50
    v_exp_f32 v51, v51
    v_exp_f32 v52, v52
    v_mfma_f32_32x32x16_bf16 v[32:47], v[64:67], v[80:83], v[32:47]
    s_waitcnt lgkmcnt(1)
    ds_read_b128 v[64:67], v8 offset:14016
    ds_read_b64 v[68:69], v9 offset:14016
    v_exp_f32 v53, v53
    v_exp_f32 v54, v54
    v_exp_f32 v55, v55
    v_cvt_pk_bf16_f32 v48, v48, v49
    v_cvt_pk_bf16_f32 v49, v50, v51
    v_cvt_pk_bf16_f32 v50, v52, v53
    v_cvt_pk_bf16_f32 v51, v54, v55
    v_mfma_f32_32x32x16_bf16 v[16:31], v[76:79], v[84:87], v[16:31]
    s_waitcnt lgkmcnt(2)
    ds_read_b128 v[76:79], v10 offset:8992
    v_exp_f32 v56, v56
    v_exp_f32 v57, v57
    v_exp_f32 v58, v58
    v_exp_f32 v59, v59
    v_exp_f32 v60, v60
    v_mfma_f32_32x32x16_bf16 v[16:31], v[72:75], v[48:51], v[16:31]
    s_waitcnt lgkmcnt(1)
    ds_read_b128 v[72:75], v10 offset:11264
    v_exp_f32 v61, v61
    v_exp_f32 v62, v62
    v_exp_f32 v63, v63
    v_cvt_pk_bf16_f32 v84, v56, v57
    v_cvt_pk_bf16_f32 v85, v58, v59
    v_cvt_pk_bf16_f32 v86, v60, v61
    v_cvt_pk_bf16_f32 v87, v62, v63
    v_mfma_f32_32x32x8bf16_1k v[48:63], v[68:69], v[70:71], 0
    v_exp_f32 v32, v32
    v_exp_f32 v33, v33
    v_exp_f32 v34, v34
    v_exp_f32 v35, v35
    v_exp_f32 v36, v36
    v_mfma_f32_32x32x16_bf16 v[48:63], v[64:67], v[80:83], v[48:63]
    s_waitcnt lgkmcnt(1)
    ds_read_b128 v[64:67], v8 offset:16768
    ds_read_b64 v[68:69], v9 offset:16768
    v_exp_f32 v37, v37
    v_exp_f32 v38, v38
    v_exp_f32 v39, v39
    v_cvt_pk_bf16_f32 v32, v32, v33
    v_cvt_pk_bf16_f32 v33, v34, v35
    v_cvt_pk_bf16_f32 v34, v36, v37
    v_cvt_pk_bf16_f32 v35, v38, v39
    v_mfma_f32_32x32x16_bf16 v[16:31], v[76:79], v[84:87], v[16:31]
    s_waitcnt lgkmcnt(2)
    ds_read_b128 v[76:79], v10 offset:12000
    v_exp_f32 v40, v40
    v_exp_f32 v41, v41
    v_exp_f32 v42, v42
    v_exp_f32 v43, v43
    v_exp_f32 v44, v44
    v_mfma_f32_32x32x16_bf16 v[16:31], v[72:75], v[32:35], v[16:31]
    s_waitcnt lgkmcnt(1)
    ds_read_b128 v[72:75], v10 offset:14016
    v_exp_f32 v45, v45
    v_exp_f32 v46, v46
    v_exp_f32 v47, v47
    v_cvt_pk_bf16_f32 v84, v40, v41
    v_cvt_pk_bf16_f32 v85, v42, v43
    v_cvt_pk_bf16_f32 v86, v44, v45
    v_cvt_pk_bf16_f32 v87, v46, v47
    v_mfma_f32_32x32x8bf16_1k v[32:47], v[68:69], v[70:71], 0
    v_exp_f32 v48, v48
    v_exp_f32 v49, v49
    v_exp_f32 v50, v50
    v_exp_f32 v51, v51
    v_exp_f32 v52, v52
    v_mfma_f32_32x32x16_bf16 v[32:47], v[64:67], v[80:83], v[32:47]
    s_waitcnt lgkmcnt(1)
    ds_read_b128 v[64:67], v8 offset:19520
    ds_read_b64 v[68:69], v9 offset:19520
    v_exp_f32 v53, v53
    v_exp_f32 v54, v54
    v_exp_f32 v55, v55
    v_cvt_pk_bf16_f32 v48, v48, v49
    v_cvt_pk_bf16_f32 v49, v50, v51
    v_cvt_pk_bf16_f32 v50, v52, v53
    v_cvt_pk_bf16_f32 v51, v54, v55
    v_mfma_f32_32x32x16_bf16 v[16:31], v[76:79], v[84:87], v[16:31]
    s_waitcnt lgkmcnt(2)
    ds_read_b128 v[76:79], v10 offset:14752
    v_exp_f32 v56, v56
    v_exp_f32 v57, v57
    v_exp_f32 v58, v58
    v_exp_f32 v59, v59
    v_exp_f32 v60, v60
    v_mfma_f32_32x32x16_bf16 v[16:31], v[72:75], v[48:51], v[16:31]
    s_waitcnt lgkmcnt(1)
    ds_read_b128 v[72:75], v10 offset:16768
    v_exp_f32 v61, v61
    v_exp_f32 v62, v62
    v_exp_f32 v63, v63
    v_cvt_pk_bf16_f32 v84, v56, v57
    v_cvt_pk_bf16_f32 v85, v58, v59
    v_cvt_pk_bf16_f32 v86, v60, v61
    v_cvt_pk_bf16_f32 v87, v62, v63
    s_waitcnt vmcnt(1)
    s_barrier
    v_mfma_f32_32x32x8bf16_1k v[48:63], v[68:69], v[70:71], 0
    s_setprio 0
    s_waitcnt vmcnt(0)
    v_cmp_ne_u32 vcc, s75, v88
    s_cbranch_vccz L_pfok_60
L_pfspin_59:
    s_lshl_b32 s87, s72, 7
    s_lshl_b32 s89, s73, 3
    v_and_b32 v90, 7, v0
    v_lshl_add_u32 v90, v90, 3, s87
    v_and_b32 v91, 31, v0
    v_lshl_add_u32 v91, v91, 7, s89
    v_cmp_gt_u32 vcc, 32, v0
    s_mov_b32 s87, 40960
    s_nop 0
    v_cndmask_b32 v90, v91, v90, vcc
    buffer_load_dwordx2 v[88:89], v90, s[32:35], s87 offen sc1
    s_waitcnt vmcnt(0)
    v_cmp_ne_u32 vcc, s75, v88
    s_cbranch_vccz L_spinout_61
    s_sub_u32 s77, s77, 1
    s_cbranch_scc1 L_spinout_61_x
    s_branch L_pfspin_59
L_spinout_61_x:
    s_mov_b32 s77, 0
L_spinout_61:
L_pfok_60:
    v_exp_f32 v32, v32
    v_exp_f32 v33, v33
    v_exp_f32 v34, v34
    v_exp_f32 v35, v35
    v_exp_f32 v36, v36
    v_mfma_f32_32x32x16_bf16 v[48:63], v[64:67], v[80:83], v[48:63]
    s_waitcnt lgkmcnt(1)
    ds_read_b128 v[64:67], v8 offset:22528
    ds_read_b64 v[68:69], v9 offset:22528
    s_add_u32 s91, s86, 0
    buffer_load_dwordx4 v[96:99], v1, s[32:35], s91 offen sc1
    v_exp_f32 v37, v37
    v_exp_f32 v38, v38
    v_exp_f32 v39, v39
    v_cvt_pk_bf16_f32 v32, v32, v33
    v_cvt_pk_bf16_f32 v33, v34, v35
    v_cvt_pk_bf16_f32 v34, v36, v37
    v_cvt_pk_bf16_f32 v35, v38, v39
    v_mfma_f32_32x32x16_bf16 v[16:31], v[76:79], v[84:87], v[16:31]
    s_waitcnt lgkmcnt(2)
    ds_read_b128 v[76:79], v10 offset:17504
    s_add_u32 s91, s86, 0
    s_add_u32 s91, s91, s93
    buffer_load_dwordx4 v[176:179], v1, s[32:35], s91 offen sc1
    v_exp_f32 v40, v40
    v_exp_f32 v41, v41
    v_exp_f32 v42, v42
    v_exp_f32 v43, v43
    v_exp_f32 v44, v44
    v_mfma_f32_32x32x16_bf16 v[16:31], v[72:75], v[32:35], v[16:31]
    s_waitcnt lgkmcnt(1)
    ds_read_b128 v[72:75], v10 offset:19520
    s_add_u32 s91, s86, 12288
    buffer_load_dwordx4 v[100:103], v1, s[32:35], s91 offen sc1
    v_exp_f32 v45, v45
    v_exp_f32 v46, v46
    v_exp_f32 v47, v47
    v_cvt_pk_bf16_f32 v84, v40, v41
    v_cvt_pk_bf16_f32 v85, v42, v43
    v_cvt_pk_bf16_f32 v86, v44, v45
    v_cvt_pk_bf16_f32 v87, v46, v47
    v_mfma_f32_32x32x8bf16_1k v[32:47], v[68:69], v[70:71], 0
    s_add_u32 s91, s86, 12288
    s_add_u32 s91, s91, s93
    buffer_load_dwordx4 v[180:183], v1, s[32:35], s91 offen sc1
    v_exp_f32 v48, v48
    v_exp_f32 v49, v49
    v_exp_f32 v50, v50
    v_exp_f32 v51, v51
    v_exp_f32 v52, v52
    v_mfma_f32_32x32x16_bf16 v[32:47], v[64:67], v[80:83], v[32:47]
    s_waitcnt lgkmcnt(1)
    ds_read_b128 v[64:67], v8 offset:25280
    ds_read_b64 v[68:69], v9 offset:25280
    s_add_u32 s91, s86, 24576
    buffer_load_dwordx4 v[104:107], v1, s[32:35], s91 offen sc1
    v_exp_f32 v53, v53
    v_exp_f32 v54, v54
    v_exp_f32 v55, v55
    v_cvt_pk_bf16_f32 v48, v48, v49
    v_cvt_pk_bf16_f32 v49, v50, v51
    v_cvt_pk_bf16_f32 v50, v52, v53
    v_cvt_pk_bf16_f32 v51, v54, v55
    v_mfma_f32_32x32x16_bf16 v[16:31], v[76:79], v[84:87], v[16:31]
    s_waitcnt lgkmcnt(2)
    ds_read_b128 v[76:79], v10 offset:20256
    v_exp_f32 v56, v56
    v_exp_f32 v57, v57
    v_exp_f32 v58, v58
    v_exp_f32 v59, v59
    v_exp_f32 v60, v60
    v_mfma_f32_32x32x16_bf16 v[16:31], v[72:75], v[48:51], v[16:31]
    s_waitcnt lgkmcnt(1)
    ds_read_b128 v[72:75], v10 offset:22528
    v_exp_f32 v61, v61
    v_exp_f32 v62, v62
    v_exp_f32 v63, v63
    v_cvt_pk_bf16_f32 v84, v56, v57
    v_cvt_pk_bf16_f32 v85, v58, v59
    v_cvt_pk_bf16_f32 v86, v60, v61
    v_cvt_pk_bf16_f32 v87, v62, v63
    v_mfma_f32_32x32x8bf16_1k v[48:63], v[68:69], v[70:71], 0
    v_exp_f32 v32, v32
    v_exp_f32 v33, v33
    v_exp_f32 v34, v34
    v_exp_f32 v35, v35
    v_exp_f32 v36, v36
    v_mfma_f32_32x32x16_bf16 v[48:63], v[64:67], v[80:83], v[48:63]
    s_waitcnt lgkmcnt(1)
    ds_read_b128 v[64:67], v8 offset:28032
    ds_read_b64 v[68:69], v9 offset:28032
    v_exp_f32 v37, v37
    v_exp_f32 v38, v38
    v_exp_f32 v39, v39
    v_cvt_pk_bf16_f32 v32, v32, v33
    v_cvt_pk_bf16_f32 v33, v34, v35
    v_cvt_pk_bf16_f32 v34, v36, v37
    v_cvt_pk_bf16_f32 v35, v38, v39
    v_mfma_f32_32x32x16_bf16 v[16:31], v[76:79], v[84:87], v[16:31]
    s_waitcnt lgkmcnt(2)
    ds_read_b128 v[76:79], v10 offset:23264
    v_exp_f32 v40, v40
    v_exp_f32 v41, v41
    v_exp_f32 v42, v42
    v_exp_f32 v43, v43
    v_exp_f32 v44, v44
    v_mfma_f32_32x32x16_bf16 v[16:31], v[72:75], v[32:35], v[16:31]
    s_waitcnt lgkmcnt(1)
    ds_read_b128 v[72:75], v10 offset:25280
    v_exp_f32 v45, v45
    v_exp_f32 v46, v46
    v_exp_f32 v47, v47
    v_cvt_pk_bf16_f32 v84, v40, v41
    v_cvt_pk_bf16_f32 v85, v42, v43
    v_cvt_pk_bf16_f32 v86, v44, v45
    v_cvt_pk_bf16_f32 v87, v46, v47
    v_mfma_f32_32x32x8bf16_1k v[32:47], v[68:69], v[70:71], 0
    v_exp_f32 v48, v48
    v_exp_f32 v49, v49
    v_exp_f32 v50, v50
    v_exp_f32 v51, v51
    v_exp_f32 v52, v52
    v_mfma_f32_32x32x16_bf16 v[32:47], v[64:67], v[80:83], v[32:47]
    s_waitcnt lgkmcnt(1)
    ds_read_b128 v[64:67], v8 offset:30784
    ds_read_b64 v[68:69], v9 offset:30784
    v_exp_f32 v53, v53
    v_exp_f32 v54, v54
    v_exp_f32 v55, v55
    v_cvt_pk_bf16_f32 v48, v48, v49
    v_cvt_pk_bf16_f32 v49, v50, v51
    v_cvt_pk_bf16_f32 v50, v52, v53
    v_cvt_pk_bf16_f32 v51, v54, v55
    v_mfma_f32_32x32x16_bf16 v[16:31], v[76:79], v[84:87], v[16:31]
    s_waitcnt lgkmcnt(2)
    ds_read_b128 v[76:79], v10 offset:26016
    v_exp_f32 v56, v56
    v_exp_f32 v57, v57
    v_exp_f32 v58, v58
    v_exp_f32 v59, v59
    v_exp_f32 v60, v60
    v_mfma_f32_32x32x16_bf16 v[16:31], v[72:75], v[48:51], v[16:31]
    s_waitcnt lgkmcnt(1)
    ds_read_b128 v[72:75], v10 offset:28032
    v_exp_f32 v61, v61
    v_exp_f32 v62, v62
    v_exp_f32 v63, v63
    v_cvt_pk_bf16_f32 v84, v56, v57
    v_cvt_pk_bf16_f32 v85, v58, v59
    v_cvt_pk_bf16_f32 v86, v60, v61
    v_cvt_pk_bf16_f32 v87, v62, v63
    s_barrier
    v_mfma_f32_32x32x8bf16_1k v[48:63], v[68:69], v[70:71], 0
    s_setprio 1
    s_add_u32 s29, s29, 22016
    s_cmp_ge_u32 s29, 176128
    s_cselect_b32 s95, 176128, 0
    s_sub_u32 s29, s29, s95
    s_add_u32 m0, s85, 113664
    s_add_u32 s95, s29, s92
    buffer_load_dwordx4 v1, s[32:35], s95 offen offset:0 sc1 lds
    buffer_load_dwordx4 v1, s[32:35], s95 offen offset:1024 sc1 lds
    v_exp_f32 v32, v32
    v_exp_f32 v33, v33
    v_exp_f32 v34, v34
    v_exp_f32 v35, v35
    v_exp_f32 v36, v36
    v_mfma_f32_32x32x16_bf16 v[48:63], v[64:67], v[80:83], v[48:63]
    s_waitcnt lgkmcnt(1)
    ds_read_b128 v[64:67], v8 offset:0
    ds_read_b64 v[68:69], v9 offset:0
    s_cmp_eq_u32 s85, 9216
    s_cbranch_scc1 L_skip_kv_62
    buffer_load_dwordx4 v1, s[32:35], s95 offen offset:2048 sc1 lds
L_skip_kv_62:
    s_mul_i32 s89, s61, 9
    s_add_u32 s89, s89, 0
    s_min_u32 s89, s89, 93184
    s_add_u32 m0, s89, 0
    s_add_u32 s87, m0, s28
    buffer_load_dwordx4 v1, s[32:35], s87 offen offset:0 sc1 lds
    v_exp_f32 v37, v37
    v_exp_f32 v38, v38
    v_exp_f32 v39, v39
    v_cvt_pk_bf16_f32 v32, v32, v33
    v_cvt_pk_bf16_f32 v33, v34, v35
    v_cvt_pk_bf16_f32 v34, v36, v37
    v_cvt_pk_bf16_f32 v35, v38, v39
    v_mfma_f32_32x32x16_bf16 v[16:31], v[76:79], v[84:87], v[16:31]
    s_waitcnt lgkmcnt(2)
    ds_read_b128 v[76:79], v10 offset:28768
    buffer_load_dwordx4 v1, s[32:35], s87 offen offset:1024 sc1 lds
    buffer_load_dwordx4 v1, s[32:35], s87 offen offset:2048 sc1 lds
    v_exp_f32 v40, v40
    v_exp_f32 v41, v41
    v_exp_f32 v42, v42
    v_exp_f32 v43, v43
    v_exp_f32 v44, v44
    v_mfma_f32_32x32x16_bf16 v[16:31], v[72:75], v[32:35], v[16:31]
    s_waitcnt lgkmcnt(1)
    ds_read_b128 v[72:75], v10 offset:30784
    buffer_load_dwordx4 v1, s[32:35], s87 offen offset:3072 sc1 lds
    s_add_u32 m0, s89, 4096
    s_add_u32 s87, m0, s28
    buffer_load_dwordx4 v1, s[32:35], s87 offen offset:0 sc1 lds
    v_exp_f32 v45, v45
    v_exp_f32 v46, v46
    v_exp_f32 v47, v47
    v_cvt_pk_bf16_f32 v84, v40, v41
    v_cvt_pk_bf16_f32 v85, v42, v43
    v_cvt_pk_bf16_f32 v86, v44, v45
    v_cvt_pk_bf16_f32 v87, v46, v47
    v_mfma_f32_32x32x8bf16_1k v[32:47], v[68:69], v[70:71], 0
    buffer_load_dwordx4 v1, s[32:35], s87 offen offset:1024 sc1 lds
    v_exp_f32 v48, v48
    v_exp_f32 v49, v49
    v_exp_f32 v50, v50
    v_exp_f32 v51, v51
    v_exp_f32 v52, v52
    v_mfma_f32_32x32x16_bf16 v[32:47], v[64:67], v[80:83], v[32:47]
    s_waitcnt lgkmcnt(1)
    ds_read_b128 v[64:67], v8 offset:2752
    ds_read_b64 v[68:69], v9 offset:2752
    buffer_load_dwordx4 v1, s[32:35], s87 offen offset:2048 sc1 lds
    v_exp_f32 v53, v53
    v_exp_f32 v54, v54
    v_exp_f32 v55, v55
    v_cvt_pk_bf16_f32 v48, v48, v49
    v_cvt_pk_bf16_f32 v49, v50, v51
    v_cvt_pk_bf16_f32 v50, v52, v53
    v_cvt_pk_bf16_f32 v51, v54, v55
    v_mfma_f32_32x32x16_bf16 v[16:31], v[76:79], v[84:87], v[16:31]
    s_waitcnt lgkmcnt(2)
    ds_read_b128 v[76:79], v10 offset:31520
    buffer_load_dwordx4 v1, s[32:35], s87 offen offset:3072 sc1 lds
    v_exp_f32 v56, v56
    v_exp_f32 v57, v57
    v_exp_f32 v58, v58
    v_exp_f32 v59, v59
    v_exp_f32 v60, v60
    v_mfma_f32_32x32x16_bf16 v[16:31], v[72:75], v[48:51], v[16:31]
    s_waitcnt lgkmcnt(1)
    ds_read_b128 v[72:75], v10 offset:0
    s_add_u32 m0, s89, 8192
    s_add_u32 s87, m0, s28
    buffer_load_dwordx4 v1, s[32:35], s87 offen offset:0 sc1 lds
    v_exp_f32 v61, v61
    v_exp_f32 v62, v62
    v_exp_f32 v63, v63
    v_cvt_pk_bf16_f32 v84, v56, v57
    v_cvt_pk_bf16_f32 v85, v58, v59
    v_cvt_pk_bf16_f32 v86, v60, v61
    v_cvt_pk_bf16_f32 v87, v62, v63
    v_mfma_f32_32x32x8bf16_1k v[48:63], v[68:69], v[70:71], 0
    s_add_u32 s91, s86, 24576
    s_add_u32 s91, s91, s93
    buffer_load_dwordx4 v[184:187], v1, s[32:35], s91 offen sc1
    v_exp_f32 v32, v32
    v_exp_f32 v33, v33
    v_exp_f32 v34, v34
    v_exp_f32 v35, v35
    v_exp_f32 v36, v36
    v_mfma_f32_32x32x16_bf16 v[48:63], v[64:67], v[80:83], v[48:63]
    s_waitcnt lgkmcnt(1)
    ds_read_b128 v[64:67], v8 offset:5504
    ds_read_b64 v[68:69], v9 offset:5504
    s_add_u32 s91, s86, 36864
    buffer_load_dwordx4 v[108:111], v1, s[32:35], s91 offen sc1
    v_exp_f32 v37, v37
    v_exp_f32 v38, v38
    v_exp_f32 v39, v39
    v_cvt_pk_bf16_f32 v32, v32, v33
    v_cvt_pk_bf16_f32 v33, v34, v35
    v_cvt_pk_bf16_f32 v34, v36, v37
    v_cvt_pk_bf16_f32 v35, v38, v39
    v_mfma_f32_32x32x16_bf16 v[16:31], v[76:79], v[84:87], v[16:31]
    s_waitcnt lgkmcnt(2)
    ds_read_b128 v[76:79], v10 offset:736
    s_add_u32 s91, s86, 36864
    s_add_u32 s91, s91, s93
    buffer_load_dwordx4 v[188:191], v1, s[32:35], s91 offen sc1
    v_exp_f32 v40, v40
    v_exp_f32 v41, v41
    v_exp_f32 v42, v42
    v_exp_f32 v43, v43
    v_exp_f32 v44, v44
    v_mfma_f32_32x32x16_bf16 v[16:31], v[72:75], v[32:35], v[16:31]
    s_waitcnt lgkmcnt(1)
    ds_read_b128 v[72:75], v10 offset:2752
    s_add_u32 s91, s86, 49152
    buffer_load_dwordx4 v[112:115], v1, s[32:35], s91 offen sc1
    v_exp_f32 v45, v45
    v_exp_f32 v46, v46
    v_exp_f32 v47, v47
    v_cvt_pk_bf16_f32 v84, v40, v41
    v_cvt_pk_bf16_f32 v85, v42, v43
    v_cvt_pk_bf16_f32 v86, v44, v45
    v_cvt_pk_bf16_f32 v87, v46, v47
    v_mfma_f32_32x32x8bf16_1k v[32:47], v[68:69], v[70:71], 0
    s_add_u32 s91, s86, 49152
    s_add_u32 s91, s91, s93
    buffer_load_dwordx4 v[192:195], v1, s[32:35], s91 offen sc1
    v_exp_f32 v48, v48
    v_exp_f32 v49, v49
    v_exp_f32 v50, v50
    v_exp_f32 v51, v51
    v_exp_f32 v52, v52
    v_mfma_f32_32x32x16_bf16 v[32:47], v[64:67], v[80:83], v[32:47]
    s_waitcnt lgkmcnt(1)
    ds_read_b128 v[64:67], v8 offset:8256
    ds_read_b64 v[68:69], v9 offset:8256
    v_exp_f32 v53, v53
    v_exp_f32 v54, v54
    v_exp_f32 v55, v55
    v_cvt_pk_bf16_f32 v48, v48, v49
    v_cvt_pk_bf16_f32 v49, v50, v51
    v_cvt_pk_bf16_f32 v50, v52, v53
    v_cvt_pk_bf16_f32 v51, v54, v55
    v_mfma_f32_32x32x16_bf16 v[16:31], v[76:79], v[84:87], v[16:31]
    s_waitcnt lgkmcnt(2)
    ds_read_b128 v[76:79], v10 offset:3488
    v_exp_f32 v56, v56
    v_exp_f32 v57, v57
    v_exp_f32 v58, v58
    v_exp_f32 v59, v59
    v_exp_f32 v60, v60
    v_mfma_f32_32x32x16_bf16 v[16:31], v[72:75], v[48:51], v[16:31]
    s_waitcnt lgkmcnt(1)
    ds_read_b128 v[72:75], v10 offset:5504
    v_exp_f32 v61, v61
    v_exp_f32 v62, v62
    v_exp_f32 v63, v63
    v_cvt_pk_bf16_f32 v84, v56, v57
    v_cvt_pk_bf16_f32 v85, v58, v59
    v_cvt_pk_bf16_f32 v86, v60, v61
    v_cvt_pk_bf16_f32 v87, v62, v63
    s_waitcnt vmcnt(14)
    s_barrier
    v_mfma_f32_32x32x8bf16_1k v[48:63], v[68:69], v[70:71], 0
    s_setprio 0
    s_add_u32 s91, s86, 61440
    buffer_load_dwordx4 v[116:119], v1, s[32:35], s91 offen sc1
    v_exp_f32 v32, v32
    v_exp_f32 v33, v33
    v_exp_f32 v34, v34
    v_exp_f32 v35, v35
    v_exp_f32 v36, v36
    v_mfma_f32_32x32x16_bf16 v[48:63], v[64:67], v[80:83], v[48:63]
    s_waitcnt lgkmcnt(1)
    ds_read_b128 v[64:67], v8 offset:11264
    ds_read_b64 v[68:69], v9 offset:11264
    s_add_u32 s91, s86, 61440
    s_add_u32 s91, s91, s93
    buffer_load_dwordx4 v[196:199], v1, s[32:35], s91 offen sc1
    v_exp_f32 v37, v37
    v_exp_f32 v38, v38
    v_exp_f32 v39, v39
    v_cvt_pk_bf16_f32 v32, v32, v33
    v_cvt_pk_bf16_f32 v33, v34, v35
    v_cvt_pk_bf16_f32 v34, v36, v37
    v_cvt_pk_bf16_f32 v35, v38, v39
    v_mfma_f32_32x32x16_bf16 v[16:31], v[76:79], v[84:87], v[16:31]
    s_waitcnt lgkmcnt(2)
    ds_read_b128 v[76:79], v10 offset:6240
    s_add_u32 s91, s86, 73728
    buffer_load_dwordx4 v[120:123], v1, s[32:35], s91 offen sc1
    v_exp_f32 v40, v40
    v_exp_f32 v41, v41
    v_exp_f32 v42, v42
    v_exp_f32 v43, v43
    v_exp_f32 v44, v44
    v_mfma_f32_32x32x16_bf16 v[16:31], v[72:75], v[32:35], v[16:31]
    s_waitcnt lgkmcnt(1)
    ds_read_b128 v[72:75], v10 offset:8256
    s_add_u32 s91, s86, 73728
    s_add_u32 s91, s91, s93
    buffer_load_dwordx4 v[200:203], v1, s[32:35], s91 offen sc1
    v_exp_f32 v45, v45
    v_exp_f32 v46, v46
    v_exp_f32 v47, v47
    v_cvt_pk_bf16_f32 v84, v40, v41
    v_cvt_pk_bf16_f32 v85, v42, v43
    v_cvt_pk_bf16_f32 v86, v44, v45
    v_cvt_pk_bf16_f32 v87, v46, v47
    v_mfma_f32_32x32x8bf16_1k v[32:47], v[68:69], v[70:71], 0
    s_add_u32 s91, s86, 86016
    buffer_load_dwordx4 v[124:127], v1, s[32:35], s91 offen sc1
    v_exp_f32 v48, v48
    v_exp_f32 v49, v49
    v_exp_f32 v50, v50
    v_exp_f32 v51, v51
    v_exp_f32 v52, v52
    v_mfma_f32_32x32x16_bf16 v[32:47], v[64:67], v[80:83], v[32:47]
    s_waitcnt lgkmcnt(1)
    ds_read_b128 v[64:67], v8 offset:14016
    ds_read_b64 v[68:69], v9 offset:14016
    v_exp_f32 v53, v53
    v_exp_f32 v54, v54
    v_exp_f32 v55, v55
    v_cvt_pk_bf16_f32 v48, v48, v49
    v_cvt_pk_bf16_f32 v49, v50, v51
    v_cvt_pk_bf16_f32 v50, v52, v53
    v_cvt_pk_bf16_f32 v51, v54, v55
    v_mfma_f32_32x32x16_bf16 v[16:31], v[76:79], v[84:87], v[16:31]
    s_waitcnt lgkmcnt(2)
    ds_read_b128 v[76:79], v10 offset:8992
    v_exp_f32 v56, v56
    v_exp_f32 v57, v57
    v_exp_f32 v58, v58
    v_exp_f32 v59, v59
    v_exp_f32 v60, v60
    v_mfma_f32_32x32x16_bf16 v[16:31], v[72:75], v[48:51], v[16:31]
    s_waitcnt lgkmcnt(1)
    ds_read_b128 v[72:75], v10 offset:11264
    v_exp_f32 v61, v61
    v_exp_f32 v62, v62
    v_exp_f32 v63, v63
    v_cvt_pk_bf16_f32 v84, v56, v57
    v_cvt_pk_bf16_f32 v85, v58, v59
    v_cvt_pk_bf16_f32 v86, v60, v61
    v_cvt_pk_bf16_f32 v87, v62, v63
    v_mfma_f32_32x32x8bf16_1k v[48:63], v[68:69], v[70:71], 0
    v_exp_f32 v32, v32
    v_exp_f32 v33, v33
    v_exp_f32 v34, v34
    v_exp_f32 v35, v35
    v_exp_f32 v36, v36
    v_mfma_f32_32x32x16_bf16 v[48:63], v[64:67], v[80:83], v[48:63]
    s_waitcnt lgkmcnt(1)
    ds_read_b128 v[64:67], v8 offset:16768
    ds_read_b64 v[68:69], v9 offset:16768
    v_exp_f32 v37, v37
    v_exp_f32 v38, v38
    v_exp_f32 v39, v39
    v_cvt_pk_bf16_f32 v32, v32, v33
    v_cvt_pk_bf16_f32 v33, v34, v35
    v_cvt_pk_bf16_f32 v34, v36, v37
    v_cvt_pk_bf16_f32 v35, v38, v39
    v_mfma_f32_32x32x16_bf16 v[16:31], v[76:79], v[84:87], v[16:31]
    s_waitcnt lgkmcnt(2)
    ds_read_b128 v[76:79], v10 offset:12000
    v_exp_f32 v40, v40
    v_exp_f32 v41, v41
    v_exp_f32 v42, v42
    v_exp_f32 v43, v43
    v_exp_f32 v44, v44
    v_mfma_f32_32x32x16_bf16 v[16:31], v[72:75], v[32:35], v[16:31]
    s_waitcnt lgkmcnt(1)
    ds_read_b128 v[72:75], v10 offset:14016
    v_exp_f32 v45, v45
    v_exp_f32 v46, v46
    v_exp_f32 v47, v47
    v_cvt_pk_bf16_f32 v84, v40, v41
    v_cvt_pk_bf16_f32 v85, v42, v43
    v_cvt_pk_bf16_f32 v86, v44, v45
    v_cvt_pk_bf16_f32 v87, v46, v47
    v_mfma_f32_32x32x8bf16_1k v[32:47], v[68:69], v[70:71], 0
    v_exp_f32 v48, v48
    v_exp_f32 v49, v49
    v_exp_f32 v50, v50
    v_exp_f32 v51, v51
    v_exp_f32 v52, v52
    v_mfma_f32_32x32x16_bf16 v[32:47], v[64:67], v[80:83], v[32:47]
    s_waitcnt lgkmcnt(1)
    ds_read_b128 v[64:67], v8 offset:19520
    ds_read_b64 v[68:69], v9 offset:19520
    v_exp_f32 v53, v53
    v_exp_f32 v54, v54
    v_exp_f32 v55, v55
    v_cvt_pk_bf16_f32 v48, v48, v49
    v_cvt_pk_bf16_f32 v49, v50, v51
    v_cvt_pk_bf16_f32 v50, v52, v53
    v_cvt_pk_bf16_f32 v51, v54, v55
    v_mfma_f32_32x32x16_bf16 v[16:31], v[76:79], v[84:87], v[16:31]
    s_waitcnt lgkmcnt(2)
    ds_read_b128 v[76:79], v10 offset:14752
    v_exp_f32 v56, v56
    v_exp_f32 v57, v57
    v_exp_f32 v58, v58
    v_exp_f32 v59, v59
    v_exp_f32 v60, v60
    v_mfma_f32_32x32x16_bf16 v[16:31], v[72:75], v[48:51], v[16:31]
    s_waitcnt lgkmcnt(1)
    ds_read_b128 v[72:75], v10 offset:16768
    v_exp_f32 v61, v61
    v_exp_f32 v62, v62
    v_exp_f32 v63, v63
    v_cvt_pk_bf16_f32 v84, v56, v57
    v_cvt_pk_bf16_f32 v85, v58, v59
    v_cvt_pk_bf16_f32 v86, v60, v61
    v_cvt_pk_bf16_f32 v87, v62, v63
    s_barrier
    v_mfma_f32_32x32x8bf16_1k v[48:63], v[68:69], v[70:71], 0
    s_setprio 1
    s_add_u32 s29, s29, 22016
    s_cmp_ge_u32 s29, 176128
    s_cselect_b32 s95, 176128, 0
    s_sub_u32 s29, s29, s95
    s_add_u32 m0, s85, 102400
    s_add_u32 s95, s29, s92
    buffer_load_dwordx4 v1, s[32:35], s95 offen offset:0 sc1 lds
    buffer_load_dwordx4 v1, s[32:35], s95 offen offset:1024 sc1 lds
    v_exp_f32 v32, v32
    v_exp_f32 v33, v33
    v_exp_f32 v34, v34
    v_exp_f32 v35, v35
    v_exp_f32 v36, v36
    v_mfma_f32_32x32x16_bf16 v[48:63], v[64:67], v[80:83], v[48:63]
    s_waitcnt lgkmcnt(1)
    ds_read_b128 v[64:67], v8 offset:22528
    ds_read_b64 v[68:69], v9 offset:22528
    s_cmp_eq_u32 s85, 9216
    s_cbranch_scc1 L_skip_kv_63
    buffer_load_dwordx4 v1, s[32:35], s95 offen offset:2048 sc1 lds
L_skip_kv_63:
    s_mul_i32 s89, s61, 9
    s_add_u32 s89, s89, 73728
    s_min_u32 s89, s89, 93184
    s_add_u32 m0, s89, 0
    s_add_u32 s87, m0, s28
    buffer_load_dwordx4 v1, s[32:35], s87 offen offset:0 sc1 lds
    v_exp_f32 v37, v37
    v_exp_f32 v38, v38
    v_exp_f32 v39, v39
    v_cvt_pk_bf16_f32 v32, v32, v33
    v_cvt_pk_bf16_f32 v33, v34, v35
    v_cvt_pk_bf16_f32 v34, v36, v37
    v_cvt_pk_bf16_f32 v35, v38, v39
    v_mfma_f32_32x32x16_bf16 v[16:31], v[76:79], v[84:87], v[16:31]
    s_waitcnt lgkmcnt(2)
    ds_read_b128 v[76:79], v10 offset:17504
    buffer_load_dwordx4 v1, s[32:35], s87 offen offset:1024 sc1 lds
    buffer_load_dwordx4 v1, s[32:35], s87 offen offset:2048 sc1 lds
    v_exp_f32 v40, v40
    v_exp_f32 v41, v41
    v_exp_f32 v42, v42
    v_exp_f32 v43, v43
    v_exp_f32 v44, v44
    v_mfma_f32_32x32x16_bf16 v[16:31], v[72:75], v[32:35], v[16:31]
    s_waitcnt lgkmcnt(1)
    ds_read_b128 v[72:75], v10 offset:19520
    buffer_load_dwordx4 v1, s[32:35], s87 offen offset:3072 sc1 lds
    s_add_u32 m0, s89, 4096
    s_add_u32 s87, m0, s28
    buffer_load_dwordx4 v1, s[32:35], s87 offen offset:0 sc1 lds
    v_exp_f32 v45, v45
    v_exp_f32 v46, v46
    v_exp_f32 v47, v47
    v_cvt_pk_bf16_f32 v84, v40, v41
    v_cvt_pk_bf16_f32 v85, v42, v43
    v_cvt_pk_bf16_f32 v86, v44, v45
    v_cvt_pk_bf16_f32 v87, v46, v47
    v_mfma_f32_32x32x8bf16_1k v[32:47], v[68:69], v[70:71], 0
    buffer_load_dwordx4 v1, s[32:35], s87 offen offset:1024 sc1 lds
    v_exp_f32 v48, v48
    v_exp_f32 v49, v49
    v_exp_f32 v50, v50
    v_exp_f32 v51, v51
    v_exp_f32 v52, v52
    v_mfma_f32_32x32x16_bf16 v[32:47], v[64:67], v[80:83], v[32:47]
    s_waitcnt lgkmcnt(1)
    ds_read_b128 v[64:67], v8 offset:25280
    ds_read_b64 v[68:69], v9 offset:25280
    buffer_load_dwordx4 v1, s[32:35], s87 offen offset:2048 sc1 lds
    v_exp_f32 v53, v53
    v_exp_f32 v54, v54
    v_exp_f32 v55, v55
    v_cvt_pk_bf16_f32 v48, v48, v49
    v_cvt_pk_bf16_f32 v49, v50, v51
    v_cvt_pk_bf16_f32 v50, v52, v53
    v_cvt_pk_bf16_f32 v51, v54, v55
    v_mfma_f32_32x32x16_bf16 v[16:31], v[76:79], v[84:87], v[16:31]
    s_waitcnt lgkmcnt(2)
    ds_read_b128 v[76:79], v10 offset:20256
    buffer_load_dwordx4 v1, s[32:35], s87 offen offset:3072 sc1 lds
    v_exp_f32 v56, v56
    v_exp_f32 v57, v57
    v_exp_f32 v58, v58
    v_exp_f32 v59, v59
    v_exp_f32 v60, v60
    v_mfma_f32_32x32x16_bf16 v[16:31], v[72:75], v[48:51], v[16:31]
    s_waitcnt lgkmcnt(1)
    ds_read_b128 v[72:75], v10 offset:22528
    s_add_u32 m0, s89, 8192
    s_add_u32 s87, m0, s28
    buffer_load_dwordx4 v1, s[32:35], s87 offen offset:0 sc1 lds
    v_exp_f32 v61, v61
    v_exp_f32 v62, v62
    v_exp_f32 v63, v63
    v_cvt_pk_bf16_f32 v84, v56, v57
    v_cvt_pk_bf16_f32 v85, v58, v59
    v_cvt_pk_bf16_f32 v86, v60, v61
    v_cvt_pk_bf16_f32 v87, v62, v63
    v_mfma_f32_32x32x8bf16_1k v[48:63], v[68:69], v[70:71], 0
    s_add_u32 s91, s86, 86016
    s_add_u32 s91, s91, s93
    buffer_load_dwordx4 v[204:207], v1, s[32:35], s91 offen sc1
    v_exp_f32 v32, v32
    v_exp_f32 v33, v33
    v_exp_f32 v34, v34
    v_exp_f32 v35, v35
    v_exp_f32 v36, v36
    v_mfma_f32_32x32x16_bf16 v[48:63], v[64:67], v[80:83], v[48:63]
    s_waitcnt lgkmcnt(1)
    ds_read_b128 v[64:67], v8 offset:28032
    ds_read_b64 v[68:69], v9 offset:28032
    s_add_u32 s91, s86, 98304
    buffer_load_dwordx4 v[128:131], v1, s[32:35], s91 offen sc1
    v_exp_f32 v37, v37
    v_exp_f32 v38, v38
    v_exp_f32 v39, v39
    v_cvt_pk_bf16_f32 v32, v32, v33
    v_cvt_pk_bf16_f32 v33, v34, v35
    v_cvt_pk_bf16_f32 v34, v36, v37
    v_cvt_pk_bf16_f32 v35, v38, v39
    v_mfma_f32_32x32x16_bf16 v[16:31], v[76:79], v[84:87], v[16:31]
    s_waitcnt lgkmcnt(2)
    ds_read_b128 v[76:79], v10 offset:23264
    s_add_u32 s91, s86, 98304
    s_add_u32 s91, s91, s93
    buffer_load_dwordx4 v[208:211], v1, s[32:35], s91 offen sc1
    v_exp_f32 v40, v40
    v_exp_f32 v41, v41
    v_exp_f32 v42, v42
    v_exp_f32 v43, v43
    v_exp_f32 v44, v44
    v_mfma_f32_32x32x16_bf16 v[16:31], v[72:75], v[32:35], v[16:31]
    s_waitcnt lgkmcnt(1)
    ds_read_b128 v[72:75], v10 offset:25280
    s_add_u32 s91, s86, 110592
    buffer_load_dwordx4 v[132:135], v1, s[32:35], s91 offen sc1
    v_exp_f32 v45, v45
    v_exp_f32 v46, v46
    v_exp_f32 v47, v47
    v_cvt_pk_bf16_f32 v84, v40, v41
    v_cvt_pk_bf16_f32 v85, v42, v43
    v_cvt_pk_bf16_f32 v86, v44, v45
    v_cvt_pk_bf16_f32 v87, v46, v47
    v_mfma_f32_32x32x8bf16_1k v[32:47], v[68:69], v[70:71], 0
    s_add_u32 s91, s86, 110592
    s_add_u32 s91, s91, s93
    buffer_load_dwordx4 v[212:215], v1, s[32:35], s91 offen sc1
    v_exp_f32 v48, v48
    v_exp_f32 v49, v49
    v_exp_f32 v50, v50
    v_exp_f32 v51, v51
    v_exp_f32 v52, v52
    v_mfma_f32_32x32x16_bf16 v[32:47], v[64:67], v[80:83], v[32:47]
    s_waitcnt lgkmcnt(1)
    ds_read_b128 v[64:67], v8 offset:30784
    ds_read_b64 v[68:69], v9 offset:30784
    s_cmp_ge_u32 s74, 6
    s_cbranch_scc1 L_skip_tab_64
    s_lshl_b32 s87, s74, 10
    s_add_u32 s62, s87, 24576
    s_add_u32 s63, s87, 19456
    s_mul_i32 s87, s73, 640
    s_add_u32 s89, s87, 14336
    s_add_u32 s87, s87, 29696
    s_cmp_eq_u32 s74, 5
    s_cselect_b32 s62, s89, s62
    s_cselect_b32 s63, s87, s63
    buffer_load_dwordx4 v[88:91], v1, s[32:35], s62 offen sc1
    buffer_load_dwordx4 v[92:95], v1, s[32:35], s63 offen sc1
L_skip_tab_64:
    v_exp_f32 v53, v53
    v_exp_f32 v54, v54
    v_exp_f32 v55, v55
    v_cvt_pk_bf16_f32 v48, v48, v49
    v_cvt_pk_bf16_f32 v49, v50, v51
    v_cvt_pk_bf16_f32 v50, v52, v53
    v_cvt_pk_bf16_f32 v51, v54, v55
    v_mfma_f32_32x32x16_bf16 v[16:31], v[76:79], v[84:87], v[16:31]
    s_waitcnt lgkmcnt(2)
    ds_read_b128 v[76:79], v10 offset:26016
    v_exp_f32 v56, v56
    v_exp_f32 v57, v57
    v_exp_f32 v58, v58
    v_exp_f32 v59, v59
    v_exp_f32 v60, v60
    v_mfma_f32_32x32x16_bf16 v[16:31], v[72:75], v[48:51], v[16:31]
    s_waitcnt lgkmcnt(1)
    ds_read_b128 v[72:75], v10 offset:28032
    v_exp_f32 v61, v61
    v_exp_f32 v62, v62
    v_exp_f32 v63, v63
    v_cvt_pk_bf16_f32 v84, v56, v57
    v_cvt_pk_bf16_f32 v85, v58, v59
    v_cvt_pk_bf16_f32 v86, v60, v61
    v_cvt_pk_bf16_f32 v87, v62, v63
    s_waitcnt vmcnt(14)
    s_barrier
    v_mfma_f32_32x32x8bf16_1k v[48:63], v[68:69], v[70:71], 0
    s_setprio 0
    s_add_u32 s91, s86, 122880
    buffer_load_dwordx4 v[136:139], v1, s[32:35], s91 offen sc1
    v_exp_f32 v32, v32
    v_exp_f32 v33, v33
    v_exp_f32 v34, v34
    v_exp_f32 v35, v35
    v_exp_f32 v36, v36
    v_mfma_f32_32x32x16_bf16 v[48:63], v[64:67], v[80:83], v[48:63]
    s_waitcnt lgkmcnt(1)
    ds_read_b128 v[64:67], v8 offset:0
    ds_read_b64 v[68:69], v9 offset:0
    s_add_u32 s91, s86, 122880
    s_add_u32 s91, s91, s93
    buffer_load_dwordx4 v[216:219], v1, s[32:35], s91 offen sc1
    v_exp_f32 v37, v37
    v_exp_f32 v38, v38
    v_exp_f32 v39, v39
    v_cvt_pk_bf16_f32 v32, v32, v33
    v_cvt_pk_bf16_f32 v33, v34, v35
    v_cvt_pk_bf16_f32 v34, v36, v37
    v_cvt_pk_bf16_f32 v35, v38, v39
    v_mfma_f32_32x32x16_bf16 v[16:31], v[76:79], v[84:87], v[16:31]
    s_waitcnt lgkmcnt(2)
    ds_read_b128 v[76:79], v10 offset:28768
    s_add_u32 s91, s86, 135168
    buffer_load_dwordx4 v[140:143], v1, s[32:35], s91 offen sc1
    v_exp_f32 v40, v40
    v_exp_f32 v41, v41
    v_exp_f32 v42, v42
    v_exp_f32 v43, v43
    v_exp_f32 v44, v44
    v_mfma_f32_32x32x16_bf16 v[16:31], v[72:75], v[32:35], v[16:31]
    s_waitcnt lgkmcnt(1)
    ds_read_b128 v[72:75], v10 offset:30784
    s_add_u32 s91, s86, 135168
    s_add_u32 s91, s91, s93
    buffer_load_dwordx4 v[220:223], v1, s[32:35], s91 offen sc1
    v_exp_f32 v45, v45
    v_exp_f32 v46, v46
    v_exp_f32 v47, v47
    v_cvt_pk_bf16_f32 v84, v40, v41
    v_cvt_pk_bf16_f32 v85, v42, v43
    v_cvt_pk_bf16_f32 v86, v44, v45
    v_cvt_pk_bf16_f32 v87, v46, v47
    v_mfma_f32_32x32x8bf16_1k v[32:47], v[68:69], v[70:71], 0
    s_add_u32 s91, s86, 147456
    buffer_load_dwordx4 v[144:147], v1, s[32:35], s91 offen sc1
    v_exp_f32 v48, v48
    v_exp_f32 v49, v49
    v_exp_f32 v50, v50
    v_exp_f32 v51, v51
    v_exp_f32 v52, v52
    v_mfma_f32_32x32x16_bf16 v[32:47], v[64:67], v[80:83], v[32:47]
    s_waitcnt lgkmcnt(1)
    ds_read_b128 v[64:67], v8 offset:2752
    ds_read_b64 v[68:69], v9 offset:2752
    v_exp_f32 v53, v53
    v_exp_f32 v54, v54
    v_exp_f32 v55, v55
    v_cvt_pk_bf16_f32 v48, v48, v49
    v_cvt_pk_bf16_f32 v49, v50, v51
    v_cvt_pk_bf16_f32 v50, v52, v53
    v_cvt_pk_bf16_f32 v51, v54, v55
    v_mfma_f32_32x32x16_bf16 v[16:31], v[76:79], v[84:87], v[16:31]
    s_waitcnt lgkmcnt(2)
    ds_read_b128 v[76:79], v10 offset:31520
    v_exp_f32 v56, v56
    v_exp_f32 v57, v57
    v_exp_f32 v58, v58
    v_exp_f32 v59, v59
    v_exp_f32 v60, v60
    v_mfma_f32_32x32x16_bf16 v[16:31], v[72:75], v[48:51], v[16:31]
    s_waitcnt lgkmcnt(1)
    ds_read_b128 v[72:75], v10 offset:0
    v_exp_f32 v61, v61
    v_exp_f32 v62, v62
    v_exp_f32 v63, v63
    v_cvt_pk_bf16_f32 v84, v56, v57
    v_cvt_pk_bf16_f32 v85, v58, v59
    v_cvt_pk_bf16_f32 v86, v60, v61
    v_cvt_pk_bf16_f32 v87, v62, v63
    v_mfma_f32_32x32x8bf16_1k v[48:63], v[68:69], v[70:71], 0
    v_exp_f32 v32, v32
    v_exp_f32 v33, v33
    v_exp_f32 v34, v34
    v_exp_f32 v35, v35
    v_exp_f32 v36, v36
    v_mfma_f32_32x32x16_bf16 v[48:63], v[64:67], v[80:83], v[48:63]
    s_waitcnt lgkmcnt(1)
    ds_read_b128 v[64:67], v8 offset:5504
    ds_read_b64 v[68:69], v9 offset:5504
    v_exp_f32 v37, v37
    v_exp_f32 v38, v38
    v_exp_f32 v39, v39
    v_cvt_pk_bf16_f32 v32, v32, v33
    v_cvt_pk_bf16_f32 v33, v34, v35
    v_cvt_pk_bf16_f32 v34, v36, v37
    v_cvt_pk_bf16_f32 v35, v38, v39
    v_mfma_f32_32x32x16_bf16 v[16:31], v[76:79], v[84:87], v[16:31]
    s_waitcnt lgkmcnt(2)
    ds_read_b128 v[76:79], v10 offset:736
    v_exp_f32 v40, v40
    v_exp_f32 v41, v41
    v_exp_f32 v42, v42
    v_exp_f32 v43, v43
    v_exp_f32 v44, v44
    v_mfma_f32_32x32x16_bf16 v[16:31], v[72:75], v[32:35], v[16:31]
    s_waitcnt lgkmcnt(1)
    ds_read_b128 v[72:75], v10 offset:2752
    v_exp_f32 v45, v45
    v_exp_f32 v46, v46
    v_exp_f32 v47, v47
    v_cvt_pk_bf16_f32 v84, v40, v41
    v_cvt_pk_bf16_f32 v85, v42, v43
    v_cvt_pk_bf16_f32 v86, v44, v45
    v_cvt_pk_bf16_f32 v87, v46, v47
    v_mfma_f32_32x32x8bf16_1k v[32:47], v[68:69], v[70:71], 0
    v_exp_f32 v48, v48
    v_exp_f32 v49, v49
    v_exp_f32 v50, v50
    v_exp_f32 v51, v51
    v_exp_f32 v52, v52
    v_mfma_f32_32x32x16_bf16 v[32:47], v[64:67], v[80:83], v[32:47]
    s_waitcnt lgkmcnt(1)
    ds_read_b128 v[64:67], v8 offset:8256
    ds_read_b64 v[68:69], v9 offset:8256
    v_exp_f32 v53, v53
    v_exp_f32 v54, v54
    v_exp_f32 v55, v55
    v_cvt_pk_bf16_f32 v48, v48, v49
    v_cvt_pk_bf16_f32 v49, v50, v51
    v_cvt_pk_bf16_f32 v50, v52, v53
    v_cvt_pk_bf16_f32 v51, v54, v55
    v_mfma_f32_32x32x16_bf16 v[16:31], v[76:79], v[84:87], v[16:31]
    s_waitcnt lgkmcnt(2)
    ds_read_b128 v[76:79], v10 offset:3488
    v_exp_f32 v56, v56
    v_exp_f32 v57, v57
    v_exp_f32 v58, v58
    v_exp_f32 v59, v59
    v_exp_f32 v60, v60
    v_mfma_f32_32x32x16_bf16 v[16:31], v[72:75], v[48:51], v[16:31]
    s_waitcnt lgkmcnt(1)
    ds_read_b128 v[72:75], v10 offset:5504
    v_exp_f32 v61, v61
    v_exp_f32 v62, v62
    v_exp_f32 v63, v63
    v_cvt_pk_bf16_f32 v84, v56, v57
    v_cvt_pk_bf16_f32 v85, v58, v59
    v_cvt_pk_bf16_f32 v86, v60, v61
    v_cvt_pk_bf16_f32 v87, v62, v63
    s_barrier
    v_mfma_f32_32x32x8bf16_1k v[48:63], v[68:69], v[70:71], 0
    s_setprio 1
    s_add_u32 s29, s29, 22016
    s_cmp_ge_u32 s29, 176128
    s_cselect_b32 s95, 176128, 0
    s_sub_u32 s29, s29, s95
    s_add_u32 m0, s85, 124928
    s_add_u32 s95, s29, s92
    buffer_load_dwordx4 v1, s[32:35], s95 offen offset:0 sc1 lds
    v_exp_f32 v32, v32
    v_exp_f32 v33, v33
    v_exp_f32 v34, v34
    v_exp_f32 v35, v35
    v_exp_f32 v36, v36
    v_mfma_f32_32x32x16_bf16 v[48:63], v[64:67], v[80:83], v[48:63]
    s_waitcnt lgkmcnt(1)
    ds_read_b128 v[64:67], v8 offset:11264
    ds_read_b64 v[68:69], v9 offset:11264
    buffer_load_dwordx4 v1, s[32:35], s95 offen offset:1024 sc1 lds
    v_exp_f32 v37, v37
    v_exp_f32 v38, v38
    v_exp_f32 v39, v39
    v_cvt_pk_bf16_f32 v32, v32, v33
    v_cvt_pk_bf16_f32 v33, v34, v35
    v_cvt_pk_bf16_f32 v34, v36, v37
    v_cvt_pk_bf16_f32 v35, v38, v39
    v_mfma_f32_32x32x16_bf16 v[16:31], v[76:79], v[84:87], v[16:31]
    s_waitcnt lgkmcnt(2)
    ds_read_b128 v[76:79], v10 offset:6240
    s_cmp_eq_u32 s85, 9216
    s_cbranch_scc1 L_skip_kv_65
    buffer_load_dwordx4 v1, s[32:35], s95 offen offset:2048 sc1 lds
L_skip_kv_65:
    v_exp_f32 v40, v40
    v_exp_f32 v41, v41
    v_exp_f32 v42, v42
    v_exp_f32 v43, v43
    v_exp_f32 v44, v44
    v_mfma_f32_32x32x16_bf16 v[16:31], v[72:75], v[32:35], v[16:31]
    s_waitcnt lgkmcnt(1)
    ds_read_b128 v[72:75], v10 offset:8256
    s_add_u32 s91, s86, 147456
    s_add_u32 s91, s91, s93
    buffer_load_dwordx4 v[224:227], v1, s[32:35], s91 offen sc1
    v_exp_f32 v45, v45
    v_exp_f32 v46, v46
    v_exp_f32 v47, v47
    v_cvt_pk_bf16_f32 v84, v40, v41
    v_cvt_pk_bf16_f32 v85, v42, v43
    v_cvt_pk_bf16_f32 v86, v44, v45
    v_cvt_pk_bf16_f32 v87, v46, v47
    v_mfma_f32_32x32x8bf16_1k v[32:47], v[68:69], v[70:71], 0
    s_add_u32 s91, s86, 159744
    buffer_load_dwordx4 v[148:151], v1, s[32:35], s91 offen sc1
    v_exp_f32 v48, v48
    v_exp_f32 v49, v49
    v_exp_f32 v50, v50
    v_exp_f32 v51, v51
    v_exp_f32 v52, v52
    v_mfma_f32_32x32x16_bf16 v[32:47], v[64:67], v[80:83], v[32:47]
    s_waitcnt lgkmcnt(1)
    ds_read_b128 v[64:67], v8 offset:14016
    ds_read_b64 v[68:69], v9 offset:14016
    s_add_u32 s91, s86, 159744
    s_add_u32 s91, s91, s93
    buffer_load_dwordx4 v[228:231], v1, s[32:35], s91 offen sc1
    v_exp_f32 v53, v53
    v_exp_f32 v54, v54
    v_exp_f32 v55, v55
    v_cvt_pk_bf16_f32 v48, v48, v49
    v_cvt_pk_bf16_f32 v49, v50, v51
    v_cvt_pk_bf16_f32 v50, v52, v53
    v_cvt_pk_bf16_f32 v51, v54, v55
    v_mfma_f32_32x32x16_bf16 v[16:31], v[76:79], v[84:87], v[16:31]
    s_waitcnt lgkmcnt(2)
    ds_read_b128 v[76:79], v10 offset:8992
    s_add_u32 s91, s86, 172032
    buffer_load_dwordx4 v[152:155], v1, s[32:35], s91 offen sc1
    v_exp_f32 v56, v56
    v_exp_f32 v57, v57
    v_exp_f32 v58, v58
    v_exp_f32 v59, v59
    v_exp_f32 v60, v60
    v_mfma_f32_32x32x16_bf16 v[16:31], v[72:75], v[48:51], v[16:31]
    s_waitcnt lgkmcnt(1)
    ds_read_b128 v[72:75], v10 offset:11264
    s_add_u32 s91, s86, 172032
    s_add_u32 s91, s91, s93
    buffer_load_dwordx4 v[232:235], v1, s[32:35], s91 offen sc1
    v_exp_f32 v61, v61
    v_exp_f32 v62, v62
    v_exp_f32 v63, v63
    v_cvt_pk_bf16_f32 v84, v56, v57
    v_cvt_pk_bf16_f32 v85, v58, v59
    v_cvt_pk_bf16_f32 v86, v60, v61
    v_cvt_pk_bf16_f32 v87, v62, v63
    v_mfma_f32_32x32x8bf16_1k v[48:63], v[68:69], v[70:71], 0
    s_waitcnt vmcnt(12)
    s_cmp_ge_u32 s74, 6
    s_cbranch_scc1 L_skip_tabm_66
    s_cmp_eq_u32 s74, 5
    s_cselect_b32 exec_hi, 0xff, -1
    v_cmp_ne_u32 vcc, s75, v89
    v_cmp_ne_u32 s[90:91], s75, v91
    s_or_b64 vcc, vcc, s[90:91]
    v_cmp_ne_u32 s[90:91], s75, v93
    s_or_b64 vcc, vcc, s[90:91]
    v_cmp_ne_u32 s[90:91], s75, v95
    s_or_b64 vcc, vcc, s[90:91]
    s_cbranch_vccz L_tabok_67
L_tabspin_68:
    buffer_load_dwordx4 v[88:91], v1, s[32:35], s62 offen sc1
    buffer_load_dwordx4 v[92:95], v1, s[32:35], s63 offen sc1
    s_waitcnt vmcnt(0)
    v_cmp_ne_u32 vcc, s75, v89
    v_cmp_ne_u32 s[90:91], s75, v91
    s_or_b64 vcc, vcc, s[90:91]
    v_cmp_ne_u32 s[90:91], s75, v93
    s_or_b64 vcc, vcc, s[90:91]
    v_cmp_ne_u32 s[90:91], s75, v95
    s_or_b64 vcc, vcc, s[90:91]
    s_cbranch_vccz L_spinout_71
    s_sub_u32 s77, s77, 1
    s_cbranch_scc1 L_spinout_71_x
    s_branch L_tabspin_68
L_spinout_71_x:
    s_mov_b32 s77, 0
L_spinout_71:
L_tabok_67:
    s_cmp_eq_u32 s74, 5
    s_cbranch_scc1 L_tab5_69
    v_add_f32 v88, 1.0, v88
    v_add_f32 v90, 1.0, v90
    s_lshl_b32 s87, s74, 8
    s_add_u32 s87, s87, 153600
    v_cvt_pk_bf16_f32 v88, v88, v90
    v_cvt_pk_bf16_f32 v89, v92, v94
    v_lshl_add_u32 v90, v0, 2, s87
    ds_write_b32 v90, v88
    ds_write_b32 v90, v89 offset:1344
    s_branch L_tabdone_70
L_tab5_69:
    v_mov_b32 v89, v90
    v_mul_f32 v92, 0xbf317218, v92
    v_mul_f32 v93, 0xbf317218, v94
    v_lshlrev_b32 v90, 3, v0
    v_add_u32 v90, 156288, v90
    ds_write_b64 v90, v[88:89]
    ds_write_b64 v90, v[92:93] offset:320
L_tabdone_70:
    s_mov_b64 exec, -1
L_skip_tabm_66:
    v_exp_f32 v32, v32
    v_exp_f32 v33, v33
    v_exp_f32 v34, v34
    v_exp_f32 v35, v35
    v_exp_f32 v36, v36
    v_mfma_f32_32x32x16_bf16 v[48:63], v[64:67], v[80:83], v[48:63]
    s_waitcnt lgkmcnt(1)
    ds_read_b128 v[64:67], v8 offset:16768
    ds_read_b64 v[68:69], v9 offset:16768
    v_exp_f32 v37, v37
    v_exp_f32 v38, v38
    v_exp_f32 v39, v39
    v_cvt_pk_bf16_f32 v32, v32, v33
    v_cvt_pk_bf16_f32 v33, v34, v35
    v_cvt_pk_bf16_f32 v34, v36, v37
    v_cvt_pk_bf16_f32 v35, v38, v39
    v_mfma_f32_32x32x16_bf16 v[16:31], v[76:79], v[84:87], v[16:31]
    s_waitcnt lgkmcnt(2)
    ds_read_b128 v[76:79], v10 offset:12000
    v_exp_f32 v40, v40
    v_exp_f32 v41, v41
    v_exp_f32 v42, v42
    v_exp_f32 v43, v43
    v_exp_f32 v44, v44
    v_mfma_f32_32x32x16_bf16 v[16:31], v[72:75], v[32:35], v[16:31]
    s_waitcnt lgkmcnt(1)
    ds_read_b128 v[72:75], v10 offset:14016
    v_exp_f32 v45, v45
    v_exp_f32 v46, v46
    v_exp_f32 v47, v47
    v_cvt_pk_bf16_f32 v84, v40, v41
    v_cvt_pk_bf16_f32 v85, v42, v43
    v_cvt_pk_bf16_f32 v86, v44, v45
    v_cvt_pk_bf16_f32 v87, v46, v47
    v_mfma_f32_32x32x8bf16_1k v[32:47], v[68:69], v[70:71], 0
    v_exp_f32 v48, v48
    v_exp_f32 v49, v49
    v_exp_f32 v50, v50
    v_exp_f32 v51, v51
    v_exp_f32 v52, v52
    v_mfma_f32_32x32x16_bf16 v[32:47], v[64:67], v[80:83], v[32:47]
    s_waitcnt lgkmcnt(1)
    ds_read_b128 v[64:67], v8 offset:19520
    ds_read_b64 v[68:69], v9 offset:19520
    v_exp_f32 v53, v53
    v_exp_f32 v54, v54
    v_exp_f32 v55, v55
    v_cvt_pk_bf16_f32 v48, v48, v49
    v_cvt_pk_bf16_f32 v49, v50, v51
    v_cvt_pk_bf16_f32 v50, v52, v53
    v_cvt_pk_bf16_f32 v51, v54, v55
    v_mfma_f32_32x32x16_bf16 v[16:31], v[76:79], v[84:87], v[16:31]
    s_waitcnt lgkmcnt(2)
    ds_read_b128 v[76:79], v10 offset:14752
    v_exp_f32 v56, v56
    v_exp_f32 v57, v57
    v_exp_f32 v58, v58
    v_exp_f32 v59, v59
    v_exp_f32 v60, v60
    v_mfma_f32_32x32x16_bf16 v[16:31], v[72:75], v[48:51], v[16:31]
    s_waitcnt lgkmcnt(1)
    ds_read_b128 v[72:75], v10 offset:16768
    v_exp_f32 v61, v61
    v_exp_f32 v62, v62
    v_exp_f32 v63, v63
    v_cvt_pk_bf16_f32 v84, v56, v57
    v_cvt_pk_bf16_f32 v85, v58, v59
    v_cvt_pk_bf16_f32 v86, v60, v61
    v_cvt_pk_bf16_f32 v87, v62, v63
    s_waitcnt vmcnt(5)
    s_barrier
    v_mfma_f32_32x32x8bf16_1k v[48:63], v[68:69], v[70:71], 0
    s_setprio 0
    s_add_u32 s91, s86, 184320
    buffer_load_dwordx4 v[156:159], v1, s[32:35], s91 offen sc1
    v_exp_f32 v32, v32
    v_exp_f32 v33, v33
    v_exp_f32 v34, v34
    v_exp_f32 v35, v35
    v_exp_f32 v36, v36
    v_mfma_f32_32x32x16_bf16 v[48:63], v[64:67], v[80:83], v[48:63]
    s_waitcnt lgkmcnt(1)
    ds_read_b128 v[64:67], v8 offset:22528
    ds_read_b64 v[68:69], v9 offset:22528
    s_add_u32 s91, s86, 184320
    s_add_u32 s91, s91, s93
    buffer_load_dwordx4 v[236:239], v1, s[32:35], s91 offen sc1
    v_exp_f32 v37, v37
    v_exp_f32 v38, v38
    v_exp_f32 v39, v39
    v_cvt_pk_bf16_f32 v32, v32, v33
    v_cvt_pk_bf16_f32 v33, v34, v35
    v_cvt_pk_bf16_f32 v34, v36, v37
    v_cvt_pk_bf16_f32 v35, v38, v39
    v_mfma_f32_32x32x16_bf16 v[16:31], v[76:79], v[84:87], v[16:31]
    s_waitcnt lgkmcnt(2)
    ds_read_b128 v[76:79], v10 offset:17504
    s_add_u32 s91, s86, 196608
    buffer_load_dwordx4 v[160:163], v1, s[32:35], s91 offen sc1
    v_exp_f32 v40, v40
    v_exp_f32 v41, v41
    v_exp_f32 v42, v42
    v_exp_f32 v43, v43
    v_exp_f32 v44, v44
    v_mfma_f32_32x32x16_bf16 v[16:31], v[72:75], v[32:35], v[16:31]
    s_waitcnt lgkmcnt(1)
    ds_read_b128 v[72:75], v10 offset:19520
    s_add_u32 s91, s86, 196608
    s_add_u32 s91, s91, s93
    buffer_load_dwordx4 v[240:243], v1, s[32:35], s91 offen sc1
    v_exp_f32 v45, v45
    v_exp_f32 v46, v46
    v_exp_f32 v47, v47
    v_cvt_pk_bf16_f32 v84, v40, v41
    v_cvt_pk_bf16_f32 v85, v42, v43
    v_cvt_pk_bf16_f32 v86, v44, v45
    v_cvt_pk_bf16_f32 v87, v46, v47
    v_mfma_f32_32x32x8bf16_1k v[32:47], v[68:69], v[70:71], 0
    s_add_u32 s91, s86, 208896
    buffer_load_dwordx4 v[164:167], v1, s[32:35], s91 offen sc1
    v_exp_f32 v48, v48
    v_exp_f32 v49, v49
    v_exp_f32 v50, v50
    v_exp_f32 v51, v51
    v_exp_f32 v52, v52
    v_mfma_f32_32x32x16_bf16 v[32:47], v[64:67], v[80:83], v[32:47]
    s_waitcnt lgkmcnt(1)
    ds_read_b128 v[64:67], v8 offset:25280
    ds_read_b64 v[68:69], v9 offset:25280
    v_exp_f32 v53, v53
    v_exp_f32 v54, v54
    v_exp_f32 v55, v55
    v_cvt_pk_bf16_f32 v48, v48, v49
    v_cvt_pk_bf16_f32 v49, v50, v51
    v_cvt_pk_bf16_f32 v50, v52, v53
    v_cvt_pk_bf16_f32 v51, v54, v55
    v_mfma_f32_32x32x16_bf16 v[16:31], v[76:79], v[84:87], v[16:31]
    s_waitcnt lgkmcnt(2)
    ds_read_b128 v[76:79], v10 offset:20256
    v_exp_f32 v56, v56
    v_exp_f32 v57, v57
    v_exp_f32 v58, v58
    v_exp_f32 v59, v59
    v_exp_f32 v60, v60
    v_mfma_f32_32x32x16_bf16 v[16:31], v[72:75], v[48:51], v[16:31]
    s_waitcnt lgkmcnt(1)
    ds_read_b128 v[72:75], v10 offset:22528
    v_exp_f32 v61, v61
    v_exp_f32 v62, v62
    v_exp_f32 v63, v63
    v_cvt_pk_bf16_f32 v84, v56, v57
    v_cvt_pk_bf16_f32 v85, v58, v59
    v_cvt_pk_bf16_f32 v86, v60, v61
    v_cvt_pk_bf16_f32 v87, v62, v63
    v_mfma_f32_32x32x8bf16_1k v[48:63], v[68:69], v[70:71], 0
    v_exp_f32 v32, v32
    v_exp_f32 v33, v33
    v_exp_f32 v34, v34
    v_exp_f32 v35, v35
    v_exp_f32 v36, v36
    v_mfma_f32_32x32x16_bf16 v[48:63], v[64:67], v[80:83], v[48:63]
    s_waitcnt lgkmcnt(1)
    ds_read_b128 v[64:67], v8 offset:28032
    ds_read_b64 v[68:69], v9 offset:28032
    v_exp_f32 v37, v37
    v_exp_f32 v38, v38
    v_exp_f32 v39, v39
    v_cvt_pk_bf16_f32 v32, v32, v33
    v_cvt_pk_bf16_f32 v33, v34, v35
    v_cvt_pk_bf16_f32 v34, v36, v37
    v_cvt_pk_bf16_f32 v35, v38, v39
    v_mfma_f32_32x32x16_bf16 v[16:31], v[76:79], v[84:87], v[16:31]
    s_waitcnt lgkmcnt(2)
    ds_read_b128 v[76:79], v10 offset:23264
    v_exp_f32 v40, v40
    v_exp_f32 v41, v41
    v_exp_f32 v42, v42
    v_exp_f32 v43, v43
    v_exp_f32 v44, v44
    v_mfma_f32_32x32x16_bf16 v[16:31], v[72:75], v[32:35], v[16:31]
    s_waitcnt lgkmcnt(1)
    ds_read_b128 v[72:75], v10 offset:25280
    v_exp_f32 v45, v45
    v_exp_f32 v46, v46
    v_exp_f32 v47, v47
    v_cvt_pk_bf16_f32 v84, v40, v41
    v_cvt_pk_bf16_f32 v85, v42, v43
    v_cvt_pk_bf16_f32 v86, v44, v45
    v_cvt_pk_bf16_f32 v87, v46, v47
    v_mfma_f32_32x32x8bf16_1k v[32:47], v[68:69], v[70:71], 0
    v_exp_f32 v48, v48
    v_exp_f32 v49, v49
    v_exp_f32 v50, v50
    v_exp_f32 v51, v51
    v_exp_f32 v52, v52
    v_mfma_f32_32x32x16_bf16 v[32:47], v[64:67], v[80:83], v[32:47]
    s_waitcnt lgkmcnt(1)
    ds_read_b128 v[64:67], v8 offset:30784
    ds_read_b64 v[68:69], v9 offset:30784
    v_exp_f32 v53, v53
    v_exp_f32 v54, v54
    v_exp_f32 v55, v55
    v_cvt_pk_bf16_f32 v48, v48, v49
    v_cvt_pk_bf16_f32 v49, v50, v51
    v_cvt_pk_bf16_f32 v50, v52, v53
    v_cvt_pk_bf16_f32 v51, v54, v55
    v_mfma_f32_32x32x16_bf16 v[16:31], v[76:79], v[84:87], v[16:31]
    s_waitcnt lgkmcnt(2)
    ds_read_b128 v[76:79], v10 offset:26016
    v_exp_f32 v56, v56
    v_exp_f32 v57, v57
    v_exp_f32 v58, v58
    v_exp_f32 v59, v59
    v_exp_f32 v60, v60
    v_mfma_f32_32x32x16_bf16 v[16:31], v[72:75], v[48:51], v[16:31]
    s_waitcnt lgkmcnt(1)
    ds_read_b128 v[72:75], v10 offset:28032
    v_exp_f32 v61, v61
    v_exp_f32 v62, v62
    v_exp_f32 v63, v63
    v_cvt_pk_bf16_f32 v84, v56, v57
    v_cvt_pk_bf16_f32 v85, v58, v59
    v_cvt_pk_bf16_f32 v86, v60, v61
    v_cvt_pk_bf16_f32 v87, v62, v63
    s_barrier
    v_mfma_f32_32x32x8bf16_1k v[48:63], v[68:69], v[70:71], 0
    s_setprio 1
    s_add_u32 s91, s86, 208896
    s_add_u32 s91, s91, s93
    buffer_load_dwordx4 v[244:247], v1, s[32:35], s91 offen sc1
    v_exp_f32 v32, v32
    v_exp_f32 v33, v33
    v_exp_f32 v34, v34
    v_exp_f32 v35, v35
    v_exp_f32 v36, v36
    v_mfma_f32_32x32x16_bf16 v[48:63], v[64:67], v[80:83], v[48:63]
    s_waitcnt lgkmcnt(1)
    ds_read_b128 v[64:67], v8 offset:0
    ds_read_b64 v[68:69], v9 offset:0
    s_add_u32 s91, s86, 221184
    buffer_load_dwordx4 v[168:171], v1, s[32:35], s91 offen sc1
    v_exp_f32 v37, v37
    v_exp_f32 v38, v38
    v_exp_f32 v39, v39
    v_cvt_pk_bf16_f32 v32, v32, v33
    v_cvt_pk_bf16_f32 v33, v34, v35
    v_cvt_pk_bf16_f32 v34, v36, v37
    v_cvt_pk_bf16_f32 v35, v38, v39
    v_mfma_f32_32x32x16_bf16 v[16:31], v[76:79], v[84:87], v[16:31]
    s_waitcnt lgkmcnt(2)
    ds_read_b128 v[76:79], v10 offset:28768
    s_add_u32 s91, s86, 221184
    s_add_u32 s91, s91, s93
    buffer_load_dwordx4 v[248:251], v1, s[32:35], s91 offen sc1
    v_exp_f32 v40, v40
    v_exp_f32 v41, v41
    v_exp_f32 v42, v42
    v_exp_f32 v43, v43
    v_exp_f32 v44, v44
    v_mfma_f32_32x32x16_bf16 v[16:31], v[72:75], v[32:35], v[16:31]
    s_waitcnt lgkmcnt(1)
    ds_read_b128 v[72:75], v10 offset:30784
    s_add_u32 s91, s86, 233472
    buffer_load_dwordx4 v[172:175], v1, s[32:35], s91 offen sc1
    v_exp_f32 v45, v45
    v_exp_f32 v46, v46
    v_exp_f32 v47, v47
    v_cvt_pk_bf16_f32 v84, v40, v41
    v_cvt_pk_bf16_f32 v85, v42, v43
    v_cvt_pk_bf16_f32 v86, v44, v45
    v_cvt_pk_bf16_f32 v87, v46, v47
    v_mfma_f32_32x32x8bf16_1k v[32:47], v[68:69], v[70:71], 0
    s_add_u32 s91, s86, 233472
    s_add_u32 s91, s91, s93
    buffer_load_dwordx4 v[252:255], v1, s[32:35], s91 offen sc1
    v_exp_f32 v48, v48
    v_exp_f32 v49, v49
    v_exp_f32 v50, v50
    v_exp_f32 v51, v51
    v_exp_f32 v52, v52
    v_mfma_f32_32x32x16_bf16 v[32:47], v[64:67], v[80:83], v[32:47]
    s_waitcnt lgkmcnt(1)
    ds_read_b128 v[64:67], v8 offset:2752
    ds_read_b64 v[68:69], v9 offset:2752
    v_exp_f32 v53, v53
    v_exp_f32 v54, v54
    v_exp_f32 v55, v55
    v_cvt_pk_bf16_f32 v48, v48, v49
    v_cvt_pk_bf16_f32 v49, v50, v51
    v_cvt_pk_bf16_f32 v50, v52, v53
    v_cvt_pk_bf16_f32 v51, v54, v55
    v_mfma_f32_32x32x16_bf16 v[16:31], v[76:79], v[84:87], v[16:31]
    s_waitcnt lgkmcnt(2)
    ds_read_b128 v[76:79], v10 offset:31520
    v_exp_f32 v56, v56
    v_exp_f32 v57, v57
    v_exp_f32 v58, v58
    v_exp_f32 v59, v59
    v_exp_f32 v60, v60
    v_mfma_f32_32x32x16_bf16 v[16:31], v[72:75], v[48:51], v[16:31]
    s_waitcnt lgkmcnt(1)
    ds_read_b128 v[72:75], v10 offset:0
    v_exp_f32 v61, v61
    v_exp_f32 v62, v62
    v_exp_f32 v63, v63
    v_cvt_pk_bf16_f32 v84, v56, v57
    v_cvt_pk_bf16_f32 v85, v58, v59
    v_cvt_pk_bf16_f32 v86, v60, v61
    v_cvt_pk_bf16_f32 v87, v62, v63
    v_mfma_f32_32x32x8bf16_1k v[48:63], v[68:69], v[70:71], 0
    v_exp_f32 v32, v32
    v_exp_f32 v33, v33
    v_exp_f32 v34, v34
    v_exp_f32 v35, v35
    v_exp_f32 v36, v36
    v_mfma_f32_32x32x16_bf16 v[48:63], v[64:67], v[80:83], v[48:63]
    s_waitcnt lgkmcnt(1)
    ds_read_b128 v[64:67], v8 offset:5504
    ds_read_b64 v[68:69], v9 offset:5504
    v_exp_f32 v37, v37
    v_exp_f32 v38, v38
    v_exp_f32 v39, v39
    v_cvt_pk_bf16_f32 v32, v32, v33
    v_cvt_pk_bf16_f32 v33, v34, v35
    v_cvt_pk_bf16_f32 v34, v36, v37
    v_cvt_pk_bf16_f32 v35, v38, v39
    v_mfma_f32_32x32x16_bf16 v[16:31], v[76:79], v[84:87], v[16:31]
    s_waitcnt lgkmcnt(2)
    ds_read_b128 v[76:79], v10 offset:736
    v_exp_f32 v40, v40
    v_exp_f32 v41, v41
    v_exp_f32 v42, v42
    v_exp_f32 v43, v43
    v_exp_f32 v44, v44
    v_mfma_f32_32x32x16_bf16 v[16:31], v[72:75], v[32:35], v[16:31]
    s_waitcnt lgkmcnt(1)
    ds_read_b128 v[72:75], v10 offset:2752
    v_exp_f32 v45, v45
    v_exp_f32 v46, v46
    v_exp_f32 v47, v47
    v_cvt_pk_bf16_f32 v84, v40, v41
    v_cvt_pk_bf16_f32 v85, v42, v43
    v_cvt_pk_bf16_f32 v86, v44, v45
    v_cvt_pk_bf16_f32 v87, v46, v47
    v_mfma_f32_32x32x8bf16_1k v[32:47], v[68:69], v[70:71], 0
    v_exp_f32 v48, v48
    v_exp_f32 v49, v49
    v_exp_f32 v50, v50
    v_exp_f32 v51, v51
    v_exp_f32 v52, v52
    v_mfma_f32_32x32x16_bf16 v[32:47], v[64:67], v[80:83], v[32:47]
    s_waitcnt lgkmcnt(1)
    ds_read_b128 v[64:67], v8 offset:8256
    ds_read_b64 v[68:69], v9 offset:8256
    v_exp_f32 v53, v53
    v_exp_f32 v54, v54
    v_exp_f32 v55, v55
    v_cvt_pk_bf16_f32 v48, v48, v49
    v_cvt_pk_bf16_f32 v49, v50, v51
    v_cvt_pk_bf16_f32 v50, v52, v53
    v_cvt_pk_bf16_f32 v51, v54, v55
    v_mfma_f32_32x32x16_bf16 v[16:31], v[76:79], v[84:87], v[16:31]
    s_waitcnt lgkmcnt(2)
    ds_read_b128 v[76:79], v10 offset:3488
    v_exp_f32 v56, v56
    v_exp_f32 v57, v57
    v_exp_f32 v58, v58
    v_exp_f32 v59, v59
    v_exp_f32 v60, v60
    v_mfma_f32_32x32x16_bf16 v[16:31], v[72:75], v[48:51], v[16:31]
    s_waitcnt lgkmcnt(1)
    ds_read_b128 v[72:75], v10 offset:5504
    v_exp_f32 v61, v61
    v_exp_f32 v62, v62
    v_exp_f32 v63, v63
    v_cvt_pk_bf16_f32 v84, v56, v57
    v_cvt_pk_bf16_f32 v85, v58, v59
    v_cvt_pk_bf16_f32 v86, v60, v61
    v_cvt_pk_bf16_f32 v87, v62, v63
    v_mfma_f32_32x32x8bf16_1k v[48:63], v[68:69], v[70:71], 0
    s_setprio 0
    v_and_b32 v14, 15, v0
    v_lshrrev_b32 v11, 4, v0
    v_mul_u32_u24 v14, 1280, v14
    v_lshl_add_u32 v14, v11, 3, v14
    s_lshl_b32 s87, s72, 12
    s_xor_b32 s89, s61, 0
    s_add_u32 s87, s87, s89
    s_mul_i32 s87, s87, 20
    s_add_u32 s87, s87, s30
    s_lshr_b32 s89, s74, 2
    s_mul_i32 s89, s89, 96
    s_add_u32 s87, s87, s89
    buffer_load_dwordx2 v[92:93], v14, s[36:39], s87 offen offset:0
    buffer_load_dwordx2 v[94:95], v14, s[36:39], s87 offen offset:32
    buffer_load_dwordx2 v[12:13], v14, s[36:39], s87 offen offset:64
    v_exp_f32 v32, v32
    v_exp_f32 v33, v33
    v_exp_f32 v34, v34
    v_exp_f32 v35, v35
    v_exp_f32 v36, v36
    v_mfma_f32_32x32x16_bf16 v[48:63], v[64:67], v[80:83], v[48:63]
    s_waitcnt lgkmcnt(1)
    v_exp_f32 v37, v37
    v_exp_f32 v38, v38
    v_exp_f32 v39, v39
    v_cvt_pk_bf16_f32 v32, v32, v33
    v_cvt_pk_bf16_f32 v33, v34, v35
    v_cvt_pk_bf16_f32 v34, v36, v37
    v_cvt_pk_bf16_f32 v35, v38, v39
    v_mfma_f32_32x32x16_bf16 v[16:31], v[76:79], v[84:87], v[16:31]
    s_waitcnt lgkmcnt(0)
    ds_read_b128 v[76:79], v10 offset:6240
    v_exp_f32 v40, v40
    v_exp_f32 v41, v41
    v_exp_f32 v42, v42
    v_exp_f32 v43, v43
    v_exp_f32 v44, v44
    v_mfma_f32_32x32x16_bf16 v[16:31], v[72:75], v[32:35], v[16:31]
    ds_read_b128 v[72:75], v10 offset:8256
    v_exp_f32 v45, v45
    v_exp_f32 v46, v46
    v_exp_f32 v47, v47
    v_cvt_pk_bf16_f32 v84, v40, v41
    v_cvt_pk_bf16_f32 v85, v42, v43
    v_cvt_pk_bf16_f32 v86, v44, v45
    v_cvt_pk_bf16_f32 v87, v46, v47
    v_exp_f32 v48, v48
    v_exp_f32 v49, v49
    v_exp_f32 v50, v50
    v_exp_f32 v51, v51
    v_exp_f32 v52, v52
    s_waitcnt lgkmcnt(1)
    v_exp_f32 v53, v53
    v_exp_f32 v54, v54
    v_exp_f32 v55, v55
    v_cvt_pk_bf16_f32 v48, v48, v49
    v_cvt_pk_bf16_f32 v49, v50, v51
    v_cvt_pk_bf16_f32 v50, v52, v53
    v_cvt_pk_bf16_f32 v51, v54, v55
    v_mfma_f32_32x32x16_bf16 v[16:31], v[76:79], v[84:87], v[16:31]
    s_waitcnt lgkmcnt(0)
    ds_read_b128 v[76:79], v10 offset:8992
    v_exp_f32 v56, v56
    v_exp_f32 v57, v57
    v_exp_f32 v58, v58
    v_exp_f32 v59, v59
    v_exp_f32 v60, v60
    v_mfma_f32_32x32x16_bf16 v[16:31], v[72:75], v[48:51], v[16:31]
    v_exp_f32 v61, v61
    v_exp_f32 v62, v62
    v_exp_f32 v63, v63
    v_cvt_pk_bf16_f32 v84, v56, v57
    v_cvt_pk_bf16_f32 v85, v58, v59
    v_cvt_pk_bf16_f32 v86, v60, v61
    v_cvt_pk_bf16_f32 v87, v62, v63
    s_waitcnt lgkmcnt(0)
    s_nop 0
    v_mfma_f32_32x32x16_bf16 v[16:31], v[76:79], v[84:87], v[16:31]
    s_branch L_att_done
L_att_b:
    v_mov_b32 v94, -1
    v_mov_b32 v95, -1
    ds_read_b128 v[64:67], v8 offset:0
    ds_read_b64 v[68:69], v9 offset:0
    ds_read_b128 v[72:75], v10 offset:0
    s_waitcnt lgkmcnt(1)
    v_mfma_f32_32x32x8bf16_1k v[32:47], v[68:69], v[70:71], 0
    v_mfma_f32_32x32x16_bf16 v[32:47], v[64:67], v[80:83], v[32:47]
    ds_read_b128 v[64:67], v8 offset:2752
    ds_read_b64 v[68:69], v9 offset:2752
    v_mov_b32 v16, 0
    v_mov_b32 v17, 0
    v_mov_b32 v18, 0
    v_mov_b32 v19, 0
    v_mov_b32 v20, 0
    v_mov_b32 v21, 0
    v_mov_b32 v22, 0
    v_mov_b32 v23, 0
    v_mov_b32 v24, 0
    v_mov_b32 v25, 0
    v_mov_b32 v26, 0
    v_mov_b32 v27, 0
    v_mov_b32 v28, 0
    v_mov_b32 v29, 0
    v_mov_b32 v30, 0
    v_mov_b32 v31, 0
    s_waitcnt lgkmcnt(0)
    v_mfma_f32_32x32x8bf16_1k v[48:63], v[68:69], v[70:71], 0
    v_exp_f32 v32, v32
    v_exp_f32 v33, v33
    v_exp_f32 v34, v34
    v_exp_f32 v35, v35
    v_exp_f32 v36, v36
    v_mfma_f32_32x32x16_bf16 v[48:63], v[64:67], v[80:83], v[48:63]
    ds_read_b128 v[64:67], v8 offset:5504
    ds_read_b64 v[68:69], v9 offset:5504
    v_exp_f32 v37, v37
    v_exp_f32 v38, v38
    v_exp_f32 v39, v39
    v_cvt_pk_bf16_f32 v32, v32, v33
    v_cvt_pk_bf16_f32 v33, v34, v35
    v_cvt_pk_bf16_f32 v34, v36, v37
    v_cvt_pk_bf16_f32 v35, v38, v39
    ds_read_b128 v[76:79], v10 offset:736
    v_exp_f32 v40, v40
    v_exp_f32 v41, v41
    v_exp_f32 v42, v42
    v_exp_f32 v43, v43
    v_exp_f32 v44, v44
    v_mfma_f32_32x32x16_bf16 v[16:31], v[72:75], v[32:35], v[16:31]
    s_waitcnt lgkmcnt(1)
    ds_read_b128 v[72:75], v10 offset:2752
    v_exp_f32 v45, v45
    v_exp_f32 v46, v46
    v_exp_f32 v47, v47
    v_cvt_pk_bf16_f32 v84, v40, v41
    v_cvt_pk_bf16_f32 v85, v42, v43
    v_cvt_pk_bf16_f32 v86, v44, v45
    v_cvt_pk_bf16_f32 v87, v46, v47
    v_mfma_f32_32x32x8bf16_1k v[32:47], v[68:69], v[70:71], 0
    v_exp_f32 v48, v48
    v_exp_f32 v49, v49
    v_exp_f32 v50, v50
    v_exp_f32 v51, v51
    v_exp_f32 v52, v52
    v_mfma_f32_32x32x16_bf16 v[32:47], v[64:67], v[80:83], v[32:47]
    s_waitcnt lgkmcnt(1)
    ds_read_b128 v[64:67], v8 offset:8256
    ds_read_b64 v[68:69], v9 offset:8256
    v_exp_f32 v53, v53
    v_exp_f32 v54, v54
    v_exp_f32 v55, v55
    v_cvt_pk_bf16_f32 v48, v48, v49
    v_cvt_pk_bf16_f32 v49, v50, v51
    v_cvt_pk_bf16_f32 v50, v52, v53
    v_cvt_pk_bf16_f32 v51, v54, v55
    v_mfma_f32_32x32x16_bf16 v[16:31], v[76:79], v[84:87], v[16:31]
    s_waitcnt lgkmcnt(2)
    ds_read_b128 v[76:79], v10 offset:3488
    v_exp_f32 v56, v56
    v_exp_f32 v57, v57
    v_exp_f32 v58, v58
    v_exp_f32 v59, v59
    v_exp_f32 v60, v60
    v_mfma_f32_32x32x16_bf16 v[16:31], v[72:75], v[48:51], v[16:31]
    s_waitcnt lgkmcnt(1)
    ds_read_b128 v[72:75], v10 offset:5504
    v_exp_f32 v61, v61
    v_exp_f32 v62, v62
    v_exp_f32 v63, v63
    v_cvt_pk_bf16_f32 v84, v56, v57
    v_cvt_pk_bf16_f32 v85, v58, v59
    v_cvt_pk_bf16_f32 v86, v60, v61
    v_cvt_pk_bf16_f32 v87, v62, v63
    s_barrier
    v_mfma_f32_32x32x8bf16_1k v[48:63], v[68:69], v[70:71], 0
    s_setprio 0
    s_lshr_b32 s87, s61, 5
    s_add_u32 s87, s87, s72
    s_cmp_ge_u32 s87, 68
    s_cbranch_scc1 L_skip_rl_72
    s_cmp_lt_u32 s87, 20
    s_cselect_b32 s40, s44, s52
    s_cselect_b32 s41, s45, s53
    s_cselect_b32 s42, s46, s54
    s_cselect_b32 s89, 0, 20
    s_sub_u32 s87, s87, s89
    s_mul_i32 s87, s87, 40960
    s_add_u32 s87, s87, s30
    s_mul_i32 s89, s61, 5
    s_add_u32 m0, s89, 73728
    s_nop 0
    buffer_load_dwordx4 v2, s[40:43], s87 offen lds
    s_add_u32 m0, s89, 74752
    s_nop 0
    buffer_load_dwordx4 v3, s[40:43], s87 offen lds
    s_add_u32 m0, s89, 75776
    s_nop 0
    buffer_load_dwordx4 v4, s[40:43], s87 offen lds
    s_add_u32 m0, s89, 76800
    s_nop 0
    buffer_load_dwordx4 v5, s[40:43], s87 offen lds
    s_add_u32 m0, s89, 77824
    s_nop 0
    buffer_load_dwordx4 v6, s[40:43], s87 offen lds
L_skip_rl_72:
    v_exp_f32 v32, v32
    v_exp_f32 v33, v33
    v_exp_f32 v34, v34
    v_exp_f32 v35, v35
    v_exp_f32 v36, v36
    v_mfma_f32_32x32x16_bf16 v[48:63], v[64:67], v[80:83], v[48:63]
    s_waitcnt lgkmcnt(1)
    ds_read_b128 v[64:67], v8 offset:11264
    ds_read_b64 v[68:69], v9 offset:11264
    v_exp_f32 v37, v37
    v_exp_f32 v38, v38
    v_exp_f32 v39, v39
    v_cvt_pk_bf16_f32 v32, v32, v33
    v_cvt_pk_bf16_f32 v33, v34, v35
    v_cvt_pk_bf16_f32 v34, v36, v37
    v_cvt_pk_bf16_f32 v35, v38, v39
    v_mfma_f32_32x32x16_bf16 v[16:31], v[76:79], v[84:87], v[16:31]
    s_waitcnt lgkmcnt(2)
    ds_read_b128 v[76:79], v10 offset:6240
    v_exp_f32 v40, v40
    v_exp_f32 v41, v41
    v_exp_f32 v42, v42
    v_exp_f32 v43, v43
    v_exp_f32 v44, v44
    v_mfma_f32_32x32x16_bf16 v[16:31], v[72:75], v[32:35], v[16:31]
    s_waitcnt lgkmcnt(1)
    ds_read_b128 v[72:75], v10 offset:8256
    v_exp_f32 v45, v45
    v_exp_f32 v46, v46
    v_exp_f32 v47, v47
    v_cvt_pk_bf16_f32 v84, v40, v41
    v_cvt_pk_bf16_f32 v85, v42, v43
    v_cvt_pk_bf16_f32 v86, v44, v45
    v_cvt_pk_bf16_f32 v87, v46, v47
    v_mfma_f32_32x32x8bf16_1k v[32:47], v[68:69], v[70:71], 0
    v_exp_f32 v48, v48
    v_exp_f32 v49, v49
    v_exp_f32 v50, v50
    v_exp_f32 v51, v51
    v_exp_f32 v52, v52
    v_mfma_f32_32x32x16_bf16 v[32:47], v[64:67], v[80:83], v[32:47]
    s_waitcnt lgkmcnt(1)
    ds_read_b128 v[64:67], v8 offset:14016
    ds_read_b64 v[68:69], v9 offset:14016
    v_exp_f32 v53, v53
    v_exp_f32 v54, v54
    v_exp_f32 v55, v55
    v_cvt_pk_bf16_f32 v48, v48, v49
    v_cvt_pk_bf16_f32 v49, v50, v51
    v_cvt_pk_bf16_f32 v50, v52, v53
    v_cvt_pk_bf16_f32 v51, v54, v55
    v_mfma_f32_32x32x16_bf16 v[16:31], v[76:79], v[84:87], v[16:31]
    s_waitcnt lgkmcnt(2)
    ds_read_b128 v[76:79], v10 offset:8992
    v_exp_f32 v56, v56
    v_exp_f32 v57, v57
    v_exp_f32 v58, v58
    v_exp_f32 v59, v59
    v_exp_f32 v60, v60
    v_mfma_f32_32x32x16_bf16 v[16:31], v[72:75], v[48:51], v[16:31]
    s_waitcnt lgkmcnt(1)
    ds_read_b128 v[72:75], v10 offset:11264
    v_exp_f32 v61, v61
    v_exp_f32 v62, v62
    v_exp_f32 v63, v63
    v_cvt_pk_bf16_f32 v84, v56, v57
    v_cvt_pk_bf16_f32 v85, v58, v59
    v_cvt_pk_bf16_f32 v86, v60, v61
    v_cvt_pk_bf16_f32 v87, v62, v63
    v_mfma_f32_32x32x8bf16_1k v[48:63], v[68:69], v[70:71], 0
    v_exp_f32 v32, v32
    v_exp_f32 v33, v33
    v_exp_f32 v34, v34
    v_exp_f32 v35, v35
    v_exp_f32 v36, v36
    v_mfma_f32_32x32x16_bf16 v[48:63], v[64:67], v[80:83], v[48:63]
    s_waitcnt lgkmcnt(1)
    ds_read_b128 v[64:67], v8 offset:16768
    ds_read_b64 v[68:69], v9 offset:16768
    v_exp_f32 v37, v37
    v_exp_f32 v38, v38
    v_exp_f32 v39, v39
    v_cvt_pk_bf16_f32 v32, v32, v33
    v_cvt_pk_bf16_f32 v33, v34, v35
    v_cvt_pk_bf16_f32 v34, v36, v37
    v_cvt_pk_bf16_f32 v35, v38, v39
    v_mfma_f32_32x32x16_bf16 v[16:31], v[76:79], v[84:87], v[16:31]
    s_waitcnt lgkmcnt(2)
    ds_read_b128 v[76:79], v10 offset:12000
    v_exp_f32 v40, v40
    v_exp_f32 v41, v41
    v_exp_f32 v42, v42
    v_exp_f32 v43, v43
    v_exp_f32 v44, v44
    v_mfma_f32_32x32x16_bf16 v[16:31], v[72:75], v[32:35], v[16:31]
    s_waitcnt lgkmcnt(1)
    ds_read_b128 v[72:75], v10 offset:14016
    v_exp_f32 v45, v45
    v_exp_f32 v46, v46
    v_exp_f32 v47, v47
    v_cvt_pk_bf16_f32 v84, v40, v41
    v_cvt_pk_bf16_f32 v85, v42, v43
    v_cvt_pk_bf16_f32 v86, v44, v45
    v_cvt_pk_bf16_f32 v87, v46, v47
    v_mfma_f32_32x32x8bf16_1k v[32:47], v[68:69], v[70:71], 0
    v_exp_f32 v48, v48
    v_exp_f32 v49, v49
    v_exp_f32 v50, v50
    v_exp_f32 v51, v51
    v_exp_f32 v52, v52
    v_mfma_f32_32x32x16_bf16 v[32:47], v[64:67], v[80:83], v[32:47]
    s_waitcnt lgkmcnt(1)
    ds_read_b128 v[64:67], v8 offset:19520
    ds_read_b64 v[68:69], v9 offset:19520
    v_exp_f32 v53, v53
    v_exp_f32 v54, v54
    v_exp_f32 v55, v55
    v_cvt_pk_bf16_f32 v48, v48, v49
    v_cvt_pk_bf16_f32 v49, v50, v51
    v_cvt_pk_bf16_f32 v50, v52, v53
    v_cvt_pk_bf16_f32 v51, v54, v55
    v_mfma_f32_32x32x16_bf16 v[16:31], v[76:79], v[84:87], v[16:31]
    s_waitcnt lgkmcnt(2)
    ds_read_b128 v[76:79], v10 offset:14752
    v_exp_f32 v56, v56
    v_exp_f32 v57, v57
    v_exp_f32 v58, v58
    v_exp_f32 v59, v59
    v_exp_f32 v60, v60
    v_mfma_f32_32x32x16_bf16 v[16:31], v[72:75], v[48:51], v[16:31]
    s_waitcnt lgkmcnt(1)
    ds_read_b128 v[72:75], v10 offset:16768
    v_exp_f32 v61, v61
    v_exp_f32 v62, v62
    v_exp_f32 v63, v63
    v_cvt_pk_bf16_f32 v84, v56, v57
    v_cvt_pk_bf16_f32 v85, v58, v59
    v_cvt_pk_bf16_f32 v86, v60, v61
    v_cvt_pk_bf16_f32 v87, v62, v63
    s_barrier
    v_mfma_f32_32x32x8bf16_1k v[48:63], v[68:69], v[70:71], 0
    s_setprio 1
    s_add_u32 s29, s29, 22016
    s_cmp_ge_u32 s29, 176128
    s_cselect_b32 s95, 176128, 0
    s_sub_u32 s29, s29, s95
    s_add_u32 m0, s85, 102400
    s_add_u32 s95, s29, s92
    buffer_load_dwordx4 v1, s[32:35], s95 offen offset:0 sc1 lds
    v_exp_f32 v32, v32
    v_exp_f32 v33, v33
    v_exp_f32 v34, v34
    v_exp_f32 v35, v35
    v_exp_f32 v36, v36
    v_mfma_f32_32x32x16_bf16 v[48:63], v[64:67], v[80:83], v[48:63]
    s_waitcnt lgkmcnt(1)
    ds_read_b128 v[64:67], v8 offset:22528
    ds_read_b64 v[68:69], v9 offset:22528
    buffer_load_dwordx4 v1, s[32:35], s95 offen offset:1024 sc1 lds
    v_exp_f32 v37, v37
    v_exp_f32 v38, v38
    v_exp_f32 v39, v39
    v_cvt_pk_bf16_f32 v32, v32, v33
    v_cvt_pk_bf16_f32 v33, v34, v35
    v_cvt_pk_bf16_f32 v34, v36, v37
    v_cvt_pk_bf16_f32 v35, v38, v39
    v_mfma_f32_32x32x16_bf16 v[16:31], v[76:79], v[84:87], v[16:31]
    s_waitcnt lgkmcnt(2)
    ds_read_b128 v[76:79], v10 offset:17504
    s_cmp_eq_u32 s85, 9216
    s_cbranch_scc1 L_skip_kv_73
    buffer_load_dwordx4 v1, s[32:35], s95 offen offset:2048 sc1 lds
L_skip_kv_73:
    v_exp_f32 v40, v40
    v_exp_f32 v41, v41
    v_exp_f32 v42, v42
    v_exp_f32 v43, v43
    v_exp_f32 v44, v44
    v_mfma_f32_32x32x16_bf16 v[16:31], v[72:75], v[32:35], v[16:31]
    s_waitcnt lgkmcnt(1)
    ds_read_b128 v[72:75], v10 offset:19520
    s_mul_i32 s87, s74, 6144
    s_add_u32 s87, s87, s88
    s_cmp_eq_u32 s76, 1
    s_cbranch_scc0 L_far_74
    buffer_store_dwordx4 v[92:95], v1, s[32:35], s87 offen offset:0
    buffer_store_dwordx4 v[92:95], v1, s[32:35], s87 offen offset:1024
    buffer_store_dwordx4 v[92:95], v1, s[32:35], s87 offen offset:2048
L_pub_75:
    v_exp_f32 v45, v45
    v_exp_f32 v46, v46
    v_exp_f32 v47, v47
    v_cvt_pk_bf16_f32 v84, v40, v41
    v_cvt_pk_bf16_f32 v85, v42, v43
    v_cvt_pk_bf16_f32 v86, v44, v45
    v_cvt_pk_bf16_f32 v87, v46, v47
    v_mfma_f32_32x32x8bf16_1k v[32:47], v[68:69], v[70:71], 0
    s_cmp_eq_u32 s74, 7
    s_cbranch_scc1 L_skip_pf_76
    s_mul_i32 s87, s74, 6144
    s_add_u32 s87, s87, s88
    s_add_u32 s87, s87, 3072
    s_cmp_eq_u32 s76, 1
    s_cbranch_scc0 L_far_77
    buffer_store_dwordx4 v[92:95], v1, s[32:35], s87 offen offset:0
    buffer_store_dwordx4 v[92:95], v1, s[32:35], s87 offen offset:1024
    buffer_store_dwordx4 v[92:95], v1, s[32:35], s87 offen offset:2048
L_pub_78:
L_skip_pf_76:
    v_exp_f32 v48, v48
    v_exp_f32 v49, v49
    v_exp_f32 v50, v50
    v_exp_f32 v51, v51
    v_exp_f32 v52, v52
    v_mfma_f32_32x32x16_bf16 v[32:47], v[64:67], v[80:83], v[32:47]
    s_waitcnt lgkmcnt(1)
    ds_read_b128 v[64:67], v8 offset:25280
    ds_read_b64 v[68:69], v9 offset:25280
    s_sub_u32 s87, s79, 80
    s_cmp_ge_u32 s87, 160
    s_cbranch_scc1 L_skip_m2_79
    s_cmp_ge_u32 s74, 5
    s_cbranch_scc1 L_skip_m2_79
    v_bfe_u32 v152, v0, 3, 2
    v_lshlrev_b32 v152, 3, v152
    v_lshrrev_b32 v153, 5, v0
    v_lshl_add_u32 v152, v153, 2, v152
    v_bfe_u32 v153, v0, 1, 2
    v_add_u32 v152, v152, v153
    v_mul_u32_u24 v152, 7680, v152
    v_and_b32 v153, 1, v0
    v_lshl_add_u32 v152, v153, 4, v152
    s_lshl_b32 s81, s74, 8
    v_lshl_add_u32 v153, v0, 2, s81
    s_mul_i32 s80, s74, 983040
    s_lshl_b32 s81, s79, 5
    s_add_u32 s80, s80, s81
    s_lshl_b32 s81, s74, 12
    buffer_load_dword v154, v153, s[68:71], 0 offen
    s_add_u32 m0, s81, 136192
    s_nop 0
    buffer_load_dwordx4 v152, s[64:67], s80 offen lds
    s_add_u32 m0, s81, 137216
    s_add_u32 s80, s80, 245760
    buffer_load_dwordx4 v152, s[64:67], s80 offen lds
L_skip_m2_79:
    v_exp_f32 v53, v53
    v_exp_f32 v54, v54
    v_exp_f32 v55, v55
    v_cvt_pk_bf16_f32 v48, v48, v49
    v_cvt_pk_bf16_f32 v49, v50, v51
    v_cvt_pk_bf16_f32 v50, v52, v53
    v_cvt_pk_bf16_f32 v51, v54, v55
    v_mfma_f32_32x32x16_bf16 v[16:31], v[76:79], v[84:87], v[16:31]
    s_waitcnt lgkmcnt(2)
    ds_read_b128 v[76:79], v10 offset:20256
    v_exp_f32 v56, v56
    v_exp_f32 v57, v57
    v_exp_f32 v58, v58
    v_exp_f32 v59, v59
    v_exp_f32 v60, v60
    v_mfma_f32_32x32x16_bf16 v[16:31], v[72:75], v[48:51], v[16:31]
    s_waitcnt lgkmcnt(1)
    ds_read_b128 v[72:75], v10 offset:22528
    v_exp_f32 v61, v61
    v_exp_f32 v62, v62
    v_exp_f32 v63, v63
    v_cvt_pk_bf16_f32 v84, v56, v57
    v_cvt_pk_bf16_f32 v85, v58, v59
    v_cvt_pk_bf16_f32 v86, v60, v61
    v_cvt_pk_bf16_f32 v87, v62, v63
    v_mfma_f32_32x32x8bf16_1k v[48:63], v[68:69], v[70:71], 0
    v_exp_f32 v32, v32
    v_exp_f32 v33, v33
    v_exp_f32 v34, v34
    v_exp_f32 v35, v35
    v_exp_f32 v36, v36
    v_mfma_f32_32x32x16_bf16 v[48:63], v[64:67], v[80:83], v[48:63]
    s_waitcnt lgkmcnt(1)
    ds_read_b128 v[64:67], v8 offset:28032
    ds_read_b64 v[68:69], v9 offset:28032
    v_exp_f32 v37, v37
    v_exp_f32 v38, v38
    v_exp_f32 v39, v39
    v_cvt_pk_bf16_f32 v32, v32, v33
    v_cvt_pk_bf16_f32 v33, v34, v35
    v_cvt_pk_bf16_f32 v34, v36, v37
    v_cvt_pk_bf16_f32 v35, v38, v39
    v_mfma_f32_32x32x16_bf16 v[16:31], v[76:79], v[84:87], v[16:31]
    s_waitcnt lgkmcnt(2)
    ds_read_b128 v[76:79], v10 offset:23264
    v_exp_f32 v40, v40
    v_exp_f32 v41, v41
    v_exp_f32 v42, v42
    v_exp_f32 v43, v43
    v_exp_f32 v44, v44
    v_mfma_f32_32x32x16_bf16 v[16:31], v[72:75], v[32:35], v[16:31]
    s_waitcnt lgkmcnt(1)
    ds_read_b128 v[72:75], v10 offset:25280
    v_exp_f32 v45, v45
    v_exp_f32 v46, v46
    v_exp_f32 v47, v47
    v_cvt_pk_bf16_f32 v84, v40, v41
    v_cvt_pk_bf16_f32 v85, v42, v43
    v_cvt_pk_bf16_f32 v86, v44, v45
    v_cvt_pk_bf16_f32 v87, v46, v47
    v_mfma_f32_32x32x8bf16_1k v[32:47], v[68:69], v[70:71], 0
    v_exp_f32 v48, v48
    v_exp_f32 v49, v49
    v_exp_f32 v50, v50
    v_exp_f32 v51, v51
    v_exp_f32 v52, v52
    v_mfma_f32_32x32x16_bf16 v[32:47], v[64:67], v[80:83], v[32:47]
    s_waitcnt lgkmcnt(1)
    ds_read_b128 v[64:67], v8 offset:30784
    ds_read_b64 v[68:69], v9 offset:30784
    v_exp_f32 v53, v53
    v_exp_f32 v54, v54
    v_exp_f32 v55, v55
    v_cvt_pk_bf16_f32 v48, v48, v49
    v_cvt_pk_bf16_f32 v49, v50, v51
    v_cvt_pk_bf16_f32 v50, v52, v53
    v_cvt_pk_bf16_f32 v51, v54, v55
    v_mfma_f32_32x32x16_bf16 v[16:31], v[76:79], v[84:87], v[16:31]
    s_waitcnt lgkmcnt(2)
    ds_read_b128 v[76:79], v10 offset:26016
    v_exp_f32 v56, v56
    v_exp_f32 v57, v57
    v_exp_f32 v58, v58
    v_exp_f32 v59, v59
    v_exp_f32 v60, v60
    v_mfma_f32_32x32x16_bf16 v[16:31], v[72:75], v[48:51], v[16:31]
    s_waitcnt lgkmcnt(1)
    ds_read_b128 v[72:75], v10 offset:28032
    v_exp_f32 v61, v61
    v_exp_f32 v62, v62
    v_exp_f32 v63, v63
    v_cvt_pk_bf16_f32 v84, v56, v57
    v_cvt_pk_bf16_f32 v85, v58, v59
    v_cvt_pk_bf16_f32 v86, v60, v61
    v_cvt_pk_bf16_f32 v87, v62, v63
    s_waitcnt vmcnt(3)
    s_barrier
    v_mfma_f32_32x32x8bf16_1k v[48:63], v[68:69], v[70:71], 0
    s_setprio 0
    v_exp_f32 v32, v32
    v_exp_f32 v33, v33
    v_exp_f32 v34, v34
    v_exp_f32 v35, v35
    v_exp_f32 v36, v36
    v_mfma_f32_32x32x16_bf16 v[48:63], v[64:67], v[80:83], v[48:63]
    s_waitcnt lgkmcnt(1)
    ds_read_b128 v[64:67], v8 offset:0
    ds_read_b64 v[68:69], v9 offset:0
    s_lshr_b32 s87, s61, 5
    s_add_u32 s87, s87, s72
    s_cmp_ge_u32 s87, 68
    s_cbranch_scc1 L_skip_rl_80
    s_mul_i32 s89, s61, 5
    s_add_u32 s89, s89, 73728
    v_lshrrev_b32 v91, 2, v0
    v_mul_u32_u24 v91, 160, v91
    v_and_b32 v90, 3, v0
    v_lshl_add_u32 v91, v90, 3, v91
    v_add_u32 v91, s89, v91
    ds_read_b64_tr_b16 v[236:237], v91 offset:0
    ds_read_b64_tr_b16 v[238:239], v91 offset:2560
    ds_read_b64_tr_b16 v[240:241], v91 offset:32
    ds_read_b64_tr_b16 v[242:243], v91 offset:2592
    ds_read_b64_tr_b16 v[244:245], v91 offset:64
    ds_read_b64_tr_b16 v[246:247], v91 offset:2624
    ds_read_b64_tr_b16 v[248:249], v91 offset:96
    ds_read_b64_tr_b16 v[250:251], v91 offset:2656
    ds_read_b64_tr_b16 v[252:253], v91 offset:128
    ds_read_b64_tr_b16 v[254:255], v91 offset:2688
    s_mul_i32 s87, s87, 5120
    s_add_u32 s87, s87, s28
    s_waitcnt lgkmcnt(0)
    buffer_store_dwordx4 v[236:239], v1, s[32:35], s87 offen sc1
    s_add_u32 s87, s87, 1024
    buffer_store_dwordx4 v[240:243], v1, s[32:35], s87 offen sc1
    s_add_u32 s87, s87, 1024
    buffer_store_dwordx4 v[244:247], v1, s[32:35], s87 offen sc1
    s_add_u32 s87, s87, 1024
    buffer_store_dwordx4 v[248:251], v1, s[32:35], s87 offen sc1
    s_add_u32 s87, s87, 1024
    buffer_store_dwordx4 v[252:255], v1, s[32:35], s87 offen sc1
L_skip_rl_80:
    v_exp_f32 v37, v37
    v_exp_f32 v38, v38
    v_exp_f32 v39, v39
    v_cvt_pk_bf16_f32 v32, v32, v33
    v_cvt_pk_bf16_f32 v33, v34, v35
    v_cvt_pk_bf16_f32 v34, v36, v37
    v_cvt_pk_bf16_f32 v35, v38, v39
    v_mfma_f32_32x32x16_bf16 v[16:31], v[76:79], v[84:87], v[16:31]
    s_waitcnt lgkmcnt(2)
    ds_read_b128 v[76:79], v10 offset:28768
    v_exp_f32 v40, v40
    v_exp_f32 v41, v41
    v_exp_f32 v42, v42
    v_exp_f32 v43, v43
    v_exp_f32 v44, v44
    v_mfma_f32_32x32x16_bf16 v[16:31], v[72:75], v[32:35], v[16:31]
    s_waitcnt lgkmcnt(1)
    ds_read_b128 v[72:75], v10 offset:30784
    v_exp_f32 v45, v45
    v_exp_f32 v46, v46
    v_exp_f32 v47, v47
    v_cvt_pk_bf16_f32 v84, v40, v41
    v_cvt_pk_bf16_f32 v85, v42, v43
    v_cvt_pk_bf16_f32 v86, v44, v45
    v_cvt_pk_bf16_f32 v87, v46, v47
    v_mfma_f32_32x32x8bf16_1k v[32:47], v[68:69], v[70:71], 0
    v_exp_f32 v48, v48
    v_exp_f32 v49, v49
    v_exp_f32 v50, v50
    v_exp_f32 v51, v51
    v_exp_f32 v52, v52
    v_mfma_f32_32x32x16_bf16 v[32:47], v[64:67], v[80:83], v[32:47]
    s_waitcnt lgkmcnt(1)
    ds_read_b128 v[64:67], v8 offset:2752
    ds_read_b64 v[68:69], v9 offset:2752
    v_exp_f32 v53, v53
    v_exp_f32 v54, v54
    v_exp_f32 v55, v55
    v_cvt_pk_bf16_f32 v48, v48, v49
    v_cvt_pk_bf16_f32 v49, v50, v51
    v_cvt_pk_bf16_f32 v50, v52, v53
    v_cvt_pk_bf16_f32 v51, v54, v55
    v_mfma_f32_32x32x16_bf16 v[16:31], v[76:79], v[84:87], v[16:31]
    s_waitcnt lgkmcnt(2)
    ds_read_b128 v[76:79], v10 offset:31520
    v_exp_f32 v56, v56
    v_exp_f32 v57, v57
    v_exp_f32 v58, v58
    v_exp_f32 v59, v59
    v_exp_f32 v60, v60
    v_mfma_f32_32x32x16_bf16 v[16:31], v[72:75], v[48:51], v[16:31]
    s_waitcnt lgkmcnt(1)
    ds_read_b128 v[72:75], v10 offset:0
    v_exp_f32 v61, v61
    v_exp_f32 v62, v62
    v_exp_f32 v63, v63
    v_cvt_pk_bf16_f32 v84, v56, v57
    v_cvt_pk_bf16_f32 v85, v58, v59
    v_cvt_pk_bf16_f32 v86, v60, v61
    v_cvt_pk_bf16_f32 v87, v62, v63
    v_mfma_f32_32x32x8bf16_1k v[48:63], v[68:69], v[70:71], 0
    v_exp_f32 v32, v32
    v_exp_f32 v33, v33
    v_exp_f32 v34, v34
    v_exp_f32 v35, v35
    v_exp_f32 v36, v36
    v_mfma_f32_32x32x16_bf16 v[48:63], v[64:67], v[80:83], v[48:63]
    s_waitcnt lgkmcnt(1)
    ds_read_b128 v[64:67], v8 offset:5504
    ds_read_b64 v[68:69], v9 offset:5504
    v_exp_f32 v37, v37
    v_exp_f32 v38, v38
    v_exp_f32 v39, v39
    v_cvt_pk_bf16_f32 v32, v32, v33
    v_cvt_pk_bf16_f32 v33, v34, v35
    v_cvt_pk_bf16_f32 v34, v36, v37
    v_cvt_pk_bf16_f32 v35, v38, v39
    v_mfma_f32_32x32x16_bf16 v[16:31], v[76:79], v[84:87], v[16:31]
    s_waitcnt lgkmcnt(2)
    ds_read_b128 v[76:79], v10 offset:736
    v_exp_f32 v40, v40
    v_exp_f32 v41, v41
    v_exp_f32 v42, v42
    v_exp_f32 v43, v43
    v_exp_f32 v44, v44
    v_mfma_f32_32x32x16_bf16 v[16:31], v[72:75], v[32:35], v[16:31]
    s_waitcnt lgkmcnt(1)
    ds_read_b128 v[72:75], v10 offset:2752
    v_exp_f32 v45, v45
    v_exp_f32 v46, v46
    v_exp_f32 v47, v47
    v_cvt_pk_bf16_f32 v84, v40, v41
    v_cvt_pk_bf16_f32 v85, v42, v43
    v_cvt_pk_bf16_f32 v86, v44, v45
    v_cvt_pk_bf16_f32 v87, v46, v47
    v_mfma_f32_32x32x8bf16_1k v[32:47], v[68:69], v[70:71], 0
    v_exp_f32 v48, v48
    v_exp_f32 v49, v49
    v_exp_f32 v50, v50
    v_exp_f32 v51, v51
    v_exp_f32 v52, v52
    v_mfma_f32_32x32x16_bf16 v[32:47], v[64:67], v[80:83], v[32:47]
    s_waitcnt lgkmcnt(1)
    ds_read_b128 v[64:67], v8 offset:8256
    ds_read_b64 v[68:69], v9 offset:8256
    v_exp_f32 v53, v53
    v_exp_f32 v54, v54
    v_exp_f32 v55, v55
    v_cvt_pk_bf16_f32 v48, v48, v49
    v_cvt_pk_bf16_f32 v49, v50, v51
    v_cvt_pk_bf16_f32 v50, v52, v53
    v_cvt_pk_bf16_f32 v51, v54, v55
    v_mfma_f32_32x32x16_bf16 v[16:31], v[76:79], v[84:87], v[16:31]
    s_waitcnt lgkmcnt(2)
    ds_read_b128 v[76:79], v10 offset:3488
    v_exp_f32 v56, v56
    v_exp_f32 v57, v57
    v_exp_f32 v58, v58
    v_exp_f32 v59, v59
    v_exp_f32 v60, v60
    v_mfma_f32_32x32x16_bf16 v[16:31], v[72:75], v[48:51], v[16:31]
    s_waitcnt lgkmcnt(1)
    ds_read_b128 v[72:75], v10 offset:5504
    v_exp_f32 v61, v61
    v_exp_f32 v62, v62
    v_exp_f32 v63, v63
    v_cvt_pk_bf16_f32 v84, v56, v57
    v_cvt_pk_bf16_f32 v85, v58, v59
    v_cvt_pk_bf16_f32 v86, v60, v61
    v_cvt_pk_bf16_f32 v87, v62, v63
    s_barrier
    v_mfma_f32_32x32x8bf16_1k v[48:63], v[68:69], v[70:71], 0
    s_setprio 1
    s_add_u32 s29, s29, 22016
    s_cmp_ge_u32 s29, 176128
    s_cselect_b32 s95, 176128, 0
    s_sub_u32 s29, s29, s95
    s_add_u32 m0, s85, 124928
    s_add_u32 s95, s29, s92
    buffer_load_dwordx4 v1, s[32:35], s95 offen offset:0 sc1 lds
    v_exp_f32 v32, v32
    v_exp_f32 v33, v33
    v_exp_f32 v34, v34
    v_exp_f32 v35, v35
    v_exp_f32 v36, v36
    v_mfma_f32_32x32x16_bf16 v[48:63], v[64:67], v[80:83], v[48:63]
    s_waitcnt lgkmcnt(1)
    ds_read_b128 v[64:67], v8 offset:11264
    ds_read_b64 v[68:69], v9 offset:11264
    buffer_load_dwordx4 v1, s[32:35], s95 offen offset:1024 sc1 lds
    v_exp_f32 v37, v37
    v_exp_f32 v38, v38
    v_exp_f32 v39, v39
    v_cvt_pk_bf16_f32 v32, v32, v33
    v_cvt_pk_bf16_f32 v33, v34, v35
    v_cvt_pk_bf16_f32 v34, v36, v37
    v_cvt_pk_bf16_f32 v35, v38, v39
    v_mfma_f32_32x32x16_bf16 v[16:31], v[76:79], v[84:87], v[16:31]
    s_waitcnt lgkmcnt(2)
    ds_read_b128 v[76:79], v10 offset:6240
    s_cmp_eq_u32 s85, 9216
    s_cbranch_scc1 L_skip_kv_81
    buffer_load_dwordx4 v1, s[32:35], s95 offen offset:2048 sc1 lds
L_skip_kv_81:
    v_exp_f32 v40, v40
    v_exp_f32 v41, v41
    v_exp_f32 v42, v42
    v_exp_f32 v43, v43
    v_exp_f32 v44, v44
    v_mfma_f32_32x32x16_bf16 v[16:31], v[72:75], v[32:35], v[16:31]
    s_waitcnt lgkmcnt(1)
    ds_read_b128 v[72:75], v10 offset:8256
    s_sub_u32 s87, s79, 80
    s_cmp_ge_u32 s87, 160
    s_cbranch_scc1 L_skip_m2_82
    s_cmp_ge_u32 s74, 5
    s_cbranch_scc1 L_skip_m2_82
    s_add_u32 m0, s81, 138240
    s_add_u32 s80, s80, 245760
    buffer_load_dwordx4 v152, s[64:67], s80 offen lds
    s_add_u32 m0, s81, 139264
    s_add_u32 s80, s80, 245760
    buffer_load_dwordx4 v152, s[64:67], s80 offen lds
L_skip_m2_82:
    v_exp_f32 v45, v45
    v_exp_f32 v46, v46
    v_exp_f32 v47, v47
    v_cvt_pk_bf16_f32 v84, v40, v41
    v_cvt_pk_bf16_f32 v85, v42, v43
    v_cvt_pk_bf16_f32 v86, v44, v45
    v_cvt_pk_bf16_f32 v87, v46, v47
    v_mfma_f32_32x32x8bf16_1k v[32:47], v[68:69], v[70:71], 0
    v_exp_f32 v48, v48
    v_exp_f32 v49, v49
    v_exp_f32 v50, v50
    v_exp_f32 v51, v51
    v_exp_f32 v52, v52
    v_mfma_f32_32x32x16_bf16 v[32:47], v[64:67], v[80:83], v[32:47]
    s_waitcnt lgkmcnt(1)
    ds_read_b128 v[64:67], v8 offset:14016
    ds_read_b64 v[68:69], v9 offset:14016
    v_exp_f32 v53, v53
    v_exp_f32 v54, v54
    v_exp_f32 v55, v55
    v_cvt_pk_bf16_f32 v48, v48, v49
    v_cvt_pk_bf16_f32 v49, v50, v51
    v_cvt_pk_bf16_f32 v50, v52, v53
    v_cvt_pk_bf16_f32 v51, v54, v55
    v_mfma_f32_32x32x16_bf16 v[16:31], v[76:79], v[84:87], v[16:31]
    s_waitcnt lgkmcnt(2)
    ds_read_b128 v[76:79], v10 offset:8992
    v_exp_f32 v56, v56
    v_exp_f32 v57, v57
    v_exp_f32 v58, v58
    v_exp_f32 v59, v59
    v_exp_f32 v60, v60
    v_mfma_f32_32x32x16_bf16 v[16:31], v[72:75], v[48:51], v[16:31]
    s_waitcnt lgkmcnt(1)
    ds_read_b128 v[72:75], v10 offset:11264
    v_exp_f32 v61, v61
    v_exp_f32 v62, v62
    v_exp_f32 v63, v63
    v_cvt_pk_bf16_f32 v84, v56, v57
    v_cvt_pk_bf16_f32 v85, v58, v59
    v_cvt_pk_bf16_f32 v86, v60, v61
    v_cvt_pk_bf16_f32 v87, v62, v63
    v_mfma_f32_32x32x8bf16_1k v[48:63], v[68:69], v[70:71], 0
    v_exp_f32 v32, v32
    v_exp_f32 v33, v33
    v_exp_f32 v34, v34
    v_exp_f32 v35, v35
    v_exp_f32 v36, v36
    v_mfma_f32_32x32x16_bf16 v[48:63], v[64:67], v[80:83], v[48:63]
    s_waitcnt lgkmcnt(1)
    ds_read_b128 v[64:67], v8 offset:16768
    ds_read_b64 v[68:69], v9 offset:16768
    v_exp_f32 v37, v37
    v_exp_f32 v38, v38
    v_exp_f32 v39, v39
    v_cvt_pk_bf16_f32 v32, v32, v33
    v_cvt_pk_bf16_f32 v33, v34, v35
    v_cvt_pk_bf16_f32 v34, v36, v37
    v_cvt_pk_bf16_f32 v35, v38, v39
    v_mfma_f32_32x32x16_bf16 v[16:31], v[76:79], v[84:87], v[16:31]
    s_waitcnt lgkmcnt(2)
    ds_read_b128 v[76:79], v10 offset:12000
    v_exp_f32 v40, v40
    v_exp_f32 v41, v41
    v_exp_f32 v42, v42
    v_exp_f32 v43, v43
    v_exp_f32 v44, v44
    v_mfma_f32_32x32x16_bf16 v[16:31], v[72:75], v[32:35], v[16:31]
    s_waitcnt lgkmcnt(1)
    ds_read_b128 v[72:75], v10 offset:14016
    v_exp_f32 v45, v45
    v_exp_f32 v46, v46
    v_exp_f32 v47, v47
    v_cvt_pk_bf16_f32 v84, v40, v41
    v_cvt_pk_bf16_f32 v85, v42, v43
    v_cvt_pk_bf16_f32 v86, v44, v45
    v_cvt_pk_bf16_f32 v87, v46, v47
    v_mfma_f32_32x32x8bf16_1k v[32:47], v[68:69], v[70:71], 0
    v_exp_f32 v48, v48
    v_exp_f32 v49, v49
    v_exp_f32 v50, v50
    v_exp_f32 v51, v51
    v_exp_f32 v52, v52
    v_mfma_f32_32x32x16_bf16 v[32:47], v[64:67], v[80:83], v[32:47]
    s_waitcnt lgkmcnt(1)
    ds_read_b128 v[64:67], v8 offset:19520
    ds_read_b64 v[68:69], v9 offset:19520
    v_exp_f32 v53, v53
    v_exp_f32 v54, v54
    v_exp_f32 v55, v55
    v_cvt_pk_bf16_f32 v48, v48, v49
    v_cvt_pk_bf16_f32 v49, v50, v51
    v_cvt_pk_bf16_f32 v50, v52, v53
    v_cvt_pk_bf16_f32 v51, v54, v55
    v_mfma_f32_32x32x16_bf16 v[16:31], v[76:79], v[84:87], v[16:31]
    s_waitcnt lgkmcnt(2)
    ds_read_b128 v[76:79], v10 offset:14752
    v_exp_f32 v56, v56
    v_exp_f32 v57, v57
    v_exp_f32 v58, v58
    v_exp_f32 v59, v59
    v_exp_f32 v60, v60
    v_mfma_f32_32x32x16_bf16 v[16:31], v[72:75], v[48:51], v[16:31]
    s_waitcnt lgkmcnt(1)
    ds_read_b128 v[72:75], v10 offset:16768
    v_exp_f32 v61, v61
    v_exp_f32 v62, v62
    v_exp_f32 v63, v63
    v_cvt_pk_bf16_f32 v84, v56, v57
    v_cvt_pk_bf16_f32 v85, v58, v59
    v_cvt_pk_bf16_f32 v86, v60, v61
    v_cvt_pk_bf16_f32 v87, v62, v63
    s_waitcnt vmcnt(0)
    s_barrier
    v_mfma_f32_32x32x8bf16_1k v[48:63], v[68:69], v[70:71], 0
    s_setprio 0
    v_exp_f32 v32, v32
    v_exp_f32 v33, v33
    v_exp_f32 v34, v34
    v_exp_f32 v35, v35
    v_exp_f32 v36, v36
    v_mfma_f32_32x32x16_bf16 v[48:63], v[64:67], v[80:83], v[48:63]
    s_waitcnt lgkmcnt(1)
    ds_read_b128 v[64:67], v8 offset:22528
    ds_read_b64 v[68:69], v9 offset:22528
    v_exp_f32 v37, v37
    v_exp_f32 v38, v38
    v_exp_f32 v39, v39
    v_cvt_pk_bf16_f32 v32, v32, v33
    v_cvt_pk_bf16_f32 v33, v34, v35
    v_cvt_pk_bf16_f32 v34, v36, v37
    v_cvt_pk_bf16_f32 v35, v38, v39
    v_mfma_f32_32x32x16_bf16 v[16:31], v[76:79], v[84:87], v[16:31]
    s_waitcnt lgkmcnt(2)
    ds_read_b128 v[76:79], v10 offset:17504
    v_exp_f32 v40, v40
    v_exp_f32 v41, v41
    v_exp_f32 v42, v42
    v_exp_f32 v43, v43
    v_exp_f32 v44, v44
    v_mfma_f32_32x32x16_bf16 v[16:31], v[72:75], v[32:35], v[16:31]
    s_waitcnt lgkmcnt(1)
    ds_read_b128 v[72:75], v10 offset:19520
    v_exp_f32 v45, v45
    v_exp_f32 v46, v46
    v_exp_f32 v47, v47
    v_cvt_pk_bf16_f32 v84, v40, v41
    v_cvt_pk_bf16_f32 v85, v42, v43
    v_cvt_pk_bf16_f32 v86, v44, v45
    v_cvt_pk_bf16_f32 v87, v46, v47
    v_mfma_f32_32x32x8bf16_1k v[32:47], v[68:69], v[70:71], 0
    v_exp_f32 v48, v48
    v_exp_f32 v49, v49
    v_exp_f32 v50, v50
    v_exp_f32 v51, v51
    v_exp_f32 v52, v52
    v_mfma_f32_32x32x16_bf16 v[32:47], v[64:67], v[80:83], v[32:47]
    s_waitcnt lgkmcnt(1)
    ds_read_b128 v[64:67], v8 offset:25280
    ds_read_b64 v[68:69], v9 offset:25280
    v_exp_f32 v53, v53
    v_exp_f32 v54, v54
    v_exp_f32 v55, v55
    v_cvt_pk_bf16_f32 v48, v48, v49
    v_cvt_pk_bf16_f32 v49, v50, v51
    v_cvt_pk_bf16_f32 v50, v52, v53
    v_cvt_pk_bf16_f32 v51, v54, v55
    v_mfma_f32_32x32x16_bf16 v[16:31], v[76:79], v[84:87], v[16:31]
    s_waitcnt lgkmcnt(2)
    ds_read_b128 v[76:79], v10 offset:20256
    v_exp_f32 v56, v56
    v_exp_f32 v57, v57
    v_exp_f32 v58, v58
    v_exp_f32 v59, v59
    v_exp_f32 v60, v60
    v_mfma_f32_32x32x16_bf16 v[16:31], v[72:75], v[48:51], v[16:31]
    s_waitcnt lgkmcnt(1)
    ds_read_b128 v[72:75], v10 offset:22528
    v_exp_f32 v61, v61
    v_exp_f32 v62, v62
    v_exp_f32 v63, v63
    v_cvt_pk_bf16_f32 v84, v56, v57
    v_cvt_pk_bf16_f32 v85, v58, v59
    v_cvt_pk_bf16_f32 v86, v60, v61
    v_cvt_pk_bf16_f32 v87, v62, v63
    v_mfma_f32_32x32x8bf16_1k v[48:63], v[68:69], v[70:71], 0
    v_exp_f32 v32, v32
    v_exp_f32 v33, v33
    v_exp_f32 v34, v34
    v_exp_f32 v35, v35
    v_exp_f32 v36, v36
    v_mfma_f32_32x32x16_bf16 v[48:63], v[64:67], v[80:83], v[48:63]
    s_waitcnt lgkmcnt(1)
    ds_read_b128 v[64:67], v8 offset:28032
    ds_read_b64 v[68:69], v9 offset:28032
    v_exp_f32 v37, v37
    v_exp_f32 v38, v38
    v_exp_f32 v39, v39
    v_cvt_pk_bf16_f32 v32, v32, v33
    v_cvt_pk_bf16_f32 v33, v34, v35
    v_cvt_pk_bf16_f32 v34, v36, v37
    v_cvt_pk_bf16_f32 v35, v38, v39
    v_mfma_f32_32x32x16_bf16 v[16:31], v[76:79], v[84:87], v[16:31]
    s_waitcnt lgkmcnt(2)
    ds_read_b128 v[76:79], v10 offset:23264
    v_exp_f32 v40, v40
    v_exp_f32 v41, v41
    v_exp_f32 v42, v42
    v_exp_f32 v43, v43
    v_exp_f32 v44, v44
    v_mfma_f32_32x32x16_bf16 v[16:31], v[72:75], v[32:35], v[16:31]
    s_waitcnt lgkmcnt(1)
    ds_read_b128 v[72:75], v10 offset:25280
    v_exp_f32 v45, v45
    v_exp_f32 v46, v46
    v_exp_f32 v47, v47
    v_cvt_pk_bf16_f32 v84, v40, v41
    v_cvt_pk_bf16_f32 v85, v42, v43
    v_cvt_pk_bf16_f32 v86, v44, v45
    v_cvt_pk_bf16_f32 v87, v46, v47
    v_mfma_f32_32x32x8bf16_1k v[32:47], v[68:69], v[70:71], 0
    v_exp_f32 v48, v48
    v_exp_f32 v49, v49
    v_exp_f32 v50, v50
    v_exp_f32 v51, v51
    v_exp_f32 v52, v52
    v_mfma_f32_32x32x16_bf16 v[32:47], v[64:67], v[80:83], v[32:47]
    s_waitcnt lgkmcnt(1)
    ds_read_b128 v[64:67], v8 offset:30784
    ds_read_b64 v[68:69], v9 offset:30784
    v_exp_f32 v53, v53
    v_exp_f32 v54, v54
    v_exp_f32 v55, v55
    v_cvt_pk_bf16_f32 v48, v48, v49
    v_cvt_pk_bf16_f32 v49, v50, v51
    v_cvt_pk_bf16_f32 v50, v52, v53
    v_cvt_pk_bf16_f32 v51, v54, v55
    v_mfma_f32_32x32x16_bf16 v[16:31], v[76:79], v[84:87], v[16:31]
    s_waitcnt lgkmcnt(2)
    ds_read_b128 v[76:79], v10 offset:26016
    v_exp_f32 v56, v56
    v_exp_f32 v57, v57
    v_exp_f32 v58, v58
    v_exp_f32 v59, v59
    v_exp_f32 v60, v60
    v_mfma_f32_32x32x16_bf16 v[16:31], v[72:75], v[48:51], v[16:31]
    s_waitcnt lgkmcnt(1)
    ds_read_b128 v[72:75], v10 offset:28032
    v_exp_f32 v61, v61
    v_exp_f32 v62, v62
    v_exp_f32 v63, v63
    v_cvt_pk_bf16_f32 v84, v56, v57
    v_cvt_pk_bf16_f32 v85, v58, v59
    v_cvt_pk_bf16_f32 v86, v60, v61
    v_cvt_pk_bf16_f32 v87, v62, v63
    s_barrier
    v_mfma_f32_32x32x8bf16_1k v[48:63], v[68:69], v[70:71], 0
    s_setprio 1
    s_add_u32 s29, s29, 22016
    s_cmp_ge_u32 s29, 176128
    s_cselect_b32 s95, 176128, 0
    s_sub_u32 s29, s29, s95
    s_add_u32 m0, s85, 113664
    s_add_u32 s95, s29, s92
    buffer_load_dwordx4 v1, s[32:35], s95 offen offset:0 sc1 lds
    v_exp_f32 v32, v32
    v_exp_f32 v33, v33
    v_exp_f32 v34, v34
    v_exp_f32 v35, v35
    v_exp_f32 v36, v36
    v_mfma_f32_32x32x16_bf16 v[48:63], v[64:67], v[80:83], v[48:63]
    s_waitcnt lgkmcnt(1)
    ds_read_b128 v[64:67], v8 offset:0
    ds_read_b64 v[68:69], v9 offset:0
    buffer_load_dwordx4 v1, s[32:35], s95 offen offset:1024 sc1 lds
    v_exp_f32 v37, v37
    v_exp_f32 v38, v38
    v_exp_f32 v39, v39
    v_cvt_pk_bf16_f32 v32, v32, v33
    v_cvt_pk_bf16_f32 v33, v34, v35
    v_cvt_pk_bf16_f32 v34, v36, v37
    v_cvt_pk_bf16_f32 v35, v38, v39
    v_mfma_f32_32x32x16_bf16 v[16:31], v[76:79], v[84:87], v[16:31]
    s_waitcnt lgkmcnt(2)
    ds_read_b128 v[76:79], v10 offset:28768
    s_cmp_eq_u32 s85, 9216
    s_cbranch_scc1 L_skip_kv_83
    buffer_load_dwordx4 v1, s[32:35], s95 offen offset:2048 sc1 lds
L_skip_kv_83:
    v_exp_f32 v40, v40
    v_exp_f32 v41, v41
    v_exp_f32 v42, v42
    v_exp_f32 v43, v43
    v_exp_f32 v44, v44
    v_mfma_f32_32x32x16_bf16 v[16:31], v[72:75], v[32:35], v[16:31]
    s_waitcnt lgkmcnt(1)
    ds_read_b128 v[72:75], v10 offset:30784
    s_waitcnt vmcnt(2)
    v_exp_f32 v45, v45
    v_exp_f32 v46, v46
    v_exp_f32 v47, v47
    v_cvt_pk_bf16_f32 v84, v40, v41
    v_cvt_pk_bf16_f32 v85, v42, v43
    v_cvt_pk_bf16_f32 v86, v44, v45
    v_cvt_pk_bf16_f32 v87, v46, v47
    v_mfma_f32_32x32x8bf16_1k v[32:47], v[68:69], v[70:71], 0
    s_sub_u32 s87, s79, 80
    s_cmp_ge_u32 s87, 160
    s_cbranch_scc1 L_skip_m2_84
    s_cmp_ge_u32 s74, 5
    s_cbranch_scc1 L_skip_m2_84
    v_mov_b32 v188, v154
    v_lshlrev_b32 v152, 16, v188
    v_and_b32 v153, 0xffff0000, v188
    v_mul_f32 v154, 0xbfb8aa3b, v152
    v_mul_f32 v155, 0xbfb8aa3b, v153
    v_exp_f32 v154, v154
    v_exp_f32 v155, v155
    s_lshl_b32 s80, s74, 8
    v_add_f32 v154, 1.0, v154
    v_add_f32 v155, 1.0, v155
    v_rcp_f32 v154, v154
    v_rcp_f32 v155, v155
    s_add_u32 s80, s80, 156672
    v_mul_f32 v152, v152, v154
    v_mul_f32 v153, v153, v155
    v_lshl_add_u32 v154, v0, 2, s80
    v_cvt_pk_bf16_f32 v152, v152, v153
    v_lshrrev_b32 v155, 4, v0
    v_lshl_add_u32 v155, v155, 4, s80
    ds_write_b32 v154, v152
    ds_read_b128 v[156:159], v155 offset:0
    ds_read_b128 v[160:163], v155 offset:64
    ds_read_b128 v[164:167], v155 offset:128
    ds_read_b128 v[168:171], v155 offset:192
    s_lshl_b32 s80, s74, 12
    s_add_u32 s80, s80, 136192
    v_lshl_add_u32 v152, v0, 3, s80
    ds_read_b64_tr_b16 v[172:173], v152 offset:0
    ds_read_b64_tr_b16 v[174:175], v152 offset:512
    ds_read_b64_tr_b16 v[176:177], v152 offset:1024
    ds_read_b64_tr_b16 v[178:179], v152 offset:1536
    ds_read_b64_tr_b16 v[180:181], v152 offset:2048
    ds_read_b64_tr_b16 v[182:183], v152 offset:2560
    ds_read_b64_tr_b16 v[184:185], v152 offset:3072
    ds_read_b64_tr_b16 v[186:187], v152 offset:3584
    s_lshl_b32 s80, s74, 6
    s_add_u32 s80, s80, 161792
    v_add_u32 v153, s80, v0
    s_waitcnt lgkmcnt(6)
    v_mfma_f32_16x16x32_bf16 v[188:191], v[172:175], v[156:159], 0
    s_waitcnt lgkmcnt(4)
    v_mfma_f32_16x16x32_bf16 v[188:191], v[176:179], v[160:163], v[188:191]
    s_waitcnt lgkmcnt(2)
    v_mfma_f32_16x16x32_bf16 v[188:191], v[180:183], v[164:167], v[188:191]
    s_waitcnt lgkmcnt(0)
    v_mfma_f32_16x16x32_bf16 v[188:191], v[184:187], v[168:171], v[188:191]
    s_mov_b32 exec_lo, 0x00010001
    s_mov_b32 exec_hi, 0x00010001
    s_nop 5
    ds_write_b128 v153, v[188:191]
    s_mov_b64 exec, -1
    s_waitcnt lgkmcnt(0)
L_skip_m2_84:
    v_exp_f32 v48, v48
    v_exp_f32 v49, v49
    v_exp_f32 v50, v50
    v_exp_f32 v51, v51
    v_exp_f32 v52, v52
    v_mfma_f32_32x32x16_bf16 v[32:47], v[64:67], v[80:83], v[32:47]
    s_waitcnt lgkmcnt(1)
    ds_read_b128 v[64:67], v8 offset:2752
    ds_read_b64 v[68:69], v9 offset:2752
    s_lshl_b32 s87, s72, 7
    s_lshl_b32 s89, s73, 3
    v_and_b32 v90, 7, v0
    v_lshl_add_u32 v90, v90, 3, s87
    v_and_b32 v91, 31, v0
    v_lshl_add_u32 v91, v91, 7, s89
    v_cmp_gt_u32 vcc, 32, v0
    s_mov_b32 s87, 40960
    s_nop 0
    v_cndmask_b32 v90, v91, v90, vcc
    buffer_load_dwordx2 v[88:89], v90, s[32:35], s87 offen sc1
    v_exp_f32 v53, v53
    v_exp_f32 v54, v54
    v_exp_f32 v55, v55
    v_cvt_pk_bf16_f32 v48, v48, v49
    v_cvt_pk_bf16_f32 v49, v50, v51
    v_cvt_pk_bf16_f32 v50, v52, v53
    v_cvt_pk_bf16_f32 v51, v54, v55
    v_mfma_f32_32x32x16_bf16 v[16:31], v[76:79], v[84:87], v[16:31]
    s_waitcnt lgkmcnt(2)
    ds_read_b128 v[76:79], v10 offset:31520
    v_exp_f32 v56, v56
    v_exp_f32 v57, v57
    v_exp_f32 v58, v58
    v_exp_f32 v59, v59
    v_exp_f32 v60, v60
    v_mfma_f32_32x32x16_bf16 v[16:31], v[72:75], v[48:51], v[16:31]
    s_waitcnt lgkmcnt(1)
    ds_read_b128 v[72:75], v10 offset:0
    v_exp_f32 v61, v61
    v_exp_f32 v62, v62
    v_exp_f32 v63, v63
    v_cvt_pk_bf16_f32 v84, v56, v57
    v_cvt_pk_bf16_f32 v85, v58, v59
    v_cvt_pk_bf16_f32 v86, v60, v61
    v_cvt_pk_bf16_f32 v87, v62, v63
    v_mfma_f32_32x32x8bf16_1k v[48:63], v[68:69], v[70:71], 0
    v_exp_f32 v32, v32
    v_exp_f32 v33, v33
    v_exp_f32 v34, v34
    v_exp_f32 v35, v35
    v_exp_f32 v36, v36
    v_mfma_f32_32x32x16_bf16 v[48:63], v[64:67], v[80:83], v[48:63]
    s_waitcnt lgkmcnt(1)
    ds_read_b128 v[64:67], v8 offset:5504
    ds_read_b64 v[68:69], v9 offset:5504
    v_exp_f32 v37, v37
    v_exp_f32 v38, v38
    v_exp_f32 v39, v39
    v_cvt_pk_bf16_f32 v32, v32, v33
    v_cvt_pk_bf16_f32 v33, v34, v35
    v_cvt_pk_bf16_f32 v34, v36, v37
    v_cvt_pk_bf16_f32 v35, v38, v39
    v_mfma_f32_32x32x16_bf16 v[16:31], v[76:79], v[84:87], v[16:31]
    s_waitcnt lgkmcnt(2)
    ds_read_b128 v[76:79], v10 offset:736
    v_exp_f32 v40, v40
    v_exp_f32 v41, v41
    v_exp_f32 v42, v42
    v_exp_f32 v43, v43
    v_exp_f32 v44, v44
    v_mfma_f32_32x32x16_bf16 v[16:31], v[72:75], v[32:35], v[16:31]
    s_waitcnt lgkmcnt(1)
    ds_read_b128 v[72:75], v10 offset:2752
    v_exp_f32 v45, v45
    v_exp_f32 v46, v46
    v_exp_f32 v47, v47
    v_cvt_pk_bf16_f32 v84, v40, v41
    v_cvt_pk_bf16_f32 v85, v42, v43
    v_cvt_pk_bf16_f32 v86, v44, v45
    v_cvt_pk_bf16_f32 v87, v46, v47
    v_mfma_f32_32x32x8bf16_1k v[32:47], v[68:69], v[70:71], 0
    v_exp_f32 v48, v48
    v_exp_f32 v49, v49
    v_exp_f32 v50, v50
    v_exp_f32 v51, v51
    v_exp_f32 v52, v52
    v_mfma_f32_32x32x16_bf16 v[32:47], v[64:67], v[80:83], v[32:47]
    s_waitcnt lgkmcnt(1)
    ds_read_b128 v[64:67], v8 offset:8256
    ds_read_b64 v[68:69], v9 offset:8256
    v_exp_f32 v53, v53
    v_exp_f32 v54, v54
    v_exp_f32 v55, v55
    v_cvt_pk_bf16_f32 v48, v48, v49
    v_cvt_pk_bf16_f32 v49, v50, v51
    v_cvt_pk_bf16_f32 v50, v52, v53
    v_cvt_pk_bf16_f32 v51, v54, v55
    v_mfma_f32_32x32x16_bf16 v[16:31], v[76:79], v[84:87], v[16:31]
    s_waitcnt lgkmcnt(2)
    ds_read_b128 v[76:79], v10 offset:3488
    v_exp_f32 v56, v56
    v_exp_f32 v57, v57
    v_exp_f32 v58, v58
    v_exp_f32 v59, v59
    v_exp_f32 v60, v60
    v_mfma_f32_32x32x16_bf16 v[16:31], v[72:75], v[48:51], v[16:31]
    s_waitcnt lgkmcnt(1)
    ds_read_b128 v[72:75], v10 offset:5504
    v_exp_f32 v61, v61
    v_exp_f32 v62, v62
    v_exp_f32 v63, v63
    v_cvt_pk_bf16_f32 v84, v56, v57
    v_cvt_pk_bf16_f32 v85, v58, v59
    v_cvt_pk_bf16_f32 v86, v60, v61
    v_cvt_pk_bf16_f32 v87, v62, v63
    s_waitcnt vmcnt(1)
    s_barrier
    v_mfma_f32_32x32x8bf16_1k v[48:63], v[68:69], v[70:71], 0
    s_setprio 0
    s_waitcnt vmcnt(0)
    v_cmp_ne_u32 vcc, s75, v88
    s_cbranch_vccz L_pfok_86
L_pfspin_85:
    s_lshl_b32 s87, s72, 7
    s_lshl_b32 s89, s73, 3
    v_and_b32 v90, 7, v0
    v_lshl_add_u32 v90, v90, 3, s87
    v_and_b32 v91, 31, v0
    v_lshl_add_u32 v91, v91, 7, s89
    v_cmp_gt_u32 vcc, 32, v0
    s_mov_b32 s87, 40960
    s_nop 0
    v_cndmask_b32 v90, v91, v90, vcc
    buffer_load_dwordx2 v[88:89], v90, s[32:35], s87 offen sc1
    s_waitcnt vmcnt(0)
    v_cmp_ne_u32 vcc, s75, v88
    s_cbranch_vccz L_spinout_87
    s_sub_u32 s77, s77, 1
    s_cbranch_scc1 L_spinout_87_x
    s_branch L_pfspin_85
L_spinout_87_x:
    s_mov_b32 s77, 0
L_spinout_87:
L_pfok_86:
    v_exp_f32 v32, v32
    v_exp_f32 v33, v33
    v_exp_f32 v34, v34
    v_exp_f32 v35, v35
    v_exp_f32 v36, v36
    v_mfma_f32_32x32x16_bf16 v[48:63], v[64:67], v[80:83], v[48:63]
    s_waitcnt lgkmcnt(1)
    ds_read_b128 v[64:67], v8 offset:11264
    ds_read_b64 v[68:69], v9 offset:11264
    s_add_u32 s91, s86, 0
    buffer_load_dwordx4 v[96:99], v1, s[32:35], s91 offen sc1
    v_exp_f32 v37, v37
    v_exp_f32 v38, v38
    v_exp_f32 v39, v39
    v_cvt_pk_bf16_f32 v32, v32, v33
    v_cvt_pk_bf16_f32 v33, v34, v35
    v_cvt_pk_bf16_f32 v34, v36, v37
    v_cvt_pk_bf16_f32 v35, v38, v39
    v_mfma_f32_32x32x16_bf16 v[16:31], v[76:79], v[84:87], v[16:31]
    s_waitcnt lgkmcnt(2)
    ds_read_b128 v[76:79], v10 offset:6240
    s_add_u32 s91, s86, 0
    s_add_u32 s91, s91, s93
    buffer_load_dwordx4 v[176:179], v1, s[32:35], s91 offen sc1
    v_exp_f32 v40, v40
    v_exp_f32 v41, v41
    v_exp_f32 v42, v42
    v_exp_f32 v43, v43
    v_exp_f32 v44, v44
    v_mfma_f32_32x32x16_bf16 v[16:31], v[72:75], v[32:35], v[16:31]
    s_waitcnt lgkmcnt(1)
    ds_read_b128 v[72:75], v10 offset:8256
    s_add_u32 s91, s86, 12288
    buffer_load_dwordx4 v[100:103], v1, s[32:35], s91 offen sc1
    v_exp_f32 v45, v45
    v_exp_f32 v46, v46
    v_exp_f32 v47, v47
    v_cvt_pk_bf16_f32 v84, v40, v41
    v_cvt_pk_bf16_f32 v85, v42, v43
    v_cvt_pk_bf16_f32 v86, v44, v45
    v_cvt_pk_bf16_f32 v87, v46, v47
    v_mfma_f32_32x32x8bf16_1k v[32:47], v[68:69], v[70:71], 0
    s_add_u32 s91, s86, 12288
    s_add_u32 s91, s91, s93
    buffer_load_dwordx4 v[180:183], v1, s[32:35], s91 offen sc1
    v_exp_f32 v48, v48
    v_exp_f32 v49, v49
    v_exp_f32 v50, v50
    v_exp_f32 v51, v51
    v_exp_f32 v52, v52
    v_mfma_f32_32x32x16_bf16 v[32:47], v[64:67], v[80:83], v[32:47]
    s_waitcnt lgkmcnt(1)
    ds_read_b128 v[64:67], v8 offset:14016
    ds_read_b64 v[68:69], v9 offset:14016
    s_add_u32 s91, s86, 24576
    buffer_load_dwordx4 v[104:107], v1, s[32:35], s91 offen sc1
    v_exp_f32 v53, v53
    v_exp_f32 v54, v54
    v_exp_f32 v55, v55
    v_cvt_pk_bf16_f32 v48, v48, v49
    v_cvt_pk_bf16_f32 v49, v50, v51
    v_cvt_pk_bf16_f32 v50, v52, v53
    v_cvt_pk_bf16_f32 v51, v54, v55
    v_mfma_f32_32x32x16_bf16 v[16:31], v[76:79], v[84:87], v[16:31]
    s_waitcnt lgkmcnt(2)
    ds_read_b128 v[76:79], v10 offset:8992
    v_exp_f32 v56, v56
    v_exp_f32 v57, v57
    v_exp_f32 v58, v58
    v_exp_f32 v59, v59
    v_exp_f32 v60, v60
    v_mfma_f32_32x32x16_bf16 v[16:31], v[72:75], v[48:51], v[16:31]
    s_waitcnt lgkmcnt(1)
    ds_read_b128 v[72:75], v10 offset:11264
    v_exp_f32 v61, v61
    v_exp_f32 v62, v62
    v_exp_f32 v63, v63
    v_cvt_pk_bf16_f32 v84, v56, v57
    v_cvt_pk_bf16_f32 v85, v58, v59
    v_cvt_pk_bf16_f32 v86, v60, v61
    v_cvt_pk_bf16_f32 v87, v62, v63
    v_mfma_f32_32x32x8bf16_1k v[48:63], v[68:69], v[70:71], 0
    v_exp_f32 v32, v32
    v_exp_f32 v33, v33
    v_exp_f32 v34, v34
    v_exp_f32 v35, v35
    v_exp_f32 v36, v36
    v_mfma_f32_32x32x16_bf16 v[48:63], v[64:67], v[80:83], v[48:63]
    s_waitcnt lgkmcnt(1)
    ds_read_b128 v[64:67], v8 offset:16768
    ds_read_b64 v[68:69], v9 offset:16768
    v_exp_f32 v37, v37
    v_exp_f32 v38, v38
    v_exp_f32 v39, v39
    v_cvt_pk_bf16_f32 v32, v32, v33
    v_cvt_pk_bf16_f32 v33, v34, v35
    v_cvt_pk_bf16_f32 v34, v36, v37
    v_cvt_pk_bf16_f32 v35, v38, v39
    v_mfma_f32_32x32x16_bf16 v[16:31], v[76:79], v[84:87], v[16:31]
    s_waitcnt lgkmcnt(2)
    ds_read_b128 v[76:79], v10 offset:12000
    v_exp_f32 v40, v40
    v_exp_f32 v41, v41
    v_exp_f32 v42, v42
    v_exp_f32 v43, v43
    v_exp_f32 v44, v44
    v_mfma_f32_32x32x16_bf16 v[16:31], v[72:75], v[32:35], v[16:31]
    s_waitcnt lgkmcnt(1)
    ds_read_b128 v[72:75], v10 offset:14016
    v_exp_f32 v45, v45
    v_exp_f32 v46, v46
    v_exp_f32 v47, v47
    v_cvt_pk_bf16_f32 v84, v40, v41
    v_cvt_pk_bf16_f32 v85, v42, v43
    v_cvt_pk_bf16_f32 v86, v44, v45
    v_cvt_pk_bf16_f32 v87, v46, v47
    v_mfma_f32_32x32x8bf16_1k v[32:47], v[68:69], v[70:71], 0
    v_exp_f32 v48, v48
    v_exp_f32 v49, v49
    v_exp_f32 v50, v50
    v_exp_f32 v51, v51
    v_exp_f32 v52, v52
    v_mfma_f32_32x32x16_bf16 v[32:47], v[64:67], v[80:83], v[32:47]
    s_waitcnt lgkmcnt(1)
    ds_read_b128 v[64:67], v8 offset:19520
    ds_read_b64 v[68:69], v9 offset:19520
    v_exp_f32 v53, v53
    v_exp_f32 v54, v54
    v_exp_f32 v55, v55
    v_cvt_pk_bf16_f32 v48, v48, v49
    v_cvt_pk_bf16_f32 v49, v50, v51
    v_cvt_pk_bf16_f32 v50, v52, v53
    v_cvt_pk_bf16_f32 v51, v54, v55
    v_mfma_f32_32x32x16_bf16 v[16:31], v[76:79], v[84:87], v[16:31]
    s_waitcnt lgkmcnt(2)
    ds_read_b128 v[76:79], v10 offset:14752
    v_exp_f32 v56, v56
    v_exp_f32 v57, v57
    v_exp_f32 v58, v58
    v_exp_f32 v59, v59
    v_exp_f32 v60, v60
    v_mfma_f32_32x32x16_bf16 v[16:31], v[72:75], v[48:51], v[16:31]
    s_waitcnt lgkmcnt(1)
    ds_read_b128 v[72:75], v10 offset:16768
    v_exp_f32 v61, v61
    v_exp_f32 v62, v62
    v_exp_f32 v63, v63
    v_cvt_pk_bf16_f32 v84, v56, v57
    v_cvt_pk_bf16_f32 v85, v58, v59
    v_cvt_pk_bf16_f32 v86, v60, v61
    v_cvt_pk_bf16_f32 v87, v62, v63
    s_barrier
    v_mfma_f32_32x32x8bf16_1k v[48:63], v[68:69], v[70:71], 0
    s_setprio 1
    s_add_u32 s29, s29, 22016
    s_cmp_ge_u32 s29, 176128
    s_cselect_b32 s95, 176128, 0
    s_sub_u32 s29, s29, s95
    s_add_u32 m0, s85, 102400
    s_add_u32 s95, s29, s92
    buffer_load_dwordx4 v1, s[32:35], s95 offen offset:0 sc1 lds
    v_exp_f32 v32, v32
    v_exp_f32 v33, v33
    v_exp_f32 v34, v34
    v_exp_f32 v35, v35
    v_exp_f32 v36, v36
    v_mfma_f32_32x32x16_bf16 v[48:63], v[64:67], v[80:83], v[48:63]
    s_waitcnt lgkmcnt(1)
    ds_read_b128 v[64:67], v8 offset:22528
    ds_read_b64 v[68:69], v9 offset:22528
    buffer_load_dwordx4 v1, s[32:35], s95 offen offset:1024 sc1 lds
    v_exp_f32 v37, v37
    v_exp_f32 v38, v38
    v_exp_f32 v39, v39
    v_cvt_pk_bf16_f32 v32, v32, v33
    v_cvt_pk_bf16_f32 v33, v34, v35
    v_cvt_pk_bf16_f32 v34, v36, v37
    v_cvt_pk_bf16_f32 v35, v38, v39
    v_mfma_f32_32x32x16_bf16 v[16:31], v[76:79], v[84:87], v[16:31]
    s_waitcnt lgkmcnt(2)
    ds_read_b128 v[76:79], v10 offset:17504
    s_cmp_eq_u32 s85, 9216
    s_cbranch_scc1 L_skip_kv_88
    buffer_load_dwordx4 v1, s[32:35], s95 offen offset:2048 sc1 lds
L_skip_kv_88:
    v_exp_f32 v40, v40
    v_exp_f32 v41, v41
    v_exp_f32 v42, v42
    v_exp_f32 v43, v43
    v_exp_f32 v44, v44
    v_mfma_f32_32x32x16_bf16 v[16:31], v[72:75], v[32:35], v[16:31]
    s_waitcnt lgkmcnt(1)
    ds_read_b128 v[72:75], v10 offset:19520
    s_add_u32 s91, s86, 24576
    s_add_u32 s91, s91, s93
    buffer_load_dwordx4 v[184:187], v1, s[32:35], s91 offen sc1
    v_exp_f32 v45, v45
    v_exp_f32 v46, v46
    v_exp_f32 v47, v47
    v_cvt_pk_bf16_f32 v84, v40, v41
    v_cvt_pk_bf16_f32 v85, v42, v43
    v_cvt_pk_bf16_f32 v86, v44, v45
    v_cvt_pk_bf16_f32 v87, v46, v47
    v_mfma_f32_32x32x8bf16_1k v[32:47], v[68:69], v[70:71], 0
    s_add_u32 s91, s86, 36864
    buffer_load_dwordx4 v[108:111], v1, s[32:35], s91 offen sc1
    v_exp_f32 v48, v48
    v_exp_f32 v49, v49
    v_exp_f32 v50, v50
    v_exp_f32 v51, v51
    v_exp_f32 v52, v52
    v_mfma_f32_32x32x16_bf16 v[32:47], v[64:67], v[80:83], v[32:47]
    s_waitcnt lgkmcnt(1)
    ds_read_b128 v[64:67], v8 offset:25280
    ds_read_b64 v[68:69], v9 offset:25280
    s_add_u32 s91, s86, 36864
    s_add_u32 s91, s91, s93
    buffer_load_dwordx4 v[188:191], v1, s[32:35], s91 offen sc1
    v_exp_f32 v53, v53
    v_exp_f32 v54, v54
    v_exp_f32 v55, v55
    v_cvt_pk_bf16_f32 v48, v48, v49
    v_cvt_pk_bf16_f32 v49, v50, v51
    v_cvt_pk_bf16_f32 v50, v52, v53
    v_cvt_pk_bf16_f32 v51, v54, v55
    v_mfma_f32_32x32x16_bf16 v[16:31], v[76:79], v[84:87], v[16:31]
    s_waitcnt lgkmcnt(2)
    ds_read_b128 v[76:79], v10 offset:20256
    s_add_u32 s91, s86, 49152
    buffer_load_dwordx4 v[112:115], v1, s[32:35], s91 offen sc1
    v_exp_f32 v56, v56
    v_exp_f32 v57, v57
    v_exp_f32 v58, v58
    v_exp_f32 v59, v59
    v_exp_f32 v60, v60
    v_mfma_f32_32x32x16_bf16 v[16:31], v[72:75], v[48:51], v[16:31]
    s_waitcnt lgkmcnt(1)
    ds_read_b128 v[72:75], v10 offset:22528
    v_exp_f32 v61, v61
    v_exp_f32 v62, v62
    v_exp_f32 v63, v63
    v_cvt_pk_bf16_f32 v84, v56, v57
    v_cvt_pk_bf16_f32 v85, v58, v59
    v_cvt_pk_bf16_f32 v86, v60, v61
    v_cvt_pk_bf16_f32 v87, v62, v63
    v_mfma_f32_32x32x8bf16_1k v[48:63], v[68:69], v[70:71], 0
    v_exp_f32 v32, v32
    v_exp_f32 v33, v33
    v_exp_f32 v34, v34
    v_exp_f32 v35, v35
    v_exp_f32 v36, v36
    v_mfma_f32_32x32x16_bf16 v[48:63], v[64:67], v[80:83], v[48:63]
    s_waitcnt lgkmcnt(1)
    ds_read_b128 v[64:67], v8 offset:28032
    ds_read_b64 v[68:69], v9 offset:28032
    v_exp_f32 v37, v37
    v_exp_f32 v38, v38
    v_exp_f32 v39, v39
    v_cvt_pk_bf16_f32 v32, v32, v33
    v_cvt_pk_bf16_f32 v33, v34, v35
    v_cvt_pk_bf16_f32 v34, v36, v37
    v_cvt_pk_bf16_f32 v35, v38, v39
    v_mfma_f32_32x32x16_bf16 v[16:31], v[76:79], v[84:87], v[16:31]
    s_waitcnt lgkmcnt(2)
    ds_read_b128 v[76:79], v10 offset:23264
    v_exp_f32 v40, v40
    v_exp_f32 v41, v41
    v_exp_f32 v42, v42
    v_exp_f32 v43, v43
    v_exp_f32 v44, v44
    v_mfma_f32_32x32x16_bf16 v[16:31], v[72:75], v[32:35], v[16:31]
    s_waitcnt lgkmcnt(1)
    ds_read_b128 v[72:75], v10 offset:25280
    v_exp_f32 v45, v45
    v_exp_f32 v46, v46
    v_exp_f32 v47, v47
    v_cvt_pk_bf16_f32 v84, v40, v41
    v_cvt_pk_bf16_f32 v85, v42, v43
    v_cvt_pk_bf16_f32 v86, v44, v45
    v_cvt_pk_bf16_f32 v87, v46, v47
    v_mfma_f32_32x32x8bf16_1k v[32:47], v[68:69], v[70:71], 0
    v_exp_f32 v48, v48
    v_exp_f32 v49, v49
    v_exp_f32 v50, v50
    v_exp_f32 v51, v51
    v_exp_f32 v52, v52
    v_mfma_f32_32x32x16_bf16 v[32:47], v[64:67], v[80:83], v[32:47]
    s_waitcnt lgkmcnt(1)
    ds_read_b128 v[64:67], v8 offset:30784
    ds_read_b64 v[68:69], v9 offset:30784
    v_exp_f32 v53, v53
    v_exp_f32 v54, v54
    v_exp_f32 v55, v55
    v_cvt_pk_bf16_f32 v48, v48, v49
    v_cvt_pk_bf16_f32 v49, v50, v51
    v_cvt_pk_bf16_f32 v50, v52, v53
    v_cvt_pk_bf16_f32 v51, v54, v55
    v_mfma_f32_32x32x16_bf16 v[16:31], v[76:79], v[84:87], v[16:31]
    s_waitcnt lgkmcnt(2)
    ds_read_b128 v[76:79], v10 offset:26016
    v_exp_f32 v56, v56
    v_exp_f32 v57, v57
    v_exp_f32 v58, v58
    v_exp_f32 v59, v59
    v_exp_f32 v60, v60
    v_mfma_f32_32x32x16_bf16 v[16:31], v[72:75], v[48:51], v[16:31]
    s_waitcnt lgkmcnt(1)
    ds_read_b128 v[72:75], v10 offset:28032
    v_exp_f32 v61, v61
    v_exp_f32 v62, v62
    v_exp_f32 v63, v63
    v_cvt_pk_bf16_f32 v84, v56, v57
    v_cvt_pk_bf16_f32 v85, v58, v59
    v_cvt_pk_bf16_f32 v86, v60, v61
    v_cvt_pk_bf16_f32 v87, v62, v63
    s_waitcnt vmcnt(4)
    s_barrier
    v_mfma_f32_32x32x8bf16_1k v[48:63], v[68:69], v[70:71], 0
    s_setprio 0
    s_add_u32 s91, s86, 49152
    s_add_u32 s91, s91, s93
    buffer_load_dwordx4 v[192:195], v1, s[32:35], s91 offen sc1
    v_exp_f32 v32, v32
    v_exp_f32 v33, v33
    v_exp_f32 v34, v34
    v_exp_f32 v35, v35
    v_exp_f32 v36, v36
    v_mfma_f32_32x32x16_bf16 v[48:63], v[64:67], v[80:83], v[48:63]
    s_waitcnt lgkmcnt(1)
    ds_read_b128 v[64:67], v8 offset:0
    ds_read_b64 v[68:69], v9 offset:0
    s_add_u32 s91, s86, 61440
    buffer_load_dwordx4 v[116:119], v1, s[32:35], s91 offen sc1
    v_exp_f32 v37, v37
    v_exp_f32 v38, v38
    v_exp_f32 v39, v39
    v_cvt_pk_bf16_f32 v32, v32, v33
    v_cvt_pk_bf16_f32 v33, v34, v35
    v_cvt_pk_bf16_f32 v34, v36, v37
    v_cvt_pk_bf16_f32 v35, v38, v39
    v_mfma_f32_32x32x16_bf16 v[16:31], v[76:79], v[84:87], v[16:31]
    s_waitcnt lgkmcnt(2)
    ds_read_b128 v[76:79], v10 offset:28768
    s_add_u32 s91, s86, 61440
    s_add_u32 s91, s91, s93
    buffer_load_dwordx4 v[196:199], v1, s[32:35], s91 offen sc1
    v_exp_f32 v40, v40
    v_exp_f32 v41, v41
    v_exp_f32 v42, v42
    v_exp_f32 v43, v43
    v_exp_f32 v44, v44
    v_mfma_f32_32x32x16_bf16 v[16:31], v[72:75], v[32:35], v[16:31]
    s_waitcnt lgkmcnt(1)
    ds_read_b128 v[72:75], v10 offset:30784
    s_add_u32 s91, s86, 73728
    buffer_load_dwordx4 v[120:123], v1, s[32:35], s91 offen sc1
    v_exp_f32 v45, v45
    v_exp_f32 v46, v46
    v_exp_f32 v47, v47
    v_cvt_pk_bf16_f32 v84, v40, v41
    v_cvt_pk_bf16_f32 v85, v42, v43
    v_cvt_pk_bf16_f32 v86, v44, v45
    v_cvt_pk_bf16_f32 v87, v46, v47
    v_mfma_f32_32x32x8bf16_1k v[32:47], v[68:69], v[70:71], 0
    s_add_u32 s91, s86, 73728
    s_add_u32 s91, s91, s93
    buffer_load_dwordx4 v[200:203], v1, s[32:35], s91 offen sc1
    v_exp_f32 v48, v48
    v_exp_f32 v49, v49
    v_exp_f32 v50, v50
    v_exp_f32 v51, v51
    v_exp_f32 v52, v52
    v_mfma_f32_32x32x16_bf16 v[32:47], v[64:67], v[80:83], v[32:47]
    s_waitcnt lgkmcnt(1)
    ds_read_b128 v[64:67], v8 offset:2752
    ds_read_b64 v[68:69], v9 offset:2752
    v_exp_f32 v53, v53
    v_exp_f32 v54, v54
    v_exp_f32 v55, v55
    v_cvt_pk_bf16_f32 v48, v48, v49
    v_cvt_pk_bf16_f32 v49, v50, v51
    v_cvt_pk_bf16_f32 v50, v52, v53
    v_cvt_pk_bf16_f32 v51, v54, v55
    v_mfma_f32_32x32x16_bf16 v[16:31], v[76:79], v[84:87], v[16:31]
    s_waitcnt lgkmcnt(2)
    ds_read_b128 v[76:79], v10 offset:31520
    v_exp_f32 v56, v56
    v_exp_f32 v57, v57
    v_exp_f32 v58, v58
    v_exp_f32 v59, v59
    v_exp_f32 v60, v60
    v_mfma_f32_32x32x16_bf16 v[16:31], v[72:75], v[48:51], v[16:31]
    s_waitcnt lgkmcnt(1)
    ds_read_b128 v[72:75], v10 offset:0
    v_exp_f32 v61, v61
    v_exp_f32 v62, v62
    v_exp_f32 v63, v63
    v_cvt_pk_bf16_f32 v84, v56, v57
    v_cvt_pk_bf16_f32 v85, v58, v59
    v_cvt_pk_bf16_f32 v86, v60, v61
    v_cvt_pk_bf16_f32 v87, v62, v63
    v_mfma_f32_32x32x8bf16_1k v[48:63], v[68:69], v[70:71], 0
    v_exp_f32 v32, v32
    v_exp_f32 v33, v33
    v_exp_f32 v34, v34
    v_exp_f32 v35, v35
    v_exp_f32 v36, v36
    v_mfma_f32_32x32x16_bf16 v[48:63], v[64:67], v[80:83], v[48:63]
    s_waitcnt lgkmcnt(1)
    ds_read_b128 v[64:67], v8 offset:5504
    ds_read_b64 v[68:69], v9 offset:5504
    v_exp_f32 v37, v37
    v_exp_f32 v38, v38
    v_exp_f32 v39, v39
    v_cvt_pk_bf16_f32 v32, v32, v33
    v_cvt_pk_bf16_f32 v33, v34, v35
    v_cvt_pk_bf16_f32 v34, v36, v37
    v_cvt_pk_bf16_f32 v35, v38, v39
    v_mfma_f32_32x32x16_bf16 v[16:31], v[76:79], v[84:87], v[16:31]
    s_waitcnt lgkmcnt(2)
    ds_read_b128 v[76:79], v10 offset:736
    v_exp_f32 v40, v40
    v_exp_f32 v41, v41
    v_exp_f32 v42, v42
    v_exp_f32 v43, v43
    v_exp_f32 v44, v44
    v_mfma_f32_32x32x16_bf16 v[16:31], v[72:75], v[32:35], v[16:31]
    s_waitcnt lgkmcnt(1)
    ds_read_b128 v[72:75], v10 offset:2752
    v_exp_f32 v45, v45
    v_exp_f32 v46, v46
    v_exp_f32 v47, v47
    v_cvt_pk_bf16_f32 v84, v40, v41
    v_cvt_pk_bf16_f32 v85, v42, v43
    v_cvt_pk_bf16_f32 v86, v44, v45
    v_cvt_pk_bf16_f32 v87, v46, v47
    v_mfma_f32_32x32x8bf16_1k v[32:47], v[68:69], v[70:71], 0
    v_exp_f32 v48, v48
    v_exp_f32 v49, v49
    v_exp_f32 v50, v50
    v_exp_f32 v51, v51
    v_exp_f32 v52, v52
    v_mfma_f32_32x32x16_bf16 v[32:47], v[64:67], v[80:83], v[32:47]
    s_waitcnt lgkmcnt(1)
    ds_read_b128 v[64:67], v8 offset:8256
    ds_read_b64 v[68:69], v9 offset:8256
    v_exp_f32 v53, v53
    v_exp_f32 v54, v54
    v_exp_f32 v55, v55
    v_cvt_pk_bf16_f32 v48, v48, v49
    v_cvt_pk_bf16_f32 v49, v50, v51
    v_cvt_pk_bf16_f32 v50, v52, v53
    v_cvt_pk_bf16_f32 v51, v54, v55
    v_mfma_f32_32x32x16_bf16 v[16:31], v[76:79], v[84:87], v[16:31]
    s_waitcnt lgkmcnt(2)
    ds_read_b128 v[76:79], v10 offset:3488
    v_exp_f32 v56, v56
    v_exp_f32 v57, v57
    v_exp_f32 v58, v58
    v_exp_f32 v59, v59
    v_exp_f32 v60, v60
    v_mfma_f32_32x32x16_bf16 v[16:31], v[72:75], v[48:51], v[16:31]
    s_waitcnt lgkmcnt(1)
    ds_read_b128 v[72:75], v10 offset:5504
    v_exp_f32 v61, v61
    v_exp_f32 v62, v62
    v_exp_f32 v63, v63
    v_cvt_pk_bf16_f32 v84, v56, v57
    v_cvt_pk_bf16_f32 v85, v58, v59
    v_cvt_pk_bf16_f32 v86, v60, v61
    v_cvt_pk_bf16_f32 v87, v62, v63
    s_barrier
    v_mfma_f32_32x32x8bf16_1k v[48:63], v[68:69], v[70:71], 0
    s_setprio 1
    s_add_u32 s29, s29, 22016
    s_cmp_ge_u32 s29, 176128
    s_cselect_b32 s95, 176128, 0
    s_sub_u32 s29, s29, s95
    s_add_u32 m0, s85, 124928
    s_add_u32 s95, s29, s92
    buffer_load_dwordx4 v1, s[32:35], s95 offen offset:0 sc1 lds
    v_exp_f32 v32, v32
    v_exp_f32 v33, v33
    v_exp_f32 v34, v34
    v_exp_f32 v35, v35
    v_exp_f32 v36, v36
    v_mfma_f32_32x32x16_bf16 v[48:63], v[64:67], v[80:83], v[48:63]
    s_waitcnt lgkmcnt(1)
    ds_read_b128 v[64:67], v8 offset:11264
    ds_read_b64 v[68:69], v9 offset:11264
    buffer_load_dwordx4 v1, s[32:35], s95 offen offset:1024 sc1 lds
    v_exp_f32 v37, v37
    v_exp_f32 v38, v38
    v_exp_f32 v39, v39
    v_cvt_pk_bf16_f32 v32, v32, v33
    v_cvt_pk_bf16_f32 v33, v34, v35
    v_cvt_pk_bf16_f32 v34, v36, v37
    v_cvt_pk_bf16_f32 v35, v38, v39
    v_mfma_f32_32x32x16_bf16 v[16:31], v[76:79], v[84:87], v[16:31]
    s_waitcnt lgkmcnt(2)
    ds_read_b128 v[76:79], v10 offset:6240
    s_cmp_eq_u32 s85, 9216
    s_cbranch_scc1 L_skip_kv_89
    buffer_load_dwordx4 v1, s[32:35], s95 offen offset:2048 sc1 lds
L_skip_kv_89:
    v_exp_f32 v40, v40
    v_exp_f32 v41, v41
    v_exp_f32 v42, v42
    v_exp_f32 v43, v43
    v_exp_f32 v44, v44
    v_mfma_f32_32x32x16_bf16 v[16:31], v[72:75], v[32:35], v[16:31]
    s_waitcnt lgkmcnt(1)
    ds_read_b128 v[72:75], v10 offset:8256
    s_mul_i32 s89, s61, 9
    s_add_u32 s89, s89, 36864
    s_min_u32 s89, s89, 93184
    s_add_u32 m0, s89, 0
    s_add_u32 s87, m0, s28
    buffer_load_dwordx4 v1, s[32:35], s87 offen offset:0 sc1 lds
    v_exp_f32 v45, v45
    v_exp_f32 v46, v46
    v_exp_f32 v47, v47
    v_cvt_pk_bf16_f32 v84, v40, v41
    v_cvt_pk_bf16_f32 v85, v42, v43
    v_cvt_pk_bf16_f32 v86, v44, v45
    v_cvt_pk_bf16_f32 v87, v46, v47
    v_mfma_f32_32x32x8bf16_1k v[32:47], v[68:69], v[70:71], 0
    buffer_load_dwordx4 v1, s[32:35], s87 offen offset:1024 sc1 lds
    v_exp_f32 v48, v48
    v_exp_f32 v49, v49
    v_exp_f32 v50, v50
    v_exp_f32 v51, v51
    v_exp_f32 v52, v52
    v_mfma_f32_32x32x16_bf16 v[32:47], v[64:67], v[80:83], v[32:47]
    s_waitcnt lgkmcnt(1)
    ds_read_b128 v[64:67], v8 offset:14016
    ds_read_b64 v[68:69], v9 offset:14016
    buffer_load_dwordx4 v1, s[32:35], s87 offen offset:2048 sc1 lds
    v_exp_f32 v53, v53
    v_exp_f32 v54, v54
    v_exp_f32 v55, v55
    v_cvt_pk_bf16_f32 v48, v48, v49
    v_cvt_pk_bf16_f32 v49, v50, v51
    v_cvt_pk_bf16_f32 v50, v52, v53
    v_cvt_pk_bf16_f32 v51, v54, v55
    v_mfma_f32_32x32x16_bf16 v[16:31], v[76:79], v[84:87], v[16:31]
    s_waitcnt lgkmcnt(2)
    ds_read_b128 v[76:79], v10 offset:8992
    buffer_load_dwordx4 v1, s[32:35], s87 offen offset:3072 sc1 lds
    v_exp_f32 v56, v56
    v_exp_f32 v57, v57
    v_exp_f32 v58, v58
    v_exp_f32 v59, v59
    v_exp_f32 v60, v60
    v_mfma_f32_32x32x16_bf16 v[16:31], v[72:75], v[48:51], v[16:31]
    s_waitcnt lgkmcnt(1)
    ds_read_b128 v[72:75], v10 offset:11264
    s_add_u32 m0, s89, 4096
    s_add_u32 s87, m0, s28
    buffer_load_dwordx4 v1, s[32:35], s87 offen offset:0 sc1 lds
    v_exp_f32 v61, v61
    v_exp_f32 v62, v62
    v_exp_f32 v63, v63
    v_cvt_pk_bf16_f32 v84, v56, v57
    v_cvt_pk_bf16_f32 v85, v58, v59
    v_cvt_pk_bf16_f32 v86, v60, v61
    v_cvt_pk_bf16_f32 v87, v62, v63
    v_mfma_f32_32x32x8bf16_1k v[48:63], v[68:69], v[70:71], 0
    buffer_load_dwordx4 v1, s[32:35], s87 offen offset:1024 sc1 lds
    v_exp_f32 v32, v32
    v_exp_f32 v33, v33
    v_exp_f32 v34, v34
    v_exp_f32 v35, v35
    v_exp_f32 v36, v36
    v_mfma_f32_32x32x16_bf16 v[48:63], v[64:67], v[80:83], v[48:63]
    s_waitcnt lgkmcnt(1)
    ds_read_b128 v[64:67], v8 offset:16768
    ds_read_b64 v[68:69], v9 offset:16768
    buffer_load_dwordx4 v1, s[32:35], s87 offen offset:2048 sc1 lds
    v_exp_f32 v37, v37
    v_exp_f32 v38, v38
    v_exp_f32 v39, v39
    v_cvt_pk_bf16_f32 v32, v32, v33
    v_cvt_pk_bf16_f32 v33, v34, v35
    v_cvt_pk_bf16_f32 v34, v36, v37
    v_cvt_pk_bf16_f32 v35, v38, v39
    v_mfma_f32_32x32x16_bf16 v[16:31], v[76:79], v[84:87], v[16:31]
    s_waitcnt lgkmcnt(2)
    ds_read_b128 v[76:79], v10 offset:12000
    buffer_load_dwordx4 v1, s[32:35], s87 offen offset:3072 sc1 lds
    v_exp_f32 v40, v40
    v_exp_f32 v41, v41
    v_exp_f32 v42, v42
    v_exp_f32 v43, v43
    v_exp_f32 v44, v44
    v_mfma_f32_32x32x16_bf16 v[16:31], v[72:75], v[32:35], v[16:31]
    s_waitcnt lgkmcnt(1)
    ds_read_b128 v[72:75], v10 offset:14016
    s_add_u32 m0, s89, 8192
    s_add_u32 s87, m0, s28
    buffer_load_dwordx4 v1, s[32:35], s87 offen offset:0 sc1 lds
    v_exp_f32 v45, v45
    v_exp_f32 v46, v46
    v_exp_f32 v47, v47
    v_cvt_pk_bf16_f32 v84, v40, v41
    v_cvt_pk_bf16_f32 v85, v42, v43
    v_cvt_pk_bf16_f32 v86, v44, v45
    v_cvt_pk_bf16_f32 v87, v46, v47
    v_mfma_f32_32x32x8bf16_1k v[32:47], v[68:69], v[70:71], 0
    s_add_u32 s91, s86, 86016
    buffer_load_dwordx4 v[124:127], v1, s[32:35], s91 offen sc1
    v_exp_f32 v48, v48
    v_exp_f32 v49, v49
    v_exp_f32 v50, v50
    v_exp_f32 v51, v51
    v_exp_f32 v52, v52
    v_mfma_f32_32x32x16_bf16 v[32:47], v[64:67], v[80:83], v[32:47]
    s_waitcnt lgkmcnt(1)
    ds_read_b128 v[64:67], v8 offset:19520
    ds_read_b64 v[68:69], v9 offset:19520
    s_add_u32 s91, s86, 86016
    s_add_u32 s91, s91, s93
    buffer_load_dwordx4 v[204:207], v1, s[32:35], s91 offen sc1
    v_exp_f32 v53, v53
    v_exp_f32 v54, v54
    v_exp_f32 v55, v55
    v_cvt_pk_bf16_f32 v48, v48, v49
    v_cvt_pk_bf16_f32 v49, v50, v51
    v_cvt_pk_bf16_f32 v50, v52, v53
    v_cvt_pk_bf16_f32 v51, v54, v55
    v_mfma_f32_32x32x16_bf16 v[16:31], v[76:79], v[84:87], v[16:31]
    s_waitcnt lgkmcnt(2)
    ds_read_b128 v[76:79], v10 offset:14752
    s_add_u32 s91, s86, 98304
    buffer_load_dwordx4 v[128:131], v1, s[32:35], s91 offen sc1
    v_exp_f32 v56, v56
    v_exp_f32 v57, v57
    v_exp_f32 v58, v58
    v_exp_f32 v59, v59
    v_exp_f32 v60, v60
    v_mfma_f32_32x32x16_bf16 v[16:31], v[72:75], v[48:51], v[16:31]
    s_waitcnt lgkmcnt(1)
    ds_read_b128 v[72:75], v10 offset:16768
    s_add_u32 s91, s86, 98304
    s_add_u32 s91, s91, s93
    buffer_load_dwordx4 v[208:211], v1, s[32:35], s91 offen sc1
    v_exp_f32 v61, v61
    v_exp_f32 v62, v62
    v_exp_f32 v63, v63
    v_cvt_pk_bf16_f32 v84, v56, v57
    v_cvt_pk_bf16_f32 v85, v58, v59
    v_cvt_pk_bf16_f32 v86, v60, v61
    v_cvt_pk_bf16_f32 v87, v62, v63
    s_waitcnt vmcnt(13)
    s_barrier
    v_mfma_f32_32x32x8bf16_1k v[48:63], v[68:69], v[70:71], 0
    s_setprio 0
    s_add_u32 s91, s86, 110592
    buffer_load_dwordx4 v[132:135], v1, s[32:35], s91 offen sc1
    v_exp_f32 v32, v32
    v_exp_f32 v33, v33
    v_exp_f32 v34, v34
    v_exp_f32 v35, v35
    v_exp_f32 v36, v36
    v_mfma_f32_32x32x16_bf16 v[48:63], v[64:67], v[80:83], v[48:63]
    s_waitcnt lgkmcnt(1)
    ds_read_b128 v[64:67], v8 offset:22528
    ds_read_b64 v[68:69], v9 offset:22528
    s_add_u32 s91, s86, 110592
    s_add_u32 s91, s91, s93
    buffer_load_dwordx4 v[212:215], v1, s[32:35], s91 offen sc1
    v_exp_f32 v37, v37
    v_exp_f32 v38, v38
    v_exp_f32 v39, v39
    v_cvt_pk_bf16_f32 v32, v32, v33
    v_cvt_pk_bf16_f32 v33, v34, v35
    v_cvt_pk_bf16_f32 v34, v36, v37
    v_cvt_pk_bf16_f32 v35, v38, v39
    v_mfma_f32_32x32x16_bf16 v[16:31], v[76:79], v[84:87], v[16:31]
    s_waitcnt lgkmcnt(2)
    ds_read_b128 v[76:79], v10 offset:17504
    s_add_u32 s91, s86, 122880
    buffer_load_dwordx4 v[136:139], v1, s[32:35], s91 offen sc1
    v_exp_f32 v40, v40
    v_exp_f32 v41, v41
    v_exp_f32 v42, v42
    v_exp_f32 v43, v43
    v_exp_f32 v44, v44
    v_mfma_f32_32x32x16_bf16 v[16:31], v[72:75], v[32:35], v[16:31]
    s_waitcnt lgkmcnt(1)
    ds_read_b128 v[72:75], v10 offset:19520
    s_add_u32 s91, s86, 122880
    s_add_u32 s91, s91, s93
    buffer_load_dwordx4 v[216:219], v1, s[32:35], s91 offen sc1
    v_exp_f32 v45, v45
    v_exp_f32 v46, v46
    v_exp_f32 v47, v47
    v_cvt_pk_bf16_f32 v84, v40, v41
    v_cvt_pk_bf16_f32 v85, v42, v43
    v_cvt_pk_bf16_f32 v86, v44, v45
    v_cvt_pk_bf16_f32 v87, v46, v47
    v_mfma_f32_32x32x8bf16_1k v[32:47], v[68:69], v[70:71], 0
    s_add_u32 s91, s86, 135168
    buffer_load_dwordx4 v[140:143], v1, s[32:35], s91 offen sc1
    v_exp_f32 v48, v48
    v_exp_f32 v49, v49
    v_exp_f32 v50, v50
    v_exp_f32 v51, v51
    v_exp_f32 v52, v52
    v_mfma_f32_32x32x16_bf16 v[32:47], v[64:67], v[80:83], v[32:47]
    s_waitcnt lgkmcnt(1)
    ds_read_b128 v[64:67], v8 offset:25280
    ds_read_b64 v[68:69], v9 offset:25280
    v_exp_f32 v53, v53
    v_exp_f32 v54, v54
    v_exp_f32 v55, v55
    v_cvt_pk_bf16_f32 v48, v48, v49
    v_cvt_pk_bf16_f32 v49, v50, v51
    v_cvt_pk_bf16_f32 v50, v52, v53
    v_cvt_pk_bf16_f32 v51, v54, v55
    v_mfma_f32_32x32x16_bf16 v[16:31], v[76:79], v[84:87], v[16:31]
    s_waitcnt lgkmcnt(2)
    ds_read_b128 v[76:79], v10 offset:20256
    v_exp_f32 v56, v56
    v_exp_f32 v57, v57
    v_exp_f32 v58, v58
    v_exp_f32 v59, v59
    v_exp_f32 v60, v60
    v_mfma_f32_32x32x16_bf16 v[16:31], v[72:75], v[48:51], v[16:31]
    s_waitcnt lgkmcnt(1)
    ds_read_b128 v[72:75], v10 offset:22528
    v_exp_f32 v61, v61
    v_exp_f32 v62, v62
    v_exp_f32 v63, v63
    v_cvt_pk_bf16_f32 v84, v56, v57
    v_cvt_pk_bf16_f32 v85, v58, v59
    v_cvt_pk_bf16_f32 v86, v60, v61
    v_cvt_pk_bf16_f32 v87, v62, v63
    v_mfma_f32_32x32x8bf16_1k v[48:63], v[68:69], v[70:71], 0
    v_exp_f32 v32, v32
    v_exp_f32 v33, v33
    v_exp_f32 v34, v34
    v_exp_f32 v35, v35
    v_exp_f32 v36, v36
    v_mfma_f32_32x32x16_bf16 v[48:63], v[64:67], v[80:83], v[48:63]
    s_waitcnt lgkmcnt(1)
    ds_read_b128 v[64:67], v8 offset:28032
    ds_read_b64 v[68:69], v9 offset:28032
    v_exp_f32 v37, v37
    v_exp_f32 v38, v38
    v_exp_f32 v39, v39
    v_cvt_pk_bf16_f32 v32, v32, v33
    v_cvt_pk_bf16_f32 v33, v34, v35
    v_cvt_pk_bf16_f32 v34, v36, v37
    v_cvt_pk_bf16_f32 v35, v38, v39
    v_mfma_f32_32x32x16_bf16 v[16:31], v[76:79], v[84:87], v[16:31]
    s_waitcnt lgkmcnt(2)
    ds_read_b128 v[76:79], v10 offset:23264
    v_exp_f32 v40, v40
    v_exp_f32 v41, v41
    v_exp_f32 v42, v42
    v_exp_f32 v43, v43
    v_exp_f32 v44, v44
    v_mfma_f32_32x32x16_bf16 v[16:31], v[72:75], v[32:35], v[16:31]
    s_waitcnt lgkmcnt(1)
    ds_read_b128 v[72:75], v10 offset:25280
    v_exp_f32 v45, v45
    v_exp_f32 v46, v46
    v_exp_f32 v47, v47
    v_cvt_pk_bf16_f32 v84, v40, v41
    v_cvt_pk_bf16_f32 v85, v42, v43
    v_cvt_pk_bf16_f32 v86, v44, v45
    v_cvt_pk_bf16_f32 v87, v46, v47
    v_mfma_f32_32x32x8bf16_1k v[32:47], v[68:69], v[70:71], 0
    v_exp_f32 v48, v48
    v_exp_f32 v49, v49
    v_exp_f32 v50, v50
    v_exp_f32 v51, v51
    v_exp_f32 v52, v52
    v_mfma_f32_32x32x16_bf16 v[32:47], v[64:67], v[80:83], v[32:47]
    s_waitcnt lgkmcnt(1)
    ds_read_b128 v[64:67], v8 offset:30784
    ds_read_b64 v[68:69], v9 offset:30784
    v_exp_f32 v53, v53
    v_exp_f32 v54, v54
    v_exp_f32 v55, v55
    v_cvt_pk_bf16_f32 v48, v48, v49
    v_cvt_pk_bf16_f32 v49, v50, v51
    v_cvt_pk_bf16_f32 v50, v52, v53
    v_cvt_pk_bf16_f32 v51, v54, v55
    v_mfma_f32_32x32x16_bf16 v[16:31], v[76:79], v[84:87], v[16:31]
    s_waitcnt lgkmcnt(2)
    ds_read_b128 v[76:79], v10 offset:26016
    v_exp_f32 v56, v56
    v_exp_f32 v57, v57
    v_exp_f32 v58, v58
    v_exp_f32 v59, v59
    v_exp_f32 v60, v60
    v_mfma_f32_32x32x16_bf16 v[16:31], v[72:75], v[48:51], v[16:31]
    s_waitcnt lgkmcnt(1)
    ds_read_b128 v[72:75], v10 offset:28032
    v_exp_f32 v61, v61
    v_exp_f32 v62, v62
    v_exp_f32 v63, v63
    v_cvt_pk_bf16_f32 v84, v56, v57
    v_cvt_pk_bf16_f32 v85, v58, v59
    v_cvt_pk_bf16_f32 v86, v60, v61
    v_cvt_pk_bf16_f32 v87, v62, v63
    s_barrier
    v_mfma_f32_32x32x8bf16_1k v[48:63], v[68:69], v[70:71], 0
    s_setprio 1
    s_add_u32 s29, s29, 22016
    s_cmp_ge_u32 s29, 176128
    s_cselect_b32 s95, 176128, 0
    s_sub_u32 s29, s29, s95
    s_add_u32 m0, s85, 113664
    s_add_u32 s95, s29, s92
    buffer_load_dwordx4 v1, s[32:35], s95 offen offset:0 sc1 lds
    v_exp_f32 v32, v32
    v_exp_f32 v33, v33
    v_exp_f32 v34, v34
    v_exp_f32 v35, v35
    v_exp_f32 v36, v36
    v_mfma_f32_32x32x16_bf16 v[48:63], v[64:67], v[80:83], v[48:63]
    s_waitcnt lgkmcnt(1)
    ds_read_b128 v[64:67], v8 offset:0
    ds_read_b64 v[68:69], v9 offset:0
    buffer_load_dwordx4 v1, s[32:35], s95 offen offset:1024 sc1 lds
    v_exp_f32 v37, v37
    v_exp_f32 v38, v38
    v_exp_f32 v39, v39
    v_cvt_pk_bf16_f32 v32, v32, v33
    v_cvt_pk_bf16_f32 v33, v34, v35
    v_cvt_pk_bf16_f32 v34, v36, v37
    v_cvt_pk_bf16_f32 v35, v38, v39
    v_mfma_f32_32x32x16_bf16 v[16:31], v[76:79], v[84:87], v[16:31]
    s_waitcnt lgkmcnt(2)
    ds_read_b128 v[76:79], v10 offset:28768
    s_cmp_eq_u32 s85, 9216
    s_cbranch_scc1 L_skip_kv_90
    buffer_load_dwordx4 v1, s[32:35], s95 offen offset:2048 sc1 lds
L_skip_kv_90:
    v_exp_f32 v40, v40
    v_exp_f32 v41, v41
    v_exp_f32 v42, v42
    v_exp_f32 v43, v43
    v_exp_f32 v44, v44
    v_mfma_f32_32x32x16_bf16 v[16:31], v[72:75], v[32:35], v[16:31]
    s_waitcnt lgkmcnt(1)
    ds_read_b128 v[72:75], v10 offset:30784
    s_add_u32 s91, s86, 135168
    s_add_u32 s91, s91, s93
    buffer_load_dwordx4 v[220:223], v1, s[32:35], s91 offen sc1
    v_exp_f32 v45, v45
    v_exp_f32 v46, v46
    v_exp_f32 v47, v47
    v_cvt_pk_bf16_f32 v84, v40, v41
    v_cvt_pk_bf16_f32 v85, v42, v43
    v_cvt_pk_bf16_f32 v86, v44, v45
    v_cvt_pk_bf16_f32 v87, v46, v47
    v_mfma_f32_32x32x8bf16_1k v[32:47], v[68:69], v[70:71], 0
    s_add_u32 s91, s86, 147456
    buffer_load_dwordx4 v[144:147], v1, s[32:35], s91 offen sc1
    v_exp_f32 v48, v48
    v_exp_f32 v49, v49
    v_exp_f32 v50, v50
    v_exp_f32 v51, v51
    v_exp_f32 v52, v52
    v_mfma_f32_32x32x16_bf16 v[32:47], v[64:67], v[80:83], v[32:47]
    s_waitcnt lgkmcnt(1)
    ds_read_b128 v[64:67], v8 offset:2752
    ds_read_b64 v[68:69], v9 offset:2752
    s_add_u32 s91, s86, 147456
    s_add_u32 s91, s91, s93
    buffer_load_dwordx4 v[224:227], v1, s[32:35], s91 offen sc1
    v_exp_f32 v53, v53
    v_exp_f32 v54, v54
    v_exp_f32 v55, v55
    v_cvt_pk_bf16_f32 v48, v48, v49
    v_cvt_pk_bf16_f32 v49, v50, v51
    v_cvt_pk_bf16_f32 v50, v52, v53
    v_cvt_pk_bf16_f32 v51, v54, v55
    v_mfma_f32_32x32x16_bf16 v[16:31], v[76:79], v[84:87], v[16:31]
    s_waitcnt lgkmcnt(2)
    ds_read_b128 v[76:79], v10 offset:31520
    s_add_u32 s91, s86, 159744
    buffer_load_dwordx4 v[148:151], v1, s[32:35], s91 offen sc1
    v_exp_f32 v56, v56
    v_exp_f32 v57, v57
    v_exp_f32 v58, v58
    v_exp_f32 v59, v59
    v_exp_f32 v60, v60
    v_mfma_f32_32x32x16_bf16 v[16:31], v[72:75], v[48:51], v[16:31]
    s_waitcnt lgkmcnt(1)
    ds_read_b128 v[72:75], v10 offset:0
    s_cmp_ge_u32 s74, 6
    s_cbranch_scc1 L_skip_tab_91
    s_lshl_b32 s87, s74, 10
    s_add_u32 s62, s87, 24576
    s_add_u32 s63, s87, 19456
    s_mul_i32 s87, s73, 640
    s_add_u32 s89, s87, 14336
    s_add_u32 s87, s87, 29696
    s_cmp_eq_u32 s74, 5
    s_cselect_b32 s62, s89, s62
    s_cselect_b32 s63, s87, s63
    buffer_load_dwordx4 v[88:91], v1, s[32:35], s62 offen sc1
    buffer_load_dwordx4 v[92:95], v1, s[32:35], s63 offen sc1
L_skip_tab_91:
    v_exp_f32 v61, v61
    v_exp_f32 v62, v62
    v_exp_f32 v63, v63
    v_cvt_pk_bf16_f32 v84, v56, v57
    v_cvt_pk_bf16_f32 v85, v58, v59
    v_cvt_pk_bf16_f32 v86, v60, v61
    v_cvt_pk_bf16_f32 v87, v62, v63
    v_mfma_f32_32x32x8bf16_1k v[48:63], v[68:69], v[70:71], 0
    v_exp_f32 v32, v32
    v_exp_f32 v33, v33
    v_exp_f32 v34, v34
    v_exp_f32 v35, v35
    v_exp_f32 v36, v36
    v_mfma_f32_32x32x16_bf16 v[48:63], v[64:67], v[80:83], v[48:63]
    s_waitcnt lgkmcnt(1)
    ds_read_b128 v[64:67], v8 offset:5504
    ds_read_b64 v[68:69], v9 offset:5504
    v_exp_f32 v37, v37
    v_exp_f32 v38, v38
    v_exp_f32 v39, v39
    v_cvt_pk_bf16_f32 v32, v32, v33
    v_cvt_pk_bf16_f32 v33, v34, v35
    v_cvt_pk_bf16_f32 v34, v36, v37
    v_cvt_pk_bf16_f32 v35, v38, v39
    v_mfma_f32_32x32x16_bf16 v[16:31], v[76:79], v[84:87], v[16:31]
    s_waitcnt lgkmcnt(2)
    ds_read_b128 v[76:79], v10 offset:736
    v_exp_f32 v40, v40
    v_exp_f32 v41, v41
    v_exp_f32 v42, v42
    v_exp_f32 v43, v43
    v_exp_f32 v44, v44
    v_mfma_f32_32x32x16_bf16 v[16:31], v[72:75], v[32:35], v[16:31]
    s_waitcnt lgkmcnt(1)
    ds_read_b128 v[72:75], v10 offset:2752
    v_exp_f32 v45, v45
    v_exp_f32 v46, v46
    v_exp_f32 v47, v47
    v_cvt_pk_bf16_f32 v84, v40, v41
    v_cvt_pk_bf16_f32 v85, v42, v43
    v_cvt_pk_bf16_f32 v86, v44, v45
    v_cvt_pk_bf16_f32 v87, v46, v47
    v_mfma_f32_32x32x8bf16_1k v[32:47], v[68:69], v[70:71], 0
    v_exp_f32 v48, v48
    v_exp_f32 v49, v49
    v_exp_f32 v50, v50
    v_exp_f32 v51, v51
    v_exp_f32 v52, v52
    v_mfma_f32_32x32x16_bf16 v[32:47], v[64:67], v[80:83], v[32:47]
    s_waitcnt lgkmcnt(1)
    ds_read_b128 v[64:67], v8 offset:8256
    ds_read_b64 v[68:69], v9 offset:8256
    v_exp_f32 v53, v53
    v_exp_f32 v54, v54
    v_exp_f32 v55, v55
    v_cvt_pk_bf16_f32 v48, v48, v49
    v_cvt_pk_bf16_f32 v49, v50, v51
    v_cvt_pk_bf16_f32 v50, v52, v53
    v_cvt_pk_bf16_f32 v51, v54, v55
    v_mfma_f32_32x32x16_bf16 v[16:31], v[76:79], v[84:87], v[16:31]
    s_waitcnt lgkmcnt(2)
    ds_read_b128 v[76:79], v10 offset:3488
    v_exp_f32 v56, v56
    v_exp_f32 v57, v57
    v_exp_f32 v58, v58
    v_exp_f32 v59, v59
    v_exp_f32 v60, v60
    v_mfma_f32_32x32x16_bf16 v[16:31], v[72:75], v[48:51], v[16:31]
    s_waitcnt lgkmcnt(1)
    ds_read_b128 v[72:75], v10 offset:5504
    v_exp_f32 v61, v61
    v_exp_f32 v62, v62
    v_exp_f32 v63, v63
    v_cvt_pk_bf16_f32 v84, v56, v57
    v_cvt_pk_bf16_f32 v85, v58, v59
    v_cvt_pk_bf16_f32 v86, v60, v61
    v_cvt_pk_bf16_f32 v87, v62, v63
    s_waitcnt vmcnt(4)
    s_barrier
    v_mfma_f32_32x32x8bf16_1k v[48:63], v[68:69], v[70:71], 0
    s_setprio 0
    s_add_u32 s91, s86, 159744
    s_add_u32 s91, s91, s93
    buffer_load_dwordx4 v[228:231], v1, s[32:35], s91 offen sc1
    v_exp_f32 v32, v32
    v_exp_f32 v33, v33
    v_exp_f32 v34, v34
    v_exp_f32 v35, v35
    v_exp_f32 v36, v36
    v_mfma_f32_32x32x16_bf16 v[48:63], v[64:67], v[80:83], v[48:63]
    s_waitcnt lgkmcnt(1)
    ds_read_b128 v[64:67], v8 offset:11264
    ds_read_b64 v[68:69], v9 offset:11264
    s_add_u32 s91, s86, 172032
    buffer_load_dwordx4 v[152:155], v1, s[32:35], s91 offen sc1
    v_exp_f32 v37, v37
    v_exp_f32 v38, v38
    v_exp_f32 v39, v39
    v_cvt_pk_bf16_f32 v32, v32, v33
    v_cvt_pk_bf16_f32 v33, v34, v35
    v_cvt_pk_bf16_f32 v34, v36, v37
    v_cvt_pk_bf16_f32 v35, v38, v39
    v_mfma_f32_32x32x16_bf16 v[16:31], v[76:79], v[84:87], v[16:31]
    s_waitcnt lgkmcnt(2)
    ds_read_b128 v[76:79], v10 offset:6240
    s_add_u32 s91, s86, 172032
    s_add_u32 s91, s91, s93
    buffer_load_dwordx4 v[232:235], v1, s[32:35], s91 offen sc1
    v_exp_f32 v40, v40
    v_exp_f32 v41, v41
    v_exp_f32 v42, v42
    v_exp_f32 v43, v43
    v_exp_f32 v44, v44
    v_mfma_f32_32x32x16_bf16 v[16:31], v[72:75], v[32:35], v[16:31]
    s_waitcnt lgkmcnt(1)
    ds_read_b128 v[72:75], v10 offset:8256
    s_add_u32 s91, s86, 184320
    buffer_load_dwordx4 v[156:159], v1, s[32:35], s91 offen sc1
    v_exp_f32 v45, v45
    v_exp_f32 v46, v46
    v_exp_f32 v47, v47
    v_cvt_pk_bf16_f32 v84, v40, v41
    v_cvt_pk_bf16_f32 v85, v42, v43
    v_cvt_pk_bf16_f32 v86, v44, v45
    v_cvt_pk_bf16_f32 v87, v46, v47
    v_mfma_f32_32x32x8bf16_1k v[32:47], v[68:69], v[70:71], 0
    s_add_u32 s91, s86, 184320
    s_add_u32 s91, s91, s93
    buffer_load_dwordx4 v[236:239], v1, s[32:35], s91 offen sc1
    v_exp_f32 v48, v48
    v_exp_f32 v49, v49
    v_exp_f32 v50, v50
    v_exp_f32 v51, v51
    v_exp_f32 v52, v52
    v_mfma_f32_32x32x16_bf16 v[32:47], v[64:67], v[80:83], v[32:47]
    s_waitcnt lgkmcnt(1)
    ds_read_b128 v[64:67], v8 offset:14016
    ds_read_b64 v[68:69], v9 offset:14016
    v_exp_f32 v53, v53
    v_exp_f32 v54, v54
    v_exp_f32 v55, v55
    v_cvt_pk_bf16_f32 v48, v48, v49
    v_cvt_pk_bf16_f32 v49, v50, v51
    v_cvt_pk_bf16_f32 v50, v52, v53
    v_cvt_pk_bf16_f32 v51, v54, v55
    v_mfma_f32_32x32x16_bf16 v[16:31], v[76:79], v[84:87], v[16:31]
    s_waitcnt lgkmcnt(2)
    ds_read_b128 v[76:79], v10 offset:8992
    v_exp_f32 v56, v56
    v_exp_f32 v57, v57
    v_exp_f32 v58, v58
    v_exp_f32 v59, v59
    v_exp_f32 v60, v60
    v_mfma_f32_32x32x16_bf16 v[16:31], v[72:75], v[48:51], v[16:31]
    s_waitcnt lgkmcnt(1)
    ds_read_b128 v[72:75], v10 offset:11264
    v_exp_f32 v61, v61
    v_exp_f32 v62, v62
    v_exp_f32 v63, v63
    v_cvt_pk_bf16_f32 v84, v56, v57
    v_cvt_pk_bf16_f32 v85, v58, v59
    v_cvt_pk_bf16_f32 v86, v60, v61
    v_cvt_pk_bf16_f32 v87, v62, v63
    v_mfma_f32_32x32x8bf16_1k v[48:63], v[68:69], v[70:71], 0
    v_exp_f32 v32, v32
    v_exp_f32 v33, v33
    v_exp_f32 v34, v34
    v_exp_f32 v35, v35
    v_exp_f32 v36, v36
    v_mfma_f32_32x32x16_bf16 v[48:63], v[64:67], v[80:83], v[48:63]
    s_waitcnt lgkmcnt(1)
    ds_read_b128 v[64:67], v8 offset:16768
    ds_read_b64 v[68:69], v9 offset:16768
    v_exp_f32 v37, v37
    v_exp_f32 v38, v38
    v_exp_f32 v39, v39
    v_cvt_pk_bf16_f32 v32, v32, v33
    v_cvt_pk_bf16_f32 v33, v34, v35
    v_cvt_pk_bf16_f32 v34, v36, v37
    v_cvt_pk_bf16_f32 v35, v38, v39
    v_mfma_f32_32x32x16_bf16 v[16:31], v[76:79], v[84:87], v[16:31]
    s_waitcnt lgkmcnt(2)
    ds_read_b128 v[76:79], v10 offset:12000
    v_exp_f32 v40, v40
    v_exp_f32 v41, v41
    v_exp_f32 v42, v42
    v_exp_f32 v43, v43
    v_exp_f32 v44, v44
    v_mfma_f32_32x32x16_bf16 v[16:31], v[72:75], v[32:35], v[16:31]
    s_waitcnt lgkmcnt(1)
    ds_read_b128 v[72:75], v10 offset:14016
    v_exp_f32 v45, v45
    v_exp_f32 v46, v46
    v_exp_f32 v47, v47
    v_cvt_pk_bf16_f32 v84, v40, v41
    v_cvt_pk_bf16_f32 v85, v42, v43
    v_cvt_pk_bf16_f32 v86, v44, v45
    v_cvt_pk_bf16_f32 v87, v46, v47
    v_mfma_f32_32x32x8bf16_1k v[32:47], v[68:69], v[70:71], 0
    v_exp_f32 v48, v48
    v_exp_f32 v49, v49
    v_exp_f32 v50, v50
    v_exp_f32 v51, v51
    v_exp_f32 v52, v52
    v_mfma_f32_32x32x16_bf16 v[32:47], v[64:67], v[80:83], v[32:47]
    s_waitcnt lgkmcnt(1)
    ds_read_b128 v[64:67], v8 offset:19520
    ds_read_b64 v[68:69], v9 offset:19520
    v_exp_f32 v53, v53
    v_exp_f32 v54, v54
    v_exp_f32 v55, v55
    v_cvt_pk_bf16_f32 v48, v48, v49
    v_cvt_pk_bf16_f32 v49, v50, v51
    v_cvt_pk_bf16_f32 v50, v52, v53
    v_cvt_pk_bf16_f32 v51, v54, v55
    v_mfma_f32_32x32x16_bf16 v[16:31], v[76:79], v[84:87], v[16:31]
    s_waitcnt lgkmcnt(2)
    ds_read_b128 v[76:79], v10 offset:14752
    v_exp_f32 v56, v56
    v_exp_f32 v57, v57
    v_exp_f32 v58, v58
    v_exp_f32 v59, v59
    v_exp_f32 v60, v60
    v_mfma_f32_32x32x16_bf16 v[16:31], v[72:75], v[48:51], v[16:31]
    s_waitcnt lgkmcnt(1)
    ds_read_b128 v[72:75], v10 offset:16768
    v_exp_f32 v61, v61
    v_exp_f32 v62, v62
    v_exp_f32 v63, v63
    v_cvt_pk_bf16_f32 v84, v56, v57
    v_cvt_pk_bf16_f32 v85, v58, v59
    v_cvt_pk_bf16_f32 v86, v60, v61
    v_cvt_pk_bf16_f32 v87, v62, v63
    s_barrier
    v_mfma_f32_32x32x8bf16_1k v[48:63], v[68:69], v[70:71], 0
    s_setprio 1
    s_add_u32 s29, s29, 22016
    s_cmp_ge_u32 s29, 176128
    s_cselect_b32 s95, 176128, 0
    s_sub_u32 s29, s29, s95
    s_add_u32 m0, s85, 102400
    s_add_u32 s95, s29, s92
    buffer_load_dwordx4 v1, s[32:35], s95 offen offset:0 sc1 lds
    v_exp_f32 v32, v32
    v_exp_f32 v33, v33
    v_exp_f32 v34, v34
    v_exp_f32 v35, v35
    v_exp_f32 v36, v36
    v_mfma_f32_32x32x16_bf16 v[48:63], v[64:67], v[80:83], v[48:63]
    s_waitcnt lgkmcnt(1)
    ds_read_b128 v[64:67], v8 offset:22528
    ds_read_b64 v[68:69], v9 offset:22528
    buffer_load_dwordx4 v1, s[32:35], s95 offen offset:1024 sc1 lds
    v_exp_f32 v37, v37
    v_exp_f32 v38, v38
    v_exp_f32 v39, v39
    v_cvt_pk_bf16_f32 v32, v32, v33
    v_cvt_pk_bf16_f32 v33, v34, v35
    v_cvt_pk_bf16_f32 v34, v36, v37
    v_cvt_pk_bf16_f32 v35, v38, v39
    v_mfma_f32_32x32x16_bf16 v[16:31], v[76:79], v[84:87], v[16:31]
    s_waitcnt lgkmcnt(2)
    ds_read_b128 v[76:79], v10 offset:17504
    s_cmp_eq_u32 s85, 9216
    s_cbranch_scc1 L_skip_kv_92
    buffer_load_dwordx4 v1, s[32:35], s95 offen offset:2048 sc1 lds
L_skip_kv_92:
    v_exp_f32 v40, v40
    v_exp_f32 v41, v41
    v_exp_f32 v42, v42
    v_exp_f32 v43, v43
    v_exp_f32 v44, v44
    v_mfma_f32_32x32x16_bf16 v[16:31], v[72:75], v[32:35], v[16:31]
    s_waitcnt lgkmcnt(1)
    ds_read_b128 v[72:75], v10 offset:19520
    s_add_u32 s91, s86, 196608
    buffer_load_dwordx4 v[160:163], v1, s[32:35], s91 offen sc1
    v_exp_f32 v45, v45
    v_exp_f32 v46, v46
    v_exp_f32 v47, v47
    v_cvt_pk_bf16_f32 v84, v40, v41
    v_cvt_pk_bf16_f32 v85, v42, v43
    v_cvt_pk_bf16_f32 v86, v44, v45
    v_cvt_pk_bf16_f32 v87, v46, v47
    v_mfma_f32_32x32x8bf16_1k v[32:47], v[68:69], v[70:71], 0
    s_add_u32 s91, s86, 196608
    s_add_u32 s91, s91, s93
    buffer_load_dwordx4 v[240:243], v1, s[32:35], s91 offen sc1
    v_exp_f32 v48, v48
    v_exp_f32 v49, v49
    v_exp_f32 v50, v50
    v_exp_f32 v51, v51
    v_exp_f32 v52, v52
    v_mfma_f32_32x32x16_bf16 v[32:47], v[64:67], v[80:83], v[32:47]
    s_waitcnt lgkmcnt(1)
    ds_read_b128 v[64:67], v8 offset:25280
    ds_read_b64 v[68:69], v9 offset:25280
    s_add_u32 s91, s86, 208896
    buffer_load_dwordx4 v[164:167], v1, s[32:35], s91 offen sc1
    v_exp_f32 v53, v53
    v_exp_f32 v54, v54
    v_exp_f32 v55, v55
    v_cvt_pk_bf16_f32 v48, v48, v49
    v_cvt_pk_bf16_f32 v49, v50, v51
    v_cvt_pk_bf16_f32 v50, v52, v53
    v_cvt_pk_bf16_f32 v51, v54, v55
    v_mfma_f32_32x32x16_bf16 v[16:31], v[76:79], v[84:87], v[16:31]
    s_waitcnt lgkmcnt(2)
    ds_read_b128 v[76:79], v10 offset:20256
    s_add_u32 s91, s86, 208896
    s_add_u32 s91, s91, s93
    buffer_load_dwordx4 v[244:247], v1, s[32:35], s91 offen sc1
    v_exp_f32 v56, v56
    v_exp_f32 v57, v57
    v_exp_f32 v58, v58
    v_exp_f32 v59, v59
    v_exp_f32 v60, v60
    v_mfma_f32_32x32x16_bf16 v[16:31], v[72:75], v[48:51], v[16:31]
    s_waitcnt lgkmcnt(1)
    ds_read_b128 v[72:75], v10 offset:22528
    s_waitcnt vmcnt(11)
    s_cmp_ge_u32 s74, 6
    s_cbranch_scc1 L_skip_tabm_93
    s_cmp_eq_u32 s74, 5
    s_cselect_b32 exec_hi, 0xff, -1
    v_cmp_ne_u32 vcc, s75, v89
    v_cmp_ne_u32 s[90:91], s75, v91
    s_or_b64 vcc, vcc, s[90:91]
    v_cmp_ne_u32 s[90:91], s75, v93
    s_or_b64 vcc, vcc, s[90:91]
    v_cmp_ne_u32 s[90:91], s75, v95
    s_or_b64 vcc, vcc, s[90:91]
    s_cbranch_vccz L_tabok_94
L_tabspin_95:
    buffer_load_dwordx4 v[88:91], v1, s[32:35], s62 offen sc1
    buffer_load_dwordx4 v[92:95], v1, s[32:35], s63 offen sc1
    s_waitcnt vmcnt(0)
    v_cmp_ne_u32 vcc, s75, v89
    v_cmp_ne_u32 s[90:91], s75, v91
    s_or_b64 vcc, vcc, s[90:91]
    v_cmp_ne_u32 s[90:91], s75, v93
    s_or_b64 vcc, vcc, s[90:91]
    v_cmp_ne_u32 s[90:91], s75, v95
    s_or_b64 vcc, vcc, s[90:91]
    s_cbranch_vccz L_spinout_98
    s_sub_u32 s77, s77, 1
    s_cbranch_scc1 L_spinout_98_x
    s_branch L_tabspin_95
L_spinout_98_x:
    s_mov_b32 s77, 0
L_spinout_98:
L_tabok_94:
    s_cmp_eq_u32 s74, 5
    s_cbranch_scc1 L_tab5_96
    v_add_f32 v88, 1.0, v88
    v_add_f32 v90, 1.0, v90
    s_lshl_b32 s87, s74, 8
    s_add_u32 s87, s87, 153600
    v_cvt_pk_bf16_f32 v88, v88, v90
    v_cvt_pk_bf16_f32 v89, v92, v94
    v_lshl_add_u32 v90, v0, 2, s87
    ds_write_b32 v90, v88
    ds_write_b32 v90, v89 offset:1344
    s_branch L_tabdone_97
L_tab5_96:
    v_mov_b32 v89, v90
    v_mul_f32 v92, 0xbf317218, v92
    v_mul_f32 v93, 0xbf317218, v94
    v_lshlrev_b32 v90, 3, v0
    v_add_u32 v90, 156288, v90
    ds_write_b64 v90, v[88:89]
    ds_write_b64 v90, v[92:93] offset:320
L_tabdone_97:
    s_mov_b64 exec, -1
L_skip_tabm_93:
    v_exp_f32 v61, v61
    v_exp_f32 v62, v62
    v_exp_f32 v63, v63
    v_cvt_pk_bf16_f32 v84, v56, v57
    v_cvt_pk_bf16_f32 v85, v58, v59
    v_cvt_pk_bf16_f32 v86, v60, v61
    v_cvt_pk_bf16_f32 v87, v62, v63
    v_mfma_f32_32x32x8bf16_1k v[48:63], v[68:69], v[70:71], 0
    v_exp_f32 v32, v32
    v_exp_f32 v33, v33
    v_exp_f32 v34, v34
    v_exp_f32 v35, v35
    v_exp_f32 v36, v36
    v_mfma_f32_32x32x16_bf16 v[48:63], v[64:67], v[80:83], v[48:63]
    s_waitcnt lgkmcnt(1)
    ds_read_b128 v[64:67], v8 offset:28032
    ds_read_b64 v[68:69], v9 offset:28032
    v_exp_f32 v37, v37
    v_exp_f32 v38, v38
    v_exp_f32 v39, v39
    v_cvt_pk_bf16_f32 v32, v32, v33
    v_cvt_pk_bf16_f32 v33, v34, v35
    v_cvt_pk_bf16_f32 v34, v36, v37
    v_cvt_pk_bf16_f32 v35, v38, v39
    v_mfma_f32_32x32x16_bf16 v[16:31], v[76:79], v[84:87], v[16:31]
    s_waitcnt lgkmcnt(2)
    ds_read_b128 v[76:79], v10 offset:23264
    v_exp_f32 v40, v40
    v_exp_f32 v41, v41
    v_exp_f32 v42, v42
    v_exp_f32 v43, v43
    v_exp_f32 v44, v44
    v_mfma_f32_32x32x16_bf16 v[16:31], v[72:75], v[32:35], v[16:31]
    s_waitcnt lgkmcnt(1)
    ds_read_b128 v[72:75], v10 offset:25280
    v_exp_f32 v45, v45
    v_exp_f32 v46, v46
    v_exp_f32 v47, v47
    v_cvt_pk_bf16_f32 v84, v40, v41
    v_cvt_pk_bf16_f32 v85, v42, v43
    v_cvt_pk_bf16_f32 v86, v44, v45
    v_cvt_pk_bf16_f32 v87, v46, v47
    v_mfma_f32_32x32x8bf16_1k v[32:47], v[68:69], v[70:71], 0
    v_exp_f32 v48, v48
    v_exp_f32 v49, v49
    v_exp_f32 v50, v50
    v_exp_f32 v51, v51
    v_exp_f32 v52, v52
    v_mfma_f32_32x32x16_bf16 v[32:47], v[64:67], v[80:83], v[32:47]
    s_waitcnt lgkmcnt(1)
    ds_read_b128 v[64:67], v8 offset:30784
    ds_read_b64 v[68:69], v9 offset:30784
    v_exp_f32 v53, v53
    v_exp_f32 v54, v54
    v_exp_f32 v55, v55
    v_cvt_pk_bf16_f32 v48, v48, v49
    v_cvt_pk_bf16_f32 v49, v50, v51
    v_cvt_pk_bf16_f32 v50, v52, v53
    v_cvt_pk_bf16_f32 v51, v54, v55
    v_mfma_f32_32x32x16_bf16 v[16:31], v[76:79], v[84:87], v[16:31]
    s_waitcnt lgkmcnt(2)
    ds_read_b128 v[76:79], v10 offset:26016
    v_exp_f32 v56, v56
    v_exp_f32 v57, v57
    v_exp_f32 v58, v58
    v_exp_f32 v59, v59
    v_exp_f32 v60, v60
    v_mfma_f32_32x32x16_bf16 v[16:31], v[72:75], v[48:51], v[16:31]
    s_waitcnt lgkmcnt(1)
    ds_read_b128 v[72:75], v10 offset:28032
    v_exp_f32 v61, v61
    v_exp_f32 v62, v62
    v_exp_f32 v63, v63
    v_cvt_pk_bf16_f32 v84, v56, v57
    v_cvt_pk_bf16_f32 v85, v58, v59
    v_cvt_pk_bf16_f32 v86, v60, v61
    v_cvt_pk_bf16_f32 v87, v62, v63
    s_waitcnt vmcnt(4)
    s_barrier
    v_mfma_f32_32x32x8bf16_1k v[48:63], v[68:69], v[70:71], 0
    s_setprio 0
    s_add_u32 s91, s86, 221184
    buffer_load_dwordx4 v[168:171], v1, s[32:35], s91 offen sc1
    v_exp_f32 v32, v32
    v_exp_f32 v33, v33
    v_exp_f32 v34, v34
    v_exp_f32 v35, v35
    v_exp_f32 v36, v36
    v_mfma_f32_32x32x16_bf16 v[48:63], v[64:67], v[80:83], v[48:63]
    s_waitcnt lgkmcnt(1)
    ds_read_b128 v[64:67], v8 offset:0
    ds_read_b64 v[68:69], v9 offset:0
    s_add_u32 s91, s86, 221184
    s_add_u32 s91, s91, s93
    buffer_load_dwordx4 v[248:251], v1, s[32:35], s91 offen sc1
    v_exp_f32 v37, v37
    v_exp_f32 v38, v38
    v_exp_f32 v39, v39
    v_cvt_pk_bf16_f32 v32, v32, v33
    v_cvt_pk_bf16_f32 v33, v34, v35
    v_cvt_pk_bf16_f32 v34, v36, v37
    v_cvt_pk_bf16_f32 v35, v38, v39
    v_mfma_f32_32x32x16_bf16 v[16:31], v[76:79], v[84:87], v[16:31]
    s_waitcnt lgkmcnt(2)
    ds_read_b128 v[76:79], v10 offset:28768
    s_add_u32 s91, s86, 233472
    buffer_load_dwordx4 v[172:175], v1, s[32:35], s91 offen sc1
    v_exp_f32 v40, v40
    v_exp_f32 v41, v41
    v_exp_f32 v42, v42
    v_exp_f32 v43, v43
    v_exp_f32 v44, v44
    v_mfma_f32_32x32x16_bf16 v[16:31], v[72:75], v[32:35], v[16:31]
    s_waitcnt lgkmcnt(1)
    ds_read_b128 v[72:75], v10 offset:30784
    s_add_u32 s91, s86, 233472
    s_add_u32 s91, s91, s93
    buffer_load_dwordx4 v[252:255], v1, s[32:35], s91 offen sc1
    v_exp_f32 v45, v45
    v_exp_f32 v46, v46
    v_exp_f32 v47, v47
    v_cvt_pk_bf16_f32 v84, v40, v41
    v_cvt_pk_bf16_f32 v85, v42, v43
    v_cvt_pk_bf16_f32 v86, v44, v45
    v_cvt_pk_bf16_f32 v87, v46, v47
    v_mfma_f32_32x32x8bf16_1k v[32:47], v[68:69], v[70:71], 0
    v_and_b32 v14, 15, v0
    v_lshrrev_b32 v11, 4, v0
    v_mul_u32_u24 v14, 1280, v14
    v_lshl_add_u32 v14, v11, 3, v14
    s_lshl_b32 s87, s72, 12
    s_xor_b32 s89, s61, 2048
    s_add_u32 s87, s87, s89
    s_mul_i32 s87, s87, 20
    s_add_u32 s87, s87, s30
    s_lshr_b32 s89, s74, 2
    s_mul_i32 s89, s89, 96
    s_add_u32 s87, s87, s89
    buffer_load_dwordx2 v[92:93], v14, s[36:39], s87 offen offset:0
    buffer_load_dwordx2 v[94:95], v14, s[36:39], s87 offen offset:32
    buffer_load_dwordx2 v[12:13], v14, s[36:39], s87 offen offset:64
    v_exp_f32 v48, v48
    v_exp_f32 v49, v49
    v_exp_f32 v50, v50
    v_exp_f32 v51, v51
    v_exp_f32 v52, v52
    v_mfma_f32_32x32x16_bf16 v[32:47], v[64:67], v[80:83], v[32:47]
    s_waitcnt lgkmcnt(1)
    ds_read_b128 v[64:67], v8 offset:2752
    ds_read_b64 v[68:69], v9 offset:2752
    v_exp_f32 v53, v53
    v_exp_f32 v54, v54
    v_exp_f32 v55, v55
    v_cvt_pk_bf16_f32 v48, v48, v49
    v_cvt_pk_bf16_f32 v49, v50, v51
    v_cvt_pk_bf16_f32 v50, v52, v53
    v_cvt_pk_bf16_f32 v51, v54, v55
    v_mfma_f32_32x32x16_bf16 v[16:31], v[76:79], v[84:87], v[16:31]
    s_waitcnt lgkmcnt(2)
    ds_read_b128 v[76:79], v10 offset:31520
    v_exp_f32 v56, v56
    v_exp_f32 v57, v57
    v_exp_f32 v58, v58
    v_exp_f32 v59, v59
    v_exp_f32 v60, v60
    v_mfma_f32_32x32x16_bf16 v[16:31], v[72:75], v[48:51], v[16:31]
    s_waitcnt lgkmcnt(1)
    ds_read_b128 v[72:75], v10 offset:0
    v_exp_f32 v61, v61
    v_exp_f32 v62, v62
    v_exp_f32 v63, v63
    v_cvt_pk_bf16_f32 v84, v56, v57
    v_cvt_pk_bf16_f32 v85, v58, v59
    v_cvt_pk_bf16_f32 v86, v60, v61
    v_cvt_pk_bf16_f32 v87, v62, v63
    v_mfma_f32_32x32x8bf16_1k v[48:63], v[68:69], v[70:71], 0
    v_exp_f32 v32, v32
    v_exp_f32 v33, v33
    v_exp_f32 v34, v34
    v_exp_f32 v35, v35
    v_exp_f32 v36, v36
    v_mfma_f32_32x32x16_bf16 v[48:63], v[64:67], v[80:83], v[48:63]
    s_waitcnt lgkmcnt(1)
    ds_read_b128 v[64:67], v8 offset:5504
    ds_read_b64 v[68:69], v9 offset:5504
    v_exp_f32 v37, v37
    v_exp_f32 v38, v38
    v_exp_f32 v39, v39
    v_cvt_pk_bf16_f32 v32, v32, v33
    v_cvt_pk_bf16_f32 v33, v34, v35
    v_cvt_pk_bf16_f32 v34, v36, v37
    v_cvt_pk_bf16_f32 v35, v38, v39
    v_mfma_f32_32x32x16_bf16 v[16:31], v[76:79], v[84:87], v[16:31]
    s_waitcnt lgkmcnt(2)
    ds_read_b128 v[76:79], v10 offset:736
    v_exp_f32 v40, v40
    v_exp_f32 v41, v41
    v_exp_f32 v42, v42
    v_exp_f32 v43, v43
    v_exp_f32 v44, v44
    v_mfma_f32_32x32x16_bf16 v[16:31], v[72:75], v[32:35], v[16:31]
    s_waitcnt lgkmcnt(1)
    ds_read_b128 v[72:75], v10 offset:2752
    v_exp_f32 v45, v45
    v_exp_f32 v46, v46
    v_exp_f32 v47, v47
    v_cvt_pk_bf16_f32 v84, v40, v41
    v_cvt_pk_bf16_f32 v85, v42, v43
    v_cvt_pk_bf16_f32 v86, v44, v45
    v_cvt_pk_bf16_f32 v87, v46, v47
    v_mfma_f32_32x32x8bf16_1k v[32:47], v[68:69], v[70:71], 0
    v_exp_f32 v48, v48
    v_exp_f32 v49, v49
    v_exp_f32 v50, v50
    v_exp_f32 v51, v51
    v_exp_f32 v52, v52
    v_mfma_f32_32x32x16_bf16 v[32:47], v[64:67], v[80:83], v[32:47]
    s_waitcnt lgkmcnt(1)
    ds_read_b128 v[64:67], v8 offset:8256
    ds_read_b64 v[68:69], v9 offset:8256
    v_exp_f32 v53, v53
    v_exp_f32 v54, v54
    v_exp_f32 v55, v55
    v_cvt_pk_bf16_f32 v48, v48, v49
    v_cvt_pk_bf16_f32 v49, v50, v51
    v_cvt_pk_bf16_f32 v50, v52, v53
    v_cvt_pk_bf16_f32 v51, v54, v55
    v_mfma_f32_32x32x16_bf16 v[16:31], v[76:79], v[84:87], v[16:31]
    s_waitcnt lgkmcnt(2)
    ds_read_b128 v[76:79], v10 offset:3488
    v_exp_f32 v56, v56
    v_exp_f32 v57, v57
    v_exp_f32 v58, v58
    v_exp_f32 v59, v59
    v_exp_f32 v60, v60
    v_mfma_f32_32x32x16_bf16 v[16:31], v[72:75], v[48:51], v[16:31]
    s_waitcnt lgkmcnt(1)
    ds_read_b128 v[72:75], v10 offset:5504
    v_exp_f32 v61, v61
    v_exp_f32 v62, v62
    v_exp_f32 v63, v63
    v_cvt_pk_bf16_f32 v84, v56, v57
    v_cvt_pk_bf16_f32 v85, v58, v59
    v_cvt_pk_bf16_f32 v86, v60, v61
    v_cvt_pk_bf16_f32 v87, v62, v63
    v_mfma_f32_32x32x8bf16_1k v[48:63], v[68:69], v[70:71], 0
    s_setprio 1
    v_exp_f32 v32, v32
    v_exp_f32 v33, v33
    v_exp_f32 v34, v34
    v_exp_f32 v35, v35
    v_exp_f32 v36, v36
    v_mfma_f32_32x32x16_bf16 v[48:63], v[64:67], v[80:83], v[48:63]
    s_waitcnt lgkmcnt(1)
    v_exp_f32 v37, v37
    v_exp_f32 v38, v38
    v_exp_f32 v39, v39
    v_cvt_pk_bf16_f32 v32, v32, v33
    v_cvt_pk_bf16_f32 v33, v34, v35
    v_cvt_pk_bf16_f32 v34, v36, v37
    v_cvt_pk_bf16_f32 v35, v38, v39
    v_mfma_f32_32x32x16_bf16 v[16:31], v[76:79], v[84:87], v[16:31]
    s_waitcnt lgkmcnt(0)
    ds_read_b128 v[76:79], v10 offset:6240
    v_exp_f32 v40, v40
    v_exp_f32 v41, v41
    v_exp_f32 v42, v42
    v_exp_f32 v43, v43
    v_exp_f32 v44, v44
    v_mfma_f32_32x32x16_bf16 v[16:31], v[72:75], v[32:35], v[16:31]
    ds_read_b128 v[72:75], v10 offset:8256
    v_exp_f32 v45, v45
    v_exp_f32 v46, v46
    v_exp_f32 v47, v47
    v_cvt_pk_bf16_f32 v84, v40, v41
    v_cvt_pk_bf16_f32 v85, v42, v43
    v_cvt_pk_bf16_f32 v86, v44, v45
    v_cvt_pk_bf16_f32 v87, v46, v47
    v_exp_f32 v48, v48
    v_exp_f32 v49, v49
    v_exp_f32 v50, v50
    v_exp_f32 v51, v51
    v_exp_f32 v52, v52
    s_waitcnt lgkmcnt(1)
    v_exp_f32 v53, v53
    v_exp_f32 v54, v54
    v_exp_f32 v55, v55
    v_cvt_pk_bf16_f32 v48, v48, v49
    v_cvt_pk_bf16_f32 v49, v50, v51
    v_cvt_pk_bf16_f32 v50, v52, v53
    v_cvt_pk_bf16_f32 v51, v54, v55
    v_mfma_f32_32x32x16_bf16 v[16:31], v[76:79], v[84:87], v[16:31]
    s_waitcnt lgkmcnt(0)
    ds_read_b128 v[76:79], v10 offset:8992
    v_exp_f32 v56, v56
    v_exp_f32 v57, v57
    v_exp_f32 v58, v58
    v_exp_f32 v59, v59
    v_exp_f32 v60, v60
    v_mfma_f32_32x32x16_bf16 v[16:31], v[72:75], v[48:51], v[16:31]
    v_exp_f32 v61, v61
    v_exp_f32 v62, v62
    v_exp_f32 v63, v63
    v_cvt_pk_bf16_f32 v84, v56, v57
    v_cvt_pk_bf16_f32 v85, v58, v59
    v_cvt_pk_bf16_f32 v86, v60, v61
    v_cvt_pk_bf16_f32 v87, v62, v63
    s_waitcnt lgkmcnt(0)
    s_nop 0
    v_mfma_f32_32x32x16_bf16 v[16:31], v[76:79], v[84:87], v[16:31]
L_att_done:
    s_and_b32 s84, s74, 3
    s_mul_i32 s86, s84, 5
    s_mul_i32 s85, s73, 20
    s_add_u32 s86, s86, s85
    v_lshrrev_b32 v32, 5, v0
    v_add_u32 v33, s86, v32
    v_and_b32 v34, 15, v0
    v_lshlrev_b32 v34, 4, v34
    v_bfe_u32 v35, v0, 4, 1
    v_mul_u32_u24 v35, 20480, v35
    v_add_u32 v34, v34, v35
    v_lshrrev_b32 v35, 1, v33
    v_lshl_add_u32 v35, v35, 8, v34
    v_and_b32 v33, 1, v33
    v_lshl_add_u32 v35, v33, 3, v35
    s_add_u32 s86, s86, 4
    s_lshr_b32 s85, s86, 1
    s_lshl_b32 s85, s85, 8
    s_and_b32 s86, s86, 1
    s_lshl_b32 s86, s86, 3
    s_add_u32 s86, s86, s85
    v_add_u32 v34, s86, v34
    v_mov_b32 v33, 0x7fffffff
    v_cmp_eq_u32 vcc, 0, v32
    s_lshr_b32 s85, s74, 2
    s_lshl_b32 s87, s85, 1
    s_and_b32 s87, s87, 2
    s_xor_b32 s60, s84, s87
    s_mul_i32 s87, s85, 40960
    v_cndmask_b32 v34, v33, v34, vcc
    s_add_u32 s87, s87, s78
    v_cndmask_b32 v28, v24, v28, vcc
    v_add_f32_e64 v36, |v16|, |v17|
    v_add_f32_e64 v37, |v18|, |v19|
    v_add_f32_e64 v36, v36, |v20|
    v_add_f32_e64 v37, v37, |v21|
    v_add_f32_e64 v36, v36, |v22|
    v_add_f32_e64 v37, v37, |v23|
    v_add_f32_e64 v36, v36, |v24|
    v_add_f32_e64 v37, v37, |v25|
    v_add_f32_e64 v36, v36, |v26|
    v_add_f32_e64 v37, v37, |v27|
    s_mov_b32 s92, 0x5d800000
    s_mov_b32 s94, 0x21800000
    s_mov_b32 s95, 0x7f800000
    v_add_f32 v36, v36, v37
    v_cmp_ngt_f32 s[88:89], s92, v28
    v_cmp_nlt_f32 s[90:91], s94, v28
    v_cmp_ngt_f32 vcc, s95, v36
    v_rcp_f32 v36, v28
    s_or_b64 s[88:89], s[88:89], s[90:91]
    s_or_b64 vcc, vcc, s[88:89]
    s_cbranch_vccnz L_fallback
L_att_norm:
    v_mul_f32 v16, v16, v36
    v_mul_f32 v17, v17, v36
    v_mul_f32 v18, v18, v36
    v_mul_f32 v19, v19, v36
    v_mul_f32 v20, v20, v36
    v_mul_f32 v21, v21, v36
    v_mul_f32 v22, v22, v36
    v_mul_f32 v23, v23, v36
    v_mul_f32 v24, v24, v36
    v_mul_f32 v25, v25, v36
    v_mul_f32 v26, v26, v36
    v_mul_f32 v27, v27, v36
    v_cvt_pk_bf16_f32 v16, v16, v17
    v_cvt_pk_bf16_f32 v17, v18, v19
    v_cvt_pk_bf16_f32 v18, v20, v21
    v_cvt_pk_bf16_f32 v19, v22, v23
    v_cvt_pk_bf16_f32 v20, v24, v25
    v_cvt_pk_bf16_f32 v21, v26, v27
    s_cmp_eq_u32 s76, 1
    s_cbranch_scc0 L_far_99
    buffer_store_dwordx2 v[16:17], v35, s[32:35], s87 offen
    buffer_store_dwordx2 v[18:19], v35, s[32:35], s87 offen offset:256
    buffer_store_dwordx2 v[20:21], v34, s[32:35], s87 offen
L_pub_100:
    s_setprio 0
    s_mul_i32 s86, s60, 20480
    s_add_u32 s86, s86, s78
    v_and_b32 v9, 3, v0
    v_mul_u32_u24 v9, 5, v9
    v_bfe_u32 v10, v0, 2, 2
    v_mul_u32_u24 v10, 20, v10
    s_mul_i32 s88, s85, 80
    s_add_u32 s88, s88, 4
    v_add3_u32 v9, v9, v10, s88
    v_lshrrev_b32 v10, 1, v9
    v_lshlrev_b32 v10, 8, v10
    v_and_b32 v9, 1, v9
    v_lshl_add_u32 v9, v9, 3, v10
    v_add_u32 v9, 244, v9
    s_mul_i32 s87, s85, 10240
    s_add_u32 s87, s87, s86
    s_mul_i32 s88, s85, 51200
    v_add_u32 v8, s88, v1
    s_waitcnt vmcnt(6)
    s_cmp_eq_u32 s85, 1
    s_cbranch_scc1 L_skip_ab0
    v_bfe_u32 v14, v0, 3, 1
    v_mul_u32_u24 v11, 1344, v14
    v_lshrrev_b32 v15, 4, v0
    v_lshl_add_u32 v11, v15, 4, v11
    v_add_u32 v11, 153600, v11
    ds_read_b128 v[32:35], v11 offset:0
    ds_read_b128 v[36:39], v11 offset:64
    ds_read_b128 v[40:43], v11 offset:128
    ds_read_b128 v[44:47], v11 offset:192
    v_lshlrev_b32 v14, 6, v14
    v_lshl_add_u32 v14, v15, 4, v14
    s_lshl_b32 s88, s74, 8
    s_add_u32 s88, s88, 157696
    v_add_u32 v14, s88, v14
    s_waitcnt lgkmcnt(3)
    v_mfma_f32_16x16x32_bf16 v[24:27], v[96:99], v[32:35], 0
    v_mfma_f32_16x16x32_bf16 v[28:31], v[176:179], v[32:35], 0
    ds_read_b128 v[32:35], v11 offset:256
    s_waitcnt lgkmcnt(3)
    v_mfma_f32_16x16x32_bf16 v[24:27], v[100:103], v[36:39], v[24:27]
    v_mfma_f32_16x16x32_bf16 v[28:31], v[180:183], v[36:39], v[28:31]
    ds_read_b128 v[36:39], v11 offset:320
    s_waitcnt lgkmcnt(3)
    v_mfma_f32_16x16x32_bf16 v[24:27], v[104:107], v[40:43], v[24:27]
    v_mfma_f32_16x16x32_bf16 v[28:31], v[184:187], v[40:43], v[28:31]
    ds_read_b128 v[40:43], v11 offset:384
    s_waitcnt lgkmcnt(3)
    v_mfma_f32_16x16x32_bf16 v[24:27], v[108:111], v[44:47], v[24:27]
    v_mfma_f32_16x16x32_bf16 v[28:31], v[188:191], v[44:47], v[28:31]
    ds_read_b128 v[44:47], v11 offset:448
    s_waitcnt lgkmcnt(3)
    v_mfma_f32_16x16x32_bf16 v[24:27], v[112:115], v[32:35], v[24:27]
    v_mfma_f32_16x16x32_bf16 v[28:31], v[192:195], v[32:35], v[28:31]
    ds_read_b128 v[32:35], v11 offset:512
    s_waitcnt lgkmcnt(3)
    v_mfma_f32_16x16x32_bf16 v[24:27], v[116:119], v[36:39], v[24:27]
    v_mfma_f32_16x16x32_bf16 v[28:31], v[196:199], v[36:39], v[28:31]
    ds_read_b128 v[36:39], v11 offset:576
    s_waitcnt lgkmcnt(3)
    v_mfma_f32_16x16x32_bf16 v[24:27], v[120:123], v[40:43], v[24:27]
    v_mfma_f32_16x16x32_bf16 v[28:31], v[200:203], v[40:43], v[28:31]
    ds_read_b128 v[40:43], v11 offset:640
    s_waitcnt lgkmcnt(3)
    v_mfma_f32_16x16x32_bf16 v[24:27], v[124:127], v[44:47], v[24:27]
    v_mfma_f32_16x16x32_bf16 v[28:31], v[204:207], v[44:47], v[28:31]
    ds_read_b128 v[44:47], v11 offset:704
    s_waitcnt lgkmcnt(3)
    v_mfma_f32_16x16x32_bf16 v[24:27], v[128:131], v[32:35], v[24:27]
    v_mfma_f32_16x16x32_bf16 v[28:31], v[208:211], v[32:35], v[28:31]
    ds_read_b128 v[32:35], v11 offset:768
    s_waitcnt lgkmcnt(3)
    v_mfma_f32_16x16x32_bf16 v[24:27], v[132:135], v[36:39], v[24:27]
    v_mfma_f32_16x16x32_bf16 v[28:31], v[212:215], v[36:39], v[28:31]
    ds_read_b128 v[36:39], v11 offset:832
    s_waitcnt lgkmcnt(3)
    v_mfma_f32_16x16x32_bf16 v[24:27], v[136:139], v[40:43], v[24:27]
    v_mfma_f32_16x16x32_bf16 v[28:31], v[216:219], v[40:43], v[28:31]
    ds_read_b128 v[40:43], v11 offset:896
    s_waitcnt lgkmcnt(3)
    v_mfma_f32_16x16x32_bf16 v[24:27], v[140:143], v[44:47], v[24:27]
    v_mfma_f32_16x16x32_bf16 v[28:31], v[220:223], v[44:47], v[28:31]
    ds_read_b128 v[44:47], v11 offset:960
    s_waitcnt lgkmcnt(3)
    v_mfma_f32_16x16x32_bf16 v[24:27], v[144:147], v[32:35], v[24:27]
    v_mfma_f32_16x16x32_bf16 v[28:31], v[224:227], v[32:35], v[28:31]
    ds_read_b128 v[32:35], v11 offset:1024
    s_waitcnt lgkmcnt(3)
    v_mfma_f32_16x16x32_bf16 v[24:27], v[148:151], v[36:39], v[24:27]
    v_mfma_f32_16x16x32_bf16 v[28:31], v[228:231], v[36:39], v[28:31]
    ds_read_b128 v[36:39], v11 offset:1088
    s_waitcnt lgkmcnt(3)
    v_mfma_f32_16x16x32_bf16 v[24:27], v[152:155], v[40:43], v[24:27]
    v_mfma_f32_16x16x32_bf16 v[28:31], v[232:235], v[40:43], v[28:31]
    ds_read_b128 v[40:43], v11 offset:1152
    s_waitcnt lgkmcnt(3)
    v_mfma_f32_16x16x32_bf16 v[24:27], v[156:159], v[44:47], v[24:27]
    v_mfma_f32_16x16x32_bf16 v[28:31], v[236:239], v[44:47], v[28:31]
    ds_read_b128 v[44:47], v11 offset:1216
    s_waitcnt lgkmcnt(3)
    v_mfma_f32_16x16x32_bf16 v[24:27], v[160:163], v[32:35], v[24:27]
    v_mfma_f32_16x16x32_bf16 v[28:31], v[240:243], v[32:35], v[28:31]
    s_waitcnt lgkmcnt(2)
    v_mfma_f32_16x16x32_bf16 v[24:27], v[164:167], v[36:39], v[24:27]
    v_mfma_f32_16x16x32_bf16 v[28:31], v[244:247], v[36:39], v[28:31]
    s_waitcnt lgkmcnt(1)
    v_mfma_f32_16x16x32_bf16 v[24:27], v[168:171], v[40:43], v[24:27]
    v_mfma_f32_16x16x32_bf16 v[28:31], v[248:251], v[40:43], v[28:31]
    s_waitcnt lgkmcnt(0)
    v_mfma_f32_16x16x32_bf16 v[24:27], v[172:175], v[44:47], v[24:27]
    v_mfma_f32_16x16x32_bf16 v[28:31], v[252:255], v[44:47], v[28:31]
    s_mov_b32 exec_lo, 0x01010101
    s_mov_b32 exec_hi, 0x01010101
    s_nop 4
    ds_write_b128 v14, v[24:27]
    ds_write_b128 v14, v[28:31] offset:128
    s_mov_b64 exec, -1
    s_waitcnt lgkmcnt(0)
L_skip_ab0:
    s_add_u32 s88, s87, 0
    buffer_load_dwordx4 v[36:39], v1, s[32:35], s88 offen offset:0 sc1
    s_add_u32 s88, s87, 0
    buffer_load_dwordx4 v[40:43], v1, s[32:35], s88 offen offset:1024 sc1
    s_add_u32 s88, s87, 0
    buffer_load_dwordx4 v[44:47], v1, s[32:35], s88 offen offset:2048 sc1
    s_add_u32 s88, s87, 0
    buffer_load_dwordx4 v[48:51], v1, s[32:35], s88 offen offset:3072 sc1
    s_add_u32 s88, s87, 4096
    buffer_load_dwordx4 v[52:55], v1, s[32:35], s88 offen offset:0 sc1
    s_add_u32 s88, s87, 4096
    buffer_load_dwordx4 v[56:59], v1, s[32:35], s88 offen offset:1024 sc1
    ds_read_b128 v[76:79], v8 offset:0
    ds_read_b128 v[80:83], v8 offset:1024
    ds_read_b128 v[84:87], v8 offset:2048
    ds_read_b128 v[88:91], v8 offset:3072
    s_waitcnt vmcnt(4)
    v_max_u32 v10, v37, v39
    v_max3_u32 v10, v10, v41, v43
    v_cmp_eq_u32 vcc, -1, v10
    s_cbranch_vccnz L_bretry_102
L_bok_101:
    s_waitcnt lgkmcnt(3)
    v_mfma_f32_16x16x32_bf16 v[16:19], v[76:79], v[36:39], 0
    ds_read_b128 v[76:79], v8 offset:4096
    s_waitcnt lgkmcnt(3)
    v_mfma_f32_16x16x32_bf16 v[20:23], v[80:83], v[36:39], 0
    ds_read_b128 v[80:83], v8 offset:5120
    s_add_u32 s88, s87, 4096
    buffer_load_dwordx4 v[60:63], v1, s[32:35], s88 offen offset:2048 sc1
    s_waitcnt lgkmcnt(3)
    v_mfma_f32_16x16x32_bf16 v[24:27], v[84:87], v[36:39], 0
    ds_read_b128 v[84:87], v8 offset:6144
    s_waitcnt lgkmcnt(3)
    v_mfma_f32_16x16x32_bf16 v[28:31], v[88:91], v[36:39], 0
    ds_read_b128 v[88:91], v8 offset:7168
    s_waitcnt lgkmcnt(3)
    v_mfma_f32_16x16x32_bf16 v[32:35], v[76:79], v[36:39], 0
    ds_read_b128 v[76:79], v8 offset:8192
    s_waitcnt lgkmcnt(3)
    v_mfma_f32_16x16x32_bf16 v[16:19], v[80:83], v[40:43], v[16:19]
    ds_read_b128 v[80:83], v8 offset:9216
    s_waitcnt lgkmcnt(3)
    v_mfma_f32_16x16x32_bf16 v[20:23], v[84:87], v[40:43], v[20:23]
    ds_read_b128 v[84:87], v8 offset:10240
    s_add_u32 s88, s87, 4096
    buffer_load_dwordx4 v[64:67], v1, s[32:35], s88 offen offset:3072 sc1
    s_waitcnt lgkmcnt(3)
    v_mfma_f32_16x16x32_bf16 v[24:27], v[88:91], v[40:43], v[24:27]
    ds_read_b128 v[88:91], v8 offset:11264
    s_waitcnt lgkmcnt(3)
    v_mfma_f32_16x16x32_bf16 v[28:31], v[76:79], v[40:43], v[28:31]
    ds_read_b128 v[76:79], v8 offset:12288
    s_waitcnt vmcnt(4)
    v_max_u32 v10, v45, v47
    v_max3_u32 v10, v10, v49, v51
    v_cmp_eq_u32 vcc, -1, v10
    s_waitcnt lgkmcnt(3)
    v_mfma_f32_16x16x32_bf16 v[32:35], v[80:83], v[40:43], v[32:35]
    ds_read_b128 v[80:83], v8 offset:13312
    s_cbranch_vccnz L_bretry_104
L_bok_103:
    s_waitcnt lgkmcnt(3)
    v_mfma_f32_16x16x32_bf16 v[16:19], v[84:87], v[44:47], v[16:19]
    ds_read_b128 v[84:87], v8 offset:14336
    s_waitcnt lgkmcnt(3)
    v_mfma_f32_16x16x32_bf16 v[20:23], v[88:91], v[44:47], v[20:23]
    ds_read_b128 v[88:91], v8 offset:15360
    s_add_u32 s88, s87, 8192
    buffer_load_dwordx4 v[68:71], v1, s[32:35], s88 offen offset:0 sc1
    s_waitcnt lgkmcnt(3)
    v_mfma_f32_16x16x32_bf16 v[24:27], v[76:79], v[44:47], v[24:27]
    ds_read_b128 v[76:79], v8 offset:16384
    s_waitcnt lgkmcnt(3)
    v_mfma_f32_16x16x32_bf16 v[28:31], v[80:83], v[44:47], v[28:31]
    ds_read_b128 v[80:83], v8 offset:17408
    s_waitcnt lgkmcnt(3)
    v_mfma_f32_16x16x32_bf16 v[32:35], v[84:87], v[44:47], v[32:35]
    ds_read_b128 v[84:87], v8 offset:18432
    s_waitcnt lgkmcnt(3)
    v_mfma_f32_16x16x32_bf16 v[16:19], v[88:91], v[48:51], v[16:19]
    ds_read_b128 v[88:91], v8 offset:19456
    s_waitcnt lgkmcnt(3)
    v_mfma_f32_16x16x32_bf16 v[20:23], v[76:79], v[48:51], v[20:23]
    ds_read_b128 v[76:79], v8 offset:20480
    s_add_u32 s88, s87, 8192
    buffer_load_dwordx4 v[72:75], v1, s[32:35], s88 offen offset:1024 sc1
    s_waitcnt lgkmcnt(3)
    v_mfma_f32_16x16x32_bf16 v[24:27], v[80:83], v[48:51], v[24:27]
    ds_read_b128 v[80:83], v8 offset:21504
    s_waitcnt lgkmcnt(3)
    v_mfma_f32_16x16x32_bf16 v[28:31], v[84:87], v[48:51], v[28:31]
    ds_read_b128 v[84:87], v8 offset:22528
    s_waitcnt vmcnt(4)
    v_max_u32 v10, v53, v55
    v_max3_u32 v10, v10, v57, v59
    v_cmp_eq_u32 vcc, -1, v10
    s_waitcnt lgkmcnt(3)
    v_mfma_f32_16x16x32_bf16 v[32:35], v[88:91], v[48:51], v[32:35]
    ds_read_b128 v[88:91], v8 offset:23552
    s_cbranch_vccnz L_bretry_106
L_bok_105:
    s_waitcnt lgkmcnt(3)
    v_mfma_f32_16x16x32_bf16 v[16:19], v[76:79], v[52:55], v[16:19]
    ds_read_b128 v[76:79], v8 offset:24576
    s_waitcnt lgkmcnt(3)
    v_mfma_f32_16x16x32_bf16 v[20:23], v[80:83], v[52:55], v[20:23]
    ds_read_b128 v[80:83], v8 offset:25600
    s_waitcnt lgkmcnt(3)
    v_mfma_f32_16x16x32_bf16 v[24:27], v[84:87], v[52:55], v[24:27]
    ds_read_b128 v[84:87], v8 offset:26624
    s_waitcnt lgkmcnt(3)
    v_mfma_f32_16x16x32_bf16 v[28:31], v[88:91], v[52:55], v[28:31]
    ds_read_b128 v[88:91], v8 offset:27648
    s_waitcnt lgkmcnt(3)
    v_mfma_f32_16x16x32_bf16 v[32:35], v[76:79], v[52:55], v[32:35]
    ds_read_b128 v[76:79], v8 offset:28672
    s_waitcnt lgkmcnt(3)
    v_mfma_f32_16x16x32_bf16 v[16:19], v[80:83], v[56:59], v[16:19]
    ds_read_b128 v[80:83], v8 offset:29696
    s_waitcnt lgkmcnt(3)
    v_mfma_f32_16x16x32_bf16 v[20:23], v[84:87], v[56:59], v[20:23]
    ds_read_b128 v[84:87], v8 offset:30720
    s_waitcnt lgkmcnt(3)
    v_mfma_f32_16x16x32_bf16 v[24:27], v[88:91], v[56:59], v[24:27]
    ds_read_b128 v[88:91], v8 offset:31744
    s_waitcnt lgkmcnt(3)
    v_mfma_f32_16x16x32_bf16 v[28:31], v[76:79], v[56:59], v[28:31]
    ds_read_b128 v[76:79], v8 offset:32768
    s_waitcnt vmcnt(2)
    v_max_u32 v10, v61, v63
    v_max3_u32 v10, v10, v65, v67
    v_cmp_eq_u32 vcc, -1, v10
    s_waitcnt lgkmcnt(3)
    v_mfma_f32_16x16x32_bf16 v[32:35], v[80:83], v[56:59], v[32:35]
    ds_read_b128 v[80:83], v8 offset:33792
    s_cbranch_vccnz L_bretry_108
L_bok_107:
    s_waitcnt lgkmcnt(3)
    v_mfma_f32_16x16x32_bf16 v[16:19], v[84:87], v[60:63], v[16:19]
    ds_read_b128 v[84:87], v8 offset:34816
    s_waitcnt lgkmcnt(3)
    v_mfma_f32_16x16x32_bf16 v[20:23], v[88:91], v[60:63], v[20:23]
    ds_read_b128 v[88:91], v8 offset:35840
    s_waitcnt lgkmcnt(3)
    v_mfma_f32_16x16x32_bf16 v[24:27], v[76:79], v[60:63], v[24:27]
    ds_read_b128 v[76:79], v8 offset:36864
    s_waitcnt lgkmcnt(3)
    v_mfma_f32_16x16x32_bf16 v[28:31], v[80:83], v[60:63], v[28:31]
    ds_read_b128 v[80:83], v8 offset:37888
    s_waitcnt lgkmcnt(3)
    v_mfma_f32_16x16x32_bf16 v[32:35], v[84:87], v[60:63], v[32:35]
    ds_read_b128 v[84:87], v8 offset:38912
    s_waitcnt lgkmcnt(3)
    v_mfma_f32_16x16x32_bf16 v[16:19], v[88:91], v[64:67], v[16:19]
    ds_read_b128 v[88:91], v8 offset:39936
    s_waitcnt lgkmcnt(3)
    v_mfma_f32_16x16x32_bf16 v[20:23], v[76:79], v[64:67], v[20:23]
    ds_read_b128 v[76:79], v8 offset:40960
    s_waitcnt lgkmcnt(3)
    v_mfma_f32_16x16x32_bf16 v[24:27], v[80:83], v[64:67], v[24:27]
    ds_read_b128 v[80:83], v8 offset:41984
    s_waitcnt lgkmcnt(3)
    v_mfma_f32_16x16x32_bf16 v[28:31], v[84:87], v[64:67], v[28:31]
    ds_read_b128 v[84:87], v8 offset:43008
    s_waitcnt vmcnt(0)
    v_max_u32 v10, v69, v71
    v_max3_u32 v10, v10, v73, v75
    v_cmp_eq_u32 vcc, -1, v10
    s_waitcnt lgkmcnt(3)
    v_mfma_f32_16x16x32_bf16 v[32:35], v[88:91], v[64:67], v[32:35]
    ds_read_b128 v[88:91], v8 offset:44032
    s_cbranch_vccnz L_bretry_110
L_bok_109:
    s_waitcnt lgkmcnt(3)
    v_mfma_f32_16x16x32_bf16 v[16:19], v[76:79], v[68:71], v[16:19]
    ds_read_b128 v[76:79], v8 offset:45056
    s_waitcnt lgkmcnt(3)
    v_mfma_f32_16x16x32_bf16 v[20:23], v[80:83], v[68:71], v[20:23]
    ds_read_b128 v[80:83], v8 offset:46080
    s_waitcnt lgkmcnt(3)
    v_mfma_f32_16x16x32_bf16 v[24:27], v[84:87], v[68:71], v[24:27]
    ds_read_b128 v[84:87], v8 offset:47104
    s_waitcnt lgkmcnt(3)
    v_mfma_f32_16x16x32_bf16 v[28:31], v[88:91], v[68:71], v[28:31]
    ds_read_b128 v[88:91], v8 offset:48128
    s_waitcnt lgkmcnt(3)
    v_mfma_f32_16x16x32_bf16 v[32:35], v[76:79], v[68:71], v[32:35]
    ds_read_b128 v[76:79], v8 offset:49152
    s_waitcnt lgkmcnt(3)
    v_mfma_f32_16x16x32_bf16 v[16:19], v[80:83], v[72:75], v[16:19]
    ds_read_b128 v[80:83], v8 offset:50176
    s_waitcnt lgkmcnt(3)
    v_mfma_f32_16x16x32_bf16 v[20:23], v[84:87], v[72:75], v[20:23]
    s_waitcnt lgkmcnt(2)
    v_mfma_f32_16x16x32_bf16 v[24:27], v[88:91], v[72:75], v[24:27]
    s_waitcnt lgkmcnt(1)
    v_mfma_f32_16x16x32_bf16 v[28:31], v[76:79], v[72:75], v[28:31]
    s_waitcnt lgkmcnt(0)
    v_mfma_f32_16x16x32_bf16 v[32:35], v[80:83], v[72:75], v[32:35]
    v_and_b32 v9, 15, v0
    v_lshrrev_b32 v10, 4, v0
    s_mul_i32 s89, s60, 5120
    s_mov_b32 s88, 113664
    s_cmp_lt_u32 s60, 2
    s_cselect_b32 s88, s88, 125952
    s_add_u32 s89, s89, s88
    v_add_u32 v15, s89, v1
    v_lshlrev_b32 v14, 4, v10
    v_add_u32 v14, 156288, v14
    v_lshlrev_b32 v11, 3, v10
    s_add_u32 s89, s30, 153600
    v_add_u32 v11, s89, v11
    v_lshrrev_b32 v8, 1, v10
    v_lshlrev_b32 v8, 8, v8
    v_lshl_add_u32 v8, v9, 4, v8
    v_and_b32 v10, 1, v10
    v_lshl_add_u32 v8, v10, 3, v8
    s_mul_i32 s89, s73, 2560
    s_add_u32 s86, s86, s89
    s_add_u32 s86, s86, 81920
    v_lshlrev_b32 v9, 4, v9
    s_lshl_b32 s87, s60, 11
    s_add_u32 s87, s87, s78
    s_lshl_b32 s89, s73, 8
    s_add_u32 s87, s87, s89
    s_lshl_b32 s89, s85, 3
    s_add_u32 s87, s87, s89
    s_add_u32 s87, s87, 163840
    s_cmp_eq_u32 s85, 1
    s_cbranch_scc1 L_p3_b1
    ds_write_b128 v15, v[28:31] offset:3072
    ds_write_b128 v15, v[32:35] offset:4096
    ds_read_b128 v[44:47], v14 offset:0
    ds_read_b64 v[56:57], v11 offset:0
    ds_read_b128 v[48:51], v14 offset:64
    ds_read_b64 v[58:59], v11 offset:32
    ds_read_b128 v[52:55], v14 offset:128
    ds_read_b64 v[60:61], v11 offset:64
    v_lshlrev_b32 v36, 16, v92
    v_and_b32 v37, 0xffff0000, v92
    v_lshlrev_b32 v38, 16, v93
    v_and_b32 v39, 0xffff0000, v93
    v_lshlrev_b32 v40, 16, v94
    v_and_b32 v41, 0xffff0000, v94
    v_lshlrev_b32 v42, 16, v95
    v_and_b32 v43, 0xffff0000, v95
    v_lshlrev_b32 v76, 16, v12
    v_and_b32 v77, 0xffff0000, v12
    v_lshlrev_b32 v78, 16, v13
    v_and_b32 v79, 0xffff0000, v13
    s_waitcnt lgkmcnt(0)
    v_fma_f32 v84, v44, v16, v36
    v_fma_f32 v85, v45, v17, v37
    v_fma_f32 v86, v46, v18, v38
    v_fma_f32 v87, v47, v19, v39
    v_fma_f32 v88, v48, v20, v40
    v_fma_f32 v89, v49, v21, v41
    v_fma_f32 v90, v50, v22, v42
    v_fma_f32 v91, v51, v23, v43
    v_fma_f32 v92, v52, v24, v76
    v_fma_f32 v93, v53, v25, v77
    v_fma_f32 v94, v54, v26, v78
    v_fma_f32 v95, v55, v27, v79
    v_lshlrev_b32 v80, 16, v56
    v_and_b32 v81, 0xffff0000, v56
    v_lshlrev_b32 v82, 16, v57
    v_and_b32 v83, 0xffff0000, v57
    v_lshlrev_b32 v28, 16, v58
    v_and_b32 v29, 0xffff0000, v58
    v_lshlrev_b32 v30, 16, v59
    v_and_b32 v31, 0xffff0000, v59
    v_lshlrev_b32 v32, 16, v60
    v_and_b32 v33, 0xffff0000, v60
    v_lshlrev_b32 v34, 16, v61
    v_and_b32 v35, 0xffff0000, v61
    s_barrier
    ds_read_b128 v[64:67], v15 offset:0
    ds_read_b128 v[68:71], v15 offset:1024
    ds_read_b128 v[72:75], v15 offset:2048
    s_waitcnt lgkmcnt(2)
    v_fmac_f32 v84, v44, v64
    v_fmac_f32 v85, v45, v65
    v_fmac_f32 v86, v46, v66
    v_fmac_f32 v87, v47, v67
    v_mul_f32 v64, v80, v84
    v_mul_f32 v65, v81, v85
    v_mul_f32 v66, v82, v86
    v_mul_f32 v67, v83, v87
    v_cvt_pk_bf16_f32 v64, v64, v65
    v_cvt_pk_bf16_f32 v65, v66, v67
    s_waitcnt lgkmcnt(1)
    v_fmac_f32 v88, v48, v68
    v_fmac_f32 v89, v49, v69
    v_fmac_f32 v90, v50, v70
    v_fmac_f32 v91, v51, v71
    v_mul_f32 v68, v28, v88
    v_mul_f32 v69, v29, v89
    v_mul_f32 v70, v30, v90
    v_mul_f32 v71, v31, v91
    v_cvt_pk_bf16_f32 v68, v68, v69
    v_cvt_pk_bf16_f32 v69, v70, v71
    s_waitcnt lgkmcnt(0)
    v_fmac_f32 v92, v52, v72
    v_fmac_f32 v93, v53, v73
    v_fmac_f32 v94, v54, v74
    v_fmac_f32 v95, v55, v75
    v_mul_f32 v72, v32, v92
    v_mul_f32 v73, v33, v93
    v_mul_f32 v74, v34, v94
    v_mul_f32 v75, v35, v95
    v_cvt_pk_bf16_f32 v72, v72, v73
    v_cvt_pk_bf16_f32 v73, v74, v75
    s_cmp_eq_u32 s76, 1
    s_cbranch_scc0 L_far_111
    buffer_store_dwordx2 v[64:65], v8, s[32:35], s86 offen offset:0
    buffer_store_dwordx2 v[68:69], v8, s[32:35], s86 offen offset:512
    buffer_store_dwordx2 v[72:73], v8, s[32:35], s86 offen offset:1024
L_pub_112:
    v_add_f32 v36, v84, v85
    v_mul_f32 v37, v84, v84
    v_add_f32 v38, v86, v87
    v_mul_f32 v39, v85, v85
    v_fmac_f32 v37, v86, v86
    v_fmac_f32 v39, v87, v87
    v_fmac_f32 v37, v88, v88
    v_add_f32 v36, v36, v88
    v_fmac_f32 v39, v89, v89
    v_add_f32 v38, v38, v89
    v_fmac_f32 v37, v90, v90
    v_add_f32 v36, v36, v90
    v_fmac_f32 v39, v91, v91
    v_add_f32 v38, v38, v91
    v_fmac_f32 v37, v92, v92
    v_add_f32 v36, v36, v92
    v_fmac_f32 v39, v93, v93
    v_add_f32 v38, v38, v93
    v_fmac_f32 v37, v94, v94
    v_add_f32 v36, v36, v94
    v_fmac_f32 v39, v95, v95
    v_add_f32 v38, v38, v95
    v_add_f32 v36, v36, v38
    v_add_f32 v37, v37, v39
    s_nop 1
    v_permlane16_swap_b32 v36, v37
    v_add_f32 v36, v36, v37
    v_mov_b32 v38, v36
    s_nop 1
    v_permlane32_swap_b32 v36, v38
    v_add_f32 v36, v36, v38
    v_mov_b32 v37, v36
    s_nop 1
    v_permlane16_swap_b32 v36, v37
    s_mov_b64 exec, 0xffff
    s_cmp_eq_u32 s76, 1
    s_cbranch_scc0 L_far_113
    buffer_store_dwordx2 v[36:37], v9, s[32:35], s87 offen
L_pub_114:
    s_mov_b64 exec, -1
    s_branch L_p3_done
L_p3_b1:
    ds_write_b128 v15, v[16:19] offset:0
    ds_write_b128 v15, v[20:23] offset:1024
    ds_write_b128 v15, v[24:27] offset:2048
    ds_read_b128 v[44:47], v14 offset:192
    ds_read_b64 v[56:57], v11 offset:96
    ds_read_b128 v[48:51], v14 offset:256
    ds_read_b64 v[58:59], v11 offset:128
    v_lshlrev_b32 v36, 16, v92
    v_and_b32 v37, 0xffff0000, v92
    v_lshlrev_b32 v38, 16, v93
    v_and_b32 v39, 0xffff0000, v93
    v_lshlrev_b32 v40, 16, v94
    v_and_b32 v41, 0xffff0000, v94
    v_lshlrev_b32 v42, 16, v95
    v_and_b32 v43, 0xffff0000, v95
    s_waitcnt lgkmcnt(0)
    v_fma_f32 v84, v44, v28, v36
    v_fma_f32 v85, v45, v29, v37
    v_fma_f32 v86, v46, v30, v38
    v_fma_f32 v87, v47, v31, v39
    v_fma_f32 v88, v48, v32, v40
    v_fma_f32 v89, v49, v33, v41
    v_fma_f32 v90, v50, v34, v42
    v_fma_f32 v91, v51, v35, v43
    v_lshlrev_b32 v80, 16, v56
    v_and_b32 v81, 0xffff0000, v56
    v_lshlrev_b32 v82, 16, v57
    v_and_b32 v83, 0xffff0000, v57
    v_lshlrev_b32 v16, 16, v58
    v_and_b32 v17, 0xffff0000, v58
    v_lshlrev_b32 v18, 16, v59
    v_and_b32 v19, 0xffff0000, v59
    s_barrier
    ds_read_b128 v[64:67], v15 offset:3072
    ds_read_b128 v[68:71], v15 offset:4096
    s_waitcnt lgkmcnt(1)
    v_fmac_f32 v84, v44, v64
    v_fmac_f32 v85, v45, v65
    v_fmac_f32 v86, v46, v66
    v_fmac_f32 v87, v47, v67
    v_mul_f32 v64, v80, v84
    v_mul_f32 v65, v81, v85
    v_mul_f32 v66, v82, v86
    v_mul_f32 v67, v83, v87
    v_cvt_pk_bf16_f32 v64, v64, v65
    v_cvt_pk_bf16_f32 v65, v66, v67
    s_waitcnt lgkmcnt(0)
    v_fmac_f32 v88, v48, v68
    v_fmac_f32 v89, v49, v69
    v_fmac_f32 v90, v50, v70
    v_fmac_f32 v91, v51, v71
    v_mul_f32 v68, v16, v88
    v_mul_f32 v69, v17, v89
    v_mul_f32 v70, v18, v90
    v_mul_f32 v71, v19, v91
    v_cvt_pk_bf16_f32 v68, v68, v69
    v_cvt_pk_bf16_f32 v69, v70, v71
    s_cmp_eq_u32 s76, 1
    s_cbranch_scc0 L_far_115
    buffer_store_dwordx2 v[64:65], v8, s[32:35], s86 offen offset:1536
    buffer_store_dwordx2 v[68:69], v8, s[32:35], s86 offen offset:2048
L_pub_116:
    v_add_f32 v36, v84, v85
    v_mul_f32 v37, v84, v84
    v_add_f32 v38, v86, v87
    v_mul_f32 v39, v85, v85
    v_fmac_f32 v37, v86, v86
    v_fmac_f32 v39, v87, v87
    v_fmac_f32 v37, v88, v88
    v_add_f32 v36, v36, v88
    v_fmac_f32 v39, v89, v89
    v_add_f32 v38, v38, v89
    v_fmac_f32 v37, v90, v90
    v_add_f32 v36, v36, v90
    v_fmac_f32 v39, v91, v91
    v_add_f32 v38, v38, v91
    v_add_f32 v36, v36, v38
    v_add_f32 v37, v37, v39
    s_nop 1
    v_permlane16_swap_b32 v36, v37
    v_add_f32 v36, v36, v37
    v_mov_b32 v38, v36
    s_nop 1
    v_permlane32_swap_b32 v36, v38
    v_add_f32 v36, v36, v38
    v_mov_b32 v37, v36
    s_nop 1
    v_permlane16_swap_b32 v36, v37
    s_mov_b64 exec, 0xffff
    s_cmp_eq_u32 s76, 1
    s_cbranch_scc0 L_far_117
    buffer_store_dwordx2 v[36:37], v9, s[32:35], s87 offen
L_pub_118:
    s_mov_b64 exec, -1
L_p3_done:
    v_lshrrev_b32 v10, 4, v0
    v_lshl_add_u32 v9, v10, 9, v9
    s_lshl_b32 s86, s60, 11
    s_add_u32 s86, s86, s78
    s_add_u32 s86, s86, 163840
    s_mul_i32 s87, s60, 20480
    s_mul_i32 s88, s85, 10240
    s_add_u32 s87, s87, s88
    s_add_u32 s88, s87, s78
    s_add_u32 s88, s88, 81920
    s_cmp_eq_u32 s85, 0
    s_cbranch_scc1 L_skip_ab1
    s_mov_b32 s89, s88
    v_bfe_u32 v14, v0, 3, 1
    v_mul_u32_u24 v11, 1344, v14
    v_lshrrev_b32 v15, 4, v0
    v_lshl_add_u32 v11, v15, 4, v11
    v_add_u32 v11, 153600, v11
    ds_read_b128 v[56:59], v11 offset:0
    ds_read_b128 v[60:63], v11 offset:64
    ds_read_b128 v[64:67], v11 offset:128
    ds_read_b128 v[68:71], v11 offset:192
    v_lshlrev_b32 v14, 6, v14
    v_lshl_add_u32 v14, v15, 4, v14
    s_lshl_b32 s88, s74, 8
    s_add_u32 s88, s88, 157696
    v_add_u32 v14, s88, v14
    s_waitcnt lgkmcnt(3)
    v_mfma_f32_16x16x32_bf16 v[16:19], v[96:99], v[56:59], 0
    v_mfma_f32_16x16x32_bf16 v[20:23], v[176:179], v[56:59], 0
    ds_read_b128 v[56:59], v11 offset:256
    s_waitcnt lgkmcnt(3)
    v_mfma_f32_16x16x32_bf16 v[16:19], v[100:103], v[60:63], v[16:19]
    v_mfma_f32_16x16x32_bf16 v[20:23], v[180:183], v[60:63], v[20:23]
    ds_read_b128 v[60:63], v11 offset:320
    s_waitcnt lgkmcnt(3)
    v_mfma_f32_16x16x32_bf16 v[16:19], v[104:107], v[64:67], v[16:19]
    v_mfma_f32_16x16x32_bf16 v[20:23], v[184:187], v[64:67], v[20:23]
    ds_read_b128 v[64:67], v11 offset:384
    s_waitcnt lgkmcnt(3)
    v_mfma_f32_16x16x32_bf16 v[16:19], v[108:111], v[68:71], v[16:19]
    v_mfma_f32_16x16x32_bf16 v[20:23], v[188:191], v[68:71], v[20:23]
    ds_read_b128 v[68:71], v11 offset:448
    s_waitcnt lgkmcnt(3)
    v_mfma_f32_16x16x32_bf16 v[16:19], v[112:115], v[56:59], v[16:19]
    v_mfma_f32_16x16x32_bf16 v[20:23], v[192:195], v[56:59], v[20:23]
    ds_read_b128 v[56:59], v11 offset:512
    s_waitcnt lgkmcnt(3)
    v_mfma_f32_16x16x32_bf16 v[16:19], v[116:119], v[60:63], v[16:19]
    v_mfma_f32_16x16x32_bf16 v[20:23], v[196:199], v[60:63], v[20:23]
    ds_read_b128 v[60:63], v11 offset:576
    s_waitcnt lgkmcnt(3)
    v_mfma_f32_16x16x32_bf16 v[16:19], v[120:123], v[64:67], v[16:19]
    v_mfma_f32_16x16x32_bf16 v[20:23], v[200:203], v[64:67], v[20:23]
    ds_read_b128 v[64:67], v11 offset:640
    s_waitcnt lgkmcnt(3)
    v_mfma_f32_16x16x32_bf16 v[16:19], v[124:127], v[68:71], v[16:19]
    v_mfma_f32_16x16x32_bf16 v[20:23], v[204:207], v[68:71], v[20:23]
    ds_read_b128 v[68:71], v11 offset:704
    s_waitcnt lgkmcnt(3)
    v_mfma_f32_16x16x32_bf16 v[16:19], v[128:131], v[56:59], v[16:19]
    v_mfma_f32_16x16x32_bf16 v[20:23], v[208:211], v[56:59], v[20:23]
    ds_read_b128 v[56:59], v11 offset:768
    s_waitcnt lgkmcnt(3)
    v_mfma_f32_16x16x32_bf16 v[16:19], v[132:135], v[60:63], v[16:19]
    v_mfma_f32_16x16x32_bf16 v[20:23], v[212:215], v[60:63], v[20:23]
    ds_read_b128 v[60:63], v11 offset:832
    buffer_load_dwordx4 v[32:35], v9, s[32:35], s86 offen sc1
    buffer_load_dwordx4 v[36:39], v9, s[32:35], s86 offen offset:256 sc1
    s_waitcnt lgkmcnt(3)
    v_mfma_f32_16x16x32_bf16 v[16:19], v[136:139], v[64:67], v[16:19]
    v_mfma_f32_16x16x32_bf16 v[20:23], v[216:219], v[64:67], v[20:23]
    ds_read_b128 v[64:67], v11 offset:896
    s_waitcnt lgkmcnt(3)
    v_mfma_f32_16x16x32_bf16 v[16:19], v[140:143], v[68:71], v[16:19]
    v_mfma_f32_16x16x32_bf16 v[20:23], v[220:223], v[68:71], v[20:23]
    ds_read_b128 v[68:71], v11 offset:960
    s_waitcnt lgkmcnt(3)
    v_mfma_f32_16x16x32_bf16 v[16:19], v[144:147], v[56:59], v[16:19]
    v_mfma_f32_16x16x32_bf16 v[20:23], v[224:227], v[56:59], v[20:23]
    ds_read_b128 v[56:59], v11 offset:1024
    s_waitcnt lgkmcnt(3)
    v_mfma_f32_16x16x32_bf16 v[16:19], v[148:151], v[60:63], v[16:19]
    v_mfma_f32_16x16x32_bf16 v[20:23], v[228:231], v[60:63], v[20:23]
    ds_read_b128 v[60:63], v11 offset:1088
    s_waitcnt lgkmcnt(3)
    v_mfma_f32_16x16x32_bf16 v[16:19], v[152:155], v[64:67], v[16:19]
    v_mfma_f32_16x16x32_bf16 v[20:23], v[232:235], v[64:67], v[20:23]
    ds_read_b128 v[64:67], v11 offset:1152
    s_waitcnt lgkmcnt(3)
    v_mfma_f32_16x16x32_bf16 v[16:19], v[156:159], v[68:71], v[16:19]
    v_mfma_f32_16x16x32_bf16 v[20:23], v[236:239], v[68:71], v[20:23]
    ds_read_b128 v[68:71], v11 offset:1216
    s_waitcnt lgkmcnt(3)
    v_mfma_f32_16x16x32_bf16 v[16:19], v[160:163], v[56:59], v[16:19]
    v_mfma_f32_16x16x32_bf16 v[20:23], v[240:243], v[56:59], v[20:23]
    s_waitcnt lgkmcnt(2)
    v_mfma_f32_16x16x32_bf16 v[16:19], v[164:167], v[60:63], v[16:19]
    v_mfma_f32_16x16x32_bf16 v[20:23], v[244:247], v[60:63], v[20:23]
    s_waitcnt lgkmcnt(1)
    v_mfma_f32_16x16x32_bf16 v[16:19], v[168:171], v[64:67], v[16:19]
    v_mfma_f32_16x16x32_bf16 v[20:23], v[248:251], v[64:67], v[20:23]
    s_waitcnt lgkmcnt(0)
    v_mfma_f32_16x16x32_bf16 v[16:19], v[172:175], v[68:71], v[16:19]
    v_mfma_f32_16x16x32_bf16 v[20:23], v[252:255], v[68:71], v[20:23]
    s_mov_b32 exec_lo, 0x01010101
    s_mov_b32 exec_hi, 0x01010101
    s_nop 4
    ds_write_b128 v14, v[16:19]
    ds_write_b128 v14, v[20:23] offset:128
    s_mov_b64 exec, -1
    s_waitcnt lgkmcnt(0)
    s_mov_b32 s88, s89
    s_branch L_stspin
L_skip_ab1:
    buffer_load_dwordx4 v[32:35], v9, s[32:35], s86 offen sc1
    buffer_load_dwordx4 v[36:39], v9, s[32:35], s86 offen offset:256 sc1
L_stspin:
    buffer_load_dwordx4 v[40:43], v9, s[32:35], s86 offen sc1
    buffer_load_dwordx4 v[44:47], v9, s[32:35], s86 offen offset:256 sc1
    s_waitcnt vmcnt(2)
    v_max_u32 v11, v32, v34
    v_max3_u32 v11, v11, v36, v38
    v_cmp_eq_u32 vcc, -1, v11
    s_cbranch_vccz L_stok
    buffer_load_dwordx4 v[32:35], v9, s[32:35], s86 offen sc1
    buffer_load_dwordx4 v[36:39], v9, s[32:35], s86 offen offset:256 sc1
    s_waitcnt vmcnt(2)
    v_max_u32 v11, v40, v42
    v_max3_u32 v11, v11, v44, v46
    v_cmp_eq_u32 vcc, -1, v11
    s_cbranch_vccz L_stok2
    s_cbranch_vccz L_spinout_119
    s_sub_u32 s77, s77, 1
    s_cbranch_scc1 L_spinout_119_x
    s_branch L_stspin
L_spinout_119_x:
    s_mov_b32 s77, 0
L_spinout_119:
L_stok2:
    s_waitcnt vmcnt(0)
L_stok:
    s_add_u32 m0, s87, 0
    s_add_u32 s89, s88, 0
    buffer_load_dwordx4 v1, s[32:35], s89 offen offset:0 sc1 lds
    buffer_load_dwordx4 v1, s[32:35], s89 offen offset:1024 sc1 lds
    buffer_load_dwordx4 v1, s[32:35], s89 offen offset:2048 sc1 lds
    buffer_load_dwordx4 v1, s[32:35], s89 offen offset:3072 sc1 lds
    s_add_u32 m0, s87, 4096
    s_add_u32 s89, s88, 4096
    buffer_load_dwordx4 v1, s[32:35], s89 offen offset:0 sc1 lds
    buffer_load_dwordx4 v1, s[32:35], s89 offen offset:1024 sc1 lds
    buffer_load_dwordx4 v1, s[32:35], s89 offen offset:2048 sc1 lds
    buffer_load_dwordx4 v1, s[32:35], s89 offen offset:3072 sc1 lds
    s_add_u32 m0, s87, 8192
    s_add_u32 s89, s88, 8192
    buffer_load_dwordx4 v1, s[32:35], s89 offen offset:0 sc1 lds
    buffer_load_dwordx4 v1, s[32:35], s89 offen offset:1024 sc1 lds
    s_lshl_b32 s89, s74, 8
    s_add_u32 s89, s89, 157696
    v_lshl_add_u32 v11, v10, 4, s89
    ds_read_b128 v[16:19], v11 offset:0
    ds_read_b128 v[20:23], v11 offset:64
    ds_read_b128 v[24:27], v11 offset:128
    ds_read_b128 v[28:31], v11 offset:192
    v_add_f32 v32, v32, v34
    v_add_f32 v33, v33, v35
    v_add_f32 v36, v36, v38
    v_add_f32 v37, v37, v39
    v_add_f32 v32, v32, v36
    v_add_f32 v33, v33, v37
    s_nop 1
    v_permlane16_swap_b32 v32, v33
    v_add_f32 v32, v32, v33
    v_mov_b32 v34, v32
    s_nop 1
    v_permlane32_swap_b32 v32, v34
    v_add_f32 v32, v32, v34
    v_mov_b32 v33, v32
    s_nop 1
    v_permlane16_swap_b32 v32, v33
    v_mul_f32 v32, 0x3acccccd, v32
    v_mul_f32 v33, 0x3acccccd, v33
    v_fma_f32 v33, -v32, v32, v33
    v_max_f32 v33, 0, v33
    v_add_f32 v33, 0x3727c5ac, v33
    v_rsq_f32 v34, v33
    v_and_b32 v9, 15, v0
    v_sub_f32 v35, 0, v32
    v_mul_f32 v34, 0xbfb8aa3b, v34
    v_lshlrev_b32 v14, 3, v9
    v_add_u32 v14, 157184, v14
    s_lshl_b32 s89, s60, 7
    v_add_u32 v10, s89, v14
    ds_write_b64 v10, v[34:35]
    v_add_u32 v15, 40960, v1
    s_mul_i32 s91, s84, 3
    s_mul_i32 s92, s73, 12
    s_add_u32 s91, s91, s92
    s_add_u32 s91, s91, 1
    s_lshl_b32 s91, s91, 9
    s_add_u32 s91, s91, s78
    s_add_u32 s94, s91, 172032
    s_lshl_b32 s91, s85, 10
    s_sub_u32 s91, s91, 512
    s_add_u32 s95, s94, s91
    v_mov_b32 v80, v8
    v_add_u32 v10, s87, v1
    s_waitcnt lgkmcnt(0)
    v_mul_f32 v20, 0xbfb8aa3b, v20
    v_mul_f32 v21, 0xbfb8aa3b, v21
    v_mul_f32 v22, 0xbfb8aa3b, v22
    v_mul_f32 v23, 0xbfb8aa3b, v23
    v_mul_f32 v28, 0xbfb8aa3b, v28
    v_mul_f32 v29, 0xbfb8aa3b, v29
    v_mul_f32 v30, 0xbfb8aa3b, v30
    v_mul_f32 v31, 0xbfb8aa3b, v31
    s_waitcnt vmcnt(5)
    ds_read_b128 v[48:51], v10 offset:0
    ds_read_b128 v[52:55], v10 offset:1024
    ds_read_b128 v[56:59], v10 offset:2048
    ds_read_b128 v[60:63], v10 offset:3072
    ds_read_b128 v[64:67], v10 offset:4096
    s_waitcnt lgkmcnt(0)
    v_max_u32 v11, v49, v51
    v_max3_u32 v11, v11, v53, v55
    v_max3_u32 v11, v11, v57, v59
    v_max3_u32 v11, v11, v61, v63
    v_max3_u32 v11, v11, v65, v67
    s_waitcnt vmcnt(0)
    ds_read_b128 v[48:51], v10 offset:5120
    ds_read_b128 v[52:55], v10 offset:6144
    ds_read_b128 v[56:59], v10 offset:7168
    ds_read_b128 v[60:63], v10 offset:8192
    ds_read_b128 v[64:67], v10 offset:9216
    s_waitcnt lgkmcnt(0)
    v_max3_u32 v11, v11, v49, v51
    v_max3_u32 v11, v11, v53, v55
    v_max3_u32 v11, v11, v57, v59
    v_max3_u32 v11, v11, v61, v63
    v_max3_u32 v11, v11, v65, v67
    v_cmp_eq_u32 vcc, -1, v11
    s_cbranch_vccnz L_xaretry
L_xaok:
    s_barrier
    s_cmp_eq_u32 s85, 1
    s_cbranch_scc1 L_p4_b1
    ds_read_b64 v[8:9], v14 offset:0
    ds_read_b64 v[10:11], v14 offset:128
    ds_read_b64 v[12:13], v14 offset:256
    ds_read_b64 v[82:83], v14 offset:384
    ds_read_b128 v[48:51], v1 offset:0
    ds_read_b128 v[52:55], v1 offset:1024
    ds_read_b128 v[56:59], v1 offset:2048
    ds_read_b128 v[60:63], v1 offset:3072
    ds_read_b128 v[64:67], v1 offset:4096
    ds_read_b128 v[68:71], v1 offset:5120
    s_waitcnt lgkmcnt(6)
    v_mul_f32 v32, v9, v16
    v_mul_f32 v33, v9, v17
    v_mul_f32 v34, v9, v18
    v_mul_f32 v35, v9, v19
    v_mul_f32 v40, v9, v24
    v_mul_f32 v41, v9, v25
    v_mul_f32 v42, v9, v26
    v_mul_f32 v43, v9, v27
    s_setprio 1
    s_waitcnt lgkmcnt(5)
    v_mfma_f32_16x16x32_bf16 v[32:35], v[96:99], v[48:51], v[32:35]
    v_mfma_f32_16x16x32_bf16 v[40:43], v[176:179], v[48:51], v[40:43]
    ds_read_b128 v[48:51], v1 offset:6144
    s_add_u32 s82, s84, 0
    s_and_b32 s83, s82, 1
    s_mul_i32 s83, s83, 24
    s_lshr_b32 s82, s82, 1
    s_add_u32 s82, s82, s83
    s_mul_i32 s82, s82, 5120
    s_add_u32 s82, s82, s28
    s_add_u32 s82, s82, 102400
    s_mul_i32 s83, s84, 5120
    s_add_u32 m0, s83, 102400
    s_nop 0
    buffer_load_dwordx4 v1, s[32:35], s82 offen offset:0 sc1 lds
    s_waitcnt lgkmcnt(5)
    v_mfma_f32_16x16x32_bf16 v[32:35], v[100:103], v[52:55], v[32:35]
    v_mfma_f32_16x16x32_bf16 v[40:43], v[180:183], v[52:55], v[40:43]
    ds_read_b128 v[52:55], v1 offset:7168
    s_waitcnt lgkmcnt(5)
    v_mfma_f32_16x16x32_bf16 v[32:35], v[104:107], v[56:59], v[32:35]
    v_mul_f32 v36, v11, v16
    v_mfma_f32_16x16x32_bf16 v[40:43], v[184:187], v[56:59], v[40:43]
    ds_read_b128 v[56:59], v1 offset:8192
    v_mul_f32 v37, v11, v17
    s_waitcnt lgkmcnt(5)
    v_mfma_f32_16x16x32_bf16 v[32:35], v[108:111], v[60:63], v[32:35]
    v_mul_f32 v38, v11, v18
    v_mfma_f32_16x16x32_bf16 v[40:43], v[188:191], v[60:63], v[40:43]
    ds_read_b128 v[60:63], v1 offset:9216
    buffer_load_dwordx4 v1, s[32:35], s82 offen offset:1024 sc1 lds
    v_mul_f32 v39, v11, v19
    s_waitcnt lgkmcnt(5)
    v_mfma_f32_16x16x32_bf16 v[32:35], v[112:115], v[64:67], v[32:35]
    v_mul_f32 v44, v11, v24
    v_mfma_f32_16x16x32_bf16 v[40:43], v[192:195], v[64:67], v[40:43]
    ds_read_b128 v[64:67], v1 offset:10240
    v_mul_f32 v45, v11, v25
    s_waitcnt lgkmcnt(5)
    v_mfma_f32_16x16x32_bf16 v[32:35], v[116:119], v[68:71], v[32:35]
    v_mul_f32 v46, v11, v26
    v_mfma_f32_16x16x32_bf16 v[40:43], v[196:199], v[68:71], v[40:43]
    ds_read_b128 v[68:71], v1 offset:11264
    v_mul_f32 v47, v11, v27
    s_waitcnt lgkmcnt(5)
    v_mfma_f32_16x16x32_bf16 v[32:35], v[120:123], v[48:51], v[32:35]
    v_mfma_f32_16x16x32_bf16 v[40:43], v[200:203], v[48:51], v[40:43]
    ds_read_b128 v[48:51], v1 offset:12288
    buffer_load_dwordx4 v1, s[32:35], s82 offen offset:2048 sc1 lds
    s_waitcnt lgkmcnt(5)
    v_mfma_f32_16x16x32_bf16 v[32:35], v[124:127], v[52:55], v[32:35]
    v_mfma_f32_16x16x32_bf16 v[40:43], v[204:207], v[52:55], v[40:43]
    ds_read_b128 v[52:55], v1 offset:13312
    s_waitcnt lgkmcnt(5)
    v_mfma_f32_16x16x32_bf16 v[32:35], v[128:131], v[56:59], v[32:35]
    v_mfma_f32_16x16x32_bf16 v[40:43], v[208:211], v[56:59], v[40:43]
    ds_read_b128 v[56:59], v1 offset:14336
    s_waitcnt lgkmcnt(5)
    v_mfma_f32_16x16x32_bf16 v[32:35], v[132:135], v[60:63], v[32:35]
    v_mfma_f32_16x16x32_bf16 v[40:43], v[212:215], v[60:63], v[40:43]
    ds_read_b128 v[60:63], v1 offset:15360
    buffer_load_dwordx4 v1, s[32:35], s82 offen offset:3072 sc1 lds
    s_waitcnt lgkmcnt(5)
    v_mfma_f32_16x16x32_bf16 v[32:35], v[136:139], v[64:67], v[32:35]
    v_mfma_f32_16x16x32_bf16 v[40:43], v[216:219], v[64:67], v[40:43]
    ds_read_b128 v[64:67], v1 offset:16384
    s_waitcnt lgkmcnt(5)
    v_mfma_f32_16x16x32_bf16 v[32:35], v[140:143], v[68:71], v[32:35]
    v_mfma_f32_16x16x32_bf16 v[40:43], v[220:223], v[68:71], v[40:43]
    ds_read_b128 v[68:71], v1 offset:17408
    s_waitcnt lgkmcnt(5)
    v_mfma_f32_16x16x32_bf16 v[32:35], v[144:147], v[48:51], v[32:35]
    v_mfma_f32_16x16x32_bf16 v[40:43], v[224:227], v[48:51], v[40:43]
    ds_read_b128 v[48:51], v1 offset:18432
    s_add_u32 m0, m0, 4096
    s_add_u32 s82, s82, 4096
    buffer_load_dwordx4 v1, s[32:35], s82 offen offset:0 sc1 lds
    s_waitcnt lgkmcnt(5)
    v_mfma_f32_16x16x32_bf16 v[32:35], v[148:151], v[52:55], v[32:35]
    v_mfma_f32_16x16x32_bf16 v[40:43], v[228:231], v[52:55], v[40:43]
    ds_read_b128 v[52:55], v1 offset:19456
    s_waitcnt lgkmcnt(5)
    v_mfma_f32_16x16x32_bf16 v[32:35], v[152:155], v[56:59], v[32:35]
    v_mfma_f32_16x16x32_bf16 v[40:43], v[232:235], v[56:59], v[40:43]
    ds_read_b128 v[56:59], v1 offset:20480
    s_waitcnt lgkmcnt(5)
    v_mfma_f32_16x16x32_bf16 v[32:35], v[156:159], v[60:63], v[32:35]
    v_mfma_f32_16x16x32_bf16 v[40:43], v[236:239], v[60:63], v[40:43]
    ds_read_b128 v[60:63], v1 offset:21504
    s_cmp_ge_u32 s84, 2
    s_cbranch_scc1 L_skip_w2_121
    s_add_u32 s82, s84, 8
    s_and_b32 s83, s82, 1
    s_mul_i32 s83, s83, 24
    s_lshr_b32 s82, s82, 1
    s_add_u32 s82, s82, s83
    s_mul_i32 s82, s82, 5120
    s_add_u32 s82, s82, s28
    s_add_u32 s82, s82, 102400
    s_mul_i32 s83, s84, 5120
    s_add_u32 m0, s83, 143360
    s_nop 0
    buffer_load_dwordx4 v1, s[32:35], s82 offen offset:0 sc1 lds
    buffer_load_dwordx4 v1, s[32:35], s82 offen offset:1024 sc1 lds
    buffer_load_dwordx4 v1, s[32:35], s82 offen offset:2048 sc1 lds
    buffer_load_dwordx4 v1, s[32:35], s82 offen offset:3072 sc1 lds
    s_add_u32 m0, m0, 4096
    s_add_u32 s82, s82, 4096
    buffer_load_dwordx4 v1, s[32:35], s82 offen offset:0 sc1 lds
L_skip_w2_121:
    s_waitcnt lgkmcnt(5)
    v_mfma_f32_16x16x32_bf16 v[32:35], v[160:163], v[64:67], v[32:35]
    v_mfma_f32_16x16x32_bf16 v[40:43], v[240:243], v[64:67], v[40:43]
    ds_read_b128 v[64:67], v1 offset:22528
    s_waitcnt lgkmcnt(5)
    v_mfma_f32_16x16x32_bf16 v[32:35], v[164:167], v[68:71], v[32:35]
    v_mfma_f32_16x16x32_bf16 v[40:43], v[244:247], v[68:71], v[40:43]
    ds_read_b128 v[68:71], v1 offset:23552
    s_waitcnt lgkmcnt(5)
    v_mfma_f32_16x16x32_bf16 v[32:35], v[168:171], v[48:51], v[32:35]
    v_mfma_f32_16x16x32_bf16 v[40:43], v[248:251], v[48:51], v[40:43]
    ds_read_b128 v[48:51], v1 offset:24576
    s_waitcnt lgkmcnt(5)
    v_mfma_f32_16x16x32_bf16 v[32:35], v[172:175], v[52:55], v[32:35]
    v_mfma_f32_16x16x32_bf16 v[40:43], v[252:255], v[52:55], v[40:43]
    ds_read_b128 v[52:55], v1 offset:25600
    s_setprio 1
    s_barrier
    s_waitcnt lgkmcnt(5)
    v_mfma_f32_16x16x32_bf16 v[36:39], v[96:99], v[56:59], v[36:39]
    v_mfma_f32_16x16x32_bf16 v[44:47], v[176:179], v[56:59], v[44:47]
    ds_read_b128 v[56:59], v1 offset:26624
    s_waitcnt lgkmcnt(5)
    v_mfma_f32_16x16x32_bf16 v[36:39], v[100:103], v[60:63], v[36:39]
    v_mfma_f32_16x16x32_bf16 v[44:47], v[180:183], v[60:63], v[44:47]
    ds_read_b128 v[60:63], v1 offset:27648
    s_add_u32 s82, s84, 14
    s_and_b32 s83, s82, 1
    s_mul_i32 s83, s83, 24
    s_lshr_b32 s82, s82, 1
    s_add_u32 s82, s82, s83
    s_mul_i32 s82, s82, 5120
    s_add_u32 s82, s82, s28
    s_add_u32 s82, s82, 102400
    s_mul_i32 s83, s84, 5120
    s_add_u32 m0, s83, 0
    s_nop 0
    buffer_load_dwordx4 v1, s[32:35], s82 offen offset:0 sc1 lds
    s_waitcnt lgkmcnt(5)
    v_mfma_f32_16x16x32_bf16 v[36:39], v[104:107], v[64:67], v[36:39]
    v_fma_f32 v40, v8, v40, v28
    v_fma_f32 v41, v8, v41, v29
    v_mfma_f32_16x16x32_bf16 v[44:47], v[184:187], v[64:67], v[44:47]
    ds_read_b128 v[64:67], v1 offset:28672
    v_fma_f32 v42, v8, v42, v30
    v_fma_f32 v43, v8, v43, v31
    s_waitcnt lgkmcnt(5)
    v_mfma_f32_16x16x32_bf16 v[36:39], v[108:111], v[68:71], v[36:39]
    v_exp_f32 v72, v40
    v_exp_f32 v73, v41
    v_mfma_f32_16x16x32_bf16 v[44:47], v[188:191], v[68:71], v[44:47]
    ds_read_b128 v[68:71], v1 offset:29696
    v_exp_f32 v74, v42
    v_exp_f32 v75, v43
    s_waitcnt lgkmcnt(5)
    v_mfma_f32_16x16x32_bf16 v[36:39], v[112:115], v[48:51], v[36:39]
    v_add_f32 v72, 1.0, v72
    v_add_f32 v73, 1.0, v73
    v_mfma_f32_16x16x32_bf16 v[44:47], v[192:195], v[48:51], v[44:47]
    ds_read_b128 v[48:51], v1 offset:30720
    buffer_load_dwordx4 v1, s[32:35], s82 offen offset:1024 sc1 lds
    v_add_f32 v74, 1.0, v74
    v_add_f32 v75, 1.0, v75
    s_waitcnt lgkmcnt(5)
    v_mfma_f32_16x16x32_bf16 v[36:39], v[116:119], v[52:55], v[36:39]
    v_rcp_f32 v72, v72
    v_rcp_f32 v73, v73
    v_mfma_f32_16x16x32_bf16 v[44:47], v[196:199], v[52:55], v[44:47]
    ds_read_b128 v[52:55], v1 offset:31744
    v_rcp_f32 v74, v74
    v_rcp_f32 v75, v75
    s_waitcnt lgkmcnt(5)
    v_mfma_f32_16x16x32_bf16 v[36:39], v[120:123], v[56:59], v[36:39]
    v_mul_f32 v40, v40, v72
    v_mul_f32 v41, v41, v73
    v_mfma_f32_16x16x32_bf16 v[44:47], v[200:203], v[56:59], v[44:47]
    ds_read_b128 v[56:59], v1 offset:32768
    v_mul_f32 v42, v42, v74
    v_mul_f32 v43, v43, v75
    s_waitcnt lgkmcnt(5)
    v_mfma_f32_16x16x32_bf16 v[36:39], v[124:127], v[60:63], v[36:39]
    v_cvt_pk_bf16_f32 v72, v40, v41
    v_cvt_pk_bf16_f32 v73, v42, v43
    v_mfma_f32_16x16x32_bf16 v[44:47], v[204:207], v[60:63], v[44:47]
    ds_read_b128 v[60:63], v1 offset:33792
    buffer_load_dwordx4 v1, s[32:35], s82 offen offset:2048 sc1 lds
    s_add_u32 s86, s94, 0
    s_cmp_eq_u32 s76, 1
    s_cbranch_scc0 L_far_123
    buffer_store_dwordx2 v[72:73], v80, s[32:35], s86 offen
L_pub_124:
    v_fma_f32 v32, v8, v32, v20
    s_waitcnt lgkmcnt(5)
    v_mfma_f32_16x16x32_bf16 v[36:39], v[128:131], v[64:67], v[36:39]
    v_fma_f32 v33, v8, v33, v21
    v_fma_f32 v34, v8, v34, v22
    v_mfma_f32_16x16x32_bf16 v[44:47], v[208:211], v[64:67], v[44:47]
    ds_read_b128 v[64:67], v1 offset:34816
    v_fma_f32 v35, v8, v35, v23
    v_exp_f32 v76, v32
    s_waitcnt lgkmcnt(5)
    v_mfma_f32_16x16x32_bf16 v[36:39], v[132:135], v[68:71], v[36:39]
    v_exp_f32 v77, v33
    v_exp_f32 v78, v34
    v_mfma_f32_16x16x32_bf16 v[44:47], v[212:215], v[68:71], v[44:47]
    ds_read_b128 v[68:71], v1 offset:35840
    v_exp_f32 v79, v35
    v_add_f32 v76, 1.0, v76
    s_waitcnt lgkmcnt(5)
    v_mfma_f32_16x16x32_bf16 v[36:39], v[136:139], v[48:51], v[36:39]
    v_add_f32 v77, 1.0, v77
    v_mfma_f32_16x16x32_bf16 v[44:47], v[216:219], v[48:51], v[44:47]
    ds_read_b128 v[48:51], v1 offset:36864
    buffer_load_dwordx4 v1, s[32:35], s82 offen offset:3072 sc1 lds
    v_add_f32 v78, 1.0, v78
    s_waitcnt lgkmcnt(5)
    v_mfma_f32_16x16x32_bf16 v[36:39], v[140:143], v[52:55], v[36:39]
    v_add_f32 v79, 1.0, v79
    v_mfma_f32_16x16x32_bf16 v[44:47], v[220:223], v[52:55], v[44:47]
    ds_read_b128 v[52:55], v1 offset:37888
    v_rcp_f32 v76, v76
    s_waitcnt lgkmcnt(5)
    v_mfma_f32_16x16x32_bf16 v[36:39], v[144:147], v[56:59], v[36:39]
    v_rcp_f32 v77, v77
    v_mfma_f32_16x16x32_bf16 v[44:47], v[224:227], v[56:59], v[44:47]
    ds_read_b128 v[56:59], v1 offset:38912
    v_rcp_f32 v78, v78
    s_waitcnt lgkmcnt(5)
    v_mfma_f32_16x16x32_bf16 v[36:39], v[148:151], v[60:63], v[36:39]
    v_rcp_f32 v79, v79
    v_mfma_f32_16x16x32_bf16 v[44:47], v[228:231], v[60:63], v[44:47]
    ds_read_b128 v[60:63], v1 offset:39936
    s_add_u32 m0, m0, 4096
    s_add_u32 s82, s82, 4096
    buffer_load_dwordx4 v1, s[32:35], s82 offen offset:0 sc1 lds
    v_mul_f32 v32, v32, v76
    s_waitcnt lgkmcnt(5)
    v_mfma_f32_16x16x32_bf16 v[36:39], v[152:155], v[64:67], v[36:39]
    v_mul_f32 v33, v33, v77
    v_mfma_f32_16x16x32_bf16 v[44:47], v[232:235], v[64:67], v[44:47]
    ds_read_b128 v[64:67], v15 offset:0
    v_mul_f32 v34, v34, v78
    s_waitcnt lgkmcnt(5)
    v_mfma_f32_16x16x32_bf16 v[36:39], v[156:159], v[68:71], v[36:39]
    v_mul_f32 v35, v35, v79
    v_mfma_f32_16x16x32_bf16 v[44:47], v[236:239], v[68:71], v[44:47]
    ds_read_b128 v[68:71], v15 offset:1024
    v_cvt_pk_bf16_f32 v76, v32, v33
    s_waitcnt lgkmcnt(5)
    v_mfma_f32_16x16x32_bf16 v[36:39], v[160:163], v[48:51], v[36:39]
    v_cvt_pk_bf16_f32 v77, v34, v35
    v_mfma_f32_16x16x32_bf16 v[44:47], v[240:243], v[48:51], v[44:47]
    ds_read_b128 v[48:51], v15 offset:2048
    s_add_u32 s86, s95, 0
    s_cmp_eq_u32 s76, 1
    s_cbranch_scc0 L_far_125
    buffer_store_dwordx2 v[76:77], v80, s[32:35], s86 offen
L_pub_126:
    s_waitcnt lgkmcnt(5)
    v_mfma_f32_16x16x32_bf16 v[36:39], v[164:167], v[52:55], v[36:39]
    v_mul_f32 v32, v13, v16
    v_mfma_f32_16x16x32_bf16 v[44:47], v[244:247], v[52:55], v[44:47]
    ds_read_b128 v[52:55], v15 offset:3072
    v_mul_f32 v33, v13, v17
    s_waitcnt lgkmcnt(5)
    v_mfma_f32_16x16x32_bf16 v[36:39], v[168:171], v[56:59], v[36:39]
    v_mul_f32 v34, v13, v18
    v_mfma_f32_16x16x32_bf16 v[44:47], v[248:251], v[56:59], v[44:47]
    ds_read_b128 v[56:59], v15 offset:4096
    v_mul_f32 v35, v13, v19
    s_waitcnt lgkmcnt(5)
    v_mfma_f32_16x16x32_bf16 v[36:39], v[172:175], v[60:63], v[36:39]
    v_mfma_f32_16x16x32_bf16 v[44:47], v[252:255], v[60:63], v[44:47]
    ds_read_b128 v[60:63], v15 offset:5120
    s_setprio 0
    s_barrier
    s_waitcnt lgkmcnt(5)
    v_mfma_f32_16x16x32_bf16 v[32:35], v[96:99], v[64:67], v[32:35]
    ds_read_b128 v[64:67], v15 offset:6144
    s_waitcnt lgkmcnt(5)
    v_mfma_f32_16x16x32_bf16 v[32:35], v[100:103], v[68:71], v[32:35]
    ds_read_b128 v[68:71], v15 offset:7168
    s_waitcnt lgkmcnt(5)
    v_mfma_f32_16x16x32_bf16 v[32:35], v[104:107], v[48:51], v[32:35]
    ds_read_b128 v[48:51], v15 offset:8192
    v_fma_f32 v44, v10, v44, v28
    v_fma_f32 v45, v10, v45, v29
    v_fma_f32 v46, v10, v46, v30
    s_waitcnt lgkmcnt(5)
    v_mfma_f32_16x16x32_bf16 v[32:35], v[108:111], v[52:55], v[32:35]
    ds_read_b128 v[52:55], v15 offset:9216
    v_fma_f32 v47, v10, v47, v31
    v_exp_f32 v72, v44
    v_exp_f32 v73, v45
    s_waitcnt lgkmcnt(5)
    v_mfma_f32_16x16x32_bf16 v[32:35], v[112:115], v[56:59], v[32:35]
    ds_read_b128 v[56:59], v15 offset:10240
    v_exp_f32 v74, v46
    v_exp_f32 v75, v47
    v_add_f32 v72, 1.0, v72
    s_waitcnt lgkmcnt(5)
    v_mfma_f32_16x16x32_bf16 v[32:35], v[116:119], v[60:63], v[32:35]
    ds_read_b128 v[60:63], v15 offset:11264
    v_add_f32 v73, 1.0, v73
    v_add_f32 v74, 1.0, v74
    v_add_f32 v75, 1.0, v75
    s_waitcnt lgkmcnt(5)
    v_mfma_f32_16x16x32_bf16 v[32:35], v[120:123], v[64:67], v[32:35]
    ds_read_b128 v[64:67], v15 offset:12288
    v_rcp_f32 v72, v72
    v_rcp_f32 v73, v73
    v_rcp_f32 v74, v74
    s_waitcnt lgkmcnt(5)
    v_mfma_f32_16x16x32_bf16 v[32:35], v[124:127], v[68:71], v[32:35]
    ds_read_b128 v[68:71], v15 offset:13312
    v_rcp_f32 v75, v75
    v_mul_f32 v44, v44, v72
    v_mul_f32 v45, v45, v73
    s_waitcnt lgkmcnt(5)
    v_mfma_f32_16x16x32_bf16 v[32:35], v[128:131], v[48:51], v[32:35]
    ds_read_b128 v[48:51], v15 offset:14336
    v_mul_f32 v46, v46, v74
    v_mul_f32 v47, v47, v75
    v_cvt_pk_bf16_f32 v72, v44, v45
    s_waitcnt lgkmcnt(5)
    v_mfma_f32_16x16x32_bf16 v[32:35], v[132:135], v[52:55], v[32:35]
    ds_read_b128 v[52:55], v15 offset:15360
    v_cvt_pk_bf16_f32 v73, v46, v47
    s_add_u32 s86, s94, 49152
    s_cmp_eq_u32 s76, 1
    s_cbranch_scc0 L_far_127
    buffer_store_dwordx2 v[72:73], v80, s[32:35], s86 offen
L_pub_128:
    v_fma_f32 v36, v10, v36, v20
    s_waitcnt lgkmcnt(5)
    v_mfma_f32_16x16x32_bf16 v[32:35], v[136:139], v[56:59], v[32:35]
    ds_read_b128 v[56:59], v15 offset:16384
    v_fma_f32 v37, v10, v37, v21
    v_fma_f32 v38, v10, v38, v22
    v_fma_f32 v39, v10, v39, v23
    s_waitcnt lgkmcnt(5)
    v_mfma_f32_16x16x32_bf16 v[32:35], v[140:143], v[60:63], v[32:35]
    ds_read_b128 v[60:63], v15 offset:17408
    v_exp_f32 v76, v36
    v_exp_f32 v77, v37
    v_exp_f32 v78, v38
    s_waitcnt lgkmcnt(5)
    v_mfma_f32_16x16x32_bf16 v[32:35], v[144:147], v[64:67], v[32:35]
    ds_read_b128 v[64:67], v15 offset:18432
    v_exp_f32 v79, v39
    v_add_f32 v76, 1.0, v76
    v_add_f32 v77, 1.0, v77
    s_waitcnt lgkmcnt(5)
    v_mfma_f32_16x16x32_bf16 v[32:35], v[148:151], v[68:71], v[32:35]
    ds_read_b128 v[68:71], v15 offset:19456
    v_add_f32 v78, 1.0, v78
    v_add_f32 v79, 1.0, v79
    v_rcp_f32 v76, v76
    s_waitcnt lgkmcnt(5)
    v_mfma_f32_16x16x32_bf16 v[32:35], v[152:155], v[48:51], v[32:35]
    ds_read_b128 v[48:51], v15 offset:20480
    v_rcp_f32 v77, v77
    v_rcp_f32 v78, v78
    v_rcp_f32 v79, v79
    s_waitcnt lgkmcnt(5)
    v_mfma_f32_16x16x32_bf16 v[32:35], v[156:159], v[52:55], v[32:35]
    ds_read_b128 v[52:55], v15 offset:21504
    v_mul_f32 v36, v36, v76
    v_mul_f32 v37, v37, v77
    v_mul_f32 v38, v38, v78
    s_waitcnt lgkmcnt(5)
    v_mfma_f32_16x16x32_bf16 v[32:35], v[160:163], v[56:59], v[32:35]
    ds_read_b128 v[56:59], v15 offset:22528
    v_mul_f32 v39, v39, v79
    v_cvt_pk_bf16_f32 v76, v36, v37
    v_cvt_pk_bf16_f32 v77, v38, v39
    s_waitcnt lgkmcnt(5)
    v_mfma_f32_16x16x32_bf16 v[32:35], v[164:167], v[60:63], v[32:35]
    ds_read_b128 v[60:63], v15 offset:23552
    s_add_u32 s86, s95, 49152
    s_cmp_eq_u32 s76, 1
    s_cbranch_scc0 L_far_129
    buffer_store_dwordx2 v[76:77], v80, s[32:35], s86 offen
L_pub_130:
    v_mul_f32 v36, v83, v16
    v_mul_f32 v37, v83, v17
    s_waitcnt lgkmcnt(5)
    v_mfma_f32_16x16x32_bf16 v[32:35], v[168:171], v[64:67], v[32:35]
    ds_read_b128 v[64:67], v15 offset:24576
    v_mul_f32 v38, v83, v18
    v_mul_f32 v39, v83, v19
    s_waitcnt lgkmcnt(5)
    v_mfma_f32_16x16x32_bf16 v[32:35], v[172:175], v[68:71], v[32:35]
    ds_read_b128 v[68:71], v15 offset:25600
    s_setprio 0
    s_barrier
    s_waitcnt lgkmcnt(5)
    v_mfma_f32_16x16x32_bf16 v[36:39], v[96:99], v[48:51], v[36:39]
    ds_read_b128 v[48:51], v15 offset:26624
    s_add_u32 s82, s84, 22
    s_and_b32 s83, s82, 1
    s_mul_i32 s83, s83, 24
    s_lshr_b32 s82, s82, 1
    s_add_u32 s82, s82, s83
    s_mul_i32 s82, s82, 5120
    s_add_u32 s82, s82, s28
    s_add_u32 s82, s82, 102400
    s_mul_i32 s83, s84, 5120
    s_add_u32 m0, s83, 40960
    s_nop 0
    buffer_load_dwordx4 v1, s[32:35], s82 offen offset:0 sc1 lds
    s_waitcnt lgkmcnt(5)
    v_mfma_f32_16x16x32_bf16 v[36:39], v[100:103], v[52:55], v[36:39]
    ds_read_b128 v[52:55], v15 offset:27648
    buffer_load_dwordx4 v1, s[32:35], s82 offen offset:1024 sc1 lds
    s_waitcnt lgkmcnt(5)
    v_mfma_f32_16x16x32_bf16 v[36:39], v[104:107], v[56:59], v[36:39]
    ds_read_b128 v[56:59], v15 offset:28672
    buffer_load_dwordx4 v1, s[32:35], s82 offen offset:2048 sc1 lds
    v_fma_f32 v32, v12, v32, v20
    v_fma_f32 v33, v12, v33, v21
    s_waitcnt lgkmcnt(5)
    v_mfma_f32_16x16x32_bf16 v[36:39], v[108:111], v[60:63], v[36:39]
    ds_read_b128 v[60:63], v15 offset:29696
    buffer_load_dwordx4 v1, s[32:35], s82 offen offset:3072 sc1 lds
    v_fma_f32 v34, v12, v34, v22
    v_fma_f32 v35, v12, v35, v23
    s_waitcnt lgkmcnt(5)
    v_mfma_f32_16x16x32_bf16 v[36:39], v[112:115], v[64:67], v[36:39]
    ds_read_b128 v[64:67], v15 offset:30720
    s_add_u32 m0, m0, 4096
    s_add_u32 s82, s82, 4096
    buffer_load_dwordx4 v1, s[32:35], s82 offen offset:0 sc1 lds
    v_exp_f32 v72, v32
    v_exp_f32 v73, v33
    s_waitcnt lgkmcnt(5)
    v_mfma_f32_16x16x32_bf16 v[36:39], v[116:119], v[68:71], v[36:39]
    ds_read_b128 v[68:71], v15 offset:31744
    v_exp_f32 v74, v34
    v_exp_f32 v75, v35
    s_waitcnt lgkmcnt(5)
    v_mfma_f32_16x16x32_bf16 v[36:39], v[120:123], v[48:51], v[36:39]
    ds_read_b128 v[48:51], v15 offset:32768
    v_add_f32 v72, 1.0, v72
    v_add_f32 v73, 1.0, v73
    s_waitcnt lgkmcnt(5)
    v_mfma_f32_16x16x32_bf16 v[36:39], v[124:127], v[52:55], v[36:39]
    ds_read_b128 v[52:55], v15 offset:33792
    v_add_f32 v74, 1.0, v74
    v_add_f32 v75, 1.0, v75
    s_waitcnt lgkmcnt(5)
    v_mfma_f32_16x16x32_bf16 v[36:39], v[128:131], v[56:59], v[36:39]
    ds_read_b128 v[56:59], v15 offset:34816
    v_rcp_f32 v72, v72
    s_waitcnt lgkmcnt(5)
    v_mfma_f32_16x16x32_bf16 v[36:39], v[132:135], v[60:63], v[36:39]
    ds_read_b128 v[60:63], v15 offset:35840
    v_rcp_f32 v73, v73
    s_waitcnt lgkmcnt(5)
    v_mfma_f32_16x16x32_bf16 v[36:39], v[136:139], v[64:67], v[36:39]
    ds_read_b128 v[64:67], v15 offset:36864
    v_rcp_f32 v74, v74
    s_waitcnt lgkmcnt(5)
    v_mfma_f32_16x16x32_bf16 v[36:39], v[140:143], v[68:71], v[36:39]
    ds_read_b128 v[68:71], v15 offset:37888
    v_rcp_f32 v75, v75
    s_waitcnt lgkmcnt(5)
    v_mfma_f32_16x16x32_bf16 v[36:39], v[144:147], v[48:51], v[36:39]
    ds_read_b128 v[48:51], v15 offset:38912
    v_mul_f32 v32, v32, v72
    s_waitcnt lgkmcnt(5)
    v_mfma_f32_16x16x32_bf16 v[36:39], v[148:151], v[52:55], v[36:39]
    ds_read_b128 v[52:55], v15 offset:39936
    v_mul_f32 v33, v33, v73
    s_waitcnt lgkmcnt(5)
    v_mfma_f32_16x16x32_bf16 v[36:39], v[152:155], v[56:59], v[36:39]
    v_mul_f32 v34, v34, v74
    s_waitcnt lgkmcnt(4)
    v_mfma_f32_16x16x32_bf16 v[36:39], v[156:159], v[60:63], v[36:39]
    v_mul_f32 v35, v35, v75
    s_waitcnt lgkmcnt(3)
    v_mfma_f32_16x16x32_bf16 v[36:39], v[160:163], v[64:67], v[36:39]
    v_cvt_pk_bf16_f32 v72, v32, v33
    s_waitcnt lgkmcnt(2)
    v_mfma_f32_16x16x32_bf16 v[36:39], v[164:167], v[68:71], v[36:39]
    v_cvt_pk_bf16_f32 v73, v34, v35
    s_waitcnt lgkmcnt(1)
    v_mfma_f32_16x16x32_bf16 v[36:39], v[168:171], v[48:51], v[36:39]
    s_add_u32 s86, s95, 98304
    s_cmp_eq_u32 s76, 1
    s_cbranch_scc0 L_far_132
    buffer_store_dwordx2 v[72:73], v80, s[32:35], s86 offen
L_pub_133:
    s_waitcnt lgkmcnt(0)
    v_mfma_f32_16x16x32_bf16 v[36:39], v[172:175], v[52:55], v[36:39]
    s_nop 7
    v_fma_f32 v36, v82, v36, v20
    v_fma_f32 v37, v82, v37, v21
    v_fma_f32 v38, v82, v38, v22
    v_fma_f32 v39, v82, v39, v23
    v_exp_f32 v72, v36
    v_exp_f32 v73, v37
    v_exp_f32 v74, v38
    v_exp_f32 v75, v39
    v_add_f32 v72, 1.0, v72
    v_add_f32 v73, 1.0, v73
    v_add_f32 v74, 1.0, v74
    v_add_f32 v75, 1.0, v75
    v_rcp_f32 v72, v72
    v_rcp_f32 v73, v73
    v_rcp_f32 v74, v74
    v_rcp_f32 v75, v75
    v_mul_f32 v36, v36, v72
    v_mul_f32 v37, v37, v73
    v_mul_f32 v38, v38, v74
    v_mul_f32 v39, v39, v75
    v_cvt_pk_bf16_f32 v72, v36, v37
    v_cvt_pk_bf16_f32 v73, v38, v39
    s_add_u32 s86, s95, 147456
    s_cmp_eq_u32 s76, 1
    s_cbranch_scc0 L_far_134
    buffer_store_dwordx2 v[72:73], v80, s[32:35], s86 offen
L_pub_135:
    s_waitcnt vmcnt(2)
    s_branch L_p4_done
L_p4_b1:
    ds_read_b64 v[8:9], v14 offset:0
    ds_read_b64 v[10:11], v14 offset:128
    ds_read_b64 v[12:13], v14 offset:256
    ds_read_b64 v[82:83], v14 offset:384
    ds_read_b128 v[48:51], v1 offset:0
    ds_read_b128 v[52:55], v1 offset:1024
    ds_read_b128 v[56:59], v1 offset:2048
    ds_read_b128 v[60:63], v1 offset:3072
    ds_read_b128 v[64:67], v1 offset:4096
    ds_read_b128 v[68:71], v1 offset:5120
    s_waitcnt lgkmcnt(6)
    v_mul_f32 v32, v9, v16
    v_mul_f32 v33, v9, v17
    v_mul_f32 v34, v9, v18
    v_mul_f32 v35, v9, v19
    s_setprio 0
    s_waitcnt lgkmcnt(5)
    v_mfma_f32_16x16x32_bf16 v[32:35], v[96:99], v[48:51], v[32:35]
    ds_read_b128 v[48:51], v1 offset:6144
    s_add_u32 s82, s84, 4
    s_and_b32 s83, s82, 1
    s_mul_i32 s83, s83, 24
    s_lshr_b32 s82, s82, 1
    s_add_u32 s82, s82, s83
    s_mul_i32 s82, s82, 5120
    s_add_u32 s82, s82, s28
    s_add_u32 s82, s82, 102400
    s_mul_i32 s83, s84, 5120
    s_add_u32 m0, s83, 122880
    s_nop 0
    buffer_load_dwordx4 v1, s[32:35], s82 offen offset:0 sc1 lds
    s_waitcnt lgkmcnt(5)
    v_mfma_f32_16x16x32_bf16 v[32:35], v[100:103], v[52:55], v[32:35]
    ds_read_b128 v[52:55], v1 offset:7168
    s_waitcnt lgkmcnt(5)
    v_mfma_f32_16x16x32_bf16 v[32:35], v[104:107], v[56:59], v[32:35]
    ds_read_b128 v[56:59], v1 offset:8192
    v_mul_f32 v36, v11, v16
    s_waitcnt lgkmcnt(5)
    v_mfma_f32_16x16x32_bf16 v[32:35], v[108:111], v[60:63], v[32:35]
    ds_read_b128 v[60:63], v1 offset:9216
    buffer_load_dwordx4 v1, s[32:35], s82 offen offset:1024 sc1 lds
    v_mul_f32 v37, v11, v17
    s_waitcnt lgkmcnt(5)
    v_mfma_f32_16x16x32_bf16 v[32:35], v[112:115], v[64:67], v[32:35]
    ds_read_b128 v[64:67], v1 offset:10240
    v_mul_f32 v38, v11, v18
    s_waitcnt lgkmcnt(5)
    v_mfma_f32_16x16x32_bf16 v[32:35], v[116:119], v[68:71], v[32:35]
    ds_read_b128 v[68:71], v1 offset:11264
    v_mul_f32 v39, v11, v19
    s_waitcnt lgkmcnt(5)
    v_mfma_f32_16x16x32_bf16 v[32:35], v[120:123], v[48:51], v[32:35]
    ds_read_b128 v[48:51], v1 offset:12288
    buffer_load_dwordx4 v1, s[32:35], s82 offen offset:2048 sc1 lds
    s_waitcnt lgkmcnt(5)
    v_mfma_f32_16x16x32_bf16 v[32:35], v[124:127], v[52:55], v[32:35]
    ds_read_b128 v[52:55], v1 offset:13312
    s_waitcnt lgkmcnt(5)
    v_mfma_f32_16x16x32_bf16 v[32:35], v[128:131], v[56:59], v[32:35]
    ds_read_b128 v[56:59], v1 offset:14336
    s_waitcnt lgkmcnt(5)
    v_mfma_f32_16x16x32_bf16 v[32:35], v[132:135], v[60:63], v[32:35]
    ds_read_b128 v[60:63], v1 offset:15360
    buffer_load_dwordx4 v1, s[32:35], s82 offen offset:3072 sc1 lds
    s_waitcnt lgkmcnt(5)
    v_mfma_f32_16x16x32_bf16 v[32:35], v[136:139], v[64:67], v[32:35]
    ds_read_b128 v[64:67], v1 offset:16384
    s_waitcnt lgkmcnt(5)
    v_mfma_f32_16x16x32_bf16 v[32:35], v[140:143], v[68:71], v[32:35]
    ds_read_b128 v[68:71], v1 offset:17408
    s_waitcnt lgkmcnt(5)
    v_mfma_f32_16x16x32_bf16 v[32:35], v[144:147], v[48:51], v[32:35]
    ds_read_b128 v[48:51], v1 offset:18432
    s_add_u32 m0, m0, 4096
    s_add_u32 s82, s82, 4096
    buffer_load_dwordx4 v1, s[32:35], s82 offen offset:0 sc1 lds
    s_waitcnt lgkmcnt(5)
    v_mfma_f32_16x16x32_bf16 v[32:35], v[148:151], v[52:55], v[32:35]
    ds_read_b128 v[52:55], v1 offset:19456
    s_waitcnt lgkmcnt(5)
    v_mfma_f32_16x16x32_bf16 v[32:35], v[152:155], v[56:59], v[32:35]
    ds_read_b128 v[56:59], v1 offset:20480
    s_waitcnt lgkmcnt(5)
    v_mfma_f32_16x16x32_bf16 v[32:35], v[156:159], v[60:63], v[32:35]
    ds_read_b128 v[60:63], v1 offset:21504
    s_add_u32 s82, s84, 10
    s_and_b32 s83, s82, 1
    s_mul_i32 s83, s83, 24
    s_lshr_b32 s82, s82, 1
    s_add_u32 s82, s82, s83
    s_mul_i32 s82, s82, 5120
    s_add_u32 s82, s82, s28
    s_add_u32 s82, s82, 102400
    s_mul_i32 s83, s84, 5120
    s_add_u32 m0, s83, 81920
    s_nop 0
    buffer_load_dwordx4 v1, s[32:35], s82 offen offset:0 sc1 lds
    s_waitcnt lgkmcnt(5)
    v_mfma_f32_16x16x32_bf16 v[32:35], v[160:163], v[64:67], v[32:35]
    ds_read_b128 v[64:67], v1 offset:22528
    s_waitcnt lgkmcnt(5)
    v_mfma_f32_16x16x32_bf16 v[32:35], v[164:167], v[68:71], v[32:35]
    ds_read_b128 v[68:71], v1 offset:23552
    s_waitcnt lgkmcnt(5)
    v_mfma_f32_16x16x32_bf16 v[32:35], v[168:171], v[48:51], v[32:35]
    ds_read_b128 v[48:51], v1 offset:24576
    buffer_load_dwordx4 v1, s[32:35], s82 offen offset:1024 sc1 lds
    s_waitcnt lgkmcnt(5)
    v_mfma_f32_16x16x32_bf16 v[32:35], v[172:175], v[52:55], v[32:35]
    ds_read_b128 v[52:55], v1 offset:25600
    s_setprio 0
    s_barrier
    s_waitcnt lgkmcnt(5)
    v_mfma_f32_16x16x32_bf16 v[36:39], v[96:99], v[56:59], v[36:39]
    ds_read_b128 v[56:59], v1 offset:26624
    s_waitcnt lgkmcnt(5)
    v_mfma_f32_16x16x32_bf16 v[36:39], v[100:103], v[60:63], v[36:39]
    ds_read_b128 v[60:63], v1 offset:27648
    buffer_load_dwordx4 v1, s[32:35], s82 offen offset:2048 sc1 lds
    s_waitcnt lgkmcnt(5)
    v_mfma_f32_16x16x32_bf16 v[36:39], v[104:107], v[64:67], v[36:39]
    ds_read_b128 v[64:67], v1 offset:28672
    v_fma_f32 v32, v8, v32, v20
    v_fma_f32 v33, v8, v33, v21
    s_waitcnt lgkmcnt(5)
    v_mfma_f32_16x16x32_bf16 v[36:39], v[108:111], v[68:71], v[36:39]
    ds_read_b128 v[68:71], v1 offset:29696
    v_fma_f32 v34, v8, v34, v22
    v_fma_f32 v35, v8, v35, v23
    s_waitcnt lgkmcnt(5)
    v_mfma_f32_16x16x32_bf16 v[36:39], v[112:115], v[48:51], v[36:39]
    ds_read_b128 v[48:51], v1 offset:30720
    buffer_load_dwordx4 v1, s[32:35], s82 offen offset:3072 sc1 lds
    v_exp_f32 v72, v32
    v_exp_f32 v73, v33
    s_waitcnt lgkmcnt(5)
    v_mfma_f32_16x16x32_bf16 v[36:39], v[116:119], v[52:55], v[36:39]
    ds_read_b128 v[52:55], v1 offset:31744
    v_exp_f32 v74, v34
    v_exp_f32 v75, v35
    s_waitcnt lgkmcnt(5)
    v_mfma_f32_16x16x32_bf16 v[36:39], v[120:123], v[56:59], v[36:39]
    ds_read_b128 v[56:59], v1 offset:32768
    v_add_f32 v72, 1.0, v72
    v_add_f32 v73, 1.0, v73
    s_waitcnt lgkmcnt(5)
    v_mfma_f32_16x16x32_bf16 v[36:39], v[124:127], v[60:63], v[36:39]
    ds_read_b128 v[60:63], v1 offset:33792
    s_add_u32 m0, m0, 4096
    s_add_u32 s82, s82, 4096
    buffer_load_dwordx4 v1, s[32:35], s82 offen offset:0 sc1 lds
    v_add_f32 v74, 1.0, v74
    v_add_f32 v75, 1.0, v75
    s_waitcnt lgkmcnt(5)
    v_mfma_f32_16x16x32_bf16 v[36:39], v[128:131], v[64:67], v[36:39]
    ds_read_b128 v[64:67], v1 offset:34816
    v_rcp_f32 v72, v72
    v_rcp_f32 v73, v73
    s_waitcnt lgkmcnt(5)
    v_mfma_f32_16x16x32_bf16 v[36:39], v[132:135], v[68:71], v[36:39]
    ds_read_b128 v[68:71], v1 offset:35840
    v_rcp_f32 v74, v74
    v_rcp_f32 v75, v75
    s_waitcnt lgkmcnt(5)
    v_mfma_f32_16x16x32_bf16 v[36:39], v[136:139], v[48:51], v[36:39]
    ds_read_b128 v[48:51], v1 offset:36864
    v_mul_f32 v32, v32, v72
    v_mul_f32 v33, v33, v73
    s_waitcnt lgkmcnt(5)
    v_mfma_f32_16x16x32_bf16 v[36:39], v[140:143], v[52:55], v[36:39]
    ds_read_b128 v[52:55], v1 offset:37888
    v_mul_f32 v34, v34, v74
    v_mul_f32 v35, v35, v75
    s_waitcnt lgkmcnt(5)
    v_mfma_f32_16x16x32_bf16 v[36:39], v[144:147], v[56:59], v[36:39]
    ds_read_b128 v[56:59], v1 offset:38912
    v_cvt_pk_bf16_f32 v72, v32, v33
    v_cvt_pk_bf16_f32 v73, v34, v35
    s_waitcnt lgkmcnt(5)
    v_mfma_f32_16x16x32_bf16 v[36:39], v[148:151], v[60:63], v[36:39]
    ds_read_b128 v[60:63], v1 offset:39936
    s_add_u32 s86, s95, 0
    s_cmp_eq_u32 s76, 1
    s_cbranch_scc0 L_far_138
    buffer_store_dwordx2 v[72:73], v80, s[32:35], s86 offen
L_pub_139:
    v_mul_f32 v32, v13, v16
    s_waitcnt lgkmcnt(5)
    v_mfma_f32_16x16x32_bf16 v[36:39], v[152:155], v[64:67], v[36:39]
    ds_read_b128 v[64:67], v15 offset:0
    v_mul_f32 v33, v13, v17
    v_mul_f32 v34, v13, v18
    s_waitcnt lgkmcnt(5)
    v_mfma_f32_16x16x32_bf16 v[36:39], v[156:159], v[68:71], v[36:39]
    ds_read_b128 v[68:71], v15 offset:1024
    v_mul_f32 v35, v13, v19
    v_mul_f32 v40, v13, v24
    s_waitcnt lgkmcnt(5)
    v_mfma_f32_16x16x32_bf16 v[36:39], v[160:163], v[48:51], v[36:39]
    ds_read_b128 v[48:51], v15 offset:2048
    v_mul_f32 v41, v13, v25
    s_waitcnt lgkmcnt(5)
    v_mfma_f32_16x16x32_bf16 v[36:39], v[164:167], v[52:55], v[36:39]
    ds_read_b128 v[52:55], v15 offset:3072
    v_mul_f32 v42, v13, v26
    s_waitcnt lgkmcnt(5)
    v_mfma_f32_16x16x32_bf16 v[36:39], v[168:171], v[56:59], v[36:39]
    ds_read_b128 v[56:59], v15 offset:4096
    v_mul_f32 v43, v13, v27
    s_waitcnt lgkmcnt(5)
    v_mfma_f32_16x16x32_bf16 v[36:39], v[172:175], v[60:63], v[36:39]
    ds_read_b128 v[60:63], v15 offset:5120
    s_setprio 1
    s_barrier
    s_waitcnt lgkmcnt(5)
    v_mfma_f32_16x16x32_bf16 v[32:35], v[96:99], v[64:67], v[32:35]
    v_mfma_f32_16x16x32_bf16 v[40:43], v[176:179], v[64:67], v[40:43]
    ds_read_b128 v[64:67], v15 offset:6144
    s_waitcnt lgkmcnt(5)
    v_mfma_f32_16x16x32_bf16 v[32:35], v[100:103], v[68:71], v[32:35]
    v_mfma_f32_16x16x32_bf16 v[40:43], v[180:183], v[68:71], v[40:43]
    ds_read_b128 v[68:71], v15 offset:7168
    s_waitcnt lgkmcnt(5)
    v_mfma_f32_16x16x32_bf16 v[32:35], v[104:107], v[48:51], v[32:35]
    v_fma_f32 v36, v10, v36, v20
    v_mfma_f32_16x16x32_bf16 v[40:43], v[184:187], v[48:51], v[40:43]
    ds_read_b128 v[48:51], v15 offset:8192
    s_add_u32 s82, s84, 18
    s_and_b32 s83, s82, 1
    s_mul_i32 s83, s83, 24
    s_lshr_b32 s82, s82, 1
    s_add_u32 s82, s82, s83
    s_mul_i32 s82, s82, 5120
    s_add_u32 s82, s82, s28
    s_add_u32 s82, s82, 102400
    s_mul_i32 s83, s84, 5120
    s_add_u32 m0, s83, 20480
    s_nop 0
    buffer_load_dwordx4 v1, s[32:35], s82 offen offset:0 sc1 lds
    v_fma_f32 v37, v10, v37, v21
    s_waitcnt lgkmcnt(5)
    v_mfma_f32_16x16x32_bf16 v[32:35], v[108:111], v[52:55], v[32:35]
    v_fma_f32 v38, v10, v38, v22
    v_mfma_f32_16x16x32_bf16 v[40:43], v[188:191], v[52:55], v[40:43]
    ds_read_b128 v[52:55], v15 offset:9216
    v_fma_f32 v39, v10, v39, v23
    s_waitcnt lgkmcnt(5)
    v_mfma_f32_16x16x32_bf16 v[32:35], v[112:115], v[56:59], v[32:35]
    v_exp_f32 v72, v36
    v_mfma_f32_16x16x32_bf16 v[40:43], v[192:195], v[56:59], v[40:43]
    ds_read_b128 v[56:59], v15 offset:10240
    v_exp_f32 v73, v37
    s_waitcnt lgkmcnt(5)
    v_mfma_f32_16x16x32_bf16 v[32:35], v[116:119], v[60:63], v[32:35]
    v_exp_f32 v74, v38
    v_mfma_f32_16x16x32_bf16 v[40:43], v[196:199], v[60:63], v[40:43]
    ds_read_b128 v[60:63], v15 offset:11264
    buffer_load_dwordx4 v1, s[32:35], s82 offen offset:1024 sc1 lds
    v_exp_f32 v75, v39
    s_waitcnt lgkmcnt(5)
    v_mfma_f32_16x16x32_bf16 v[32:35], v[120:123], v[64:67], v[32:35]
    v_add_f32 v72, 1.0, v72
    v_mfma_f32_16x16x32_bf16 v[40:43], v[200:203], v[64:67], v[40:43]
    ds_read_b128 v[64:67], v15 offset:12288
    v_add_f32 v73, 1.0, v73
    s_waitcnt lgkmcnt(5)
    v_mfma_f32_16x16x32_bf16 v[32:35], v[124:127], v[68:71], v[32:35]
    v_add_f32 v74, 1.0, v74
    v_mfma_f32_16x16x32_bf16 v[40:43], v[204:207], v[68:71], v[40:43]
    ds_read_b128 v[68:71], v15 offset:13312
    v_add_f32 v75, 1.0, v75
    s_waitcnt lgkmcnt(5)
    v_mfma_f32_16x16x32_bf16 v[32:35], v[128:131], v[48:51], v[32:35]
    v_rcp_f32 v72, v72
    v_mfma_f32_16x16x32_bf16 v[40:43], v[208:211], v[48:51], v[40:43]
    ds_read_b128 v[48:51], v15 offset:14336
    buffer_load_dwordx4 v1, s[32:35], s82 offen offset:2048 sc1 lds
    v_rcp_f32 v73, v73
    s_waitcnt lgkmcnt(5)
    v_mfma_f32_16x16x32_bf16 v[32:35], v[132:135], v[52:55], v[32:35]
    v_rcp_f32 v74, v74
    v_mfma_f32_16x16x32_bf16 v[40:43], v[212:215], v[52:55], v[40:43]
    ds_read_b128 v[52:55], v15 offset:15360
    v_rcp_f32 v75, v75
    s_waitcnt lgkmcnt(5)
    v_mfma_f32_16x16x32_bf16 v[32:35], v[136:139], v[56:59], v[32:35]
    v_mul_f32 v36, v36, v72
    v_mfma_f32_16x16x32_bf16 v[40:43], v[216:219], v[56:59], v[40:43]
    ds_read_b128 v[56:59], v15 offset:16384
    v_mul_f32 v37, v37, v73
    s_waitcnt lgkmcnt(5)
    v_mfma_f32_16x16x32_bf16 v[32:35], v[140:143], v[60:63], v[32:35]
    v_mul_f32 v38, v38, v74
    v_mfma_f32_16x16x32_bf16 v[40:43], v[220:223], v[60:63], v[40:43]
    ds_read_b128 v[60:63], v15 offset:17408
    buffer_load_dwordx4 v1, s[32:35], s82 offen offset:3072 sc1 lds
    v_mul_f32 v39, v39, v75
    s_waitcnt lgkmcnt(5)
    v_mfma_f32_16x16x32_bf16 v[32:35], v[144:147], v[64:67], v[32:35]
    v_cvt_pk_bf16_f32 v72, v36, v37
    v_mfma_f32_16x16x32_bf16 v[40:43], v[224:227], v[64:67], v[40:43]
    ds_read_b128 v[64:67], v15 offset:18432
    v_cvt_pk_bf16_f32 v73, v38, v39
    s_waitcnt lgkmcnt(5)
    v_mfma_f32_16x16x32_bf16 v[32:35], v[148:151], v[68:71], v[32:35]
    s_add_u32 s86, s95, 49152
    s_cmp_eq_u32 s76, 1
    s_cbranch_scc0 L_far_141
    buffer_store_dwordx2 v[72:73], v80, s[32:35], s86 offen
L_pub_142:
    v_mfma_f32_16x16x32_bf16 v[40:43], v[228:231], v[68:71], v[40:43]
    ds_read_b128 v[68:71], v15 offset:19456
    v_mul_f32 v36, v83, v16
    s_waitcnt lgkmcnt(5)
    v_mfma_f32_16x16x32_bf16 v[32:35], v[152:155], v[48:51], v[32:35]
    v_mul_f32 v37, v83, v17
    v_mfma_f32_16x16x32_bf16 v[40:43], v[232:235], v[48:51], v[40:43]
    ds_read_b128 v[48:51], v15 offset:20480
    s_add_u32 m0, m0, 4096
    s_add_u32 s82, s82, 4096
    buffer_load_dwordx4 v1, s[32:35], s82 offen offset:0 sc1 lds
    v_mul_f32 v38, v83, v18
    s_waitcnt lgkmcnt(5)
    v_mfma_f32_16x16x32_bf16 v[32:35], v[156:159], v[52:55], v[32:35]
    v_mul_f32 v39, v83, v19
    v_mfma_f32_16x16x32_bf16 v[40:43], v[236:239], v[52:55], v[40:43]
    ds_read_b128 v[52:55], v15 offset:21504
    v_mul_f32 v44, v83, v24
    s_waitcnt lgkmcnt(5)
    v_mfma_f32_16x16x32_bf16 v[32:35], v[160:163], v[56:59], v[32:35]
    v_mul_f32 v45, v83, v25
    v_mfma_f32_16x16x32_bf16 v[40:43], v[240:243], v[56:59], v[40:43]
    ds_read_b128 v[56:59], v15 offset:22528
    v_mul_f32 v46, v83, v26
    s_waitcnt lgkmcnt(5)
    v_mfma_f32_16x16x32_bf16 v[32:35], v[164:167], v[60:63], v[32:35]
    v_mul_f32 v47, v83, v27
    v_mfma_f32_16x16x32_bf16 v[40:43], v[244:247], v[60:63], v[40:43]
    ds_read_b128 v[60:63], v15 offset:23552
    s_waitcnt lgkmcnt(5)
    v_mfma_f32_16x16x32_bf16 v[32:35], v[168:171], v[64:67], v[32:35]
    v_mfma_f32_16x16x32_bf16 v[40:43], v[248:251], v[64:67], v[40:43]
    ds_read_b128 v[64:67], v15 offset:24576
    s_waitcnt lgkmcnt(5)
    v_mfma_f32_16x16x32_bf16 v[32:35], v[172:175], v[68:71], v[32:35]
    v_mfma_f32_16x16x32_bf16 v[40:43], v[252:255], v[68:71], v[40:43]
    ds_read_b128 v[68:71], v15 offset:25600
    s_setprio 1
    s_barrier
    s_waitcnt lgkmcnt(5)
    v_mfma_f32_16x16x32_bf16 v[36:39], v[96:99], v[48:51], v[36:39]
    v_mfma_f32_16x16x32_bf16 v[44:47], v[176:179], v[48:51], v[44:47]
    ds_read_b128 v[48:51], v15 offset:26624
    s_waitcnt lgkmcnt(5)
    v_mfma_f32_16x16x32_bf16 v[36:39], v[100:103], v[52:55], v[36:39]
    v_mfma_f32_16x16x32_bf16 v[44:47], v[180:183], v[52:55], v[44:47]
    ds_read_b128 v[52:55], v15 offset:27648
    s_waitcnt lgkmcnt(5)
    v_mfma_f32_16x16x32_bf16 v[36:39], v[104:107], v[56:59], v[36:39]
    v_fma_f32 v40, v12, v40, v28
    v_fma_f32 v41, v12, v41, v29
    v_mfma_f32_16x16x32_bf16 v[44:47], v[184:187], v[56:59], v[44:47]
    ds_read_b128 v[56:59], v15 offset:28672
    v_fma_f32 v42, v12, v42, v30
    v_fma_f32 v43, v12, v43, v31
    s_waitcnt lgkmcnt(5)
    v_mfma_f32_16x16x32_bf16 v[36:39], v[108:111], v[60:63], v[36:39]
    v_exp_f32 v72, v40
    v_exp_f32 v73, v41
    v_mfma_f32_16x16x32_bf16 v[44:47], v[188:191], v[60:63], v[44:47]
    ds_read_b128 v[60:63], v15 offset:29696
    v_exp_f32 v74, v42
    v_exp_f32 v75, v43
    s_waitcnt lgkmcnt(5)
    v_mfma_f32_16x16x32_bf16 v[36:39], v[112:115], v[64:67], v[36:39]
    v_add_f32 v72, 1.0, v72
    v_add_f32 v73, 1.0, v73
    v_mfma_f32_16x16x32_bf16 v[44:47], v[192:195], v[64:67], v[44:47]
    ds_read_b128 v[64:67], v15 offset:30720
    v_add_f32 v74, 1.0, v74
    v_add_f32 v75, 1.0, v75
    s_waitcnt lgkmcnt(5)
    v_mfma_f32_16x16x32_bf16 v[36:39], v[116:119], v[68:71], v[36:39]
    v_rcp_f32 v72, v72
    v_rcp_f32 v73, v73
    v_mfma_f32_16x16x32_bf16 v[44:47], v[196:199], v[68:71], v[44:47]
    ds_read_b128 v[68:71], v15 offset:31744
    v_rcp_f32 v74, v74
    v_rcp_f32 v75, v75
    s_waitcnt lgkmcnt(5)
    v_mfma_f32_16x16x32_bf16 v[36:39], v[120:123], v[48:51], v[36:39]
    v_mul_f32 v40, v40, v72
    v_mul_f32 v41, v41, v73
    v_mfma_f32_16x16x32_bf16 v[44:47], v[200:203], v[48:51], v[44:47]
    ds_read_b128 v[48:51], v15 offset:32768
    s_mul_i32 s82, s84, 1
    s_add_u32 s82, s82, 26
    s_and_b32 s83, s82, 1
    s_mul_i32 s83, s83, 24
    s_lshr_b32 s82, s82, 1
    s_add_u32 s82, s82, s83
    s_mul_i32 s82, s82, 5120
    s_add_u32 s82, s82, s28
    s_add_u32 s82, s82, 102400
    buffer_load_dwordx4 v[96:99], v1, s[32:35], s82 offen offset:0 sc1
    v_mul_f32 v42, v42, v74
    v_mul_f32 v43, v43, v75
    s_waitcnt lgkmcnt(5)
    v_mfma_f32_16x16x32_bf16 v[36:39], v[124:127], v[52:55], v[36:39]
    v_cvt_pk_bf16_f32 v72, v40, v41
    v_cvt_pk_bf16_f32 v73, v42, v43
    v_mfma_f32_16x16x32_bf16 v[44:47], v[204:207], v[52:55], v[44:47]
    ds_read_b128 v[52:55], v15 offset:33792
    buffer_load_dwordx4 v[100:103], v1, s[32:35], s82 offen offset:1024 sc1
    s_add_u32 s86, s94, 98304
    s_cmp_eq_u32 s76, 1
    s_cbranch_scc0 L_far_144
    buffer_store_dwordx2 v[72:73], v80, s[32:35], s86 offen
L_pub_145:
    v_fma_f32 v32, v12, v32, v20
    s_waitcnt lgkmcnt(5)
    v_mfma_f32_16x16x32_bf16 v[36:39], v[128:131], v[56:59], v[36:39]
    v_fma_f32 v33, v12, v33, v21
    v_mfma_f32_16x16x32_bf16 v[44:47], v[208:211], v[56:59], v[44:47]
    ds_read_b128 v[56:59], v15 offset:34816
    buffer_load_dwordx4 v[104:107], v1, s[32:35], s82 offen offset:2048 sc1
    v_fma_f32 v34, v12, v34, v22
    s_waitcnt lgkmcnt(5)
    v_mfma_f32_16x16x32_bf16 v[36:39], v[132:135], v[60:63], v[36:39]
    v_fma_f32 v35, v12, v35, v23
    v_mfma_f32_16x16x32_bf16 v[44:47], v[212:215], v[60:63], v[44:47]
    ds_read_b128 v[60:63], v15 offset:35840
    buffer_load_dwordx4 v[108:111], v1, s[32:35], s82 offen offset:3072 sc1
    v_exp_f32 v76, v32
    s_waitcnt lgkmcnt(5)
    v_mfma_f32_16x16x32_bf16 v[36:39], v[136:139], v[64:67], v[36:39]
    v_exp_f32 v77, v33
    v_mfma_f32_16x16x32_bf16 v[44:47], v[216:219], v[64:67], v[44:47]
    ds_read_b128 v[64:67], v15 offset:36864
    s_add_u32 s82, s82, 4096
    buffer_load_dwordx4 v[112:115], v1, s[32:35], s82 offen offset:0 sc1
    v_exp_f32 v78, v34
    s_waitcnt lgkmcnt(5)
    v_mfma_f32_16x16x32_bf16 v[36:39], v[140:143], v[68:71], v[36:39]
    v_exp_f32 v79, v35
    v_mfma_f32_16x16x32_bf16 v[44:47], v[220:223], v[68:71], v[44:47]
    ds_read_b128 v[68:71], v15 offset:37888
    v_add_f32 v76, 1.0, v76
    s_waitcnt lgkmcnt(5)
    v_mfma_f32_16x16x32_bf16 v[36:39], v[144:147], v[48:51], v[36:39]
    v_add_f32 v77, 1.0, v77
    v_mfma_f32_16x16x32_bf16 v[44:47], v[224:227], v[48:51], v[44:47]
    ds_read_b128 v[48:51], v15 offset:38912
    v_add_f32 v78, 1.0, v78
    s_waitcnt lgkmcnt(5)
    v_mfma_f32_16x16x32_bf16 v[36:39], v[148:151], v[52:55], v[36:39]
    v_add_f32 v79, 1.0, v79
    v_mfma_f32_16x16x32_bf16 v[44:47], v[228:231], v[52:55], v[44:47]
    ds_read_b128 v[52:55], v15 offset:39936
    v_rcp_f32 v76, v76
    s_waitcnt lgkmcnt(5)
    v_mfma_f32_16x16x32_bf16 v[36:39], v[152:155], v[56:59], v[36:39]
    v_rcp_f32 v77, v77
    v_mfma_f32_16x16x32_bf16 v[44:47], v[232:235], v[56:59], v[44:47]
    v_rcp_f32 v78, v78
    s_waitcnt lgkmcnt(4)
    v_mfma_f32_16x16x32_bf16 v[36:39], v[156:159], v[60:63], v[36:39]
    v_rcp_f32 v79, v79
    v_mfma_f32_16x16x32_bf16 v[44:47], v[236:239], v[60:63], v[44:47]
    v_mul_f32 v32, v32, v76
    s_waitcnt lgkmcnt(3)
    v_mfma_f32_16x16x32_bf16 v[36:39], v[160:163], v[64:67], v[36:39]
    v_mul_f32 v33, v33, v77
    v_mfma_f32_16x16x32_bf16 v[44:47], v[240:243], v[64:67], v[44:47]
    v_mul_f32 v34, v34, v78
    s_waitcnt lgkmcnt(2)
    v_mfma_f32_16x16x32_bf16 v[36:39], v[164:167], v[68:71], v[36:39]
    v_mul_f32 v35, v35, v79
    v_mfma_f32_16x16x32_bf16 v[44:47], v[244:247], v[68:71], v[44:47]
    v_cvt_pk_bf16_f32 v76, v32, v33
    s_waitcnt lgkmcnt(1)
    v_mfma_f32_16x16x32_bf16 v[36:39], v[168:171], v[48:51], v[36:39]
    v_cvt_pk_bf16_f32 v77, v34, v35
    v_mfma_f32_16x16x32_bf16 v[44:47], v[248:251], v[48:51], v[44:47]
    s_add_u32 s86, s95, 98304
    s_cmp_eq_u32 s76, 1
    s_cbranch_scc0 L_far_146
    buffer_store_dwordx2 v[76:77], v80, s[32:35], s86 offen
L_pub_147:
    s_waitcnt lgkmcnt(0)
    v_mfma_f32_16x16x32_bf16 v[36:39], v[172:175], v[52:55], v[36:39]
    v_mfma_f32_16x16x32_bf16 v[44:47], v[252:255], v[52:55], v[44:47]
    s_nop 7
    v_fma_f32 v44, v82, v44, v28
    v_fma_f32 v45, v82, v45, v29
    v_fma_f32 v46, v82, v46, v30
    v_fma_f32 v47, v82, v47, v31
    v_exp_f32 v72, v44
    v_exp_f32 v73, v45
    v_exp_f32 v74, v46
    v_exp_f32 v75, v47
    v_add_f32 v72, 1.0, v72
    v_add_f32 v73, 1.0, v73
    v_add_f32 v74, 1.0, v74
    v_add_f32 v75, 1.0, v75
    v_rcp_f32 v72, v72
    v_rcp_f32 v73, v73
    v_rcp_f32 v74, v74
    v_rcp_f32 v75, v75
    v_mul_f32 v44, v44, v72
    v_mul_f32 v45, v45, v73
    v_mul_f32 v46, v46, v74
    v_mul_f32 v47, v47, v75
    v_cvt_pk_bf16_f32 v72, v44, v45
    v_cvt_pk_bf16_f32 v73, v46, v47
    s_add_u32 s86, s94, 147456
    s_cmp_eq_u32 s76, 1
    s_cbranch_scc0 L_far_148
    buffer_store_dwordx2 v[72:73], v80, s[32:35], s86 offen
L_pub_149:
    v_fma_f32 v36, v82, v36, v20
    v_fma_f32 v37, v82, v37, v21
    v_fma_f32 v38, v82, v38, v22
    v_fma_f32 v39, v82, v39, v23
    v_exp_f32 v76, v36
    v_exp_f32 v77, v37
    v_exp_f32 v78, v38
    v_exp_f32 v79, v39
    v_add_f32 v76, 1.0, v76
    v_add_f32 v77, 1.0, v77
    v_add_f32 v78, 1.0, v78
    v_add_f32 v79, 1.0, v79
    v_rcp_f32 v76, v76
    v_rcp_f32 v77, v77
    v_rcp_f32 v78, v78
    v_rcp_f32 v79, v79
    v_mul_f32 v36, v36, v76
    v_mul_f32 v37, v37, v77
    v_mul_f32 v38, v38, v78
    v_mul_f32 v39, v39, v79
    v_cvt_pk_bf16_f32 v76, v36, v37
    v_cvt_pk_bf16_f32 v77, v38, v39
    s_add_u32 s86, s95, 147456
    s_cmp_eq_u32 s76, 1
    s_cbranch_scc0 L_far_150
    buffer_store_dwordx2 v[76:77], v80, s[32:35], s86 offen
L_pub_151:
    s_waitcnt vmcnt(3)
L_p4_done:
    s_setprio 0
    v_bfe_u32 v9, v0, 3, 2
    v_mul_u32_u24 v9, 12, v9
    v_and_b32 v10, 3, v0
    v_mul_u32_u24 v10, 3, v10
    v_bfe_u32 v11, v0, 2, 1
    v_lshlrev_b32 v11, 1, v11
    v_add3_u32 v9, v9, v10, v11
    v_lshlrev_b32 v9, 9, v9
    v_add_u32 v9, 508, v9
    s_mul_i32 s86, s60, 49152
    s_mul_i32 s87, s85, 24576
    s_add_u32 s86, s86, s87
    s_add_u32 s86, s86, s78
    s_add_u32 s86, s86, 172032
    s_mul_i32 s87, s85, 5120
    v_add_u32 v10, s87, v1
    v_add_u32 v11, 81920, v10
    v_add_u32 v15, 102400, v10
    v_add_u32 v12, 40960, v10
    s_barrier
    s_cmp_eq_u32 s85, 0
    s_cbranch_scc1 L_skip_w2d
    s_mul_i32 s87, s84, 5120
    s_add_u32 s87, s87, 61440
    v_add_u32 v8, s87, v1
    ds_write_b128 v8, v[96:99] offset:0
    ds_write_b128 v8, v[100:103] offset:1024
    ds_write_b128 v8, v[104:107] offset:2048
    ds_write_b128 v8, v[108:111] offset:3072
    ds_write_b128 v8, v[112:115] offset:4096
    s_waitcnt lgkmcnt(0)
L_skip_w2d:
    s_add_u32 s87, s86, 0
    buffer_load_dwordx4 v[96:99], v1, s[32:35], s87 offen offset:0 sc1
    s_add_u32 s87, s86, 0
    buffer_load_dwordx4 v[100:103], v1, s[32:35], s87 offen offset:1024 sc1
    s_add_u32 s87, s86, 0
    buffer_load_dwordx4 v[104:107], v1, s[32:35], s87 offen offset:2048 sc1
    s_add_u32 s87, s86, 0
    buffer_load_dwordx4 v[108:111], v1, s[32:35], s87 offen offset:3072 sc1
    s_add_u32 s87, s86, 4096
    buffer_load_dwordx4 v[112:115], v1, s[32:35], s87 offen offset:0 sc1
    s_add_u32 s87, s86, 4096
    buffer_load_dwordx4 v[116:119], v1, s[32:35], s87 offen offset:1024 sc1
    ds_read_b128 v[36:39], v15 offset:0
    ds_read_b128 v[40:43], v15 offset:1024
    ds_read_b128 v[44:47], v15 offset:2048
    ds_read_b128 v[48:51], v15 offset:3072
    ds_read_b128 v[52:55], v15 offset:4096
    ds_read_b128 v[56:59], v15 offset:10240
    ds_read_b128 v[60:63], v15 offset:11264
    ds_read_b128 v[64:67], v15 offset:12288
    s_waitcnt vmcnt(4)
    v_max_u32 v13, v97, v99
    v_max3_u32 v13, v13, v101, v103
    v_cmp_eq_u32 vcc, -1, v13
    s_cbranch_vccnz L_bretry_153
L_bok_152:
    s_waitcnt lgkmcnt(7)
    v_mfma_f32_16x16x32_bf16 v[16:19], v[36:39], v[96:99], 0
    ds_read_b128 v[36:39], v15 offset:13312
    s_waitcnt lgkmcnt(7)
    v_mfma_f32_16x16x32_bf16 v[20:23], v[40:43], v[96:99], 0
    ds_read_b128 v[40:43], v15 offset:14336
    s_add_u32 s87, s86, 4096
    buffer_load_dwordx4 v[120:123], v1, s[32:35], s87 offen offset:2048 sc1
    s_waitcnt lgkmcnt(7)
    v_mfma_f32_16x16x32_bf16 v[24:27], v[44:47], v[96:99], 0
    ds_read_b128 v[44:47], v15 offset:20480
    s_waitcnt lgkmcnt(7)
    v_mfma_f32_16x16x32_bf16 v[28:31], v[48:51], v[96:99], 0
    ds_read_b128 v[48:51], v15 offset:21504
    s_waitcnt lgkmcnt(7)
    v_mfma_f32_16x16x32_bf16 v[32:35], v[52:55], v[96:99], 0
    ds_read_b128 v[52:55], v15 offset:22528
    s_waitcnt lgkmcnt(7)
    v_mfma_f32_16x16x32_bf16 v[16:19], v[56:59], v[100:103], v[16:19]
    ds_read_b128 v[56:59], v15 offset:23552
    s_waitcnt lgkmcnt(7)
    v_mfma_f32_16x16x32_bf16 v[20:23], v[60:63], v[100:103], v[20:23]
    ds_read_b128 v[60:63], v15 offset:24576
    s_add_u32 s87, s86, 4096
    buffer_load_dwordx4 v[124:127], v1, s[32:35], s87 offen offset:3072 sc1
    s_waitcnt lgkmcnt(7)
    v_mfma_f32_16x16x32_bf16 v[24:27], v[64:67], v[100:103], v[24:27]
    ds_read_b128 v[64:67], v15 offset:30720
    s_waitcnt lgkmcnt(7)
    v_mfma_f32_16x16x32_bf16 v[28:31], v[36:39], v[100:103], v[28:31]
    ds_read_b128 v[36:39], v15 offset:31744
    s_waitcnt vmcnt(4)
    v_max_u32 v13, v105, v107
    v_max3_u32 v13, v13, v109, v111
    v_cmp_eq_u32 vcc, -1, v13
    s_waitcnt lgkmcnt(7)
    v_mfma_f32_16x16x32_bf16 v[32:35], v[40:43], v[100:103], v[32:35]
    ds_read_b128 v[40:43], v15 offset:32768
    s_cbranch_vccnz L_bretry_155
L_bok_154:
    s_waitcnt lgkmcnt(7)
    v_mfma_f32_16x16x32_bf16 v[16:19], v[44:47], v[104:107], v[16:19]
    ds_read_b128 v[44:47], v15 offset:33792
    s_waitcnt lgkmcnt(7)
    v_mfma_f32_16x16x32_bf16 v[20:23], v[48:51], v[104:107], v[20:23]
    ds_read_b128 v[48:51], v15 offset:34816
    s_add_u32 s87, s86, 8192
    buffer_load_dwordx4 v[128:131], v1, s[32:35], s87 offen offset:0 sc1
    s_waitcnt lgkmcnt(7)
    v_mfma_f32_16x16x32_bf16 v[24:27], v[52:55], v[104:107], v[24:27]
    ds_read_b128 v[52:55], v15 offset:40960
    s_waitcnt lgkmcnt(7)
    v_mfma_f32_16x16x32_bf16 v[28:31], v[56:59], v[104:107], v[28:31]
    ds_read_b128 v[56:59], v15 offset:41984
    s_waitcnt lgkmcnt(7)
    v_mfma_f32_16x16x32_bf16 v[32:35], v[60:63], v[104:107], v[32:35]
    ds_read_b128 v[60:63], v15 offset:43008
    s_waitcnt lgkmcnt(7)
    v_mfma_f32_16x16x32_bf16 v[16:19], v[64:67], v[108:111], v[16:19]
    ds_read_b128 v[64:67], v15 offset:44032
    s_waitcnt lgkmcnt(7)
    v_mfma_f32_16x16x32_bf16 v[20:23], v[36:39], v[108:111], v[20:23]
    ds_read_b128 v[36:39], v15 offset:45056
    s_add_u32 s87, s86, 8192
    buffer_load_dwordx4 v[132:135], v1, s[32:35], s87 offen offset:1024 sc1
    s_waitcnt lgkmcnt(7)
    v_mfma_f32_16x16x32_bf16 v[24:27], v[40:43], v[108:111], v[24:27]
    ds_read_b128 v[40:43], v11 offset:0
    s_waitcnt lgkmcnt(7)
    v_mfma_f32_16x16x32_bf16 v[28:31], v[44:47], v[108:111], v[28:31]
    ds_read_b128 v[44:47], v11 offset:1024
    s_waitcnt vmcnt(4)
    v_max_u32 v13, v113, v115
    v_max3_u32 v13, v13, v117, v119
    v_cmp_eq_u32 vcc, -1, v13
    s_waitcnt lgkmcnt(7)
    v_mfma_f32_16x16x32_bf16 v[32:35], v[48:51], v[108:111], v[32:35]
    ds_read_b128 v[48:51], v11 offset:2048
    s_cbranch_vccnz L_bretry_157
L_bok_156:
    s_barrier
    s_waitcnt lgkmcnt(7)
    v_mfma_f32_16x16x32_bf16 v[16:19], v[52:55], v[112:115], v[16:19]
    ds_read_b128 v[52:55], v11 offset:3072
    s_add_u32 s82, s74, 30
    s_and_b32 s83, s82, 1
    s_mul_i32 s83, s83, 24
    s_lshr_b32 s82, s82, 1
    s_add_u32 s82, s82, s83
    s_mul_i32 s82, s82, 5120
    s_add_u32 s82, s82, s28
    s_add_u32 s82, s82, 102400
    s_mul_i32 s83, s74, 5120
    s_add_u32 m0, s83, 102400
    s_nop 0
    buffer_load_dwordx4 v1, s[32:35], s82 offen offset:0 sc1 lds
    s_waitcnt lgkmcnt(7)
    v_mfma_f32_16x16x32_bf16 v[20:23], v[56:59], v[112:115], v[20:23]
    ds_read_b128 v[56:59], v11 offset:4096
    s_add_u32 s87, s86, 8192
    buffer_load_dwordx4 v[136:139], v1, s[32:35], s87 offen offset:2048 sc1
    s_waitcnt lgkmcnt(7)
    v_mfma_f32_16x16x32_bf16 v[24:27], v[60:63], v[112:115], v[24:27]
    ds_read_b128 v[60:63], v11 offset:10240
    buffer_load_dwordx4 v1, s[32:35], s82 offen offset:1024 sc1 lds
    s_waitcnt lgkmcnt(7)
    v_mfma_f32_16x16x32_bf16 v[28:31], v[64:67], v[112:115], v[28:31]
    ds_read_b128 v[64:67], v11 offset:11264
    s_waitcnt lgkmcnt(7)
    v_mfma_f32_16x16x32_bf16 v[32:35], v[36:39], v[112:115], v[32:35]
    ds_read_b128 v[36:39], v11 offset:12288
    s_waitcnt lgkmcnt(7)
    v_mfma_f32_16x16x32_bf16 v[16:19], v[40:43], v[116:119], v[16:19]
    ds_read_b128 v[40:43], v11 offset:13312
    buffer_load_dwordx4 v1, s[32:35], s82 offen offset:2048 sc1 lds
    s_waitcnt lgkmcnt(7)
    v_mfma_f32_16x16x32_bf16 v[20:23], v[44:47], v[116:119], v[20:23]
    ds_read_b128 v[44:47], v11 offset:14336
    s_add_u32 s87, s86, 8192
    buffer_load_dwordx4 v[140:143], v1, s[32:35], s87 offen offset:3072 sc1
    s_waitcnt lgkmcnt(7)
    v_mfma_f32_16x16x32_bf16 v[24:27], v[48:51], v[116:119], v[24:27]
    ds_read_b128 v[48:51], v10 offset:0
    buffer_load_dwordx4 v1, s[32:35], s82 offen offset:3072 sc1 lds
    s_waitcnt lgkmcnt(7)
    v_mfma_f32_16x16x32_bf16 v[28:31], v[52:55], v[116:119], v[28:31]
    ds_read_b128 v[52:55], v10 offset:1024
    s_waitcnt vmcnt(8)
    v_max_u32 v13, v121, v123
    v_max3_u32 v13, v13, v125, v127
    v_cmp_eq_u32 vcc, -1, v13
    s_waitcnt lgkmcnt(7)
    v_mfma_f32_16x16x32_bf16 v[32:35], v[56:59], v[116:119], v[32:35]
    ds_read_b128 v[56:59], v10 offset:2048
    s_cbranch_vccnz L_bretry_160
L_bok_159:
    s_waitcnt lgkmcnt(7)
    v_mfma_f32_16x16x32_bf16 v[16:19], v[60:63], v[120:123], v[16:19]
    ds_read_b128 v[60:63], v10 offset:3072
    s_add_u32 m0, m0, 4096
    s_add_u32 s82, s82, 4096
    buffer_load_dwordx4 v1, s[32:35], s82 offen offset:0 sc1 lds
    s_waitcnt lgkmcnt(7)
    v_mfma_f32_16x16x32_bf16 v[20:23], v[64:67], v[120:123], v[20:23]
    ds_read_b128 v[64:67], v10 offset:4096
    s_add_u32 s87, s86, 12288
    buffer_load_dwordx4 v[144:147], v1, s[32:35], s87 offen offset:0 sc1
    s_waitcnt lgkmcnt(7)
    v_mfma_f32_16x16x32_bf16 v[24:27], v[36:39], v[120:123], v[24:27]
    ds_read_b128 v[36:39], v10 offset:10240
    s_waitcnt lgkmcnt(7)
    v_mfma_f32_16x16x32_bf16 v[28:31], v[40:43], v[120:123], v[28:31]
    ds_read_b128 v[40:43], v10 offset:11264
    s_waitcnt lgkmcnt(7)
    v_mfma_f32_16x16x32_bf16 v[32:35], v[44:47], v[120:123], v[32:35]
    ds_read_b128 v[44:47], v10 offset:12288
    s_waitcnt lgkmcnt(7)
    v_mfma_f32_16x16x32_bf16 v[16:19], v[48:51], v[124:127], v[16:19]
    ds_read_b128 v[48:51], v10 offset:13312
    s_waitcnt lgkmcnt(7)
    v_mfma_f32_16x16x32_bf16 v[20:23], v[52:55], v[124:127], v[20:23]
    ds_read_b128 v[52:55], v10 offset:14336
    s_add_u32 s87, s86, 12288
    buffer_load_dwordx4 v[148:151], v1, s[32:35], s87 offen offset:1024 sc1
    s_waitcnt lgkmcnt(7)
    v_mfma_f32_16x16x32_bf16 v[24:27], v[56:59], v[124:127], v[24:27]
    ds_read_b128 v[56:59], v10 offset:20480
    s_waitcnt lgkmcnt(7)
    v_mfma_f32_16x16x32_bf16 v[28:31], v[60:63], v[124:127], v[28:31]
    ds_read_b128 v[60:63], v10 offset:21504
    s_waitcnt vmcnt(9)
    v_max_u32 v13, v129, v131
    v_max3_u32 v13, v13, v133, v135
    v_cmp_eq_u32 vcc, -1, v13
    s_waitcnt lgkmcnt(7)
    v_mfma_f32_16x16x32_bf16 v[32:35], v[64:67], v[124:127], v[32:35]
    ds_read_b128 v[64:67], v10 offset:22528
    s_cbranch_vccnz L_bretry_162
L_bok_161:
    s_waitcnt lgkmcnt(7)
    v_mfma_f32_16x16x32_bf16 v[16:19], v[36:39], v[128:131], v[16:19]
    ds_read_b128 v[36:39], v10 offset:23552
    s_waitcnt lgkmcnt(7)
    v_mfma_f32_16x16x32_bf16 v[20:23], v[40:43], v[128:131], v[20:23]
    ds_read_b128 v[40:43], v10 offset:24576
    s_add_u32 s87, s86, 12288
    buffer_load_dwordx4 v[152:155], v1, s[32:35], s87 offen offset:2048 sc1
    s_waitcnt lgkmcnt(7)
    v_mfma_f32_16x16x32_bf16 v[24:27], v[44:47], v[128:131], v[24:27]
    ds_read_b128 v[44:47], v10 offset:30720
    s_waitcnt lgkmcnt(7)
    v_mfma_f32_16x16x32_bf16 v[28:31], v[48:51], v[128:131], v[28:31]
    ds_read_b128 v[48:51], v10 offset:31744
    s_waitcnt lgkmcnt(7)
    v_mfma_f32_16x16x32_bf16 v[32:35], v[52:55], v[128:131], v[32:35]
    ds_read_b128 v[52:55], v10 offset:32768
    s_waitcnt lgkmcnt(7)
    v_mfma_f32_16x16x32_bf16 v[16:19], v[56:59], v[132:135], v[16:19]
    ds_read_b128 v[56:59], v10 offset:33792
    s_waitcnt lgkmcnt(7)
    v_mfma_f32_16x16x32_bf16 v[20:23], v[60:63], v[132:135], v[20:23]
    ds_read_b128 v[60:63], v10 offset:34816
    s_add_u32 s87, s86, 12288
    buffer_load_dwordx4 v[156:159], v1, s[32:35], s87 offen offset:3072 sc1
    s_waitcnt lgkmcnt(7)
    v_mfma_f32_16x16x32_bf16 v[24:27], v[64:67], v[132:135], v[24:27]
    ds_read_b128 v[64:67], v12 offset:0
    s_waitcnt lgkmcnt(7)
    v_mfma_f32_16x16x32_bf16 v[28:31], v[36:39], v[132:135], v[28:31]
    ds_read_b128 v[36:39], v12 offset:1024
    s_waitcnt vmcnt(6)
    v_max_u32 v13, v137, v139
    v_max3_u32 v13, v13, v141, v143
    v_cmp_eq_u32 vcc, -1, v13
    s_waitcnt lgkmcnt(7)
    v_mfma_f32_16x16x32_bf16 v[32:35], v[40:43], v[132:135], v[32:35]
    ds_read_b128 v[40:43], v12 offset:2048
    s_cbranch_vccnz L_bretry_164
L_bok_163:
    s_waitcnt vmcnt(4)
    s_barrier
    s_mov_b32 s81, 81920
    s_cmp_lt_u32 s74, 4
    s_cselect_b32 s81, s81, 4294946816
    s_waitcnt lgkmcnt(7)
    v_mfma_f32_16x16x32_bf16 v[16:19], v[44:47], v[136:139], v[16:19]
    ds_read_b128 v[44:47], v12 offset:3072
    s_add_u32 s82, s74, 40
    s_and_b32 s83, s82, 1
    s_mul_i32 s83, s83, 24
    s_lshr_b32 s82, s82, 1
    s_add_u32 s82, s82, s83
    s_mul_i32 s82, s82, 5120
    s_add_u32 s82, s82, s28
    s_add_u32 s82, s82, 102400
    s_mul_i32 s83, s74, 5120
    s_add_u32 m0, s83, s81
    s_nop 0
    buffer_load_dwordx4 v1, s[32:35], s82 offen offset:0 sc1 lds
    s_waitcnt lgkmcnt(7)
    v_mfma_f32_16x16x32_bf16 v[20:23], v[48:51], v[136:139], v[20:23]
    ds_read_b128 v[48:51], v12 offset:4096
    s_add_u32 s87, s86, 16384
    buffer_load_dwordx4 v[96:99], v1, s[32:35], s87 offen offset:0 sc1
    s_waitcnt lgkmcnt(7)
    v_mfma_f32_16x16x32_bf16 v[24:27], v[52:55], v[136:139], v[24:27]
    ds_read_b128 v[52:55], v12 offset:10240
    buffer_load_dwordx4 v1, s[32:35], s82 offen offset:1024 sc1 lds
    s_waitcnt lgkmcnt(7)
    v_mfma_f32_16x16x32_bf16 v[28:31], v[56:59], v[136:139], v[28:31]
    ds_read_b128 v[56:59], v12 offset:11264
    s_waitcnt lgkmcnt(7)
    v_mfma_f32_16x16x32_bf16 v[32:35], v[60:63], v[136:139], v[32:35]
    ds_read_b128 v[60:63], v12 offset:12288
    s_waitcnt lgkmcnt(7)
    v_mfma_f32_16x16x32_bf16 v[16:19], v[64:67], v[140:143], v[16:19]
    ds_read_b128 v[64:67], v12 offset:13312
    buffer_load_dwordx4 v1, s[32:35], s82 offen offset:2048 sc1 lds
    s_waitcnt lgkmcnt(7)
    v_mfma_f32_16x16x32_bf16 v[20:23], v[36:39], v[140:143], v[20:23]
    ds_read_b128 v[36:39], v12 offset:14336
    s_add_u32 s87, s86, 16384
    buffer_load_dwordx4 v[100:103], v1, s[32:35], s87 offen offset:1024 sc1
    s_waitcnt lgkmcnt(7)
    v_mfma_f32_16x16x32_bf16 v[24:27], v[40:43], v[140:143], v[24:27]
    ds_read_b128 v[40:43], v12 offset:20480
    buffer_load_dwordx4 v1, s[32:35], s82 offen offset:3072 sc1 lds
    s_waitcnt lgkmcnt(7)
    v_mfma_f32_16x16x32_bf16 v[28:31], v[44:47], v[140:143], v[28:31]
    ds_read_b128 v[44:47], v12 offset:21504
    s_waitcnt vmcnt(8)
    v_max_u32 v13, v145, v147
    v_max3_u32 v13, v13, v149, v151
    v_cmp_eq_u32 vcc, -1, v13
    s_waitcnt lgkmcnt(7)
    v_mfma_f32_16x16x32_bf16 v[32:35], v[48:51], v[140:143], v[32:35]
    ds_read_b128 v[48:51], v12 offset:22528
    s_cbranch_vccnz L_bretry_168
L_bok_167:
    s_waitcnt lgkmcnt(7)
    v_mfma_f32_16x16x32_bf16 v[16:19], v[52:55], v[144:147], v[16:19]
    ds_read_b128 v[52:55], v12 offset:23552
    s_add_u32 m0, m0, 4096
    s_add_u32 s82, s82, 4096
    buffer_load_dwordx4 v1, s[32:35], s82 offen offset:0 sc1 lds
    s_waitcnt lgkmcnt(7)
    v_mfma_f32_16x16x32_bf16 v[20:23], v[56:59], v[144:147], v[20:23]
    ds_read_b128 v[56:59], v12 offset:24576
    s_add_u32 s87, s86, 16384
    buffer_load_dwordx4 v[104:107], v1, s[32:35], s87 offen offset:2048 sc1
    s_waitcnt lgkmcnt(7)
    v_mfma_f32_16x16x32_bf16 v[24:27], v[60:63], v[144:147], v[24:27]
    ds_read_b128 v[60:63], v12 offset:30720
    s_cmp_ge_u32 s74, 2
    s_cbranch_scc1 L_skip_w2_166
    s_add_u32 s82, s74, 38
    s_and_b32 s83, s82, 1
    s_mul_i32 s83, s83, 24
    s_lshr_b32 s82, s82, 1
    s_add_u32 s82, s82, s83
    s_mul_i32 s82, s82, 5120
    s_add_u32 s82, s82, s28
    s_add_u32 s82, s82, 102400
    s_mul_i32 s83, s74, 5120
    s_add_u32 m0, s83, 143360
    s_nop 0
    buffer_load_dwordx4 v1, s[32:35], s82 offen offset:0 sc1 lds
    buffer_load_dwordx4 v1, s[32:35], s82 offen offset:1024 sc1 lds
    buffer_load_dwordx4 v1, s[32:35], s82 offen offset:2048 sc1 lds
    buffer_load_dwordx4 v1, s[32:35], s82 offen offset:3072 sc1 lds
    s_add_u32 m0, m0, 4096
    s_add_u32 s82, s82, 4096
    buffer_load_dwordx4 v1, s[32:35], s82 offen offset:0 sc1 lds
L_skip_w2_166:
    s_waitcnt lgkmcnt(7)
    v_mfma_f32_16x16x32_bf16 v[28:31], v[64:67], v[144:147], v[28:31]
    ds_read_b128 v[64:67], v12 offset:31744
    s_waitcnt lgkmcnt(7)
    v_mfma_f32_16x16x32_bf16 v[32:35], v[36:39], v[144:147], v[32:35]
    ds_read_b128 v[36:39], v12 offset:32768
    s_waitcnt lgkmcnt(7)
    v_mfma_f32_16x16x32_bf16 v[16:19], v[40:43], v[148:151], v[16:19]
    ds_read_b128 v[40:43], v12 offset:33792
    s_waitcnt lgkmcnt(7)
    v_mfma_f32_16x16x32_bf16 v[20:23], v[44:47], v[148:151], v[20:23]
    ds_read_b128 v[44:47], v12 offset:34816
    s_add_u32 s87, s86, 16384
    buffer_load_dwordx4 v[108:111], v1, s[32:35], s87 offen offset:3072 sc1
    s_waitcnt lgkmcnt(7)
    v_mfma_f32_16x16x32_bf16 v[24:27], v[48:51], v[148:151], v[24:27]
    ds_read_b128 v[48:51], v15 offset:0
    s_waitcnt lgkmcnt(7)
    v_mfma_f32_16x16x32_bf16 v[28:31], v[52:55], v[148:151], v[28:31]
    ds_read_b128 v[52:55], v15 offset:1024
    s_waitcnt vmcnt(9)
    v_max_u32 v13, v153, v155
    v_max3_u32 v13, v13, v157, v159
    v_cmp_eq_u32 vcc, -1, v13
    s_waitcnt lgkmcnt(7)
    v_mfma_f32_16x16x32_bf16 v[32:35], v[56:59], v[148:151], v[32:35]
    ds_read_b128 v[56:59], v15 offset:2048
    s_cbranch_vccnz L_bretry_170
L_bok_169:
    s_waitcnt lgkmcnt(7)
    v_mfma_f32_16x16x32_bf16 v[16:19], v[60:63], v[152:155], v[16:19]
    ds_read_b128 v[60:63], v15 offset:3072
    s_waitcnt lgkmcnt(7)
    v_mfma_f32_16x16x32_bf16 v[20:23], v[64:67], v[152:155], v[20:23]
    ds_read_b128 v[64:67], v15 offset:4096
    s_add_u32 s87, s86, 20480
    buffer_load_dwordx4 v[112:115], v1, s[32:35], s87 offen offset:0 sc1
    s_waitcnt lgkmcnt(7)
    v_mfma_f32_16x16x32_bf16 v[24:27], v[36:39], v[152:155], v[24:27]
    ds_read_b128 v[36:39], v15 offset:10240
    s_waitcnt lgkmcnt(7)
    v_mfma_f32_16x16x32_bf16 v[28:31], v[40:43], v[152:155], v[28:31]
    ds_read_b128 v[40:43], v15 offset:11264
    s_waitcnt lgkmcnt(7)
    v_mfma_f32_16x16x32_bf16 v[32:35], v[44:47], v[152:155], v[32:35]
    ds_read_b128 v[44:47], v15 offset:12288
    s_waitcnt lgkmcnt(7)
    v_mfma_f32_16x16x32_bf16 v[16:19], v[48:51], v[156:159], v[16:19]
    ds_read_b128 v[48:51], v15 offset:13312
    s_waitcnt lgkmcnt(7)
    v_mfma_f32_16x16x32_bf16 v[20:23], v[52:55], v[156:159], v[20:23]
    ds_read_b128 v[52:55], v15 offset:14336
    s_add_u32 s87, s86, 20480
    buffer_load_dwordx4 v[116:119], v1, s[32:35], s87 offen offset:1024 sc1
    s_waitcnt lgkmcnt(7)
    v_mfma_f32_16x16x32_bf16 v[24:27], v[56:59], v[156:159], v[24:27]
    ds_read_b128 v[56:59], v15 offset:20480
    s_waitcnt lgkmcnt(7)
    v_mfma_f32_16x16x32_bf16 v[28:31], v[60:63], v[156:159], v[28:31]
    ds_read_b128 v[60:63], v15 offset:21504
    s_waitcnt vmcnt(6)
    v_max_u32 v13, v97, v99
    v_max3_u32 v13, v13, v101, v103
    v_cmp_eq_u32 vcc, -1, v13
    s_waitcnt lgkmcnt(7)
    v_mfma_f32_16x16x32_bf16 v[32:35], v[64:67], v[156:159], v[32:35]
    ds_read_b128 v[64:67], v15 offset:22528
    s_cbranch_vccnz L_bretry_172
L_bok_171:
    s_waitcnt lgkmcnt(7)
    v_mfma_f32_16x16x32_bf16 v[16:19], v[36:39], v[96:99], v[16:19]
    ds_read_b128 v[36:39], v15 offset:23552
    s_waitcnt lgkmcnt(7)
    v_mfma_f32_16x16x32_bf16 v[20:23], v[40:43], v[96:99], v[20:23]
    ds_read_b128 v[40:43], v15 offset:24576
    s_add_u32 s87, s86, 20480
    buffer_load_dwordx4 v[120:123], v1, s[32:35], s87 offen offset:2048 sc1
    s_waitcnt lgkmcnt(7)
    v_mfma_f32_16x16x32_bf16 v[24:27], v[44:47], v[96:99], v[24:27]
    ds_read_b128 v[44:47], v15 offset:30720
    s_waitcnt lgkmcnt(7)
    v_mfma_f32_16x16x32_bf16 v[28:31], v[48:51], v[96:99], v[28:31]
    ds_read_b128 v[48:51], v15 offset:31744
    s_waitcnt lgkmcnt(7)
    v_mfma_f32_16x16x32_bf16 v[32:35], v[52:55], v[96:99], v[32:35]
    ds_read_b128 v[52:55], v15 offset:32768
    s_waitcnt vmcnt(4)
    s_barrier
    s_waitcnt lgkmcnt(7)
    v_mfma_f32_16x16x32_bf16 v[16:19], v[56:59], v[100:103], v[16:19]
    ds_read_b128 v[56:59], v15 offset:33792
    s_waitcnt lgkmcnt(7)
    v_mfma_f32_16x16x32_bf16 v[20:23], v[60:63], v[100:103], v[20:23]
    ds_read_b128 v[60:63], v15 offset:34816
    s_add_u32 s87, s86, 20480
    buffer_load_dwordx4 v[124:127], v1, s[32:35], s87 offen offset:3072 sc1
    s_waitcnt lgkmcnt(7)
    v_mfma_f32_16x16x32_bf16 v[24:27], v[64:67], v[100:103], v[24:27]
    ds_read_b128 v[64:67], v15 offset:40960
    s_waitcnt lgkmcnt(7)
    v_mfma_f32_16x16x32_bf16 v[28:31], v[36:39], v[100:103], v[28:31]
    ds_read_b128 v[36:39], v15 offset:41984
    s_waitcnt vmcnt(4)
    v_max_u32 v13, v105, v107
    v_max3_u32 v13, v13, v109, v111
    v_cmp_eq_u32 vcc, -1, v13
    s_waitcnt lgkmcnt(7)
    v_mfma_f32_16x16x32_bf16 v[32:35], v[40:43], v[100:103], v[32:35]
    ds_read_b128 v[40:43], v15 offset:43008
    s_cbranch_vccnz L_bretry_174
L_bok_173:
    s_waitcnt lgkmcnt(7)
    v_mfma_f32_16x16x32_bf16 v[16:19], v[44:47], v[104:107], v[16:19]
    ds_read_b128 v[44:47], v15 offset:44032
    s_waitcnt lgkmcnt(7)
    v_mfma_f32_16x16x32_bf16 v[20:23], v[48:51], v[104:107], v[20:23]
    ds_read_b128 v[48:51], v15 offset:45056
    s_waitcnt lgkmcnt(7)
    v_mfma_f32_16x16x32_bf16 v[24:27], v[52:55], v[104:107], v[24:27]
    ds_read_b128 v[52:55], v11 offset:0
    s_waitcnt lgkmcnt(7)
    v_mfma_f32_16x16x32_bf16 v[28:31], v[56:59], v[104:107], v[28:31]
    ds_read_b128 v[56:59], v11 offset:1024
    s_waitcnt lgkmcnt(7)
    v_mfma_f32_16x16x32_bf16 v[32:35], v[60:63], v[104:107], v[32:35]
    ds_read_b128 v[60:63], v11 offset:2048
    s_waitcnt lgkmcnt(7)
    v_mfma_f32_16x16x32_bf16 v[16:19], v[64:67], v[108:111], v[16:19]
    ds_read_b128 v[64:67], v11 offset:3072
    s_waitcnt lgkmcnt(7)
    v_mfma_f32_16x16x32_bf16 v[20:23], v[36:39], v[108:111], v[20:23]
    ds_read_b128 v[36:39], v11 offset:4096
    s_waitcnt lgkmcnt(7)
    v_mfma_f32_16x16x32_bf16 v[24:27], v[40:43], v[108:111], v[24:27]
    ds_read_b128 v[40:43], v11 offset:10240
    s_waitcnt lgkmcnt(7)
    v_mfma_f32_16x16x32_bf16 v[28:31], v[44:47], v[108:111], v[28:31]
    ds_read_b128 v[44:47], v11 offset:11264
    s_waitcnt vmcnt(2)
    v_max_u32 v13, v113, v115
    v_max3_u32 v13, v13, v117, v119
    v_cmp_eq_u32 vcc, -1, v13
    s_waitcnt lgkmcnt(7)
    v_mfma_f32_16x16x32_bf16 v[32:35], v[48:51], v[108:111], v[32:35]
    ds_read_b128 v[48:51], v11 offset:12288
    s_cbranch_vccnz L_bretry_176
L_bok_175:
    s_waitcnt lgkmcnt(7)
    v_mfma_f32_16x16x32_bf16 v[16:19], v[52:55], v[112:115], v[16:19]
    ds_read_b128 v[52:55], v11 offset:13312
    s_waitcnt lgkmcnt(7)
    v_mfma_f32_16x16x32_bf16 v[20:23], v[56:59], v[112:115], v[20:23]
    ds_read_b128 v[56:59], v11 offset:14336
    s_waitcnt lgkmcnt(7)
    v_mfma_f32_16x16x32_bf16 v[24:27], v[60:63], v[112:115], v[24:27]
    ds_read_b128 v[60:63], v10 offset:0
    s_waitcnt lgkmcnt(7)
    v_mfma_f32_16x16x32_bf16 v[28:31], v[64:67], v[112:115], v[28:31]
    ds_read_b128 v[64:67], v10 offset:1024
    s_waitcnt lgkmcnt(7)
    v_mfma_f32_16x16x32_bf16 v[32:35], v[36:39], v[112:115], v[32:35]
    ds_read_b128 v[36:39], v10 offset:2048
    s_waitcnt lgkmcnt(7)
    v_mfma_f32_16x16x32_bf16 v[16:19], v[40:43], v[116:119], v[16:19]
    ds_read_b128 v[40:43], v10 offset:3072
    s_waitcnt lgkmcnt(7)
    v_mfma_f32_16x16x32_bf16 v[20:23], v[44:47], v[116:119], v[20:23]
    ds_read_b128 v[44:47], v10 offset:4096
    s_waitcnt lgkmcnt(7)
    v_mfma_f32_16x16x32_bf16 v[24:27], v[48:51], v[116:119], v[24:27]
    ds_read_b128 v[48:51], v10 offset:10240
    s_waitcnt lgkmcnt(7)
    v_mfma_f32_16x16x32_bf16 v[28:31], v[52:55], v[116:119], v[28:31]
    ds_read_b128 v[52:55], v10 offset:11264
    s_waitcnt vmcnt(0)
    v_max_u32 v13, v121, v123
    v_max3_u32 v13, v13, v125, v127
    v_cmp_eq_u32 vcc, -1, v13
    s_waitcnt lgkmcnt(7)
    v_mfma_f32_16x16x32_bf16 v[32:35], v[56:59], v[116:119], v[32:35]
    ds_read_b128 v[56:59], v10 offset:12288
    s_cbranch_vccnz L_bretry_178
L_bok_177:
    s_waitcnt lgkmcnt(7)
    v_mfma_f32_16x16x32_bf16 v[16:19], v[60:63], v[120:123], v[16:19]
    ds_read_b128 v[60:63], v10 offset:13312
    s_waitcnt lgkmcnt(7)
    v_mfma_f32_16x16x32_bf16 v[20:23], v[64:67], v[120:123], v[20:23]
    ds_read_b128 v[64:67], v10 offset:14336
    s_waitcnt lgkmcnt(7)
    v_mfma_f32_16x16x32_bf16 v[24:27], v[36:39], v[120:123], v[24:27]
    s_waitcnt lgkmcnt(6)
    v_mfma_f32_16x16x32_bf16 v[28:31], v[40:43], v[120:123], v[28:31]
    s_waitcnt lgkmcnt(5)
    v_mfma_f32_16x16x32_bf16 v[32:35], v[44:47], v[120:123], v[32:35]
    s_waitcnt lgkmcnt(4)
    v_mfma_f32_16x16x32_bf16 v[16:19], v[48:51], v[124:127], v[16:19]
    s_waitcnt lgkmcnt(3)
    v_mfma_f32_16x16x32_bf16 v[20:23], v[52:55], v[124:127], v[20:23]
    s_waitcnt lgkmcnt(2)
    v_mfma_f32_16x16x32_bf16 v[24:27], v[56:59], v[124:127], v[24:27]
    s_waitcnt lgkmcnt(1)
    v_mfma_f32_16x16x32_bf16 v[28:31], v[60:63], v[124:127], v[28:31]
    s_waitcnt lgkmcnt(0)
    v_mfma_f32_16x16x32_bf16 v[32:35], v[64:67], v[124:127], v[32:35]
    v_lshrrev_b32 v9, 2, v0
    v_and_b32 v10, 3, v0
    v_mul_u32_u24 v12, 1280, v9
    v_lshl_add_u32 v12, v10, 3, v12
    v_lshl_add_u32 v9, v10, 4, v9
    v_lshlrev_b32 v9, 2, v9
    s_lshl_b32 s88, s72, 2
    s_add_u32 s88, s88, s60
    s_mul_i32 s88, s88, 20480
    s_add_u32 s88, s88, s30
    s_mul_i32 s89, s60, 5120
    s_add_u32 s89, s89, 40960
    v_add_u32 v13, s89, v1
    v_lshrrev_b32 v10, 4, v0
    v_lshlrev_b32 v14, 4, v10
    v_add_u32 v14, 156608, v14
    s_cmp_eq_u32 s85, 1
    s_cbranch_scc1 L_p5_b1
    ds_write_b128 v13, v[28:31] offset:3072
    ds_write_b128 v13, v[32:35] offset:4096
    ds_read_b128 v[44:47], v14 offset:0
    ds_read_b128 v[48:51], v14 offset:64
    ds_read_b128 v[52:55], v14 offset:128
    s_waitcnt lgkmcnt(0)
    v_fmac_f32 v84, v44, v16
    v_fmac_f32 v85, v45, v17
    v_fmac_f32 v86, v46, v18
    v_fmac_f32 v87, v47, v19
    v_fmac_f32 v88, v48, v20
    v_fmac_f32 v89, v49, v21
    v_fmac_f32 v90, v50, v22
    v_fmac_f32 v91, v51, v23
    v_fmac_f32 v92, v52, v24
    v_fmac_f32 v93, v53, v25
    v_fmac_f32 v94, v54, v26
    v_fmac_f32 v95, v55, v27
    s_barrier
    ds_read_b128 v[64:67], v13 offset:0
    ds_read_b128 v[68:71], v13 offset:1024
    ds_read_b128 v[72:75], v13 offset:2048
    s_waitcnt lgkmcnt(2)
    v_fmac_f32 v84, v44, v64
    v_fmac_f32 v85, v45, v65
    v_fmac_f32 v86, v46, v66
    v_fmac_f32 v87, v47, v67
    v_cvt_pk_bf16_f32 v64, v84, v85
    v_cvt_pk_bf16_f32 v65, v86, v87
    ds_bpermute_b32 v66, v9, v64
    ds_bpermute_b32 v67, v9, v65
    s_waitcnt lgkmcnt(3)
    v_fmac_f32 v88, v48, v68
    v_fmac_f32 v89, v49, v69
    v_fmac_f32 v90, v50, v70
    v_fmac_f32 v91, v51, v71
    v_cvt_pk_bf16_f32 v68, v88, v89
    v_cvt_pk_bf16_f32 v69, v90, v91
    ds_bpermute_b32 v70, v9, v68
    ds_bpermute_b32 v71, v9, v69
    s_waitcnt lgkmcnt(4)
    v_fmac_f32 v92, v52, v72
    v_fmac_f32 v93, v53, v73
    v_fmac_f32 v94, v54, v74
    v_fmac_f32 v95, v55, v75
    v_cvt_pk_bf16_f32 v72, v92, v93
    v_cvt_pk_bf16_f32 v73, v94, v95
    ds_bpermute_b32 v74, v9, v72
    ds_bpermute_b32 v75, v9, v73
    s_waitcnt lgkmcnt(4)
    buffer_store_dwordx2 v[66:67], v12, s[56:59], s88 offen offset:0
    s_waitcnt lgkmcnt(2)
    buffer_store_dwordx2 v[70:71], v12, s[56:59], s88 offen offset:32
    s_waitcnt lgkmcnt(0)
    buffer_store_dwordx2 v[74:75], v12, s[56:59], s88 offen offset:64
    s_branch L_p5_done
L_p5_b1:
    ds_write_b128 v13, v[16:19] offset:0
    ds_write_b128 v13, v[20:23] offset:1024
    ds_write_b128 v13, v[24:27] offset:2048
    ds_read_b128 v[44:47], v14 offset:192
    ds_read_b128 v[48:51], v14 offset:256
    s_waitcnt lgkmcnt(0)
    v_fmac_f32 v84, v44, v28
    v_fmac_f32 v85, v45, v29
    v_fmac_f32 v86, v46, v30
    v_fmac_f32 v87, v47, v31
    v_fmac_f32 v88, v48, v32
    v_fmac_f32 v89, v49, v33
    v_fmac_f32 v90, v50, v34
    v_fmac_f32 v91, v51, v35
    s_barrier
    ds_read_b128 v[64:67], v13 offset:3072
    ds_read_b128 v[68:71], v13 offset:4096
    s_waitcnt lgkmcnt(1)
    v_fmac_f32 v84, v44, v64
    v_fmac_f32 v85, v45, v65
    v_fmac_f32 v86, v46, v66
    v_fmac_f32 v87, v47, v67
    v_cvt_pk_bf16_f32 v64, v84, v85
    v_cvt_pk_bf16_f32 v65, v86, v87
    ds_bpermute_b32 v66, v9, v64
    ds_bpermute_b32 v67, v9, v65
    s_waitcnt lgkmcnt(2)
    v_fmac_f32 v88, v48, v68
    v_fmac_f32 v89, v49, v69
    v_fmac_f32 v90, v50, v70
    v_fmac_f32 v91, v51, v71
    v_cvt_pk_bf16_f32 v68, v88, v89
    v_cvt_pk_bf16_f32 v69, v90, v91
    ds_bpermute_b32 v70, v9, v68
    ds_bpermute_b32 v71, v9, v69
    s_waitcnt lgkmcnt(2)
    buffer_store_dwordx2 v[66:67], v12, s[56:59], s88 offen offset:96
    s_waitcnt lgkmcnt(0)
    buffer_store_dwordx2 v[70:71], v12, s[56:59], s88 offen offset:128
L_p5_done:
L_end:
    s_endpgm
L_fallback:
    s_waitcnt vmcnt(0) lgkmcnt(0)
    v_mov_b32 v38, 0xff800000
    s_mov_b32 s86, 65536
    v_subrev_u32 v8, 102400, v8
    v_subrev_u32 v9, 102400, v9
    v_subrev_u32 v10, 102400, v10
L_fb1:
    buffer_load_dwordx4 v[64:67], v8, s[32:35], s86 offen sc1
    buffer_load_dwordx2 v[68:69], v9, s[32:35], s86 offen sc1
    s_waitcnt vmcnt(0)
    v_mfma_f32_32x32x16_bf16 v[48:63], v[64:67], v[80:83], 0
    v_mfma_f32_32x32x8bf16_1k v[48:63], v[68:69], v[70:71], v[48:63]
    s_nop 11
    v_max3_f32 v38, v38, v48, v49
    v_max3_f32 v38, v38, v50, v51
    v_max3_f32 v38, v38, v52, v53
    v_max3_f32 v38, v38, v54, v55
    v_max3_f32 v38, v38, v56, v57
    v_max3_f32 v38, v38, v58, v59
    v_max3_f32 v38, v38, v60, v61
    v_max3_f32 v38, v38, v62, v63
    s_add_u32 s86, s86, 2752
    s_cmp_lt_u32 s86, 241664
    s_cbranch_scc1 L_fb1
    v_mov_b32 v39, v38
    s_nop 1
    v_permlane32_swap_b32 v38, v39
    v_max_f32 v38, v38, v39
    v_mov_b32 v84, v34
    v_mov_b32 v85, v35
    v_sub_f32 v47, 0, v38
    v_mov_b32 v32, v47
    v_mov_b32 v33, v47
    v_mov_b32 v34, v47
    v_mov_b32 v35, v47
    v_mov_b32 v36, v47
    v_mov_b32 v37, v47
    v_mov_b32 v38, v47
    v_mov_b32 v39, v47
    v_mov_b32 v40, v47
    v_mov_b32 v41, v47
    v_mov_b32 v42, v47
    v_mov_b32 v43, v47
    v_mov_b32 v44, v47
    v_mov_b32 v45, v47
    v_mov_b32 v46, v47
    v_mov_b32 v16, 0
    v_mov_b32 v17, 0
    v_mov_b32 v18, 0
    v_mov_b32 v19, 0
    v_mov_b32 v20, 0
    v_mov_b32 v21, 0
    v_mov_b32 v22, 0
    v_mov_b32 v23, 0
    v_mov_b32 v24, 0
    v_mov_b32 v25, 0
    v_mov_b32 v26, 0
    v_mov_b32 v27, 0
    v_mov_b32 v28, 0
    v_mov_b32 v29, 0
    v_mov_b32 v30, 0
    v_mov_b32 v31, 0
    s_mov_b32 s86, 65536
L_fb2:
    buffer_load_dwordx4 v[64:67], v8, s[32:35], s86 offen sc1
    buffer_load_dwordx2 v[68:69], v9, s[32:35], s86 offen sc1
    buffer_load_dwordx4 v[72:75], v10, s[32:35], s86 offen sc1
    buffer_load_dwordx4 v[76:79], v10, s[32:35], s86 offen offset:736 sc1
    s_waitcnt vmcnt(0)
    v_mfma_f32_32x32x16_bf16 v[48:63], v[64:67], v[80:83], v[32:47]
    v_mfma_f32_32x32x8bf16_1k v[48:63], v[68:69], v[70:71], v[48:63]
    s_nop 11
    v_exp_f32 v48, v48
    v_exp_f32 v49, v49
    v_exp_f32 v50, v50
    v_exp_f32 v51, v51
    v_exp_f32 v52, v52
    v_exp_f32 v53, v53
    v_exp_f32 v54, v54
    v_exp_f32 v55, v55
    v_exp_f32 v56, v56
    v_exp_f32 v57, v57
    v_exp_f32 v58, v58
    v_exp_f32 v59, v59
    v_exp_f32 v60, v60
    v_exp_f32 v61, v61
    v_exp_f32 v62, v62
    v_exp_f32 v63, v63
    v_cvt_pk_bf16_f32 v48, v48, v49
    v_cvt_pk_bf16_f32 v49, v50, v51
    v_cvt_pk_bf16_f32 v50, v52, v53
    v_cvt_pk_bf16_f32 v51, v54, v55
    v_cvt_pk_bf16_f32 v56, v56, v57
    v_cvt_pk_bf16_f32 v57, v58, v59
    v_cvt_pk_bf16_f32 v58, v60, v61
    v_cvt_pk_bf16_f32 v59, v62, v63
    v_mfma_f32_32x32x16_bf16 v[16:31], v[72:75], v[48:51], v[16:31]
    s_nop 0
    v_mfma_f32_32x32x16_bf16 v[16:31], v[76:79], v[56:59], v[16:31]
    s_add_u32 s86, s86, 2752
    s_cmp_lt_u32 s86, 241664
    s_nop 7
    s_cbranch_scc1 L_fb2
    v_mov_b32 v34, v84
    v_mov_b32 v35, v85
    s_nop 7
    v_cmp_gt_u32 vcc, 32, v0
    s_nop 1
    v_cndmask_b32 v28, v24, v28, vcc
    v_rcp_f32 v36, v28
    s_nop 0
    s_branch L_att_norm
L_far_44:
    buffer_store_dwordx4 v[92:95], v1, s[32:35], s87 offen offset:0 sc1
    buffer_store_dwordx4 v[92:95], v1, s[32:35], s87 offen offset:1024 sc1
    buffer_store_dwordx4 v[92:95], v1, s[32:35], s87 offen offset:2048 sc1
    s_branch L_pub_45
L_far_47:
    buffer_store_dwordx4 v[92:95], v1, s[32:35], s87 offen offset:0 sc1
    buffer_store_dwordx4 v[92:95], v1, s[32:35], s87 offen offset:1024 sc1
    buffer_store_dwordx4 v[92:95], v1, s[32:35], s87 offen offset:2048 sc1
    s_branch L_pub_48
L_far_74:
    buffer_store_dwordx4 v[92:95], v1, s[32:35], s87 offen offset:0 sc1
    buffer_store_dwordx4 v[92:95], v1, s[32:35], s87 offen offset:1024 sc1
    buffer_store_dwordx4 v[92:95], v1, s[32:35], s87 offen offset:2048 sc1
    s_branch L_pub_75
L_far_77:
    buffer_store_dwordx4 v[92:95], v1, s[32:35], s87 offen offset:0 sc1
    buffer_store_dwordx4 v[92:95], v1, s[32:35], s87 offen offset:1024 sc1
    buffer_store_dwordx4 v[92:95], v1, s[32:35], s87 offen offset:2048 sc1
    s_branch L_pub_78
L_far_99:
    buffer_store_dwordx2 v[16:17], v35, s[32:35], s87 offen sc1
    buffer_store_dwordx2 v[18:19], v35, s[32:35], s87 offen offset:256 sc1
    buffer_store_dwordx2 v[20:21], v34, s[32:35], s87 offen sc1
    s_branch L_pub_100
L_bretry_102:
    s_add_u32 s88, s87, 0
    buffer_load_dwordx4 v[36:39], v1, s[32:35], s88 offen offset:0 sc1
    s_add_u32 s88, s87, 0
    buffer_load_dwordx4 v[40:43], v1, s[32:35], s88 offen offset:1024 sc1
    s_waitcnt vmcnt(0)
    v_max_u32 v10, v37, v39
    v_max3_u32 v10, v10, v41, v43
    v_cmp_eq_u32 vcc, -1, v10
    s_cbranch_vccz L_spinout_179
    s_sub_u32 s77, s77, 1
    s_cbranch_scc1 L_spinout_179_x
    s_branch L_bretry_102
L_spinout_179_x:
    s_mov_b32 s77, 0
L_spinout_179:
    s_add_u32 s88, s87, 0
    buffer_load_dwordx4 v[44:47], v1, s[32:35], s88 offen offset:2048 sc1
    s_add_u32 s88, s87, 0
    buffer_load_dwordx4 v[48:51], v1, s[32:35], s88 offen offset:3072 sc1
    s_add_u32 s88, s87, 4096
    buffer_load_dwordx4 v[52:55], v1, s[32:35], s88 offen offset:0 sc1
    s_add_u32 s88, s87, 4096
    buffer_load_dwordx4 v[56:59], v1, s[32:35], s88 offen offset:1024 sc1
    s_branch L_bok_101
L_bretry_104:
    s_add_u32 s88, s87, 0
    buffer_load_dwordx4 v[44:47], v1, s[32:35], s88 offen offset:2048 sc1
    s_add_u32 s88, s87, 0
    buffer_load_dwordx4 v[48:51], v1, s[32:35], s88 offen offset:3072 sc1
    s_waitcnt vmcnt(0)
    v_max_u32 v10, v45, v47
    v_max3_u32 v10, v10, v49, v51
    v_cmp_eq_u32 vcc, -1, v10
    s_cbranch_vccz L_spinout_180
    s_sub_u32 s77, s77, 1
    s_cbranch_scc1 L_spinout_180_x
    s_branch L_bretry_104
L_spinout_180_x:
    s_mov_b32 s77, 0
L_spinout_180:
    s_add_u32 s88, s87, 4096
    buffer_load_dwordx4 v[52:55], v1, s[32:35], s88 offen offset:0 sc1
    s_add_u32 s88, s87, 4096
    buffer_load_dwordx4 v[56:59], v1, s[32:35], s88 offen offset:1024 sc1
    s_add_u32 s88, s87, 4096
    buffer_load_dwordx4 v[60:63], v1, s[32:35], s88 offen offset:2048 sc1
    s_add_u32 s88, s87, 4096
    buffer_load_dwordx4 v[64:67], v1, s[32:35], s88 offen offset:3072 sc1
    s_branch L_bok_103
L_bretry_106:
    s_add_u32 s88, s87, 4096
    buffer_load_dwordx4 v[52:55], v1, s[32:35], s88 offen offset:0 sc1
    s_add_u32 s88, s87, 4096
    buffer_load_dwordx4 v[56:59], v1, s[32:35], s88 offen offset:1024 sc1
    s_waitcnt vmcnt(0)
    v_max_u32 v10, v53, v55
    v_max3_u32 v10, v10, v57, v59
    v_cmp_eq_u32 vcc, -1, v10
    s_cbranch_vccz L_spinout_181
    s_sub_u32 s77, s77, 1
    s_cbranch_scc1 L_spinout_181_x
    s_branch L_bretry_106
L_spinout_181_x:
    s_mov_b32 s77, 0
L_spinout_181:
    s_add_u32 s88, s87, 4096
    buffer_load_dwordx4 v[60:63], v1, s[32:35], s88 offen offset:2048 sc1
    s_add_u32 s88, s87, 4096
    buffer_load_dwordx4 v[64:67], v1, s[32:35], s88 offen offset:3072 sc1
    s_add_u32 s88, s87, 8192
    buffer_load_dwordx4 v[68:71], v1, s[32:35], s88 offen offset:0 sc1
    s_add_u32 s88, s87, 8192
    buffer_load_dwordx4 v[72:75], v1, s[32:35], s88 offen offset:1024 sc1
    s_branch L_bok_105
L_bretry_108:
    s_add_u32 s88, s87, 4096
    buffer_load_dwordx4 v[60:63], v1, s[32:35], s88 offen offset:2048 sc1
    s_add_u32 s88, s87, 4096
    buffer_load_dwordx4 v[64:67], v1, s[32:35], s88 offen offset:3072 sc1
    s_waitcnt vmcnt(0)
    v_max_u32 v10, v61, v63
    v_max3_u32 v10, v10, v65, v67
    v_cmp_eq_u32 vcc, -1, v10
    s_cbranch_vccz L_spinout_182
    s_sub_u32 s77, s77, 1
    s_cbranch_scc1 L_spinout_182_x
    s_branch L_bretry_108
L_spinout_182_x:
    s_mov_b32 s77, 0
L_spinout_182:
    s_add_u32 s88, s87, 8192
    buffer_load_dwordx4 v[68:71], v1, s[32:35], s88 offen offset:0 sc1
    s_add_u32 s88, s87, 8192
    buffer_load_dwordx4 v[72:75], v1, s[32:35], s88 offen offset:1024 sc1
    s_branch L_bok_107
L_bretry_110:
    s_add_u32 s88, s87, 8192
    buffer_load_dwordx4 v[68:71], v1, s[32:35], s88 offen offset:0 sc1
    s_add_u32 s88, s87, 8192
    buffer_load_dwordx4 v[72:75], v1, s[32:35], s88 offen offset:1024 sc1
    s_waitcnt vmcnt(0)
    v_max_u32 v10, v69, v71
    v_max3_u32 v10, v10, v73, v75
    v_cmp_eq_u32 vcc, -1, v10
    s_cbranch_vccz L_spinout_183
    s_sub_u32 s77, s77, 1
    s_cbranch_scc1 L_spinout_183_x
    s_branch L_bretry_110
L_spinout_183_x:
    s_mov_b32 s77, 0
L_spinout_183:
    s_branch L_bok_109
L_far_111:
    buffer_store_dwordx2 v[64:65], v8, s[32:35], s86 offen offset:0 sc1
    buffer_store_dwordx2 v[68:69], v8, s[32:35], s86 offen offset:512 sc1
    buffer_store_dwordx2 v[72:73], v8, s[32:35], s86 offen offset:1024 sc1
    s_branch L_pub_112
L_far_113:
    buffer_store_dwordx2 v[36:37], v9, s[32:35], s87 offen sc1
    s_branch L_pub_114
L_far_115:
    buffer_store_dwordx2 v[64:65], v8, s[32:35], s86 offen offset:1536 sc1
    buffer_store_dwordx2 v[68:69], v8, s[32:35], s86 offen offset:2048 sc1
    s_branch L_pub_116
L_far_117:
    buffer_store_dwordx2 v[36:37], v9, s[32:35], s87 offen sc1
    s_branch L_pub_118
L_xaretry:
    s_add_u32 m0, s87, 0
    s_add_u32 s89, s88, 0
    buffer_load_dwordx4 v1, s[32:35], s89 offen offset:0 sc1 lds
    buffer_load_dwordx4 v1, s[32:35], s89 offen offset:1024 sc1 lds
    buffer_load_dwordx4 v1, s[32:35], s89 offen offset:2048 sc1 lds
    buffer_load_dwordx4 v1, s[32:35], s89 offen offset:3072 sc1 lds
    s_add_u32 m0, s87, 4096
    s_add_u32 s89, s88, 4096
    buffer_load_dwordx4 v1, s[32:35], s89 offen offset:0 sc1 lds
    buffer_load_dwordx4 v1, s[32:35], s89 offen offset:1024 sc1 lds
    buffer_load_dwordx4 v1, s[32:35], s89 offen offset:2048 sc1 lds
    buffer_load_dwordx4 v1, s[32:35], s89 offen offset:3072 sc1 lds
    s_add_u32 m0, s87, 8192
    s_add_u32 s89, s88, 8192
    buffer_load_dwordx4 v1, s[32:35], s89 offen offset:0 sc1 lds
    buffer_load_dwordx4 v1, s[32:35], s89 offen offset:1024 sc1 lds
    s_waitcnt vmcnt(0)
    ds_read_b128 v[48:51], v10 offset:0
    ds_read_b128 v[52:55], v10 offset:1024
    ds_read_b128 v[56:59], v10 offset:2048
    ds_read_b128 v[60:63], v10 offset:3072
    ds_read_b128 v[64:67], v10 offset:4096
    s_waitcnt lgkmcnt(0)
    v_max_u32 v11, v49, v51
    v_max3_u32 v11, v11, v53, v55
    v_max3_u32 v11, v11, v57, v59
    v_max3_u32 v11, v11, v61, v63
    v_max3_u32 v11, v11, v65, v67
    ds_read_b128 v[48:51], v10 offset:5120
    ds_read_b128 v[52:55], v10 offset:6144
    ds_read_b128 v[56:59], v10 offset:7168
    ds_read_b128 v[60:63], v10 offset:8192
    ds_read_b128 v[64:67], v10 offset:9216
    s_waitcnt lgkmcnt(0)
    v_max3_u32 v11, v11, v49, v51
    v_max3_u32 v11, v11, v53, v55
    v_max3_u32 v11, v11, v57, v59
    v_max3_u32 v11, v11, v61, v63
    v_max3_u32 v11, v11, v65, v67
    v_cmp_eq_u32 vcc, -1, v11
    s_cbranch_vccz L_spinout_184
    s_sub_u32 s77, s77, 1
    s_cbranch_scc1 L_spinout_184_x
    s_branch L_xaretry
L_spinout_184_x:
    s_mov_b32 s77, 0
L_spinout_184:
    s_branch L_xaok
L_far_123:
    buffer_store_dwordx2 v[72:73], v80, s[32:35], s86 offen sc1
    s_branch L_pub_124
L_far_125:
    buffer_store_dwordx2 v[76:77], v80, s[32:35], s86 offen sc1
    s_branch L_pub_126
L_far_127:
    buffer_store_dwordx2 v[72:73], v80, s[32:35], s86 offen sc1
    s_branch L_pub_128
L_far_129:
    buffer_store_dwordx2 v[76:77], v80, s[32:35], s86 offen sc1
    s_branch L_pub_130
L_far_132:
    buffer_store_dwordx2 v[72:73], v80, s[32:35], s86 offen sc1
    s_branch L_pub_133
L_far_134:
    buffer_store_dwordx2 v[72:73], v80, s[32:35], s86 offen sc1
    s_branch L_pub_135
L_far_138:
    buffer_store_dwordx2 v[72:73], v80, s[32:35], s86 offen sc1
    s_branch L_pub_139
L_far_141:
    buffer_store_dwordx2 v[72:73], v80, s[32:35], s86 offen sc1
    s_branch L_pub_142
L_far_144:
    buffer_store_dwordx2 v[72:73], v80, s[32:35], s86 offen sc1
    s_branch L_pub_145
L_far_146:
    buffer_store_dwordx2 v[76:77], v80, s[32:35], s86 offen sc1
    s_branch L_pub_147
L_far_148:
    buffer_store_dwordx2 v[72:73], v80, s[32:35], s86 offen sc1
    s_branch L_pub_149
L_far_150:
    buffer_store_dwordx2 v[76:77], v80, s[32:35], s86 offen sc1
    s_branch L_pub_151
L_bretry_153:
    s_add_u32 s87, s86, 0
    buffer_load_dwordx4 v[96:99], v1, s[32:35], s87 offen offset:0 sc1
    s_add_u32 s87, s86, 0
    buffer_load_dwordx4 v[100:103], v1, s[32:35], s87 offen offset:1024 sc1
    s_waitcnt vmcnt(0)
    v_max_u32 v13, v97, v99
    v_max3_u32 v13, v13, v101, v103
    v_cmp_eq_u32 vcc, -1, v13
    s_cbranch_vccz L_spinout_185
    s_sub_u32 s77, s77, 1
    s_cbranch_scc1 L_spinout_185_x
    s_branch L_bretry_153
L_spinout_185_x:
    s_mov_b32 s77, 0
L_spinout_185:
    s_add_u32 s87, s86, 0
    buffer_load_dwordx4 v[104:107], v1, s[32:35], s87 offen offset:2048 sc1
    s_add_u32 s87, s86, 0
    buffer_load_dwordx4 v[108:111], v1, s[32:35], s87 offen offset:3072 sc1
    s_add_u32 s87, s86, 4096
    buffer_load_dwordx4 v[112:115], v1, s[32:35], s87 offen offset:0 sc1
    s_add_u32 s87, s86, 4096
    buffer_load_dwordx4 v[116:119], v1, s[32:35], s87 offen offset:1024 sc1
    s_branch L_bok_152
L_bretry_155:
    s_add_u32 s87, s86, 0
    buffer_load_dwordx4 v[104:107], v1, s[32:35], s87 offen offset:2048 sc1
    s_add_u32 s87, s86, 0
    buffer_load_dwordx4 v[108:111], v1, s[32:35], s87 offen offset:3072 sc1
    s_waitcnt vmcnt(0)
    v_max_u32 v13, v105, v107
    v_max3_u32 v13, v13, v109, v111
    v_cmp_eq_u32 vcc, -1, v13
    s_cbranch_vccz L_spinout_186
    s_sub_u32 s77, s77, 1
    s_cbranch_scc1 L_spinout_186_x
    s_branch L_bretry_155
L_spinout_186_x:
    s_mov_b32 s77, 0
L_spinout_186:
    s_add_u32 s87, s86, 4096
    buffer_load_dwordx4 v[112:115], v1, s[32:35], s87 offen offset:0 sc1
    s_add_u32 s87, s86, 4096
    buffer_load_dwordx4 v[116:119], v1, s[32:35], s87 offen offset:1024 sc1
    s_add_u32 s87, s86, 4096
    buffer_load_dwordx4 v[120:123], v1, s[32:35], s87 offen offset:2048 sc1
    s_add_u32 s87, s86, 4096
    buffer_load_dwordx4 v[124:127], v1, s[32:35], s87 offen offset:3072 sc1
    s_branch L_bok_154
L_bretry_157:
    s_add_u32 s87, s86, 4096
    buffer_load_dwordx4 v[112:115], v1, s[32:35], s87 offen offset:0 sc1
    s_add_u32 s87, s86, 4096
    buffer_load_dwordx4 v[116:119], v1, s[32:35], s87 offen offset:1024 sc1
    s_waitcnt vmcnt(0)
    v_max_u32 v13, v113, v115
    v_max3_u32 v13, v13, v117, v119
    v_cmp_eq_u32 vcc, -1, v13
    s_cbranch_vccz L_spinout_187
    s_sub_u32 s77, s77, 1
    s_cbranch_scc1 L_spinout_187_x
    s_branch L_bretry_157
L_spinout_187_x:
    s_mov_b32 s77, 0
L_spinout_187:
    s_add_u32 s87, s86, 4096
    buffer_load_dwordx4 v[120:123], v1, s[32:35], s87 offen offset:2048 sc1
    s_add_u32 s87, s86, 4096
    buffer_load_dwordx4 v[124:127], v1, s[32:35], s87 offen offset:3072 sc1
    s_add_u32 s87, s86, 8192
    buffer_load_dwordx4 v[128:131], v1, s[32:35], s87 offen offset:0 sc1
    s_add_u32 s87, s86, 8192
    buffer_load_dwordx4 v[132:135], v1, s[32:35], s87 offen offset:1024 sc1
    s_waitcnt vmcnt(0)
    s_branch L_bok_156
L_bretry_160:
    s_add_u32 s87, s86, 4096
    buffer_load_dwordx4 v[120:123], v1, s[32:35], s87 offen offset:2048 sc1
    s_add_u32 s87, s86, 4096
    buffer_load_dwordx4 v[124:127], v1, s[32:35], s87 offen offset:3072 sc1
    s_waitcnt vmcnt(0)
    v_max_u32 v13, v121, v123
    v_max3_u32 v13, v13, v125, v127
    v_cmp_eq_u32 vcc, -1, v13
    s_cbranch_vccz L_spinout_188
    s_sub_u32 s77, s77, 1
    s_cbranch_scc1 L_spinout_188_x
    s_branch L_bretry_160
L_spinout_188_x:
    s_mov_b32 s77, 0
L_spinout_188:
    s_add_u32 s87, s86, 8192
    buffer_load_dwordx4 v[128:131], v1, s[32:35], s87 offen offset:0 sc1
    s_add_u32 s87, s86, 8192
    buffer_load_dwordx4 v[132:135], v1, s[32:35], s87 offen offset:1024 sc1
    s_add_u32 s87, s86, 8192
    buffer_load_dwordx4 v[136:139], v1, s[32:35], s87 offen offset:2048 sc1
    s_add_u32 s87, s86, 8192
    buffer_load_dwordx4 v[140:143], v1, s[32:35], s87 offen offset:3072 sc1
    s_waitcnt vmcnt(0)
    s_branch L_bok_159
L_bretry_162:
    s_add_u32 s87, s86, 8192
    buffer_load_dwordx4 v[128:131], v1, s[32:35], s87 offen offset:0 sc1
    s_add_u32 s87, s86, 8192
    buffer_load_dwordx4 v[132:135], v1, s[32:35], s87 offen offset:1024 sc1
    s_waitcnt vmcnt(0)
    v_max_u32 v13, v129, v131
    v_max3_u32 v13, v13, v133, v135
    v_cmp_eq_u32 vcc, -1, v13
    s_cbranch_vccz L_spinout_189
    s_sub_u32 s77, s77, 1
    s_cbranch_scc1 L_spinout_189_x
    s_branch L_bretry_162
L_spinout_189_x:
    s_mov_b32 s77, 0
L_spinout_189:
    s_add_u32 s87, s86, 8192
    buffer_load_dwordx4 v[136:139], v1, s[32:35], s87 offen offset:2048 sc1
    s_add_u32 s87, s86, 8192
    buffer_load_dwordx4 v[140:143], v1, s[32:35], s87 offen offset:3072 sc1
    s_add_u32 s87, s86, 12288
    buffer_load_dwordx4 v[144:147], v1, s[32:35], s87 offen offset:0 sc1
    s_add_u32 s87, s86, 12288
    buffer_load_dwordx4 v[148:151], v1, s[32:35], s87 offen offset:1024 sc1
    s_waitcnt vmcnt(0)
    s_branch L_bok_161
L_bretry_164:
    s_add_u32 s87, s86, 8192
    buffer_load_dwordx4 v[136:139], v1, s[32:35], s87 offen offset:2048 sc1
    s_add_u32 s87, s86, 8192
    buffer_load_dwordx4 v[140:143], v1, s[32:35], s87 offen offset:3072 sc1
    s_waitcnt vmcnt(0)
    v_max_u32 v13, v137, v139
    v_max3_u32 v13, v13, v141, v143
    v_cmp_eq_u32 vcc, -1, v13
    s_cbranch_vccz L_spinout_190
    s_sub_u32 s77, s77, 1
    s_cbranch_scc1 L_spinout_190_x
    s_branch L_bretry_164
L_spinout_190_x:
    s_mov_b32 s77, 0
L_spinout_190:
    s_add_u32 s87, s86, 12288
    buffer_load_dwordx4 v[144:147], v1, s[32:35], s87 offen offset:0 sc1
    s_add_u32 s87, s86, 12288
    buffer_load_dwordx4 v[148:151], v1, s[32:35], s87 offen offset:1024 sc1
    s_add_u32 s87, s86, 12288
    buffer_load_dwordx4 v[152:155], v1, s[32:35], s87 offen offset:2048 sc1
    s_add_u32 s87, s86, 12288
    buffer_load_dwordx4 v[156:159], v1, s[32:35], s87 offen offset:3072 sc1
    s_waitcnt vmcnt(0)
    s_branch L_bok_163
L_bretry_168:
    s_add_u32 s87, s86, 12288
    buffer_load_dwordx4 v[144:147], v1, s[32:35], s87 offen offset:0 sc1
    s_add_u32 s87, s86, 12288
    buffer_load_dwordx4 v[148:151], v1, s[32:35], s87 offen offset:1024 sc1
    s_waitcnt vmcnt(0)
    v_max_u32 v13, v145, v147
    v_max3_u32 v13, v13, v149, v151
    v_cmp_eq_u32 vcc, -1, v13
    s_cbranch_vccz L_spinout_191
    s_sub_u32 s77, s77, 1
    s_cbranch_scc1 L_spinout_191_x
    s_branch L_bretry_168
L_spinout_191_x:
    s_mov_b32 s77, 0
L_spinout_191:
    s_add_u32 s87, s86, 12288
    buffer_load_dwordx4 v[152:155], v1, s[32:35], s87 offen offset:2048 sc1
    s_add_u32 s87, s86, 12288
    buffer_load_dwordx4 v[156:159], v1, s[32:35], s87 offen offset:3072 sc1
    s_add_u32 s87, s86, 16384
    buffer_load_dwordx4 v[96:99], v1, s[32:35], s87 offen offset:0 sc1
    s_add_u32 s87, s86, 16384
    buffer_load_dwordx4 v[100:103], v1, s[32:35], s87 offen offset:1024 sc1
    s_waitcnt vmcnt(0)
    s_branch L_bok_167
L_bretry_170:
    s_add_u32 s87, s86, 12288
    buffer_load_dwordx4 v[152:155], v1, s[32:35], s87 offen offset:2048 sc1
    s_add_u32 s87, s86, 12288
    buffer_load_dwordx4 v[156:159], v1, s[32:35], s87 offen offset:3072 sc1
    s_waitcnt vmcnt(0)
    v_max_u32 v13, v153, v155
    v_max3_u32 v13, v13, v157, v159
    v_cmp_eq_u32 vcc, -1, v13
    s_cbranch_vccz L_spinout_192
    s_sub_u32 s77, s77, 1
    s_cbranch_scc1 L_spinout_192_x
    s_branch L_bretry_170
L_spinout_192_x:
    s_mov_b32 s77, 0
L_spinout_192:
    s_add_u32 s87, s86, 16384
    buffer_load_dwordx4 v[96:99], v1, s[32:35], s87 offen offset:0 sc1
    s_add_u32 s87, s86, 16384
    buffer_load_dwordx4 v[100:103], v1, s[32:35], s87 offen offset:1024 sc1
    s_add_u32 s87, s86, 16384
    buffer_load_dwordx4 v[104:107], v1, s[32:35], s87 offen offset:2048 sc1
    s_add_u32 s87, s86, 16384
    buffer_load_dwordx4 v[108:111], v1, s[32:35], s87 offen offset:3072 sc1
    s_waitcnt vmcnt(0)
    s_branch L_bok_169
L_bretry_172:
    s_add_u32 s87, s86, 16384
    buffer_load_dwordx4 v[96:99], v1, s[32:35], s87 offen offset:0 sc1
    s_add_u32 s87, s86, 16384
    buffer_load_dwordx4 v[100:103], v1, s[32:35], s87 offen offset:1024 sc1
    s_waitcnt vmcnt(0)
    v_max_u32 v13, v97, v99
    v_max3_u32 v13, v13, v101, v103
    v_cmp_eq_u32 vcc, -1, v13
    s_cbranch_vccz L_spinout_193
    s_sub_u32 s77, s77, 1
    s_cbranch_scc1 L_spinout_193_x
    s_branch L_bretry_172
L_spinout_193_x:
    s_mov_b32 s77, 0
L_spinout_193:
    s_add_u32 s87, s86, 16384
    buffer_load_dwordx4 v[104:107], v1, s[32:35], s87 offen offset:2048 sc1
    s_add_u32 s87, s86, 16384
    buffer_load_dwordx4 v[108:111], v1, s[32:35], s87 offen offset:3072 sc1
    s_add_u32 s87, s86, 20480
    buffer_load_dwordx4 v[112:115], v1, s[32:35], s87 offen offset:0 sc1
    s_add_u32 s87, s86, 20480
    buffer_load_dwordx4 v[116:119], v1, s[32:35], s87 offen offset:1024 sc1
    s_waitcnt vmcnt(0)
    s_branch L_bok_171
L_bretry_174:
    s_add_u32 s87, s86, 16384
    buffer_load_dwordx4 v[104:107], v1, s[32:35], s87 offen offset:2048 sc1
    s_add_u32 s87, s86, 16384
    buffer_load_dwordx4 v[108:111], v1, s[32:35], s87 offen offset:3072 sc1
    s_waitcnt vmcnt(0)
    v_max_u32 v13, v105, v107
    v_max3_u32 v13, v13, v109, v111
    v_cmp_eq_u32 vcc, -1, v13
    s_cbranch_vccz L_spinout_194
    s_sub_u32 s77, s77, 1
    s_cbranch_scc1 L_spinout_194_x
    s_branch L_bretry_174
L_spinout_194_x:
    s_mov_b32 s77, 0
L_spinout_194:
    s_add_u32 s87, s86, 20480
    buffer_load_dwordx4 v[112:115], v1, s[32:35], s87 offen offset:0 sc1
    s_add_u32 s87, s86, 20480
    buffer_load_dwordx4 v[116:119], v1, s[32:35], s87 offen offset:1024 sc1
    s_add_u32 s87, s86, 20480
    buffer_load_dwordx4 v[120:123], v1, s[32:35], s87 offen offset:2048 sc1
    s_add_u32 s87, s86, 20480
    buffer_load_dwordx4 v[124:127], v1, s[32:35], s87 offen offset:3072 sc1
    s_waitcnt vmcnt(0)
    s_branch L_bok_173
L_bretry_176:
    s_add_u32 s87, s86, 20480
    buffer_load_dwordx4 v[112:115], v1, s[32:35], s87 offen offset:0 sc1
    s_add_u32 s87, s86, 20480
    buffer_load_dwordx4 v[116:119], v1, s[32:35], s87 offen offset:1024 sc1
    s_waitcnt vmcnt(0)
    v_max_u32 v13, v113, v115
    v_max3_u32 v13, v13, v117, v119
    v_cmp_eq_u32 vcc, -1, v13
    s_cbranch_vccz L_spinout_195
    s_sub_u32 s77, s77, 1
    s_cbranch_scc1 L_spinout_195_x
    s_branch L_bretry_176
L_spinout_195_x:
    s_mov_b32 s77, 0
L_spinout_195:
    s_add_u32 s87, s86, 20480
    buffer_load_dwordx4 v[120:123], v1, s[32:35], s87 offen offset:2048 sc1
    s_add_u32 s87, s86, 20480
    buffer_load_dwordx4 v[124:127], v1, s[32:35], s87 offen offset:3072 sc1
    s_waitcnt vmcnt(0)
    s_branch L_bok_175
L_bretry_178:
    s_add_u32 s87, s86, 20480
    buffer_load_dwordx4 v[120:123], v1, s[32:35], s87 offen offset:2048 sc1
    s_add_u32 s87, s86, 20480
    buffer_load_dwordx4 v[124:127], v1, s[32:35], s87 offen offset:3072 sc1
    s_waitcnt vmcnt(0)
    v_max_u32 v13, v121, v123
    v_max3_u32 v13, v13, v125, v127
    v_cmp_eq_u32 vcc, -1, v13
    s_cbranch_vccz L_spinout_196
    s_sub_u32 s77, s77, 1
    s_cbranch_scc1 L_spinout_196_x
    s_branch L_bretry_178
L_spinout_196_x:
    s_mov_b32 s77, 0
L_spinout_196:
    s_waitcnt vmcnt(0)
    s_branch L_bok_177
.section .rodata,"a"
.p2align 6
.amdhsa_kernel adaLN_cond__grouped_kv_mqa__dense_activation_silu__prompt_kernel
  .amdhsa_next_free_vgpr 256
  .amdhsa_next_free_sgpr 102
  .amdhsa_accum_offset 256
  .amdhsa_group_segment_fixed_size 0
  .amdhsa_kernarg_size 104
  .amdhsa_user_sgpr_count 2
  .amdhsa_user_sgpr_kernarg_segment_ptr 1
  .amdhsa_system_sgpr_workgroup_id_x 1
.end_amdhsa_kernel
```
